```python
import torch

def _softmax(x, axis=-1):
    return torch.softmax(x, dim=axis)
def _gelu(x):
    return torch.nn.functional.gelu(x, approximate="tanh")
def _silu(x):
    return torch.nn.functional.silu(x)
def _sigmoid(x):
    return torch.sigmoid(x)
def _layernorm(x, axis=-1, eps=1e-5):
    m = x.mean(dim=axis, keepdim=True)
    v = x.var(dim=axis, keepdim=True, unbiased=False)
    return (x - m) / torch.sqrt(v + eps)
def _scatter_add(tgt, idx, src, axis=0):
    return tgt.clone().index_add_(axis, idx, src)
def _segment_sum(src, seg, n):
    out = torch.zeros((n,) + src.shape[1:], dtype=src.dtype)
    return out.index_add_(0, seg, src)
def _pad(x, pw):
    flat = tuple(v for pair in reversed(pw) for v in pair)
    return torch.nn.functional.pad(x, flat)

kernel_name = 'parallel_sum__compressed_kv_cla__swiglu_ffn__prompt'

def setup_inputs():

    _w = (lambda a: (lambda t: t.to(torch.bfloat16) if t.is_floating_point() else t)(torch.as_tensor(a)))
    def _A_setup():
        B, H, Sq, Sk, D, M = 1, 32, 2048, 2048, 128, 512
        Dc = 4 * D
        return {
            "x": _w((lambda *s: torch.randn(*s, dtype=torch.bfloat16) * 0.05)(B, Sq, M)),
            "c_kv": _w((lambda *s: torch.randn(*s, dtype=torch.bfloat16) * 1.6)(B, Sk, Dc)),
            "w_q": _w((lambda *s: torch.randn(*s, dtype=torch.bfloat16) * 0.8)(M, H, D) * (M ** -0.5)),
            "w_uk": _w((lambda *s: torch.randn(*s, dtype=torch.bfloat16) * 0.8)(Dc, H, D) * (Dc ** -0.5)),
            "w_uv": _w((lambda *s: torch.randn(*s, dtype=torch.bfloat16) * 1.6)(Dc, H, D) * (Dc ** -0.5)),
            "w_o": _w((lambda *s: torch.randn(*s, dtype=torch.bfloat16) * 1.6)(H, D, M) * ((H * D) ** -0.5)),
        }
    _A_in = _A_setup()

    def _B_setup():
        B, S, D, F = 1, 2048, 512, 1792
        return {
            "x": _w((lambda *s: torch.randn(*s, dtype=torch.bfloat16) * 0.05)(B, S, D)),
            "w_gate": _w((lambda *s: torch.randn(*s, dtype=torch.bfloat16) * 0.05)(D, F)),
            "w_up": _w((lambda *s: torch.randn(*s, dtype=torch.bfloat16) * 0.05)(D, F)),
            "w_down": _w((lambda *s: torch.randn(*s, dtype=torch.bfloat16) * 0.05)(F, D)),
        }
    _B_in = _B_setup()

    return {
        "A_x": _A_in["x"],
        "A_c_kv": _A_in["c_kv"],
        "A_w_q": _A_in["w_q"],
        "A_w_uk": _A_in["w_uk"],
        "A_w_uv": _A_in["w_uv"],
        "A_w_o": _A_in["w_o"],
        "B_x": _B_in["x"],
        "B_w_gate": _B_in["w_gate"],
        "B_w_up": _B_in["w_up"],
        "B_w_down": _B_in["w_down"],
    }

def reference(A_x, A_c_kv, A_w_q, A_w_uk, A_w_uv, A_w_o, B_x, B_w_gate, B_w_up, B_w_down):
    def _A_ref(x, c_kv, w_q, w_uk, w_uv, w_o):
        B, Sq, M = x.shape[0], x.shape[1], x.shape[2]
        Sk = c_kv.shape[1]
        H, D = w_q.shape[1], w_q.shape[2]
        q = torch.einsum("bqm,mhd->bhqd", x, w_q)
        k = torch.einsum("bkc,chd->bhkd", c_kv, w_uk)
        v = torch.einsum("bkc,chd->bhkd", c_kv, w_uv)
        scores = torch.einsum("bhqd,bhkd->bhqk", q, k) * (D ** -0.5)
        off = Sk - Sq
        qi = torch.arange(Sq)[:, None]
        kj = torch.arange(Sk)[None, :]
        cmask = kj <= (qi + off)
        scores = torch.where(cmask[None, None], scores, -1e9)
        p = _softmax(scores, axis=-1)
        ctx = torch.einsum("bhqk,bhkd->bhqd", p, v)
        return torch.einsum("bhqd,hdm->bqm", ctx, w_o)

    def _B_ref(x, w_gate, w_up, w_down):
        g = _silu(x @ w_gate)
        u = x @ w_up
        return (g * u) @ w_down

    x = A_x
    xn = _layernorm(x, axis=-1)
    return x + _A_ref(xn, A_c_kv, A_w_q, A_w_uk, A_w_uv, A_w_o) + _B_ref(xn, B_w_gate, B_w_up, B_w_down)
```

```asm
; @launch grid=(256,1,1) block=(512,1,1) lds=163840
.amdgcn_target "amdgcn-amd-amdhsa--gfx950"
.text
.globl parallel_sum__compressed_kv_cla__swiglu_ffn__prompt_kernel
.p2align 8
.type parallel_sum__compressed_kv_cla__swiglu_ffn__prompt_kernel,@function
parallel_sum__compressed_kv_cla__swiglu_ffn__prompt_kernel:
    s_cmp_ge_u32 s2, 256
    s_cbranch_scc1 K_END
    s_lshr_b32 s6, s2, 2
    s_and_b32 s54, s6, 1
    s_lshl_b32 s6, s54, 3
    s_add_u32 s6, s6, 24
    s_load_dwordx2 s[12:13], s[0:1], s6
    s_load_dwordx2 s[16:17], s[0:1], 8
    s_load_dwordx2 s[8:9], s[0:1], 96
    s_load_dwordx2 s[20:21], s[0:1], 0
    s_load_dwordx2 s[24:25], s[0:1], 16
    s_load_dwordx2 s[36:37], s[0:1], 40
    s_load_dwordx2 s[28:29], s[0:1], 56
    s_load_dwordx2 s[32:33], s[0:1], 64
    s_load_dwordx2 s[40:41], s[0:1], 72
    s_load_dwordx2 s[44:45], s[0:1], 80
    s_load_dwordx2 s[48:49], s[0:1], 88
    s_mov_b32 s14, 0x400000
    s_mov_b32 s15, 0x00020000
    s_mov_b32 s18, 0x200000
    s_mov_b32 s19, 0x00020000
    s_mov_b32 s10, 0x10000000
    s_mov_b32 s11, 0x00020000
    s_mov_b32 s22, 0x200000
    s_mov_b32 s23, 0x00020000
    s_mov_b32 s26, 0x400000
    s_mov_b32 s27, 0x00020000
    s_mov_b32 s38, 0x400000
    s_mov_b32 s39, 0x00020000
    s_mov_b32 s30, 0x1c0000
    s_mov_b32 s31, 0x00020000
    s_mov_b32 s34, 0x1c0000
    s_mov_b32 s35, 0x00020000
    s_mov_b32 s42, 0x1c0000
    s_mov_b32 s43, 0x00020000
    s_mov_b32 s46, 0x200000
    s_mov_b32 s47, 0x00020000
    s_mov_b32 s50, 0x100
    s_mov_b32 s51, 0x00020000
    v_lshrrev_b32 v1, 6, v0
    v_and_b32 v96, 63, v0
    v_readfirstlane_b32 s3, v1
    s_lshr_b32 s4, s2, 3
    s_and_b32 s5, s2, 7
    v_lshlrev_b32 v112, 4, v96
    v_lshlrev_b32 v126, 7, v96
    v_cmp_ne_u32 vcc, 0, v96
    v_mov_b32 v123, 0
    v_mov_b32 v97, 0x40000000
    v_cndmask_b32 v123, v123, v97, vcc
    v_bfe_u32 v97, v96, 1, 2
    v_bfe_u32 v98, v96, 4, 1
    v_xor_b32 v97, v97, v98
    s_and_b32 s6, s3, 1
    s_lshl_b32 s6, s6, 1
    v_xor_b32 v97, s6, v97
    v_and_b32 v98, 1, v96
    v_lshlrev_b32 v98, 4, v98
    v_lshl_add_u32 v97, v97, 5, v98
    v_lshrrev_b32 v98, 3, v96
    s_lshl_b32 s6, s3, 3
    v_add_u32 v98, s6, v98
    v_lshl_add_u32 v117, v98, 13, v97
    v_mul_u32_u24 v98, 3584, v98
    v_add_u32 v118, v98, v97
    s_and_b32 s6, s2, 1
    s_lshl_b32 s6, s6, 2
    s_and_b32 s7, s4, 3
    s_add_u32 s6, s6, s7
    s_lshl_b32 s6, s6, 3
    s_add_u32 s56, s6, s3
    v_lshrrev_b32 v97, 3, v96
    v_lshlrev_b32 v97, 10, v97
    s_lshl_b32 s6, s56, 15
    v_add_u32 v97, s6, v97
    v_lshrrev_b32 v98, 4, v96
    v_and_b32 v99, 7, v96
    v_xor_b32 v98, v98, v99
    v_lshl_add_u32 v119, v98, 4, v97
    v_xor_b32 v98, 4, v98
    v_lshl_add_u32 v120, v98, 4, v97
    s_lshl_b32 s58, s3, 12
    s_add_u32 s58, s58, 65536
    s_lshl_b32 s57, s3, 10
    s_lshr_b32 s6, s4, 2
    s_lshl_b32 s7, s7, 1
    s_add_u32 s7, s7, s6
    s_and_b32 s52, s2, 2
    s_lshl_b32 s52, s52, 2
    s_add_u32 s52, s52, s6
    s_lshl_b32 s55, s52, 20
    s_lshl_b32 s52, s52, 9
    s_add_u32 s6, s7, 0
    s_and_b32 s6, s6, 7
    s_lshl_b32 s80, s6, 7
    s_lshl_b32 s6, s6, 19
    s_add_u32 s88, s6, s52
    s_add_u32 s6, s7, 1
    s_and_b32 s6, s6, 7
    s_lshl_b32 s81, s6, 7
    s_lshl_b32 s6, s6, 19
    s_add_u32 s89, s6, s52
    s_add_u32 s6, s7, 2
    s_and_b32 s6, s6, 7
    s_lshl_b32 s82, s6, 7
    s_lshl_b32 s6, s6, 19
    s_add_u32 s90, s6, s52
    s_add_u32 s6, s7, 3
    s_and_b32 s6, s6, 7
    s_lshl_b32 s83, s6, 7
    s_lshl_b32 s6, s6, 19
    s_add_u32 s91, s6, s52
    s_add_u32 s6, s7, 4
    s_and_b32 s6, s6, 7
    s_lshl_b32 s84, s6, 7
    s_lshl_b32 s6, s6, 19
    s_add_u32 s92, s6, s52
    s_add_u32 s6, s7, 5
    s_and_b32 s6, s6, 7
    s_lshl_b32 s85, s6, 7
    s_lshl_b32 s6, s6, 19
    s_add_u32 s93, s6, s52
    s_add_u32 s6, s7, 6
    s_and_b32 s6, s6, 7
    s_lshl_b32 s86, s6, 7
    s_lshl_b32 s6, s6, 19
    s_add_u32 s94, s6, s52
    s_add_u32 s6, s7, 7
    s_and_b32 s6, s6, 7
    s_lshl_b32 s87, s6, 7
    s_lshl_b32 s6, s6, 19
    s_add_u32 s95, s6, s52
    s_waitcnt lgkmcnt(0)
    s_add_u32 m0, s57, 0
    s_nop 0
    buffer_load_dwordx4 v117, s[12:15], s88 offen lds
    s_add_u32 m0, s58, 0
    s_nop 0
    buffer_load_dwordx4 v119, s[16:19], s80 offen offset:0 lds
    s_add_u32 s52, s80, 7168
    buffer_load_dwordx4 v120, s[16:19], s52 offen offset:1024 lds
    s_add_u32 s52, s80, 14336
    buffer_load_dwordx4 v119, s[16:19], s52 offen offset:2048 lds
    s_add_u32 s52, s80, 21504
    buffer_load_dwordx4 v120, s[16:19], s52 offen offset:3072 lds
    s_add_u32 m0, s57, 8192
    s_nop 0
    buffer_load_dwordx4 v117, s[12:15], s89 offen lds
    s_barrier
    s_add_u32 m0, s58, 32768
    s_nop 0
    buffer_load_dwordx4 v119, s[16:19], s81 offen offset:0 lds
    s_add_u32 s52, s81, 7168
    buffer_load_dwordx4 v120, s[16:19], s52 offen offset:1024 lds
    s_add_u32 s52, s81, 14336
    buffer_load_dwordx4 v119, s[16:19], s52 offen offset:2048 lds
    s_add_u32 s52, s81, 21504
    buffer_load_dwordx4 v120, s[16:19], s52 offen offset:3072 lds
    s_lshl_b32 s53, s2, 13
    s_lshl_b32 s6, s3, 10
    s_add_u32 s53, s53, s6
    buffer_load_dwordx4 v[60:63], v112, s[20:23], s53 offen
    s_add_u32 m0, s57, 16384
    s_nop 0
    buffer_load_dwordx4 v117, s[12:15], s90 offen lds
    s_add_u32 m0, s58, 65536
    s_nop 0
    buffer_load_dwordx4 v119, s[16:19], s82 offen offset:0 lds
    s_add_u32 s52, s82, 7168
    buffer_load_dwordx4 v120, s[16:19], s52 offen offset:1024 lds
    s_add_u32 s52, s82, 14336
    buffer_load_dwordx4 v119, s[16:19], s52 offen offset:2048 lds
    s_add_u32 s52, s82, 21504
    buffer_load_dwordx4 v120, s[16:19], s52 offen offset:3072 lds
    s_add_u32 m0, s57, 24576
    s_nop 0
    buffer_load_dwordx4 v117, s[12:15], s91 offen lds
    v_bfe_u32 v97, v96, 2, 2
    v_lshrrev_b32 v98, 4, v96
    v_lshl_add_u32 v99, v98, 3, v97
    v_lshlrev_b32 v99, 7, v99
    v_and_b32 v100, 3, v96
    v_lshl_add_u32 v99, v100, 3, v99
    v_bfe_u32 v97, v96, 3, 2
    v_xor_b32 v100, 0, v97
    v_lshl_add_u32 v113, v100, 5, v99
    v_xor_b32 v100, 1, v97
    v_lshl_add_u32 v114, v100, 5, v99
    v_xor_b32 v100, 2, v97
    v_lshl_add_u32 v115, v100, 5, v99
    v_xor_b32 v100, 3, v97
    v_lshl_add_u32 v116, v100, 5, v99
    v_and_b32 v97, 15, v96
    v_bfe_u32 v98, v96, 1, 3
    v_lshrrev_b32 v99, 4, v96
    v_xor_b32 v98, v98, v99
    v_lshlrev_b32 v98, 4, v98
    v_lshl_add_u32 v97, v97, 7, v98
    v_add_u32 v121, s58, v97
    v_xor_b32 v122, 64, v121
    s_lshl_b32 s6, s54, 24
    s_add_u32 s55, s55, s6
    s_add_u32 s55, s55, 0x200000
    s_lshl_b32 s6, s56, 13
    s_add_u32 s55, s55, s6
    s_add_u32 s56, s55, 4096
    s_lshl_b32 s59, s2, 3
    s_add_u32 s59, s59, s3
    s_lshl_b32 s60, s5, 2
    s_and_b32 s6, s4, 3
    s_add_u32 s60, s60, s6
    s_and_b32 s63, s3, 3
    s_and_b32 s6, s4, 28
    s_add_u32 s61, s6, 3
    s_sub_u32 s61, s61, s63
    s_sub_u32 s6, 60, s6
    s_add_u32 s7, s6, s63
    s_cmp_ge_u32 s3, 4
    s_cselect_b32 s61, s7, s61
    s_add_u32 s62, s6, 3
    s_lshl_b32 s64, s60, 7
    s_lshl_b32 s6, s60, 6
    s_add_u32 s6, s6, 1536
    s_cmp_ge_u32 s60, 24
    s_cselect_b32 s64, s6, s64
    s_lshl_b32 s65, s60, 8
    s_lshl_b32 s66, s61, 15
    s_add_u32 s66, s66, 0x0
    s_mul_i32 s69, s61, 376832
    s_add_u32 s69, s69, 0x2200000
    s_lshl_b32 s67, s64, 5
    s_add_u32 s67, s67, s69
    s_add_u32 s67, s67, 262144
    s_add_u32 s68, s67, 2048
    s_cmp_ge_u32 s60, 24
    s_cselect_b32 s68, 0x20000000, s68
    s_lshl_b32 s6, s60, 13
    s_add_u32 s69, s69, s6
    s_lshl_b32 s70, s60, 19
    s_and_b32 s96, s4, 3
    s_lshl_b32 s96, s96, 1
    s_lshr_b32 s6, s4, 2
    s_add_u32 s96, s96, s6
    s_and_b32 s96, s96, 7
    s_lshr_b32 s97, s4, 2
    s_add_u32 s97, s97, s4
    s_cmp_lg_u32 s54, 0
    s_cbranch_scc1 P1_V
    s_waitcnt vmcnt(11)
    s_barrier
    ds_read_b128 a[0:3], v121 offset:0
    ds_read_b128 a[4:7], v121 offset:2048
    ds_read_b128 a[8:11], v122 offset:0
    ds_read_b128 a[12:15], v122 offset:2048
    ds_read_b64_tr_b16 v[64:65], v113 offset:0
    ds_read_b64_tr_b16 v[66:67], v113 offset:512
    ds_read_b64_tr_b16 v[68:69], v114 offset:0
    ds_read_b64_tr_b16 v[70:71], v114 offset:512
    ds_read_b64_tr_b16 v[72:73], v115 offset:0
    ds_read_b64_tr_b16 v[74:75], v115 offset:512
    ds_read_b64_tr_b16 v[76:77], v116 offset:0
    ds_read_b64_tr_b16 v[78:79], v116 offset:512
    ds_read_b64_tr_b16 v[80:81], v113 offset:4096
    ds_read_b64_tr_b16 v[82:83], v113 offset:4608
    ds_read_b64_tr_b16 v[84:85], v114 offset:4096
    ds_read_b64_tr_b16 v[86:87], v114 offset:4608
    s_waitcnt lgkmcnt(8)
    v_mfma_f32_16x16x32_bf16 v[0:3], v[64:67], a[0:3], 0
    ds_read_b64_tr_b16 v[88:89], v115 offset:4096
    s_add_u32 m0, s57, 32768
    v_mfma_f32_16x16x32_bf16 v[4:7], v[64:67], a[4:7], 0
    ds_read_b64_tr_b16 v[90:91], v115 offset:4608
    s_nop 0
    v_mfma_f32_16x16x32_bf16 v[8:11], v[68:71], a[0:3], 0
    ds_read_b64_tr_b16 v[92:93], v116 offset:4096
    buffer_load_dwordx4 v117, s[12:15], s92 offen lds
    v_mfma_f32_16x16x32_bf16 v[12:15], v[68:71], a[4:7], 0
    ds_read_b64_tr_b16 v[94:95], v116 offset:4608
    s_add_u32 m0, s57, 40960
    s_waitcnt lgkmcnt(8)
    v_mfma_f32_16x16x32_bf16 v[16:19], v[72:75], a[0:3], 0
    ds_read_b64_tr_b16 v[64:65], v113 offset:8192
    s_nop 0
    v_mfma_f32_16x16x32_bf16 v[20:23], v[72:75], a[4:7], 0
    ds_read_b64_tr_b16 v[66:67], v113 offset:8704
    buffer_load_dwordx4 v117, s[12:15], s93 offen lds
    v_mfma_f32_16x16x32_bf16 v[24:27], v[76:79], a[0:3], 0
    ds_read_b64_tr_b16 v[68:69], v114 offset:8192
    s_waitcnt vmcnt(9)
    ds_read_b128 a[16:19], v121 offset:32768
    ds_read_b128 a[20:23], v121 offset:34816
    ds_read_b128 a[24:27], v122 offset:32768
    ds_read_b128 a[28:31], v122 offset:34816
    v_mfma_f32_16x16x32_bf16 v[28:31], v[76:79], a[4:7], 0
    ds_read_b64_tr_b16 v[70:71], v114 offset:8704
    s_waitcnt lgkmcnt(12)
    v_mfma_f32_16x16x32_bf16 v[0:3], v[80:83], a[8:11], v[0:3]
    ds_read_b64_tr_b16 v[72:73], v115 offset:8192
    v_mfma_f32_16x16x32_bf16 v[4:7], v[80:83], a[12:15], v[4:7]
    ds_read_b64_tr_b16 v[74:75], v115 offset:8704
    v_mfma_f32_16x16x32_bf16 v[8:11], v[84:87], a[8:11], v[8:11]
    ds_read_b64_tr_b16 v[76:77], v116 offset:8192
    s_add_u32 m0, s58, 0
    s_nop 0
    v_mfma_f32_16x16x32_bf16 v[12:15], v[84:87], a[12:15], v[12:15]
    ds_read_b64_tr_b16 v[78:79], v116 offset:8704
    buffer_load_dwordx4 v119, s[16:19], s83 offen offset:0 lds
    s_add_u32 s52, s83, 7168
    s_waitcnt lgkmcnt(12)
    v_mfma_f32_16x16x32_bf16 v[16:19], v[88:91], a[8:11], v[16:19]
    ds_read_b64_tr_b16 v[80:81], v113 offset:12288
    buffer_load_dwordx4 v120, s[16:19], s52 offen offset:1024 lds
    s_add_u32 s52, s83, 14336
    v_mfma_f32_16x16x32_bf16 v[20:23], v[88:91], a[12:15], v[20:23]
    ds_read_b64_tr_b16 v[82:83], v113 offset:12800
    buffer_load_dwordx4 v119, s[16:19], s52 offen offset:2048 lds
    s_add_u32 s52, s83, 21504
    v_mfma_f32_16x16x32_bf16 v[24:27], v[92:95], a[8:11], v[24:27]
    ds_read_b64_tr_b16 v[84:85], v114 offset:12288
    buffer_load_dwordx4 v120, s[16:19], s52 offen offset:3072 lds
    v_mfma_f32_16x16x32_bf16 v[28:31], v[92:95], a[12:15], v[28:31]
    ds_read_b64_tr_b16 v[86:87], v114 offset:12800
    s_waitcnt vmcnt(6)
    s_barrier
    s_waitcnt lgkmcnt(8)
    v_mfma_f32_16x16x32_bf16 v[0:3], v[64:67], a[16:19], v[0:3]
    ds_read_b64_tr_b16 v[88:89], v115 offset:12288
    s_add_u32 m0, s57, 0
    v_mfma_f32_16x16x32_bf16 v[4:7], v[64:67], a[20:23], v[4:7]
    ds_read_b64_tr_b16 v[90:91], v115 offset:12800
    s_add_u32 s52, s88, 128
    v_mfma_f32_16x16x32_bf16 v[8:11], v[68:71], a[16:19], v[8:11]
    ds_read_b64_tr_b16 v[92:93], v116 offset:12288
    buffer_load_dwordx4 v117, s[12:15], s52 offen lds
    v_mfma_f32_16x16x32_bf16 v[12:15], v[68:71], a[20:23], v[12:15]
    ds_read_b64_tr_b16 v[94:95], v116 offset:12800
    s_add_u32 m0, s57, 49152
    s_waitcnt lgkmcnt(8)
    v_mfma_f32_16x16x32_bf16 v[16:19], v[72:75], a[16:19], v[16:19]
    ds_read_b64_tr_b16 v[64:65], v113 offset:16384
    s_nop 0
    v_mfma_f32_16x16x32_bf16 v[20:23], v[72:75], a[20:23], v[20:23]
    ds_read_b64_tr_b16 v[66:67], v113 offset:16896
    buffer_load_dwordx4 v117, s[12:15], s94 offen lds
    v_mfma_f32_16x16x32_bf16 v[24:27], v[76:79], a[16:19], v[24:27]
    ds_read_b64_tr_b16 v[68:69], v114 offset:16384
    v_add_u32 v96, 0x10000, v121
    ds_read_b128 a[32:35], v96 offset:0
    ds_read_b128 a[36:39], v96 offset:2048
    v_add_u32 v97, 0x10000, v122
    ds_read_b128 a[40:43], v97 offset:0
    ds_read_b128 a[44:47], v97 offset:2048
    s_add_u32 m0, s57, 57344
    v_mfma_f32_16x16x32_bf16 v[28:31], v[76:79], a[20:23], v[28:31]
    ds_read_b64_tr_b16 v[70:71], v114 offset:16896
    s_nop 0
    s_waitcnt lgkmcnt(12)
    v_mfma_f32_16x16x32_bf16 v[0:3], v[80:83], a[24:27], v[0:3]
    ds_read_b64_tr_b16 v[72:73], v115 offset:16384
    buffer_load_dwordx4 v117, s[12:15], s95 offen lds
    v_mfma_f32_16x16x32_bf16 v[4:7], v[80:83], a[28:31], v[4:7]
    ds_read_b64_tr_b16 v[74:75], v115 offset:16896
    v_mfma_f32_16x16x32_bf16 v[8:11], v[84:87], a[24:27], v[8:11]
    ds_read_b64_tr_b16 v[76:77], v116 offset:16384
    s_add_u32 m0, s58, 32768
    s_nop 0
    v_mov_b32 v104, 0
    s_lshl_b32 s53, s2, 8
    s_add_u32 s53, s53, 0x5000000
    v_lshrrev_b32 v106, 2, v112
    s_cmp_eq_u32 s3, 0
    s_cselect_b32 s53, s53, 0x20000000
    buffer_store_dword v104, v106, s[8:11], s53 offen sc1
    v_mfma_f32_16x16x32_bf16 v[12:15], v[84:87], a[28:31], v[12:15]
    ds_read_b64_tr_b16 v[78:79], v116 offset:16896
    buffer_load_dwordx4 v119, s[16:19], s84 offen offset:0 lds
    s_add_u32 s52, s84, 7168
    s_waitcnt lgkmcnt(12)
    v_mfma_f32_16x16x32_bf16 v[16:19], v[88:91], a[24:27], v[16:19]
    ds_read_b64_tr_b16 v[80:81], v113 offset:20480
    buffer_load_dwordx4 v120, s[16:19], s52 offen offset:1024 lds
    s_add_u32 s52, s84, 14336
    v_lshlrev_b32 v104, 16, v60
    v_and_b32 v105, 0xffff0000, v60
    v_lshlrev_b32 v106, 16, v61
    v_mfma_f32_16x16x32_bf16 v[20:23], v[88:91], a[28:31], v[20:23]
    ds_read_b64_tr_b16 v[82:83], v113 offset:20992
    buffer_load_dwordx4 v119, s[16:19], s52 offen offset:2048 lds
    s_add_u32 s52, s84, 21504
    v_and_b32 v107, 0xffff0000, v61
    v_lshlrev_b32 v108, 16, v62
    v_and_b32 v109, 0xffff0000, v62
    v_mfma_f32_16x16x32_bf16 v[24:27], v[92:95], a[24:27], v[24:27]
    ds_read_b64_tr_b16 v[84:85], v114 offset:20480
    buffer_load_dwordx4 v120, s[16:19], s52 offen offset:3072 lds
    v_lshlrev_b32 v110, 16, v63
    v_and_b32 v111, 0xffff0000, v63
    v_and_b32 v98, 0x70, v112
    v_mfma_f32_16x16x32_bf16 v[28:31], v[92:95], a[28:31], v[28:31]
    ds_read_b64_tr_b16 v[86:87], v114 offset:20992
    v_lshlrev_b32 v98, 6, v98
    v_lshrrev_b32 v99, 7, v112
    v_lshl_add_u32 v98, v99, 4, v98
    s_waitcnt lgkmcnt(8)
    v_mfma_f32_16x16x32_bf16 v[0:3], v[64:67], a[32:35], v[0:3]
    ds_read_b64_tr_b16 v[88:89], v115 offset:20480
    s_lshl_b32 s71, s2, 13
    s_lshl_b32 s72, s3, 7
    s_add_u32 s71, s71, s72
    v_mfma_f32_16x16x32_bf16 v[4:7], v[64:67], a[36:39], v[4:7]
    ds_read_b64_tr_b16 v[90:91], v115 offset:20992
    buffer_load_dwordx4 v[100:103], v98, s[20:23], s71 offen
    v_add_f32 v125, v104, v105
    v_add_f32 v125, v125, v106
    v_mfma_f32_16x16x32_bf16 v[8:11], v[68:71], a[32:35], v[8:11]
    ds_read_b64_tr_b16 v[92:93], v116 offset:20480
    v_add_f32 v125, v125, v107
    v_add_f32 v125, v125, v108
    v_add_f32 v125, v125, v109
    v_mfma_f32_16x16x32_bf16 v[12:15], v[68:71], a[36:39], v[12:15]
    ds_read_b64_tr_b16 v[94:95], v116 offset:20992
    v_add_f32 v125, v125, v110
    v_add_f32 v125, v125, v111
    s_nop 1
    s_waitcnt lgkmcnt(8)
    v_mfma_f32_16x16x32_bf16 v[16:19], v[72:75], a[32:35], v[16:19]
    ds_read_b64_tr_b16 v[64:65], v113 offset:24576
    v_add_f32_dpp v125, v125, v125 row_shr:1 row_mask:0xf bank_mask:0xf bound_ctrl:0
    s_nop 1
    v_add_f32_dpp v125, v125, v125 row_shr:2 row_mask:0xf bank_mask:0xf bound_ctrl:0
    v_mfma_f32_16x16x32_bf16 v[20:23], v[72:75], a[36:39], v[20:23]
    ds_read_b64_tr_b16 v[66:67], v113 offset:25088
    s_nop 1
    v_add_f32_dpp v125, v125, v125 row_shr:4 row_mask:0xf bank_mask:0xf bound_ctrl:0
    s_nop 1
    v_mfma_f32_16x16x32_bf16 v[24:27], v[76:79], a[32:35], v[24:27]
    ds_read_b64_tr_b16 v[68:69], v114 offset:24576
    s_waitcnt vmcnt(9)
    ds_read_b128 a[48:51], v121 offset:0
    ds_read_b128 a[52:55], v121 offset:2048
    ds_read_b128 a[56:59], v122 offset:0
    ds_read_b128 a[60:63], v122 offset:2048
    v_add_f32_dpp v125, v125, v125 row_shr:8 row_mask:0xf bank_mask:0xf bound_ctrl:0
    s_nop 1
    v_add_f32_dpp v125, v125, v125 row_bcast:15 row_mask:0xa bank_mask:0xf
    v_mfma_f32_16x16x32_bf16 v[28:31], v[76:79], a[36:39], v[28:31]
    ds_read_b64_tr_b16 v[70:71], v114 offset:25088
    s_nop 1
    v_add_f32_dpp v125, v125, v125 row_bcast:31 row_mask:0xc bank_mask:0xf
    s_nop 0
    s_waitcnt lgkmcnt(12)
    v_mfma_f32_16x16x32_bf16 v[0:3], v[80:83], a[40:43], v[0:3]
    ds_read_b64_tr_b16 v[72:73], v115 offset:24576
    v_readlane_b32 s71, v125, 63
    v_mov_b32 v98, 0x3b000000
    s_nop 0
    v_mfma_f32_16x16x32_bf16 v[4:7], v[80:83], a[44:47], v[4:7]
    ds_read_b64_tr_b16 v[74:75], v115 offset:25088
    v_mul_f32 v98, s71, v98
    v_sub_f32 v99, v104, v98
    v_mul_f32 v125, v99, v99
    v_mfma_f32_16x16x32_bf16 v[8:11], v[84:87], a[40:43], v[8:11]
    ds_read_b64_tr_b16 v[76:77], v116 offset:24576
    s_add_u32 m0, s58, 65536
    s_nop 0
    v_sub_f32 v99, v105, v98
    v_fmac_f32 v125, v99, v99
    v_sub_f32 v99, v106, v98
    v_mfma_f32_16x16x32_bf16 v[12:15], v[84:87], a[44:47], v[12:15]
    ds_read_b64_tr_b16 v[78:79], v116 offset:25088
    buffer_load_dwordx4 v119, s[16:19], s85 offen offset:0 lds
    s_add_u32 s52, s85, 7168
    v_fmac_f32 v125, v99, v99
    v_sub_f32 v99, v107, v98
    v_fmac_f32 v125, v99, v99
    s_waitcnt lgkmcnt(12)
    v_mfma_f32_16x16x32_bf16 v[16:19], v[88:91], a[40:43], v[16:19]
    ds_read_b64_tr_b16 v[80:81], v113 offset:28672
    buffer_load_dwordx4 v120, s[16:19], s52 offen offset:1024 lds
    s_add_u32 s52, s85, 14336
    v_sub_f32 v99, v108, v98
    v_fmac_f32 v125, v99, v99
    v_sub_f32 v99, v109, v98
    v_mfma_f32_16x16x32_bf16 v[20:23], v[88:91], a[44:47], v[20:23]
    ds_read_b64_tr_b16 v[82:83], v113 offset:29184
    buffer_load_dwordx4 v119, s[16:19], s52 offen offset:2048 lds
    s_add_u32 s52, s85, 21504
    v_fmac_f32 v125, v99, v99
    v_sub_f32 v99, v110, v98
    v_fmac_f32 v125, v99, v99
    v_mfma_f32_16x16x32_bf16 v[24:27], v[92:95], a[40:43], v[24:27]
    ds_read_b64_tr_b16 v[84:85], v114 offset:28672
    buffer_load_dwordx4 v120, s[16:19], s52 offen offset:3072 lds
    v_sub_f32 v99, v111, v98
    v_fmac_f32 v125, v99, v99
    s_nop 1
    v_mfma_f32_16x16x32_bf16 v[28:31], v[92:95], a[44:47], v[28:31]
    ds_read_b64_tr_b16 v[86:87], v114 offset:29184
    v_add_f32_dpp v125, v125, v125 row_shr:1 row_mask:0xf bank_mask:0xf bound_ctrl:0
    s_nop 1
    v_add_f32_dpp v125, v125, v125 row_shr:2 row_mask:0xf bank_mask:0xf bound_ctrl:0
    s_barrier
    s_waitcnt lgkmcnt(8)
    v_mfma_f32_16x16x32_bf16 v[0:3], v[64:67], a[48:51], v[0:3]
    ds_read_b64_tr_b16 v[88:89], v115 offset:28672
    s_add_u32 m0, s57, 8192
    s_nop 1
    v_add_f32_dpp v125, v125, v125 row_shr:4 row_mask:0xf bank_mask:0xf bound_ctrl:0
    s_nop 1
    v_mfma_f32_16x16x32_bf16 v[4:7], v[64:67], a[52:55], v[4:7]
    ds_read_b64_tr_b16 v[90:91], v115 offset:29184
    s_add_u32 s52, s89, 128
    v_add_f32_dpp v125, v125, v125 row_shr:8 row_mask:0xf bank_mask:0xf bound_ctrl:0
    s_nop 1
    v_add_f32_dpp v125, v125, v125 row_bcast:15 row_mask:0xa bank_mask:0xf
    v_mfma_f32_16x16x32_bf16 v[8:11], v[68:71], a[48:51], v[8:11]
    ds_read_b64_tr_b16 v[92:93], v116 offset:28672
    buffer_load_dwordx4 v117, s[12:15], s52 offen lds
    s_nop 1
    v_add_f32_dpp v125, v125, v125 row_bcast:31 row_mask:0xc bank_mask:0xf
    s_nop 0
    v_mfma_f32_16x16x32_bf16 v[12:15], v[68:71], a[52:55], v[12:15]
    ds_read_b64_tr_b16 v[94:95], v116 offset:29184
    s_add_u32 m0, s57, 16384
    v_readlane_b32 s71, v125, 63
    v_mov_b32 v99, 0x3b000000
    s_nop 0
    s_waitcnt lgkmcnt(8)
    v_mfma_f32_16x16x32_bf16 v[16:19], v[72:75], a[48:51], v[16:19]
    ds_read_b64_tr_b16 v[64:65], v113 offset:32768
    s_add_u32 s52, s90, 128
    v_mul_f32 v99, s71, v99
    v_cvt_pk_bf16_f32 v125, v98, v99
    v_lshlrev_b32 v98, 16, v125
    v_mfma_f32_16x16x32_bf16 v[20:23], v[72:75], a[52:55], v[20:23]
    ds_read_b64_tr_b16 v[66:67], v113 offset:33280
    buffer_load_dwordx4 v117, s[12:15], s52 offen lds
    v_and_b32 v99, 0xffff0000, v125
    v_add_f32 v99, 0x3727c5ac, v99
    v_cvt_pk_bf16_f32 v99, v99, v99
    v_mfma_f32_16x16x32_bf16 v[24:27], v[76:79], a[48:51], v[24:27]
    ds_read_b64_tr_b16 v[68:69], v114 offset:32768
    s_waitcnt vmcnt(7)
    ds_read_b128 a[64:67], v121 offset:32768
    ds_read_b128 a[68:71], v121 offset:34816
    ds_read_b128 a[72:75], v122 offset:32768
    ds_read_b128 a[76:79], v122 offset:34816
    v_lshlrev_b32 v99, 16, v99
    v_sqrt_f32 v99, v99
    s_lshl_b32 s71, s59, 3
    v_mfma_f32_16x16x32_bf16 v[28:31], v[76:79], a[52:55], v[28:31]
    ds_read_b64_tr_b16 v[70:71], v114 offset:33280
    v_cvt_pk_bf16_f32 v99, v99, v99
    v_lshlrev_b32 v99, 16, v99
    s_add_u32 s71, s71, 0x5100000
    s_waitcnt lgkmcnt(12)
    v_mfma_f32_16x16x32_bf16 v[0:3], v[80:83], a[56:59], v[0:3]
    ds_read_b64_tr_b16 v[72:73], v115 offset:32768
    buffer_store_dwordx2 v[98:99], v123, s[8:11], s71 offen sc1
    v_mfma_f32_16x16x32_bf16 v[4:7], v[80:83], a[60:63], v[4:7]
    ds_read_b64_tr_b16 v[74:75], v115 offset:33280
    v_mfma_f32_16x16x32_bf16 v[8:11], v[84:87], a[56:59], v[8:11]
    ds_read_b64_tr_b16 v[76:77], v116 offset:32768
    s_add_u32 m0, s58, 0
    s_nop 0
    v_mfma_f32_16x16x32_bf16 v[12:15], v[84:87], a[60:63], v[12:15]
    ds_read_b64_tr_b16 v[78:79], v116 offset:33280
    buffer_load_dwordx4 v119, s[16:19], s86 offen offset:0 lds
    s_add_u32 s52, s86, 7168
    s_waitcnt lgkmcnt(12)
    v_mfma_f32_16x16x32_bf16 v[16:19], v[88:91], a[56:59], v[16:19]
    ds_read_b64_tr_b16 v[80:81], v113 offset:36864
    buffer_load_dwordx4 v120, s[16:19], s52 offen offset:1024 lds
    s_add_u32 s52, s86, 14336
    v_mfma_f32_16x16x32_bf16 v[20:23], v[88:91], a[60:63], v[20:23]
    ds_read_b64_tr_b16 v[82:83], v113 offset:37376
    buffer_load_dwordx4 v119, s[16:19], s52 offen offset:2048 lds
    s_add_u32 s52, s86, 21504
    v_mfma_f32_16x16x32_bf16 v[24:27], v[92:95], a[56:59], v[24:27]
    ds_read_b64_tr_b16 v[84:85], v114 offset:36864
    buffer_load_dwordx4 v120, s[16:19], s52 offen offset:3072 lds
    v_mfma_f32_16x16x32_bf16 v[28:31], v[92:95], a[60:63], v[28:31]
    ds_read_b64_tr_b16 v[86:87], v114 offset:37376
    s_waitcnt lgkmcnt(8)
    v_mfma_f32_16x16x32_bf16 v[0:3], v[64:67], a[64:67], v[0:3]
    ds_read_b64_tr_b16 v[88:89], v115 offset:36864
    v_mfma_f32_16x16x32_bf16 v[4:7], v[64:67], a[68:71], v[4:7]
    ds_read_b64_tr_b16 v[90:91], v115 offset:37376
    v_mfma_f32_16x16x32_bf16 v[8:11], v[68:71], a[64:67], v[8:11]
    ds_read_b64_tr_b16 v[92:93], v116 offset:36864
    v_mfma_f32_16x16x32_bf16 v[12:15], v[68:71], a[68:71], v[12:15]
    ds_read_b64_tr_b16 v[94:95], v116 offset:37376
    s_waitcnt lgkmcnt(8)
    v_mfma_f32_16x16x32_bf16 v[16:19], v[72:75], a[64:67], v[16:19]
    ds_read_b64_tr_b16 v[64:65], v113 offset:40960
    v_mfma_f32_16x16x32_bf16 v[20:23], v[72:75], a[68:71], v[20:23]
    ds_read_b64_tr_b16 v[66:67], v113 offset:41472
    v_mfma_f32_16x16x32_bf16 v[24:27], v[76:79], a[64:67], v[24:27]
    ds_read_b64_tr_b16 v[68:69], v114 offset:40960
    s_waitcnt vmcnt(7)
    v_add_u32 v96, 0x10000, v121
    ds_read_b128 a[80:83], v96 offset:0
    ds_read_b128 a[84:87], v96 offset:2048
    v_add_u32 v97, 0x10000, v122
    ds_read_b128 a[88:91], v97 offset:0
    ds_read_b128 a[92:95], v97 offset:2048
    v_mfma_f32_16x16x32_bf16 v[28:31], v[76:79], a[68:71], v[28:31]
    ds_read_b64_tr_b16 v[70:71], v114 offset:41472
    s_waitcnt lgkmcnt(12)
    v_mfma_f32_16x16x32_bf16 v[0:3], v[80:83], a[72:75], v[0:3]
    ds_read_b64_tr_b16 v[72:73], v115 offset:40960
    v_mfma_f32_16x16x32_bf16 v[4:7], v[80:83], a[76:79], v[4:7]
    ds_read_b64_tr_b16 v[74:75], v115 offset:41472
    v_mfma_f32_16x16x32_bf16 v[8:11], v[84:87], a[72:75], v[8:11]
    ds_read_b64_tr_b16 v[76:77], v116 offset:40960
    s_add_u32 m0, s58, 32768
    s_nop 0
    v_mfma_f32_16x16x32_bf16 v[12:15], v[84:87], a[76:79], v[12:15]
    ds_read_b64_tr_b16 v[78:79], v116 offset:41472
    buffer_load_dwordx4 v119, s[16:19], s87 offen offset:0 lds
    s_add_u32 s52, s87, 7168
    s_waitcnt lgkmcnt(12)
    v_mfma_f32_16x16x32_bf16 v[16:19], v[88:91], a[72:75], v[16:19]
    ds_read_b64_tr_b16 v[80:81], v113 offset:45056
    buffer_load_dwordx4 v120, s[16:19], s52 offen offset:1024 lds
    s_add_u32 s52, s87, 14336
    v_mfma_f32_16x16x32_bf16 v[20:23], v[88:91], a[76:79], v[20:23]
    ds_read_b64_tr_b16 v[82:83], v113 offset:45568
    buffer_load_dwordx4 v119, s[16:19], s52 offen offset:2048 lds
    s_add_u32 s52, s87, 21504
    v_mfma_f32_16x16x32_bf16 v[24:27], v[92:95], a[72:75], v[24:27]
    ds_read_b64_tr_b16 v[84:85], v114 offset:45056
    buffer_load_dwordx4 v120, s[16:19], s52 offen offset:3072 lds
    v_mfma_f32_16x16x32_bf16 v[28:31], v[92:95], a[76:79], v[28:31]
    ds_read_b64_tr_b16 v[86:87], v114 offset:45568
    s_waitcnt vmcnt(8)
    s_barrier
    s_waitcnt lgkmcnt(8)
    v_mfma_f32_16x16x32_bf16 v[0:3], v[64:67], a[80:83], v[0:3]
    ds_read_b64_tr_b16 v[88:89], v115 offset:45056
    s_add_u32 m0, s57, 24576
    v_and_b32 v104, 0x70, v112
    v_lshrrev_b32 v104, 1, v104
    v_mfma_f32_16x16x32_bf16 v[4:7], v[64:67], a[84:87], v[4:7]
    ds_read_b64_tr_b16 v[90:91], v115 offset:45568
    s_add_u32 s52, s91, 128
    s_lshl_b32 s71, s2, 6
    s_add_u32 s71, s71, 0x5100000
    v_mfma_f32_16x16x32_bf16 v[8:11], v[68:71], a[80:83], v[8:11]
    ds_read_b64_tr_b16 v[92:93], v116 offset:45056
    buffer_load_dwordx4 v117, s[12:15], s52 offen lds
    buffer_load_dwordx2 v[98:99], v104, s[8:11], s71 offen sc1
    v_mfma_f32_16x16x32_bf16 v[12:15], v[68:71], a[84:87], v[12:15]
    ds_read_b64_tr_b16 v[94:95], v116 offset:45568
    s_add_u32 m0, s57, 32768
    s_waitcnt lgkmcnt(8)
    v_mfma_f32_16x16x32_bf16 v[16:19], v[72:75], a[80:83], v[16:19]
    ds_read_b64_tr_b16 v[64:65], v113 offset:49152
    s_add_u32 s52, s92, 128
    v_mfma_f32_16x16x32_bf16 v[20:23], v[72:75], a[84:87], v[20:23]
    ds_read_b64_tr_b16 v[66:67], v113 offset:49664
    buffer_load_dwordx4 v117, s[12:15], s52 offen lds
    v_mfma_f32_16x16x32_bf16 v[24:27], v[76:79], a[80:83], v[24:27]
    ds_read_b64_tr_b16 v[68:69], v114 offset:49152
    s_waitcnt vmcnt(7)
    ds_read_b128 a[96:99], v121 offset:0
    ds_read_b128 a[100:103], v121 offset:2048
    ds_read_b128 a[104:107], v122 offset:0
    ds_read_b128 a[108:111], v122 offset:2048
    v_mfma_f32_16x16x32_bf16 v[28:31], v[76:79], a[84:87], v[28:31]
    ds_read_b64_tr_b16 v[70:71], v114 offset:49664
    s_waitcnt lgkmcnt(12)
    v_mfma_f32_16x16x32_bf16 v[0:3], v[80:83], a[88:91], v[0:3]
    ds_read_b64_tr_b16 v[72:73], v115 offset:49152
    v_mfma_f32_16x16x32_bf16 v[4:7], v[80:83], a[92:95], v[4:7]
    ds_read_b64_tr_b16 v[74:75], v115 offset:49664
    v_mfma_f32_16x16x32_bf16 v[8:11], v[84:87], a[88:91], v[8:11]
    ds_read_b64_tr_b16 v[76:77], v116 offset:49152
    v_mfma_f32_16x16x32_bf16 v[12:15], v[84:87], a[92:95], v[12:15]
    ds_read_b64_tr_b16 v[78:79], v116 offset:49664
    s_waitcnt lgkmcnt(12)
    v_mfma_f32_16x16x32_bf16 v[16:19], v[88:91], a[88:91], v[16:19]
    ds_read_b64_tr_b16 v[80:81], v113 offset:53248
    v_mfma_f32_16x16x32_bf16 v[20:23], v[88:91], a[92:95], v[20:23]
    ds_read_b64_tr_b16 v[82:83], v113 offset:53760
    v_mfma_f32_16x16x32_bf16 v[24:27], v[92:95], a[88:91], v[24:27]
    ds_read_b64_tr_b16 v[84:85], v114 offset:53248
    v_mfma_f32_16x16x32_bf16 v[28:31], v[92:95], a[92:95], v[28:31]
    ds_read_b64_tr_b16 v[86:87], v114 offset:53760
    s_waitcnt lgkmcnt(8)
    v_mfma_f32_16x16x32_bf16 v[0:3], v[64:67], a[96:99], v[0:3]
    ds_read_b64_tr_b16 v[88:89], v115 offset:53248
    v_mfma_f32_16x16x32_bf16 v[4:7], v[64:67], a[100:103], v[4:7]
    ds_read_b64_tr_b16 v[90:91], v115 offset:53760
    v_mfma_f32_16x16x32_bf16 v[8:11], v[68:71], a[96:99], v[8:11]
    ds_read_b64_tr_b16 v[92:93], v116 offset:53248
    v_mfma_f32_16x16x32_bf16 v[12:15], v[68:71], a[100:103], v[12:15]
    ds_read_b64_tr_b16 v[94:95], v116 offset:53760
    s_waitcnt lgkmcnt(8)
    v_mfma_f32_16x16x32_bf16 v[16:19], v[72:75], a[96:99], v[16:19]
    ds_read_b64_tr_b16 v[64:65], v113 offset:57344
    s_waitcnt vmcnt(1)
    v_rcp_f32 v127, v99
    v_lshlrev_b32 v104, 16, v100
    v_and_b32 v105, 0xffff0000, v100
    v_mfma_f32_16x16x32_bf16 v[20:23], v[72:75], a[100:103], v[20:23]
    ds_read_b64_tr_b16 v[66:67], v113 offset:57856
    v_lshlrev_b32 v106, 16, v101
    v_and_b32 v107, 0xffff0000, v101
    v_lshlrev_b32 v108, 16, v102
    v_mfma_f32_16x16x32_bf16 v[24:27], v[76:79], a[96:99], v[24:27]
    ds_read_b64_tr_b16 v[68:69], v114 offset:57344
    ds_read_b128 a[112:115], v121 offset:32768
    ds_read_b128 a[116:119], v121 offset:34816
    ds_read_b128 a[120:123], v122 offset:32768
    ds_read_b128 a[124:127], v122 offset:34816
    v_and_b32 v109, 0xffff0000, v102
    v_lshlrev_b32 v110, 16, v103
    v_and_b32 v111, 0xffff0000, v103
    v_mfma_f32_16x16x32_bf16 v[28:31], v[76:79], a[100:103], v[28:31]
    ds_read_b64_tr_b16 v[70:71], v114 offset:57856
    v_sub_f32 v104, v104, v98
    v_sub_f32 v105, v105, v98
    v_sub_f32 v106, v106, v98
    s_waitcnt lgkmcnt(12)
    v_mfma_f32_16x16x32_bf16 v[0:3], v[80:83], a[104:107], v[0:3]
    ds_read_b64_tr_b16 v[72:73], v115 offset:57344
    v_sub_f32 v107, v107, v98
    v_sub_f32 v108, v108, v98
    v_sub_f32 v109, v109, v98
    v_mfma_f32_16x16x32_bf16 v[4:7], v[80:83], a[108:111], v[4:7]
    ds_read_b64_tr_b16 v[74:75], v115 offset:57856
    v_sub_f32 v110, v110, v98
    v_sub_f32 v111, v111, v98
    v_cvt_pk_bf16_f32 v100, v104, v105
    v_mfma_f32_16x16x32_bf16 v[8:11], v[84:87], a[104:107], v[8:11]
    ds_read_b64_tr_b16 v[76:77], v116 offset:57344
    v_cvt_pk_bf16_f32 v101, v106, v107
    v_cvt_pk_bf16_f32 v102, v108, v109
    v_cvt_pk_bf16_f32 v103, v110, v111
    v_mfma_f32_16x16x32_bf16 v[12:15], v[84:87], a[108:111], v[12:15]
    ds_read_b64_tr_b16 v[78:79], v116 offset:57856
    v_lshlrev_b32 v104, 16, v100
    v_and_b32 v105, 0xffff0000, v100
    v_lshlrev_b32 v106, 16, v101
    s_waitcnt lgkmcnt(12)
    v_mfma_f32_16x16x32_bf16 v[16:19], v[88:91], a[104:107], v[16:19]
    ds_read_b64_tr_b16 v[80:81], v113 offset:61440
    v_and_b32 v107, 0xffff0000, v101
    v_lshlrev_b32 v108, 16, v102
    v_and_b32 v109, 0xffff0000, v102
    v_mfma_f32_16x16x32_bf16 v[20:23], v[88:91], a[108:111], v[20:23]
    ds_read_b64_tr_b16 v[82:83], v113 offset:61952
    v_lshlrev_b32 v110, 16, v103
    v_and_b32 v111, 0xffff0000, v103
    v_mul_f32 v125, v104, v127
    v_mfma_f32_16x16x32_bf16 v[24:27], v[92:95], a[104:107], v[24:27]
    ds_read_b64_tr_b16 v[84:85], v114 offset:61440
    v_fma_f32 v104, -v125, v99, v104
    v_fma_f32 v104, v104, v127, v125
    v_mul_f32 v125, v105, v127
    v_mfma_f32_16x16x32_bf16 v[28:31], v[92:95], a[108:111], v[28:31]
    ds_read_b64_tr_b16 v[86:87], v114 offset:61952
    v_fma_f32 v105, -v125, v99, v105
    v_fma_f32 v105, v105, v127, v125
    v_mul_f32 v125, v106, v127
    s_barrier
    s_waitcnt lgkmcnt(8)
    v_mfma_f32_16x16x32_bf16 v[0:3], v[64:67], a[112:115], v[0:3]
    ds_read_b64_tr_b16 v[88:89], v115 offset:61440
    s_add_u32 m0, s57, 40960
    v_fma_f32 v106, -v125, v99, v106
    v_fma_f32 v106, v106, v127, v125
    v_mul_f32 v125, v107, v127
    v_mfma_f32_16x16x32_bf16 v[4:7], v[64:67], a[116:119], v[4:7]
    ds_read_b64_tr_b16 v[90:91], v115 offset:61952
    s_add_u32 s52, s93, 128
    v_fma_f32 v107, -v125, v99, v107
    v_fma_f32 v107, v107, v127, v125
    v_mul_f32 v125, v108, v127
    v_mfma_f32_16x16x32_bf16 v[8:11], v[68:71], a[112:115], v[8:11]
    ds_read_b64_tr_b16 v[92:93], v116 offset:61440
    buffer_load_dwordx4 v117, s[12:15], s52 offen lds
    v_fma_f32 v108, -v125, v99, v108
    v_fma_f32 v108, v108, v127, v125
    v_mul_f32 v125, v109, v127
    v_mfma_f32_16x16x32_bf16 v[12:15], v[68:71], a[116:119], v[12:15]
    ds_read_b64_tr_b16 v[94:95], v116 offset:61952
    s_add_u32 m0, s57, 49152
    v_fma_f32 v109, -v125, v99, v109
    v_fma_f32 v109, v109, v127, v125
    v_mul_f32 v125, v110, v127
    s_waitcnt lgkmcnt(8)
    v_mfma_f32_16x16x32_bf16 v[16:19], v[72:75], a[112:115], v[16:19]
    ds_read_b64_tr_b16 v[64:65], v113 offset:0
    s_add_u32 s52, s94, 128
    v_fma_f32 v110, -v125, v99, v110
    v_fma_f32 v110, v110, v127, v125
    v_mul_f32 v125, v111, v127
    v_mfma_f32_16x16x32_bf16 v[20:23], v[72:75], a[116:119], v[20:23]
    ds_read_b64_tr_b16 v[66:67], v113 offset:512
    buffer_load_dwordx4 v117, s[12:15], s52 offen lds
    v_fma_f32 v111, -v125, v99, v111
    v_fma_f32 v111, v111, v127, v125
    v_cvt_pk_bf16_f32 v100, v104, v105
    v_mfma_f32_16x16x32_bf16 v[24:27], v[76:79], a[112:115], v[24:27]
    ds_read_b64_tr_b16 v[68:69], v114 offset:0
    v_cvt_pk_bf16_f32 v101, v106, v107
    v_cvt_pk_bf16_f32 v102, v108, v109
    v_cvt_pk_bf16_f32 v103, v110, v111
    v_mfma_f32_16x16x32_bf16 v[28:31], v[76:79], a[116:119], v[28:31]
    ds_read_b64_tr_b16 v[70:71], v114 offset:512
    v_and_b32 v125, 0x200, v112
    v_lshlrev_b32 v125, 2, v125
    v_and_b32 v127, 0x180, v112
    s_waitcnt lgkmcnt(8)
    v_mfma_f32_16x16x32_bf16 v[0:3], v[80:83], a[120:123], v[0:3]
    ds_read_b64_tr_b16 v[72:73], v115 offset:0
    v_lshl_add_u32 v125, v127, 1, v125
    v_and_b32 v127, 0x70, v112
    v_add_u32 v125, v125, v127
    v_mfma_f32_16x16x32_bf16 v[4:7], v[80:83], a[124:127], v[4:7]
    ds_read_b64_tr_b16 v[74:75], v115 offset:512
    s_lshr_b32 s71, s2, 2
    s_lshl_b32 s71, s71, 15
    s_and_b32 s72, s2, 1
    v_mfma_f32_16x16x32_bf16 v[8:11], v[84:87], a[120:123], v[8:11]
    ds_read_b64_tr_b16 v[76:77], v116 offset:0
    s_lshl_b32 s72, s72, 7
    s_add_u32 s71, s71, s72
    s_and_b32 s72, s2, 2
    v_mfma_f32_16x16x32_bf16 v[12:15], v[84:87], a[124:127], v[12:15]
    ds_read_b64_tr_b16 v[78:79], v116 offset:512
    s_lshl_b32 s72, s72, 9
    s_add_u32 s71, s71, s72
    s_lshl_b32 s72, s3, 12
    s_waitcnt lgkmcnt(8)
    v_mfma_f32_16x16x32_bf16 v[16:19], v[88:91], a[120:123], v[16:19]
    ds_read_b64_tr_b16 v[80:81], v113 offset:4096
    s_add_u32 s71, s71, s72
    buffer_store_dwordx4 v[100:103], v125, s[8:11], s71 offen sc1
    v_mfma_f32_16x16x32_bf16 v[20:23], v[88:91], a[124:127], v[20:23]
    ds_read_b64_tr_b16 v[82:83], v113 offset:4608
    v_mfma_f32_16x16x32_bf16 v[24:27], v[92:95], a[120:123], v[24:27]
    ds_read_b64_tr_b16 v[84:85], v114 offset:4096
    v_mfma_f32_16x16x32_bf16 v[28:31], v[92:95], a[124:127], v[28:31]
    ds_read_b64_tr_b16 v[86:87], v114 offset:4608
    s_waitcnt lgkmcnt(8)
    v_mfma_f32_16x16x32_bf16 v[32:35], v[64:67], a[0:3], 0
    ds_read_b64_tr_b16 v[88:89], v115 offset:4096
    v_mfma_f32_16x16x32_bf16 v[36:39], v[64:67], a[4:7], 0
    ds_read_b64_tr_b16 v[90:91], v115 offset:4608
    v_mfma_f32_16x16x32_bf16 v[40:43], v[68:71], a[0:3], 0
    ds_read_b64_tr_b16 v[92:93], v116 offset:4096
    v_mfma_f32_16x16x32_bf16 v[44:47], v[68:71], a[4:7], 0
    ds_read_b64_tr_b16 v[94:95], v116 offset:4608
    s_waitcnt lgkmcnt(8)
    v_mfma_f32_16x16x32_bf16 v[48:51], v[72:75], a[0:3], 0
    ds_read_b64_tr_b16 v[64:65], v113 offset:8192
    v_mfma_f32_16x16x32_bf16 v[52:55], v[72:75], a[4:7], 0
    ds_read_b64_tr_b16 v[66:67], v113 offset:8704
    v_mfma_f32_16x16x32_bf16 v[56:59], v[76:79], a[0:3], 0
    ds_read_b64_tr_b16 v[68:69], v114 offset:8192
    v_mfma_f32_16x16x32_bf16 v[60:63], v[76:79], a[4:7], 0
    ds_read_b64_tr_b16 v[70:71], v114 offset:8704
    s_waitcnt lgkmcnt(8)
    v_mfma_f32_16x16x32_bf16 v[32:35], v[80:83], a[8:11], v[32:35]
    ds_read_b64_tr_b16 v[72:73], v115 offset:8192
    v_cvt_pk_bf16_f32 v96, v0, v1
    v_mfma_f32_16x16x32_bf16 v[36:39], v[80:83], a[12:15], v[36:39]
    ds_read_b64_tr_b16 v[74:75], v115 offset:8704
    v_cvt_pk_bf16_f32 v97, v2, v3
    v_mfma_f32_16x16x32_bf16 v[40:43], v[84:87], a[8:11], v[40:43]
    ds_read_b64_tr_b16 v[76:77], v116 offset:8192
    v_cvt_pk_bf16_f32 v98, v8, v9
    v_mfma_f32_16x16x32_bf16 v[44:47], v[84:87], a[12:15], v[44:47]
    ds_read_b64_tr_b16 v[78:79], v116 offset:8704
    v_cvt_pk_bf16_f32 v99, v10, v11
    s_waitcnt lgkmcnt(8)
    v_mfma_f32_16x16x32_bf16 v[48:51], v[88:91], a[8:11], v[48:51]
    ds_read_b64_tr_b16 v[80:81], v113 offset:12288
    v_mfma_f32_16x16x32_bf16 v[52:55], v[88:91], a[12:15], v[52:55]
    ds_read_b64_tr_b16 v[82:83], v113 offset:12800
    v_mfma_f32_16x16x32_bf16 v[56:59], v[92:95], a[8:11], v[56:59]
    ds_read_b64_tr_b16 v[84:85], v114 offset:12288
    buffer_store_dwordx4 v[96:99], v112, s[8:11], s55 offen offset:0 sc1
    v_mfma_f32_16x16x32_bf16 v[60:63], v[92:95], a[12:15], v[60:63]
    ds_read_b64_tr_b16 v[86:87], v114 offset:12800
    s_barrier
    s_waitcnt lgkmcnt(8)
    v_mfma_f32_16x16x32_bf16 v[32:35], v[64:67], a[16:19], v[32:35]
    ds_read_b64_tr_b16 v[88:89], v115 offset:12288
    s_add_u32 m0, s57, 57344
    v_mfma_f32_16x16x32_bf16 v[36:39], v[64:67], a[20:23], v[36:39]
    ds_read_b64_tr_b16 v[90:91], v115 offset:12800
    s_add_u32 s52, s95, 128
    v_mfma_f32_16x16x32_bf16 v[40:43], v[68:71], a[16:19], v[40:43]
    ds_read_b64_tr_b16 v[92:93], v116 offset:12288
    buffer_load_dwordx4 v117, s[12:15], s52 offen lds
    v_mfma_f32_16x16x32_bf16 v[44:47], v[68:71], a[20:23], v[44:47]
    ds_read_b64_tr_b16 v[94:95], v116 offset:12800
    s_add_u32 m0, s57, 0
    s_waitcnt lgkmcnt(8)
    v_mfma_f32_16x16x32_bf16 v[48:51], v[72:75], a[16:19], v[48:51]
    ds_read_b64_tr_b16 v[64:65], v113 offset:16384
    s_add_u32 s52, s88, 256
    v_mfma_f32_16x16x32_bf16 v[52:55], v[72:75], a[20:23], v[52:55]
    ds_read_b64_tr_b16 v[66:67], v113 offset:16896
    buffer_load_dwordx4 v117, s[12:15], s52 offen lds
    v_mfma_f32_16x16x32_bf16 v[56:59], v[76:79], a[16:19], v[56:59]
    ds_read_b64_tr_b16 v[68:69], v114 offset:16384
    v_mfma_f32_16x16x32_bf16 v[60:63], v[76:79], a[20:23], v[60:63]
    ds_read_b64_tr_b16 v[70:71], v114 offset:16896
    s_waitcnt lgkmcnt(8)
    v_mfma_f32_16x16x32_bf16 v[32:35], v[80:83], a[24:27], v[32:35]
    ds_read_b64_tr_b16 v[72:73], v115 offset:16384
    v_mfma_f32_16x16x32_bf16 v[36:39], v[80:83], a[28:31], v[36:39]
    ds_read_b64_tr_b16 v[74:75], v115 offset:16896
    v_mfma_f32_16x16x32_bf16 v[40:43], v[84:87], a[24:27], v[40:43]
    ds_read_b64_tr_b16 v[76:77], v116 offset:16384
    v_mfma_f32_16x16x32_bf16 v[44:47], v[84:87], a[28:31], v[44:47]
    ds_read_b64_tr_b16 v[78:79], v116 offset:16896
    s_waitcnt lgkmcnt(8)
    v_mfma_f32_16x16x32_bf16 v[48:51], v[88:91], a[24:27], v[48:51]
    ds_read_b64_tr_b16 v[80:81], v113 offset:20480
    v_mfma_f32_16x16x32_bf16 v[52:55], v[88:91], a[28:31], v[52:55]
    ds_read_b64_tr_b16 v[82:83], v113 offset:20992
    v_mfma_f32_16x16x32_bf16 v[56:59], v[92:95], a[24:27], v[56:59]
    ds_read_b64_tr_b16 v[84:85], v114 offset:20480
    v_mfma_f32_16x16x32_bf16 v[60:63], v[92:95], a[28:31], v[60:63]
    ds_read_b64_tr_b16 v[86:87], v114 offset:20992
    s_waitcnt lgkmcnt(8)
    v_mfma_f32_16x16x32_bf16 v[32:35], v[64:67], a[32:35], v[32:35]
    ds_read_b64_tr_b16 v[88:89], v115 offset:20480
    v_mfma_f32_16x16x32_bf16 v[36:39], v[64:67], a[36:39], v[36:39]
    ds_read_b64_tr_b16 v[90:91], v115 offset:20992
    v_mfma_f32_16x16x32_bf16 v[40:43], v[68:71], a[32:35], v[40:43]
    ds_read_b64_tr_b16 v[92:93], v116 offset:20480
    v_mfma_f32_16x16x32_bf16 v[44:47], v[68:71], a[36:39], v[44:47]
    ds_read_b64_tr_b16 v[94:95], v116 offset:20992
    s_waitcnt lgkmcnt(8)
    v_mfma_f32_16x16x32_bf16 v[48:51], v[72:75], a[32:35], v[48:51]
    ds_read_b64_tr_b16 v[64:65], v113 offset:24576
    v_cvt_pk_bf16_f32 v100, v4, v5
    v_mfma_f32_16x16x32_bf16 v[52:55], v[72:75], a[36:39], v[52:55]
    ds_read_b64_tr_b16 v[66:67], v113 offset:25088
    v_cvt_pk_bf16_f32 v101, v6, v7
    v_mfma_f32_16x16x32_bf16 v[56:59], v[76:79], a[32:35], v[56:59]
    ds_read_b64_tr_b16 v[68:69], v114 offset:24576
    v_cvt_pk_bf16_f32 v102, v12, v13
    v_mfma_f32_16x16x32_bf16 v[60:63], v[76:79], a[36:39], v[60:63]
    ds_read_b64_tr_b16 v[70:71], v114 offset:25088
    v_cvt_pk_bf16_f32 v103, v14, v15
    s_waitcnt lgkmcnt(8)
    v_mfma_f32_16x16x32_bf16 v[32:35], v[80:83], a[40:43], v[32:35]
    ds_read_b64_tr_b16 v[72:73], v115 offset:24576
    v_mfma_f32_16x16x32_bf16 v[36:39], v[80:83], a[44:47], v[36:39]
    ds_read_b64_tr_b16 v[74:75], v115 offset:25088
    v_mfma_f32_16x16x32_bf16 v[40:43], v[84:87], a[40:43], v[40:43]
    ds_read_b64_tr_b16 v[76:77], v116 offset:24576
    buffer_store_dwordx4 v[100:103], v112, s[8:11], s55 offen offset:1024 sc1
    v_mfma_f32_16x16x32_bf16 v[44:47], v[84:87], a[44:47], v[44:47]
    ds_read_b64_tr_b16 v[78:79], v116 offset:25088
    s_waitcnt lgkmcnt(8)
    v_mfma_f32_16x16x32_bf16 v[48:51], v[88:91], a[40:43], v[48:51]
    ds_read_b64_tr_b16 v[80:81], v113 offset:28672
    v_mfma_f32_16x16x32_bf16 v[52:55], v[88:91], a[44:47], v[52:55]
    ds_read_b64_tr_b16 v[82:83], v113 offset:29184
    v_mfma_f32_16x16x32_bf16 v[56:59], v[92:95], a[40:43], v[56:59]
    ds_read_b64_tr_b16 v[84:85], v114 offset:28672
    v_mfma_f32_16x16x32_bf16 v[60:63], v[92:95], a[44:47], v[60:63]
    ds_read_b64_tr_b16 v[86:87], v114 offset:29184
    s_waitcnt vmcnt(4)
    s_barrier
    s_cmp_lg_u32 s3, 0
    s_cbranch_scc1 SG_1
    v_mov_b32 v127, 1
    buffer_atomic_add v127, v123, s[48:51], 0 offen offset:0 sc1
SG_1:
    s_waitcnt lgkmcnt(8)
    v_mfma_f32_16x16x32_bf16 v[32:35], v[64:67], a[48:51], v[32:35]
    ds_read_b64_tr_b16 v[88:89], v115 offset:28672
    s_add_u32 m0, s57, 8192
    v_mfma_f32_16x16x32_bf16 v[36:39], v[64:67], a[52:55], v[36:39]
    ds_read_b64_tr_b16 v[90:91], v115 offset:29184
    s_add_u32 s52, s89, 256
    v_mfma_f32_16x16x32_bf16 v[40:43], v[68:71], a[48:51], v[40:43]
    ds_read_b64_tr_b16 v[92:93], v116 offset:28672
    buffer_load_dwordx4 v117, s[12:15], s52 offen lds
    v_mfma_f32_16x16x32_bf16 v[44:47], v[68:71], a[52:55], v[44:47]
    ds_read_b64_tr_b16 v[94:95], v116 offset:29184
    s_add_u32 m0, s57, 16384
    s_waitcnt lgkmcnt(8)
    v_mfma_f32_16x16x32_bf16 v[48:51], v[72:75], a[48:51], v[48:51]
    ds_read_b64_tr_b16 v[64:65], v113 offset:32768
    s_add_u32 s52, s90, 256
    v_mfma_f32_16x16x32_bf16 v[52:55], v[72:75], a[52:55], v[52:55]
    ds_read_b64_tr_b16 v[66:67], v113 offset:33280
    buffer_load_dwordx4 v117, s[12:15], s52 offen lds
    v_mfma_f32_16x16x32_bf16 v[56:59], v[76:79], a[48:51], v[56:59]
    ds_read_b64_tr_b16 v[68:69], v114 offset:32768
    v_mfma_f32_16x16x32_bf16 v[60:63], v[76:79], a[52:55], v[60:63]
    ds_read_b64_tr_b16 v[70:71], v114 offset:33280
    s_waitcnt lgkmcnt(8)
    v_mfma_f32_16x16x32_bf16 v[32:35], v[80:83], a[56:59], v[32:35]
    ds_read_b64_tr_b16 v[72:73], v115 offset:32768
    v_mfma_f32_16x16x32_bf16 v[36:39], v[80:83], a[60:63], v[36:39]
    ds_read_b64_tr_b16 v[74:75], v115 offset:33280
    v_mfma_f32_16x16x32_bf16 v[40:43], v[84:87], a[56:59], v[40:43]
    ds_read_b64_tr_b16 v[76:77], v116 offset:32768
    v_mfma_f32_16x16x32_bf16 v[44:47], v[84:87], a[60:63], v[44:47]
    ds_read_b64_tr_b16 v[78:79], v116 offset:33280
    s_waitcnt lgkmcnt(8)
    v_mfma_f32_16x16x32_bf16 v[48:51], v[88:91], a[56:59], v[48:51]
    ds_read_b64_tr_b16 v[80:81], v113 offset:36864
    v_mfma_f32_16x16x32_bf16 v[52:55], v[88:91], a[60:63], v[52:55]
    ds_read_b64_tr_b16 v[82:83], v113 offset:37376
    v_mfma_f32_16x16x32_bf16 v[56:59], v[92:95], a[56:59], v[56:59]
    ds_read_b64_tr_b16 v[84:85], v114 offset:36864
    v_mfma_f32_16x16x32_bf16 v[60:63], v[92:95], a[60:63], v[60:63]
    ds_read_b64_tr_b16 v[86:87], v114 offset:37376
    s_waitcnt lgkmcnt(8)
    v_mfma_f32_16x16x32_bf16 v[32:35], v[64:67], a[64:67], v[32:35]
    ds_read_b64_tr_b16 v[88:89], v115 offset:36864
    v_cvt_pk_bf16_f32 v104, v16, v17
    v_mfma_f32_16x16x32_bf16 v[36:39], v[64:67], a[68:71], v[36:39]
    ds_read_b64_tr_b16 v[90:91], v115 offset:37376
    v_cvt_pk_bf16_f32 v105, v18, v19
    v_mfma_f32_16x16x32_bf16 v[40:43], v[68:71], a[64:67], v[40:43]
    ds_read_b64_tr_b16 v[92:93], v116 offset:36864
    v_cvt_pk_bf16_f32 v106, v24, v25
    v_mfma_f32_16x16x32_bf16 v[44:47], v[68:71], a[68:71], v[44:47]
    ds_read_b64_tr_b16 v[94:95], v116 offset:37376
    v_cvt_pk_bf16_f32 v107, v26, v27
    s_waitcnt lgkmcnt(8)
    v_mfma_f32_16x16x32_bf16 v[48:51], v[72:75], a[64:67], v[48:51]
    ds_read_b64_tr_b16 v[64:65], v113 offset:40960
    v_mfma_f32_16x16x32_bf16 v[52:55], v[72:75], a[68:71], v[52:55]
    ds_read_b64_tr_b16 v[66:67], v113 offset:41472
    v_mfma_f32_16x16x32_bf16 v[56:59], v[76:79], a[64:67], v[56:59]
    ds_read_b64_tr_b16 v[68:69], v114 offset:40960
    buffer_store_dwordx4 v[104:107], v112, s[8:11], s55 offen offset:2048 sc1
    v_mfma_f32_16x16x32_bf16 v[60:63], v[76:79], a[68:71], v[60:63]
    ds_read_b64_tr_b16 v[70:71], v114 offset:41472
    s_waitcnt lgkmcnt(8)
    v_mfma_f32_16x16x32_bf16 v[32:35], v[80:83], a[72:75], v[32:35]
    ds_read_b64_tr_b16 v[72:73], v115 offset:40960
    v_mfma_f32_16x16x32_bf16 v[36:39], v[80:83], a[76:79], v[36:39]
    ds_read_b64_tr_b16 v[74:75], v115 offset:41472
    v_mfma_f32_16x16x32_bf16 v[40:43], v[84:87], a[72:75], v[40:43]
    ds_read_b64_tr_b16 v[76:77], v116 offset:40960
    v_mfma_f32_16x16x32_bf16 v[44:47], v[84:87], a[76:79], v[44:47]
    ds_read_b64_tr_b16 v[78:79], v116 offset:41472
    s_waitcnt lgkmcnt(8)
    v_mfma_f32_16x16x32_bf16 v[48:51], v[88:91], a[72:75], v[48:51]
    ds_read_b64_tr_b16 v[80:81], v113 offset:45056
    v_mfma_f32_16x16x32_bf16 v[52:55], v[88:91], a[76:79], v[52:55]
    ds_read_b64_tr_b16 v[82:83], v113 offset:45568
    v_mfma_f32_16x16x32_bf16 v[56:59], v[92:95], a[72:75], v[56:59]
    ds_read_b64_tr_b16 v[84:85], v114 offset:45056
    v_mfma_f32_16x16x32_bf16 v[60:63], v[92:95], a[76:79], v[60:63]
    ds_read_b64_tr_b16 v[86:87], v114 offset:45568
    s_waitcnt vmcnt(5)
    s_barrier
    s_waitcnt lgkmcnt(8)
    v_mfma_f32_16x16x32_bf16 v[32:35], v[64:67], a[80:83], v[32:35]
    ds_read_b64_tr_b16 v[88:89], v115 offset:45056
    s_add_u32 m0, s57, 24576
    v_mfma_f32_16x16x32_bf16 v[36:39], v[64:67], a[84:87], v[36:39]
    ds_read_b64_tr_b16 v[90:91], v115 offset:45568
    s_add_u32 s52, s91, 256
    v_mfma_f32_16x16x32_bf16 v[40:43], v[68:71], a[80:83], v[40:43]
    ds_read_b64_tr_b16 v[92:93], v116 offset:45056
    buffer_load_dwordx4 v117, s[12:15], s52 offen lds
    v_mfma_f32_16x16x32_bf16 v[44:47], v[68:71], a[84:87], v[44:47]
    ds_read_b64_tr_b16 v[94:95], v116 offset:45568
    s_add_u32 m0, s57, 32768
    s_waitcnt lgkmcnt(8)
    v_mfma_f32_16x16x32_bf16 v[48:51], v[72:75], a[80:83], v[48:51]
    ds_read_b64_tr_b16 v[64:65], v113 offset:49152
    s_add_u32 s52, s92, 256
    v_mfma_f32_16x16x32_bf16 v[52:55], v[72:75], a[84:87], v[52:55]
    ds_read_b64_tr_b16 v[66:67], v113 offset:49664
    buffer_load_dwordx4 v117, s[12:15], s52 offen lds
    v_mfma_f32_16x16x32_bf16 v[56:59], v[76:79], a[80:83], v[56:59]
    ds_read_b64_tr_b16 v[68:69], v114 offset:49152
    v_mfma_f32_16x16x32_bf16 v[60:63], v[76:79], a[84:87], v[60:63]
    ds_read_b64_tr_b16 v[70:71], v114 offset:49664
    s_waitcnt lgkmcnt(8)
    v_mfma_f32_16x16x32_bf16 v[32:35], v[80:83], a[88:91], v[32:35]
    ds_read_b64_tr_b16 v[72:73], v115 offset:49152
    v_mfma_f32_16x16x32_bf16 v[36:39], v[80:83], a[92:95], v[36:39]
    ds_read_b64_tr_b16 v[74:75], v115 offset:49664
    v_mfma_f32_16x16x32_bf16 v[40:43], v[84:87], a[88:91], v[40:43]
    ds_read_b64_tr_b16 v[76:77], v116 offset:49152
    v_mfma_f32_16x16x32_bf16 v[44:47], v[84:87], a[92:95], v[44:47]
    ds_read_b64_tr_b16 v[78:79], v116 offset:49664
    s_waitcnt lgkmcnt(8)
    v_mfma_f32_16x16x32_bf16 v[48:51], v[88:91], a[88:91], v[48:51]
    ds_read_b64_tr_b16 v[80:81], v113 offset:53248
    v_cvt_pk_bf16_f32 v108, v20, v21
    v_mfma_f32_16x16x32_bf16 v[52:55], v[88:91], a[92:95], v[52:55]
    ds_read_b64_tr_b16 v[82:83], v113 offset:53760
    v_cvt_pk_bf16_f32 v109, v22, v23
    v_mfma_f32_16x16x32_bf16 v[56:59], v[92:95], a[88:91], v[56:59]
    ds_read_b64_tr_b16 v[84:85], v114 offset:53248
    v_cvt_pk_bf16_f32 v110, v28, v29
    v_mfma_f32_16x16x32_bf16 v[60:63], v[92:95], a[92:95], v[60:63]
    ds_read_b64_tr_b16 v[86:87], v114 offset:53760
    v_cvt_pk_bf16_f32 v111, v30, v31
    s_waitcnt lgkmcnt(8)
    v_mfma_f32_16x16x32_bf16 v[32:35], v[64:67], a[96:99], v[32:35]
    ds_read_b64_tr_b16 v[88:89], v115 offset:53248
    v_mfma_f32_16x16x32_bf16 v[36:39], v[64:67], a[100:103], v[36:39]
    ds_read_b64_tr_b16 v[90:91], v115 offset:53760
    v_mfma_f32_16x16x32_bf16 v[40:43], v[68:71], a[96:99], v[40:43]
    ds_read_b64_tr_b16 v[92:93], v116 offset:53248
    buffer_store_dwordx4 v[108:111], v112, s[8:11], s55 offen offset:3072 sc1
    v_mfma_f32_16x16x32_bf16 v[44:47], v[68:71], a[100:103], v[44:47]
    ds_read_b64_tr_b16 v[94:95], v116 offset:53760
    s_waitcnt lgkmcnt(8)
    v_mfma_f32_16x16x32_bf16 v[48:51], v[72:75], a[96:99], v[48:51]
    ds_read_b64_tr_b16 v[64:65], v113 offset:57344
    v_mfma_f32_16x16x32_bf16 v[52:55], v[72:75], a[100:103], v[52:55]
    ds_read_b64_tr_b16 v[66:67], v113 offset:57856
    v_mfma_f32_16x16x32_bf16 v[56:59], v[76:79], a[96:99], v[56:59]
    ds_read_b64_tr_b16 v[68:69], v114 offset:57344
    v_mfma_f32_16x16x32_bf16 v[60:63], v[76:79], a[100:103], v[60:63]
    ds_read_b64_tr_b16 v[70:71], v114 offset:57856
    s_waitcnt lgkmcnt(8)
    v_mfma_f32_16x16x32_bf16 v[32:35], v[80:83], a[104:107], v[32:35]
    ds_read_b64_tr_b16 v[72:73], v115 offset:57344
    v_mfma_f32_16x16x32_bf16 v[36:39], v[80:83], a[108:111], v[36:39]
    ds_read_b64_tr_b16 v[74:75], v115 offset:57856
    v_mfma_f32_16x16x32_bf16 v[40:43], v[84:87], a[104:107], v[40:43]
    ds_read_b64_tr_b16 v[76:77], v116 offset:57344
    v_mfma_f32_16x16x32_bf16 v[44:47], v[84:87], a[108:111], v[44:47]
    ds_read_b64_tr_b16 v[78:79], v116 offset:57856
    s_waitcnt lgkmcnt(8)
    v_mfma_f32_16x16x32_bf16 v[48:51], v[88:91], a[104:107], v[48:51]
    ds_read_b64_tr_b16 v[80:81], v113 offset:61440
    v_mfma_f32_16x16x32_bf16 v[52:55], v[88:91], a[108:111], v[52:55]
    ds_read_b64_tr_b16 v[82:83], v113 offset:61952
    v_mfma_f32_16x16x32_bf16 v[56:59], v[92:95], a[104:107], v[56:59]
    ds_read_b64_tr_b16 v[84:85], v114 offset:61440
    v_mfma_f32_16x16x32_bf16 v[60:63], v[92:95], a[108:111], v[60:63]
    ds_read_b64_tr_b16 v[86:87], v114 offset:61952
    s_waitcnt vmcnt(5)
    s_barrier
    s_waitcnt lgkmcnt(8)
    v_mfma_f32_16x16x32_bf16 v[32:35], v[64:67], a[112:115], v[32:35]
    ds_read_b64_tr_b16 v[88:89], v115 offset:61440
    s_add_u32 m0, s57, 40960
    v_mfma_f32_16x16x32_bf16 v[36:39], v[64:67], a[116:119], v[36:39]
    ds_read_b64_tr_b16 v[90:91], v115 offset:61952
    s_add_u32 s52, s93, 256
    v_mfma_f32_16x16x32_bf16 v[40:43], v[68:71], a[112:115], v[40:43]
    ds_read_b64_tr_b16 v[92:93], v116 offset:61440
    buffer_load_dwordx4 v117, s[12:15], s52 offen lds
    v_mfma_f32_16x16x32_bf16 v[44:47], v[68:71], a[116:119], v[44:47]
    ds_read_b64_tr_b16 v[94:95], v116 offset:61952
    s_add_u32 m0, s57, 49152
    s_waitcnt lgkmcnt(8)
    v_mfma_f32_16x16x32_bf16 v[48:51], v[72:75], a[112:115], v[48:51]
    ds_read_b64_tr_b16 v[64:65], v113 offset:0
    s_add_u32 s52, s94, 256
    v_mfma_f32_16x16x32_bf16 v[52:55], v[72:75], a[116:119], v[52:55]
    ds_read_b64_tr_b16 v[66:67], v113 offset:512
    buffer_load_dwordx4 v117, s[12:15], s52 offen lds
    v_mfma_f32_16x16x32_bf16 v[56:59], v[76:79], a[112:115], v[56:59]
    ds_read_b64_tr_b16 v[68:69], v114 offset:0
    v_mfma_f32_16x16x32_bf16 v[60:63], v[76:79], a[116:119], v[60:63]
    ds_read_b64_tr_b16 v[70:71], v114 offset:512
    s_waitcnt lgkmcnt(8)
    v_mfma_f32_16x16x32_bf16 v[32:35], v[80:83], a[120:123], v[32:35]
    ds_read_b64_tr_b16 v[72:73], v115 offset:0
    v_mfma_f32_16x16x32_bf16 v[36:39], v[80:83], a[124:127], v[36:39]
    ds_read_b64_tr_b16 v[74:75], v115 offset:512
    v_mfma_f32_16x16x32_bf16 v[40:43], v[84:87], a[120:123], v[40:43]
    ds_read_b64_tr_b16 v[76:77], v116 offset:0
    s_add_u32 s55, s55, 0x80000
    v_mfma_f32_16x16x32_bf16 v[44:47], v[84:87], a[124:127], v[44:47]
    ds_read_b64_tr_b16 v[78:79], v116 offset:512
    s_waitcnt lgkmcnt(8)
    v_mfma_f32_16x16x32_bf16 v[48:51], v[88:91], a[120:123], v[48:51]
    ds_read_b64_tr_b16 v[80:81], v113 offset:4096
    v_mfma_f32_16x16x32_bf16 v[52:55], v[88:91], a[124:127], v[52:55]
    ds_read_b64_tr_b16 v[82:83], v113 offset:4608
    v_mfma_f32_16x16x32_bf16 v[56:59], v[92:95], a[120:123], v[56:59]
    ds_read_b64_tr_b16 v[84:85], v114 offset:4096
    v_mfma_f32_16x16x32_bf16 v[60:63], v[92:95], a[124:127], v[60:63]
    ds_read_b64_tr_b16 v[86:87], v114 offset:4608
    s_waitcnt lgkmcnt(8)
    v_mfma_f32_16x16x32_bf16 v[0:3], v[64:67], a[0:3], 0
    ds_read_b64_tr_b16 v[88:89], v115 offset:4096
    v_mfma_f32_16x16x32_bf16 v[4:7], v[64:67], a[4:7], 0
    ds_read_b64_tr_b16 v[90:91], v115 offset:4608
    v_mfma_f32_16x16x32_bf16 v[8:11], v[68:71], a[0:3], 0
    ds_read_b64_tr_b16 v[92:93], v116 offset:4096
    v_mfma_f32_16x16x32_bf16 v[12:15], v[68:71], a[4:7], 0
    ds_read_b64_tr_b16 v[94:95], v116 offset:4608
    s_waitcnt lgkmcnt(8)
    v_mfma_f32_16x16x32_bf16 v[16:19], v[72:75], a[0:3], 0
    ds_read_b64_tr_b16 v[64:65], v113 offset:8192
    v_mfma_f32_16x16x32_bf16 v[20:23], v[72:75], a[4:7], 0
    ds_read_b64_tr_b16 v[66:67], v113 offset:8704
    v_mfma_f32_16x16x32_bf16 v[24:27], v[76:79], a[0:3], 0
    ds_read_b64_tr_b16 v[68:69], v114 offset:8192
    v_mfma_f32_16x16x32_bf16 v[28:31], v[76:79], a[4:7], 0
    ds_read_b64_tr_b16 v[70:71], v114 offset:8704
    s_waitcnt lgkmcnt(8)
    v_mfma_f32_16x16x32_bf16 v[0:3], v[80:83], a[8:11], v[0:3]
    ds_read_b64_tr_b16 v[72:73], v115 offset:8192
    v_cvt_pk_bf16_f32 v96, v32, v33
    v_mfma_f32_16x16x32_bf16 v[4:7], v[80:83], a[12:15], v[4:7]
    ds_read_b64_tr_b16 v[74:75], v115 offset:8704
    v_cvt_pk_bf16_f32 v97, v34, v35
    v_mfma_f32_16x16x32_bf16 v[8:11], v[84:87], a[8:11], v[8:11]
    ds_read_b64_tr_b16 v[76:77], v116 offset:8192
    v_cvt_pk_bf16_f32 v98, v40, v41
    v_mfma_f32_16x16x32_bf16 v[12:15], v[84:87], a[12:15], v[12:15]
    ds_read_b64_tr_b16 v[78:79], v116 offset:8704
    v_cvt_pk_bf16_f32 v99, v42, v43
    s_waitcnt lgkmcnt(8)
    v_mfma_f32_16x16x32_bf16 v[16:19], v[88:91], a[8:11], v[16:19]
    ds_read_b64_tr_b16 v[80:81], v113 offset:12288
    v_mfma_f32_16x16x32_bf16 v[20:23], v[88:91], a[12:15], v[20:23]
    ds_read_b64_tr_b16 v[82:83], v113 offset:12800
    v_mfma_f32_16x16x32_bf16 v[24:27], v[92:95], a[8:11], v[24:27]
    ds_read_b64_tr_b16 v[84:85], v114 offset:12288
    buffer_store_dwordx4 v[96:99], v112, s[8:11], s56 offen offset:0 sc1
    v_mfma_f32_16x16x32_bf16 v[28:31], v[92:95], a[12:15], v[28:31]
    ds_read_b64_tr_b16 v[86:87], v114 offset:12800
    s_waitcnt vmcnt(5)
    s_barrier
    s_waitcnt lgkmcnt(8)
    v_mfma_f32_16x16x32_bf16 v[0:3], v[64:67], a[16:19], v[0:3]
    ds_read_b64_tr_b16 v[88:89], v115 offset:12288
    s_add_u32 m0, s57, 57344
    v_mfma_f32_16x16x32_bf16 v[4:7], v[64:67], a[20:23], v[4:7]
    ds_read_b64_tr_b16 v[90:91], v115 offset:12800
    s_add_u32 s52, s95, 256
    v_mfma_f32_16x16x32_bf16 v[8:11], v[68:71], a[16:19], v[8:11]
    ds_read_b64_tr_b16 v[92:93], v116 offset:12288
    buffer_load_dwordx4 v117, s[12:15], s52 offen lds
    v_mfma_f32_16x16x32_bf16 v[12:15], v[68:71], a[20:23], v[12:15]
    ds_read_b64_tr_b16 v[94:95], v116 offset:12800
    s_add_u32 m0, s57, 0
    s_waitcnt lgkmcnt(8)
    v_mfma_f32_16x16x32_bf16 v[16:19], v[72:75], a[16:19], v[16:19]
    ds_read_b64_tr_b16 v[64:65], v113 offset:16384
    s_add_u32 s52, s88, 384
    v_mfma_f32_16x16x32_bf16 v[20:23], v[72:75], a[20:23], v[20:23]
    ds_read_b64_tr_b16 v[66:67], v113 offset:16896
    buffer_load_dwordx4 v117, s[12:15], s52 offen lds
    v_mfma_f32_16x16x32_bf16 v[24:27], v[76:79], a[16:19], v[24:27]
    ds_read_b64_tr_b16 v[68:69], v114 offset:16384
    v_mfma_f32_16x16x32_bf16 v[28:31], v[76:79], a[20:23], v[28:31]
    ds_read_b64_tr_b16 v[70:71], v114 offset:16896
    s_waitcnt lgkmcnt(8)
    v_mfma_f32_16x16x32_bf16 v[0:3], v[80:83], a[24:27], v[0:3]
    ds_read_b64_tr_b16 v[72:73], v115 offset:16384
    v_mfma_f32_16x16x32_bf16 v[4:7], v[80:83], a[28:31], v[4:7]
    ds_read_b64_tr_b16 v[74:75], v115 offset:16896
    v_mfma_f32_16x16x32_bf16 v[8:11], v[84:87], a[24:27], v[8:11]
    ds_read_b64_tr_b16 v[76:77], v116 offset:16384
    v_mfma_f32_16x16x32_bf16 v[12:15], v[84:87], a[28:31], v[12:15]
    ds_read_b64_tr_b16 v[78:79], v116 offset:16896
    s_waitcnt lgkmcnt(8)
    v_mfma_f32_16x16x32_bf16 v[16:19], v[88:91], a[24:27], v[16:19]
    ds_read_b64_tr_b16 v[80:81], v113 offset:20480
    v_mfma_f32_16x16x32_bf16 v[20:23], v[88:91], a[28:31], v[20:23]
    ds_read_b64_tr_b16 v[82:83], v113 offset:20992
    v_mfma_f32_16x16x32_bf16 v[24:27], v[92:95], a[24:27], v[24:27]
    ds_read_b64_tr_b16 v[84:85], v114 offset:20480
    v_mfma_f32_16x16x32_bf16 v[28:31], v[92:95], a[28:31], v[28:31]
    ds_read_b64_tr_b16 v[86:87], v114 offset:20992
    s_waitcnt lgkmcnt(8)
    v_mfma_f32_16x16x32_bf16 v[0:3], v[64:67], a[32:35], v[0:3]
    ds_read_b64_tr_b16 v[88:89], v115 offset:20480
    v_mfma_f32_16x16x32_bf16 v[4:7], v[64:67], a[36:39], v[4:7]
    ds_read_b64_tr_b16 v[90:91], v115 offset:20992
    v_mfma_f32_16x16x32_bf16 v[8:11], v[68:71], a[32:35], v[8:11]
    ds_read_b64_tr_b16 v[92:93], v116 offset:20480
    v_mfma_f32_16x16x32_bf16 v[12:15], v[68:71], a[36:39], v[12:15]
    ds_read_b64_tr_b16 v[94:95], v116 offset:20992
    s_waitcnt lgkmcnt(8)
    v_mfma_f32_16x16x32_bf16 v[16:19], v[72:75], a[32:35], v[16:19]
    ds_read_b64_tr_b16 v[64:65], v113 offset:24576
    v_cvt_pk_bf16_f32 v100, v36, v37
    v_mfma_f32_16x16x32_bf16 v[20:23], v[72:75], a[36:39], v[20:23]
    ds_read_b64_tr_b16 v[66:67], v113 offset:25088
    v_cvt_pk_bf16_f32 v101, v38, v39
    v_mfma_f32_16x16x32_bf16 v[24:27], v[76:79], a[32:35], v[24:27]
    ds_read_b64_tr_b16 v[68:69], v114 offset:24576
    v_cvt_pk_bf16_f32 v102, v44, v45
    v_mfma_f32_16x16x32_bf16 v[28:31], v[76:79], a[36:39], v[28:31]
    ds_read_b64_tr_b16 v[70:71], v114 offset:25088
    v_cvt_pk_bf16_f32 v103, v46, v47
    s_waitcnt lgkmcnt(8)
    v_mfma_f32_16x16x32_bf16 v[0:3], v[80:83], a[40:43], v[0:3]
    ds_read_b64_tr_b16 v[72:73], v115 offset:24576
    v_mfma_f32_16x16x32_bf16 v[4:7], v[80:83], a[44:47], v[4:7]
    ds_read_b64_tr_b16 v[74:75], v115 offset:25088
    v_mfma_f32_16x16x32_bf16 v[8:11], v[84:87], a[40:43], v[8:11]
    ds_read_b64_tr_b16 v[76:77], v116 offset:24576
    buffer_store_dwordx4 v[100:103], v112, s[8:11], s56 offen offset:1024 sc1
    v_mfma_f32_16x16x32_bf16 v[12:15], v[84:87], a[44:47], v[12:15]
    ds_read_b64_tr_b16 v[78:79], v116 offset:25088
    s_waitcnt lgkmcnt(8)
    v_mfma_f32_16x16x32_bf16 v[16:19], v[88:91], a[40:43], v[16:19]
    ds_read_b64_tr_b16 v[80:81], v113 offset:28672
    v_mfma_f32_16x16x32_bf16 v[20:23], v[88:91], a[44:47], v[20:23]
    ds_read_b64_tr_b16 v[82:83], v113 offset:29184
    v_mfma_f32_16x16x32_bf16 v[24:27], v[92:95], a[40:43], v[24:27]
    ds_read_b64_tr_b16 v[84:85], v114 offset:28672
    v_mfma_f32_16x16x32_bf16 v[28:31], v[92:95], a[44:47], v[28:31]
    ds_read_b64_tr_b16 v[86:87], v114 offset:29184
    s_waitcnt vmcnt(5)
    s_barrier
    s_waitcnt lgkmcnt(8)
    v_mfma_f32_16x16x32_bf16 v[0:3], v[64:67], a[48:51], v[0:3]
    ds_read_b64_tr_b16 v[88:89], v115 offset:28672
    s_add_u32 m0, s57, 8192
    v_mfma_f32_16x16x32_bf16 v[4:7], v[64:67], a[52:55], v[4:7]
    ds_read_b64_tr_b16 v[90:91], v115 offset:29184
    s_add_u32 s52, s89, 384
    v_mfma_f32_16x16x32_bf16 v[8:11], v[68:71], a[48:51], v[8:11]
    ds_read_b64_tr_b16 v[92:93], v116 offset:28672
    buffer_load_dwordx4 v117, s[12:15], s52 offen lds
    v_mfma_f32_16x16x32_bf16 v[12:15], v[68:71], a[52:55], v[12:15]
    ds_read_b64_tr_b16 v[94:95], v116 offset:29184
    s_add_u32 m0, s57, 16384
    s_waitcnt lgkmcnt(8)
    v_mfma_f32_16x16x32_bf16 v[16:19], v[72:75], a[48:51], v[16:19]
    ds_read_b64_tr_b16 v[64:65], v113 offset:32768
    s_add_u32 s52, s90, 384
    v_mfma_f32_16x16x32_bf16 v[20:23], v[72:75], a[52:55], v[20:23]
    ds_read_b64_tr_b16 v[66:67], v113 offset:33280
    buffer_load_dwordx4 v117, s[12:15], s52 offen lds
    v_mfma_f32_16x16x32_bf16 v[24:27], v[76:79], a[48:51], v[24:27]
    ds_read_b64_tr_b16 v[68:69], v114 offset:32768
    s_add_u32 m0, s57, 65536
    v_mfma_f32_16x16x32_bf16 v[28:31], v[76:79], a[52:55], v[28:31]
    ds_read_b64_tr_b16 v[70:71], v114 offset:33280
    s_add_u32 s52, s96, 0
    s_waitcnt lgkmcnt(8)
    v_mfma_f32_16x16x32_bf16 v[0:3], v[80:83], a[56:59], v[0:3]
    ds_read_b64_tr_b16 v[72:73], v115 offset:32768
    s_and_b32 s52, s52, 7
    v_mfma_f32_16x16x32_bf16 v[4:7], v[80:83], a[60:63], v[4:7]
    ds_read_b64_tr_b16 v[74:75], v115 offset:33280
    s_mul_i32 s52, s52, 229376
    v_mfma_f32_16x16x32_bf16 v[8:11], v[84:87], a[56:59], v[8:11]
    ds_read_b64_tr_b16 v[76:77], v116 offset:32768
    s_add_u32 s52, s52, s64
    v_mfma_f32_16x16x32_bf16 v[12:15], v[84:87], a[60:63], v[12:15]
    ds_read_b64_tr_b16 v[78:79], v116 offset:33280
    buffer_load_dwordx4 v118, s[28:31], s52 offen lds
    s_waitcnt lgkmcnt(8)
    v_mfma_f32_16x16x32_bf16 v[16:19], v[88:91], a[56:59], v[16:19]
    ds_read_b64_tr_b16 v[80:81], v113 offset:36864
    s_add_u32 m0, s57, 73728
    v_mfma_f32_16x16x32_bf16 v[20:23], v[88:91], a[60:63], v[20:23]
    ds_read_b64_tr_b16 v[82:83], v113 offset:37376
    s_nop 0
    v_mfma_f32_16x16x32_bf16 v[24:27], v[92:95], a[56:59], v[24:27]
    ds_read_b64_tr_b16 v[84:85], v114 offset:36864
    buffer_load_dwordx4 v118, s[32:35], s52 offen offset:0 lds
    v_mfma_f32_16x16x32_bf16 v[28:31], v[92:95], a[60:63], v[28:31]
    ds_read_b64_tr_b16 v[86:87], v114 offset:37376
    s_waitcnt lgkmcnt(8)
    v_mfma_f32_16x16x32_bf16 v[0:3], v[64:67], a[64:67], v[0:3]
    ds_read_b64_tr_b16 v[88:89], v115 offset:36864
    v_cvt_pk_bf16_f32 v104, v48, v49
    v_mfma_f32_16x16x32_bf16 v[4:7], v[64:67], a[68:71], v[4:7]
    ds_read_b64_tr_b16 v[90:91], v115 offset:37376
    v_cvt_pk_bf16_f32 v105, v50, v51
    v_mfma_f32_16x16x32_bf16 v[8:11], v[68:71], a[64:67], v[8:11]
    ds_read_b64_tr_b16 v[92:93], v116 offset:36864
    v_cvt_pk_bf16_f32 v106, v56, v57
    v_mfma_f32_16x16x32_bf16 v[12:15], v[68:71], a[68:71], v[12:15]
    ds_read_b64_tr_b16 v[94:95], v116 offset:37376
    v_cvt_pk_bf16_f32 v107, v58, v59
    s_waitcnt lgkmcnt(8)
    v_mfma_f32_16x16x32_bf16 v[16:19], v[72:75], a[64:67], v[16:19]
    ds_read_b64_tr_b16 v[64:65], v113 offset:40960
    v_mfma_f32_16x16x32_bf16 v[20:23], v[72:75], a[68:71], v[20:23]
    ds_read_b64_tr_b16 v[66:67], v113 offset:41472
    v_mfma_f32_16x16x32_bf16 v[24:27], v[76:79], a[64:67], v[24:27]
    ds_read_b64_tr_b16 v[68:69], v114 offset:40960
    buffer_store_dwordx4 v[104:107], v112, s[8:11], s56 offen offset:2048 sc1
    v_mfma_f32_16x16x32_bf16 v[28:31], v[76:79], a[68:71], v[28:31]
    ds_read_b64_tr_b16 v[70:71], v114 offset:41472
    s_waitcnt lgkmcnt(8)
    v_mfma_f32_16x16x32_bf16 v[0:3], v[80:83], a[72:75], v[0:3]
    ds_read_b64_tr_b16 v[72:73], v115 offset:40960
    v_mfma_f32_16x16x32_bf16 v[4:7], v[80:83], a[76:79], v[4:7]
    ds_read_b64_tr_b16 v[74:75], v115 offset:41472
    v_mfma_f32_16x16x32_bf16 v[8:11], v[84:87], a[72:75], v[8:11]
    ds_read_b64_tr_b16 v[76:77], v116 offset:40960
    v_mfma_f32_16x16x32_bf16 v[12:15], v[84:87], a[76:79], v[12:15]
    ds_read_b64_tr_b16 v[78:79], v116 offset:41472
    s_waitcnt lgkmcnt(8)
    v_mfma_f32_16x16x32_bf16 v[16:19], v[88:91], a[72:75], v[16:19]
    ds_read_b64_tr_b16 v[80:81], v113 offset:45056
    v_mfma_f32_16x16x32_bf16 v[20:23], v[88:91], a[76:79], v[20:23]
    ds_read_b64_tr_b16 v[82:83], v113 offset:45568
    v_mfma_f32_16x16x32_bf16 v[24:27], v[92:95], a[72:75], v[24:27]
    ds_read_b64_tr_b16 v[84:85], v114 offset:45056
    v_mfma_f32_16x16x32_bf16 v[28:31], v[92:95], a[76:79], v[28:31]
    ds_read_b64_tr_b16 v[86:87], v114 offset:45568
    s_waitcnt vmcnt(7)
    s_barrier
    s_waitcnt lgkmcnt(8)
    v_mfma_f32_16x16x32_bf16 v[0:3], v[64:67], a[80:83], v[0:3]
    ds_read_b64_tr_b16 v[88:89], v115 offset:45056
    s_add_u32 m0, s57, 24576
    v_mfma_f32_16x16x32_bf16 v[4:7], v[64:67], a[84:87], v[4:7]
    ds_read_b64_tr_b16 v[90:91], v115 offset:45568
    s_add_u32 s52, s91, 384
    v_mfma_f32_16x16x32_bf16 v[8:11], v[68:71], a[80:83], v[8:11]
    ds_read_b64_tr_b16 v[92:93], v116 offset:45056
    buffer_load_dwordx4 v117, s[12:15], s52 offen lds
    v_mfma_f32_16x16x32_bf16 v[12:15], v[68:71], a[84:87], v[12:15]
    ds_read_b64_tr_b16 v[94:95], v116 offset:45568
    s_add_u32 m0, s57, 32768
    s_waitcnt lgkmcnt(8)
    v_mfma_f32_16x16x32_bf16 v[16:19], v[72:75], a[80:83], v[16:19]
    ds_read_b64_tr_b16 v[64:65], v113 offset:49152
    s_add_u32 s52, s92, 384
    v_mfma_f32_16x16x32_bf16 v[20:23], v[72:75], a[84:87], v[20:23]
    ds_read_b64_tr_b16 v[66:67], v113 offset:49664
    buffer_load_dwordx4 v117, s[12:15], s52 offen lds
    v_mfma_f32_16x16x32_bf16 v[24:27], v[76:79], a[80:83], v[24:27]
    ds_read_b64_tr_b16 v[68:69], v114 offset:49152
    s_add_u32 m0, s57, 81920
    v_mfma_f32_16x16x32_bf16 v[28:31], v[76:79], a[84:87], v[28:31]
    ds_read_b64_tr_b16 v[70:71], v114 offset:49664
    s_add_u32 s52, s96, 1
    s_waitcnt lgkmcnt(8)
    v_mfma_f32_16x16x32_bf16 v[0:3], v[80:83], a[88:91], v[0:3]
    ds_read_b64_tr_b16 v[72:73], v115 offset:49152
    s_and_b32 s52, s52, 7
    s_cmp_lg_u32 s3, 0
    s_cbranch_scc1 PI_2
    buffer_load_dword v125, off, s[48:51], 0 offset:0 sc1
PI_2:
    v_mfma_f32_16x16x32_bf16 v[4:7], v[80:83], a[92:95], v[4:7]
    ds_read_b64_tr_b16 v[74:75], v115 offset:49664
    s_mul_i32 s52, s52, 229376
    v_mfma_f32_16x16x32_bf16 v[8:11], v[84:87], a[88:91], v[8:11]
    ds_read_b64_tr_b16 v[76:77], v116 offset:49152
    s_add_u32 s52, s52, s64
    v_mfma_f32_16x16x32_bf16 v[12:15], v[84:87], a[92:95], v[12:15]
    ds_read_b64_tr_b16 v[78:79], v116 offset:49664
    buffer_load_dwordx4 v118, s[28:31], s52 offen lds
    s_waitcnt lgkmcnt(8)
    v_mfma_f32_16x16x32_bf16 v[16:19], v[88:91], a[88:91], v[16:19]
    ds_read_b64_tr_b16 v[80:81], v113 offset:53248
    s_add_u32 m0, s57, 90112
    v_cvt_pk_bf16_f32 v108, v52, v53
    v_mfma_f32_16x16x32_bf16 v[20:23], v[88:91], a[92:95], v[20:23]
    ds_read_b64_tr_b16 v[82:83], v113 offset:53760
    s_nop 0
    v_cvt_pk_bf16_f32 v109, v54, v55
    v_mfma_f32_16x16x32_bf16 v[24:27], v[92:95], a[88:91], v[24:27]
    ds_read_b64_tr_b16 v[84:85], v114 offset:53248
    buffer_load_dwordx4 v118, s[32:35], s52 offen offset:0 lds
    v_cvt_pk_bf16_f32 v110, v60, v61
    v_mfma_f32_16x16x32_bf16 v[28:31], v[92:95], a[92:95], v[28:31]
    ds_read_b64_tr_b16 v[86:87], v114 offset:53760
    v_cvt_pk_bf16_f32 v111, v62, v63
    s_waitcnt lgkmcnt(8)
    v_mfma_f32_16x16x32_bf16 v[0:3], v[64:67], a[96:99], v[0:3]
    ds_read_b64_tr_b16 v[88:89], v115 offset:53248
    v_mfma_f32_16x16x32_bf16 v[4:7], v[64:67], a[100:103], v[4:7]
    ds_read_b64_tr_b16 v[90:91], v115 offset:53760
    v_mfma_f32_16x16x32_bf16 v[8:11], v[68:71], a[96:99], v[8:11]
    ds_read_b64_tr_b16 v[92:93], v116 offset:53248
    buffer_store_dwordx4 v[108:111], v112, s[8:11], s56 offen offset:3072 sc1
    v_mfma_f32_16x16x32_bf16 v[12:15], v[68:71], a[100:103], v[12:15]
    ds_read_b64_tr_b16 v[94:95], v116 offset:53760
    s_waitcnt lgkmcnt(8)
    v_mfma_f32_16x16x32_bf16 v[16:19], v[72:75], a[96:99], v[16:19]
    ds_read_b64_tr_b16 v[64:65], v113 offset:57344
    v_mfma_f32_16x16x32_bf16 v[20:23], v[72:75], a[100:103], v[20:23]
    ds_read_b64_tr_b16 v[66:67], v113 offset:57856
    v_mfma_f32_16x16x32_bf16 v[24:27], v[76:79], a[96:99], v[24:27]
    ds_read_b64_tr_b16 v[68:69], v114 offset:57344
    v_mfma_f32_16x16x32_bf16 v[28:31], v[76:79], a[100:103], v[28:31]
    ds_read_b64_tr_b16 v[70:71], v114 offset:57856
    s_waitcnt lgkmcnt(8)
    v_mfma_f32_16x16x32_bf16 v[0:3], v[80:83], a[104:107], v[0:3]
    ds_read_b64_tr_b16 v[72:73], v115 offset:57344
    v_mfma_f32_16x16x32_bf16 v[4:7], v[80:83], a[108:111], v[4:7]
    ds_read_b64_tr_b16 v[74:75], v115 offset:57856
    v_mfma_f32_16x16x32_bf16 v[8:11], v[84:87], a[104:107], v[8:11]
    ds_read_b64_tr_b16 v[76:77], v116 offset:57344
    v_mfma_f32_16x16x32_bf16 v[12:15], v[84:87], a[108:111], v[12:15]
    ds_read_b64_tr_b16 v[78:79], v116 offset:57856
    s_waitcnt lgkmcnt(8)
    v_mfma_f32_16x16x32_bf16 v[16:19], v[88:91], a[104:107], v[16:19]
    ds_read_b64_tr_b16 v[80:81], v113 offset:61440
    v_mfma_f32_16x16x32_bf16 v[20:23], v[88:91], a[108:111], v[20:23]
    ds_read_b64_tr_b16 v[82:83], v113 offset:61952
    v_mfma_f32_16x16x32_bf16 v[24:27], v[92:95], a[104:107], v[24:27]
    ds_read_b64_tr_b16 v[84:85], v114 offset:61440
    v_mfma_f32_16x16x32_bf16 v[28:31], v[92:95], a[108:111], v[28:31]
    ds_read_b64_tr_b16 v[86:87], v114 offset:61952
    s_cmp_lg_u32 s3, 0
    s_cbranch_scc1 PK_3
    s_waitcnt vmcnt(3)
    v_readfirstlane_b32 s6, v125
    s_mov_b32 s7, 0
    s_cmp_ge_u32 s6, 256
    s_cbranch_scc1 PK_3
PL_4:
    s_sleep 4
    buffer_load_dword v125, off, s[48:51], 0 offset:0 sc1
    s_add_u32 s7, s7, 1
    s_waitcnt vmcnt(0)
    v_readfirstlane_b32 s6, v125
    s_cmp_ge_u32 s7, 0x40000
    s_cbranch_scc1 PK_3
    s_cmp_lt_u32 s6, 256
    s_cbranch_scc1 PL_4
PK_3:
    s_waitcnt vmcnt(9)
    s_barrier
    s_waitcnt lgkmcnt(8)
    v_mfma_f32_16x16x32_bf16 v[0:3], v[64:67], a[112:115], v[0:3]
    ds_read_b64_tr_b16 v[88:89], v115 offset:61440
    s_add_u32 m0, s57, 40960
    v_mfma_f32_16x16x32_bf16 v[4:7], v[64:67], a[116:119], v[4:7]
    ds_read_b64_tr_b16 v[90:91], v115 offset:61952
    s_add_u32 s52, s93, 384
    v_mfma_f32_16x16x32_bf16 v[8:11], v[68:71], a[112:115], v[8:11]
    ds_read_b64_tr_b16 v[92:93], v116 offset:61440
    buffer_load_dwordx4 v117, s[12:15], s52 offen lds
    v_mfma_f32_16x16x32_bf16 v[12:15], v[68:71], a[116:119], v[12:15]
    ds_read_b64_tr_b16 v[94:95], v116 offset:61952
    s_add_u32 m0, s57, 49152
    s_waitcnt lgkmcnt(8)
    v_mfma_f32_16x16x32_bf16 v[16:19], v[72:75], a[112:115], v[16:19]
    ds_read_b64_tr_b16 v[64:65], v113 offset:0
    s_add_u32 s52, s94, 384
    v_mfma_f32_16x16x32_bf16 v[20:23], v[72:75], a[116:119], v[20:23]
    ds_read_b64_tr_b16 v[66:67], v113 offset:512
    buffer_load_dwordx4 v117, s[12:15], s52 offen lds
    v_mfma_f32_16x16x32_bf16 v[24:27], v[76:79], a[112:115], v[24:27]
    ds_read_b64_tr_b16 v[68:69], v114 offset:0
    s_add_u32 m0, s57, 98304
    v_mfma_f32_16x16x32_bf16 v[28:31], v[76:79], a[116:119], v[28:31]
    ds_read_b64_tr_b16 v[70:71], v114 offset:512
    s_add_u32 s52, s96, 2
    s_waitcnt lgkmcnt(8)
    v_mfma_f32_16x16x32_bf16 v[0:3], v[80:83], a[120:123], v[0:3]
    ds_read_b64_tr_b16 v[72:73], v115 offset:0
    s_and_b32 s52, s52, 7
    v_mfma_f32_16x16x32_bf16 v[4:7], v[80:83], a[124:127], v[4:7]
    ds_read_b64_tr_b16 v[74:75], v115 offset:512
    s_mul_i32 s52, s52, 229376
    v_mfma_f32_16x16x32_bf16 v[8:11], v[84:87], a[120:123], v[8:11]
    ds_read_b64_tr_b16 v[76:77], v116 offset:0
    s_add_u32 s52, s52, s64
    s_add_u32 s56, s56, 0x80000
    v_mfma_f32_16x16x32_bf16 v[12:15], v[84:87], a[124:127], v[12:15]
    ds_read_b64_tr_b16 v[78:79], v116 offset:512
    buffer_load_dwordx4 v118, s[28:31], s52 offen lds
    s_waitcnt lgkmcnt(8)
    v_mfma_f32_16x16x32_bf16 v[16:19], v[88:91], a[120:123], v[16:19]
    ds_read_b64_tr_b16 v[80:81], v113 offset:4096
    s_add_u32 m0, s57, 106496
    v_mfma_f32_16x16x32_bf16 v[20:23], v[88:91], a[124:127], v[20:23]
    ds_read_b64_tr_b16 v[82:83], v113 offset:4608
    s_nop 0
    v_mfma_f32_16x16x32_bf16 v[24:27], v[92:95], a[120:123], v[24:27]
    ds_read_b64_tr_b16 v[84:85], v114 offset:4096
    buffer_load_dwordx4 v118, s[32:35], s52 offen offset:0 lds
    v_mfma_f32_16x16x32_bf16 v[28:31], v[92:95], a[124:127], v[28:31]
    ds_read_b64_tr_b16 v[86:87], v114 offset:4608
    s_waitcnt lgkmcnt(8)
    v_mfma_f32_16x16x32_bf16 v[32:35], v[64:67], a[0:3], 0
    ds_read_b64_tr_b16 v[88:89], v115 offset:4096
    v_mfma_f32_16x16x32_bf16 v[36:39], v[64:67], a[4:7], 0
    ds_read_b64_tr_b16 v[90:91], v115 offset:4608
    v_mfma_f32_16x16x32_bf16 v[40:43], v[68:71], a[0:3], 0
    ds_read_b64_tr_b16 v[92:93], v116 offset:4096
    v_mfma_f32_16x16x32_bf16 v[44:47], v[68:71], a[4:7], 0
    ds_read_b64_tr_b16 v[94:95], v116 offset:4608
    s_waitcnt lgkmcnt(8)
    v_mfma_f32_16x16x32_bf16 v[48:51], v[72:75], a[0:3], 0
    ds_read_b64_tr_b16 v[64:65], v113 offset:8192
    v_mfma_f32_16x16x32_bf16 v[52:55], v[72:75], a[4:7], 0
    ds_read_b64_tr_b16 v[66:67], v113 offset:8704
    v_mfma_f32_16x16x32_bf16 v[56:59], v[76:79], a[0:3], 0
    ds_read_b64_tr_b16 v[68:69], v114 offset:8192
    v_mfma_f32_16x16x32_bf16 v[60:63], v[76:79], a[4:7], 0
    ds_read_b64_tr_b16 v[70:71], v114 offset:8704
    s_waitcnt lgkmcnt(8)
    v_mfma_f32_16x16x32_bf16 v[32:35], v[80:83], a[8:11], v[32:35]
    ds_read_b64_tr_b16 v[72:73], v115 offset:8192
    v_cvt_pk_bf16_f32 v96, v0, v1
    v_mfma_f32_16x16x32_bf16 v[36:39], v[80:83], a[12:15], v[36:39]
    ds_read_b64_tr_b16 v[74:75], v115 offset:8704
    v_cvt_pk_bf16_f32 v97, v2, v3
    v_mfma_f32_16x16x32_bf16 v[40:43], v[84:87], a[8:11], v[40:43]
    ds_read_b64_tr_b16 v[76:77], v116 offset:8192
    v_cvt_pk_bf16_f32 v98, v8, v9
    v_mfma_f32_16x16x32_bf16 v[44:47], v[84:87], a[12:15], v[44:47]
    ds_read_b64_tr_b16 v[78:79], v116 offset:8704
    v_cvt_pk_bf16_f32 v99, v10, v11
    s_waitcnt lgkmcnt(8)
    v_mfma_f32_16x16x32_bf16 v[48:51], v[88:91], a[8:11], v[48:51]
    ds_read_b64_tr_b16 v[80:81], v113 offset:12288
    v_mfma_f32_16x16x32_bf16 v[52:55], v[88:91], a[12:15], v[52:55]
    ds_read_b64_tr_b16 v[82:83], v113 offset:12800
    v_mfma_f32_16x16x32_bf16 v[56:59], v[92:95], a[8:11], v[56:59]
    ds_read_b64_tr_b16 v[84:85], v114 offset:12288
    buffer_store_dwordx4 v[96:99], v112, s[8:11], s55 offen offset:0 sc1
    v_mfma_f32_16x16x32_bf16 v[60:63], v[92:95], a[12:15], v[60:63]
    ds_read_b64_tr_b16 v[86:87], v114 offset:12800
    s_waitcnt vmcnt(9)
    s_barrier
    s_waitcnt lgkmcnt(8)
    v_mfma_f32_16x16x32_bf16 v[32:35], v[64:67], a[16:19], v[32:35]
    ds_read_b64_tr_b16 v[88:89], v115 offset:12288
    s_add_u32 m0, s57, 57344
    v_mfma_f32_16x16x32_bf16 v[36:39], v[64:67], a[20:23], v[36:39]
    ds_read_b64_tr_b16 v[90:91], v115 offset:12800
    s_add_u32 s52, s95, 384
    v_mfma_f32_16x16x32_bf16 v[40:43], v[68:71], a[16:19], v[40:43]
    ds_read_b64_tr_b16 v[92:93], v116 offset:12288
    buffer_load_dwordx4 v117, s[12:15], s52 offen lds
    v_mfma_f32_16x16x32_bf16 v[44:47], v[68:71], a[20:23], v[44:47]
    ds_read_b64_tr_b16 v[94:95], v116 offset:12800
    s_add_u32 m0, s57, 114688
    s_waitcnt lgkmcnt(8)
    v_mfma_f32_16x16x32_bf16 v[48:51], v[72:75], a[16:19], v[48:51]
    ds_read_b64_tr_b16 v[64:65], v113 offset:16384
    s_add_u32 s52, s96, 3
    v_cvt_pk_bf16_f32 v100, v4, v5
    v_mfma_f32_16x16x32_bf16 v[52:55], v[72:75], a[20:23], v[52:55]
    ds_read_b64_tr_b16 v[66:67], v113 offset:16896
    s_and_b32 s52, s52, 7
    v_cvt_pk_bf16_f32 v101, v6, v7
    v_mfma_f32_16x16x32_bf16 v[56:59], v[76:79], a[16:19], v[56:59]
    ds_read_b64_tr_b16 v[68:69], v114 offset:16384
    s_mul_i32 s52, s52, 229376
    v_cvt_pk_bf16_f32 v102, v12, v13
    v_mfma_f32_16x16x32_bf16 v[60:63], v[76:79], a[20:23], v[60:63]
    ds_read_b64_tr_b16 v[70:71], v114 offset:16896
    s_add_u32 s52, s52, s64
    v_cvt_pk_bf16_f32 v103, v14, v15
    s_waitcnt lgkmcnt(8)
    v_mfma_f32_16x16x32_bf16 v[32:35], v[80:83], a[24:27], v[32:35]
    ds_read_b64_tr_b16 v[72:73], v115 offset:16384
    buffer_load_dwordx4 v118, s[28:31], s52 offen lds
    v_mfma_f32_16x16x32_bf16 v[36:39], v[80:83], a[28:31], v[36:39]
    ds_read_b64_tr_b16 v[74:75], v115 offset:16896
    s_add_u32 m0, s57, 122880
    v_mfma_f32_16x16x32_bf16 v[40:43], v[84:87], a[24:27], v[40:43]
    ds_read_b64_tr_b16 v[76:77], v116 offset:16384
    s_nop 0
    buffer_store_dwordx4 v[100:103], v112, s[8:11], s55 offen offset:1024 sc1
    v_mfma_f32_16x16x32_bf16 v[44:47], v[84:87], a[28:31], v[44:47]
    ds_read_b64_tr_b16 v[78:79], v116 offset:16896
    buffer_load_dwordx4 v118, s[32:35], s52 offen offset:0 lds
    s_waitcnt lgkmcnt(8)
    v_mfma_f32_16x16x32_bf16 v[48:51], v[88:91], a[24:27], v[48:51]
    ds_read_b64_tr_b16 v[80:81], v113 offset:20480
    s_add_u32 s53, s96, 0
    s_and_b32 s53, s53, 7
    s_lshl_b32 s53, s53, 12
    s_add_u32 s53, s53, s66
    v_mfma_f32_16x16x32_bf16 v[52:55], v[88:91], a[28:31], v[52:55]
    ds_read_b64_tr_b16 v[82:83], v113 offset:20992
    buffer_load_dwordx4 a[0:3], v112, s[8:11], s53 offen offset:0 sc1
    v_mfma_f32_16x16x32_bf16 v[56:59], v[92:95], a[24:27], v[56:59]
    ds_read_b64_tr_b16 v[84:85], v114 offset:20480
    v_mfma_f32_16x16x32_bf16 v[60:63], v[92:95], a[28:31], v[60:63]
    ds_read_b64_tr_b16 v[86:87], v114 offset:20992
    buffer_load_dwordx4 a[4:7], v112, s[8:11], s53 offen offset:1024 sc1
    s_waitcnt lgkmcnt(8)
    v_mfma_f32_16x16x32_bf16 v[32:35], v[64:67], a[32:35], v[32:35]
    ds_read_b64_tr_b16 v[88:89], v115 offset:20480
    v_cvt_pk_bf16_f32 v104, v16, v17
    v_mfma_f32_16x16x32_bf16 v[36:39], v[64:67], a[36:39], v[36:39]
    ds_read_b64_tr_b16 v[90:91], v115 offset:20992
    v_cvt_pk_bf16_f32 v105, v18, v19
    buffer_load_dwordx4 a[8:11], v112, s[8:11], s53 offen offset:2048 sc1
    v_mfma_f32_16x16x32_bf16 v[40:43], v[68:71], a[32:35], v[40:43]
    ds_read_b64_tr_b16 v[92:93], v116 offset:20480
    v_cvt_pk_bf16_f32 v106, v24, v25
    v_mfma_f32_16x16x32_bf16 v[44:47], v[68:71], a[36:39], v[44:47]
    ds_read_b64_tr_b16 v[94:95], v116 offset:20992
    v_cvt_pk_bf16_f32 v107, v26, v27
    buffer_load_dwordx4 a[12:15], v112, s[8:11], s53 offen offset:3072 sc1
    s_waitcnt lgkmcnt(8)
    v_mfma_f32_16x16x32_bf16 v[48:51], v[72:75], a[32:35], v[48:51]
    ds_read_b64_tr_b16 v[64:65], v113 offset:24576
    v_mfma_f32_16x16x32_bf16 v[52:55], v[72:75], a[36:39], v[52:55]
    ds_read_b64_tr_b16 v[66:67], v113 offset:25088
    v_mfma_f32_16x16x32_bf16 v[56:59], v[76:79], a[32:35], v[56:59]
    ds_read_b64_tr_b16 v[68:69], v114 offset:24576
    buffer_store_dwordx4 v[104:107], v112, s[8:11], s55 offen offset:2048 sc1
    v_mfma_f32_16x16x32_bf16 v[60:63], v[76:79], a[36:39], v[60:63]
    ds_read_b64_tr_b16 v[70:71], v114 offset:25088
    s_waitcnt lgkmcnt(8)
    v_mfma_f32_16x16x32_bf16 v[32:35], v[80:83], a[40:43], v[32:35]
    ds_read_b64_tr_b16 v[72:73], v115 offset:24576
    v_mfma_f32_16x16x32_bf16 v[36:39], v[80:83], a[44:47], v[36:39]
    ds_read_b64_tr_b16 v[74:75], v115 offset:25088
    v_mfma_f32_16x16x32_bf16 v[40:43], v[84:87], a[40:43], v[40:43]
    ds_read_b64_tr_b16 v[76:77], v116 offset:24576
    v_mfma_f32_16x16x32_bf16 v[44:47], v[84:87], a[44:47], v[44:47]
    ds_read_b64_tr_b16 v[78:79], v116 offset:25088
    s_waitcnt lgkmcnt(8)
    v_mfma_f32_16x16x32_bf16 v[48:51], v[88:91], a[40:43], v[48:51]
    ds_read_b64_tr_b16 v[80:81], v113 offset:28672
    v_cvt_pk_bf16_f32 v108, v20, v21
    s_add_u32 s53, s96, 1
    s_and_b32 s53, s53, 7
    s_lshl_b32 s53, s53, 12
    s_add_u32 s53, s53, s66
    v_mfma_f32_16x16x32_bf16 v[52:55], v[88:91], a[44:47], v[52:55]
    ds_read_b64_tr_b16 v[82:83], v113 offset:29184
    v_cvt_pk_bf16_f32 v109, v22, v23
    buffer_load_dwordx4 a[16:19], v112, s[8:11], s53 offen offset:0 sc1
    v_mfma_f32_16x16x32_bf16 v[56:59], v[92:95], a[40:43], v[56:59]
    ds_read_b64_tr_b16 v[84:85], v114 offset:28672
    v_cvt_pk_bf16_f32 v110, v28, v29
    v_mfma_f32_16x16x32_bf16 v[60:63], v[92:95], a[44:47], v[60:63]
    ds_read_b64_tr_b16 v[86:87], v114 offset:29184
    v_cvt_pk_bf16_f32 v111, v30, v31
    buffer_load_dwordx4 a[20:23], v112, s[8:11], s53 offen offset:1024 sc1
    s_waitcnt vmcnt(15)
    s_barrier
    s_waitcnt lgkmcnt(8)
    v_mfma_f32_16x16x32_bf16 v[32:35], v[64:67], a[48:51], v[32:35]
    ds_read_b64_tr_b16 v[88:89], v115 offset:28672
    s_add_u32 m0, s57, 131072
    v_mfma_f32_16x16x32_bf16 v[36:39], v[64:67], a[52:55], v[36:39]
    ds_read_b64_tr_b16 v[90:91], v115 offset:29184
    s_add_u32 s52, s96, 4
    buffer_load_dwordx4 a[24:27], v112, s[8:11], s53 offen offset:2048 sc1
    v_mfma_f32_16x16x32_bf16 v[40:43], v[68:71], a[48:51], v[40:43]
    ds_read_b64_tr_b16 v[92:93], v116 offset:28672
    s_and_b32 s52, s52, 7
    buffer_store_dwordx4 v[108:111], v112, s[8:11], s55 offen offset:3072 sc1
    v_mfma_f32_16x16x32_bf16 v[44:47], v[68:71], a[52:55], v[44:47]
    ds_read_b64_tr_b16 v[94:95], v116 offset:29184
    s_mul_i32 s52, s52, 229376
    buffer_load_dwordx4 a[28:31], v112, s[8:11], s53 offen offset:3072 sc1
    s_waitcnt lgkmcnt(8)
    v_mfma_f32_16x16x32_bf16 v[48:51], v[72:75], a[48:51], v[48:51]
    ds_read_b64_tr_b16 v[64:65], v113 offset:32768
    s_add_u32 s52, s52, s64
    v_mfma_f32_16x16x32_bf16 v[52:55], v[72:75], a[52:55], v[52:55]
    ds_read_b64_tr_b16 v[66:67], v113 offset:33280
    buffer_load_dwordx4 v118, s[28:31], s52 offen lds
    v_mfma_f32_16x16x32_bf16 v[56:59], v[76:79], a[48:51], v[56:59]
    ds_read_b64_tr_b16 v[68:69], v114 offset:32768
    s_add_u32 m0, s57, 139264
    v_mfma_f32_16x16x32_bf16 v[60:63], v[76:79], a[52:55], v[60:63]
    ds_read_b64_tr_b16 v[70:71], v114 offset:33280
    s_nop 0
    s_waitcnt lgkmcnt(8)
    v_mfma_f32_16x16x32_bf16 v[32:35], v[80:83], a[56:59], v[32:35]
    ds_read_b64_tr_b16 v[72:73], v115 offset:32768
    buffer_load_dwordx4 v118, s[32:35], s52 offen offset:0 lds
    v_mfma_f32_16x16x32_bf16 v[36:39], v[80:83], a[60:63], v[36:39]
    ds_read_b64_tr_b16 v[74:75], v115 offset:33280
    s_add_u32 m0, s57, 0
    v_mfma_f32_16x16x32_bf16 v[40:43], v[84:87], a[56:59], v[40:43]
    ds_read_b64_tr_b16 v[76:77], v116 offset:32768
    s_add_u32 s52, s96, 6
    v_mfma_f32_16x16x32_bf16 v[44:47], v[84:87], a[60:63], v[44:47]
    ds_read_b64_tr_b16 v[78:79], v116 offset:33280
    s_and_b32 s52, s52, 7
    s_waitcnt lgkmcnt(8)
    v_mfma_f32_16x16x32_bf16 v[48:51], v[88:91], a[56:59], v[48:51]
    ds_read_b64_tr_b16 v[80:81], v113 offset:36864
    s_mul_i32 s52, s52, 229376
    v_mfma_f32_16x16x32_bf16 v[52:55], v[88:91], a[60:63], v[52:55]
    ds_read_b64_tr_b16 v[82:83], v113 offset:37376
    s_add_u32 s52, s52, s64
    v_mfma_f32_16x16x32_bf16 v[56:59], v[92:95], a[56:59], v[56:59]
    ds_read_b64_tr_b16 v[84:85], v114 offset:36864
    buffer_load_dwordx4 v118, s[28:31], s52 offen lds
    v_mfma_f32_16x16x32_bf16 v[60:63], v[92:95], a[60:63], v[60:63]
    ds_read_b64_tr_b16 v[86:87], v114 offset:37376
    s_add_u32 m0, s57, 8192
    s_waitcnt lgkmcnt(8)
    v_mfma_f32_16x16x32_bf16 v[32:35], v[64:67], a[64:67], v[32:35]
    ds_read_b64_tr_b16 v[88:89], v115 offset:36864
    s_nop 0
    v_mfma_f32_16x16x32_bf16 v[36:39], v[64:67], a[68:71], v[36:39]
    ds_read_b64_tr_b16 v[90:91], v115 offset:37376
    buffer_load_dwordx4 v118, s[32:35], s52 offen offset:0 lds
    v_mfma_f32_16x16x32_bf16 v[40:43], v[68:71], a[64:67], v[40:43]
    ds_read_b64_tr_b16 v[92:93], v116 offset:36864
    v_mfma_f32_16x16x32_bf16 v[44:47], v[68:71], a[68:71], v[44:47]
    ds_read_b64_tr_b16 v[94:95], v116 offset:37376
    s_waitcnt lgkmcnt(8)
    v_mfma_f32_16x16x32_bf16 v[48:51], v[72:75], a[64:67], v[48:51]
    ds_read_b64_tr_b16 v[64:65], v113 offset:40960
    v_mfma_f32_16x16x32_bf16 v[52:55], v[72:75], a[68:71], v[52:55]
    ds_read_b64_tr_b16 v[66:67], v113 offset:41472
    v_mfma_f32_16x16x32_bf16 v[56:59], v[76:79], a[64:67], v[56:59]
    ds_read_b64_tr_b16 v[68:69], v114 offset:40960
    v_mfma_f32_16x16x32_bf16 v[60:63], v[76:79], a[68:71], v[60:63]
    ds_read_b64_tr_b16 v[70:71], v114 offset:41472
    s_waitcnt lgkmcnt(8)
    v_mfma_f32_16x16x32_bf16 v[32:35], v[80:83], a[72:75], v[32:35]
    ds_read_b64_tr_b16 v[72:73], v115 offset:40960
    v_mfma_f32_16x16x32_bf16 v[36:39], v[80:83], a[76:79], v[36:39]
    ds_read_b64_tr_b16 v[74:75], v115 offset:41472
    v_mfma_f32_16x16x32_bf16 v[40:43], v[84:87], a[72:75], v[40:43]
    ds_read_b64_tr_b16 v[76:77], v116 offset:40960
    v_mfma_f32_16x16x32_bf16 v[44:47], v[84:87], a[76:79], v[44:47]
    ds_read_b64_tr_b16 v[78:79], v116 offset:41472
    s_waitcnt lgkmcnt(8)
    v_mfma_f32_16x16x32_bf16 v[48:51], v[88:91], a[72:75], v[48:51]
    ds_read_b64_tr_b16 v[80:81], v113 offset:45056
    v_mfma_f32_16x16x32_bf16 v[52:55], v[88:91], a[76:79], v[52:55]
    ds_read_b64_tr_b16 v[82:83], v113 offset:45568
    v_mfma_f32_16x16x32_bf16 v[56:59], v[92:95], a[72:75], v[56:59]
    ds_read_b64_tr_b16 v[84:85], v114 offset:45056
    v_mfma_f32_16x16x32_bf16 v[60:63], v[92:95], a[76:79], v[60:63]
    ds_read_b64_tr_b16 v[86:87], v114 offset:45568
    s_waitcnt vmcnt(17)
    s_barrier
    s_waitcnt lgkmcnt(8)
    v_mfma_f32_16x16x32_bf16 v[32:35], v[64:67], a[80:83], v[32:35]
    ds_read_b64_tr_b16 v[88:89], v115 offset:45056
    s_add_u32 m0, s57, 147456
    v_mfma_f32_16x16x32_bf16 v[36:39], v[64:67], a[84:87], v[36:39]
    ds_read_b64_tr_b16 v[90:91], v115 offset:45568
    s_add_u32 s52, s96, 5
    v_mfma_f32_16x16x32_bf16 v[40:43], v[68:71], a[80:83], v[40:43]
    ds_read_b64_tr_b16 v[92:93], v116 offset:45056
    s_and_b32 s52, s52, 7
    v_mfma_f32_16x16x32_bf16 v[44:47], v[68:71], a[84:87], v[44:47]
    ds_read_b64_tr_b16 v[94:95], v116 offset:45568
    s_mul_i32 s52, s52, 229376
    s_waitcnt lgkmcnt(8)
    v_mfma_f32_16x16x32_bf16 v[48:51], v[72:75], a[80:83], v[48:51]
    ds_read_b64_tr_b16 v[64:65], v113 offset:49152
    s_add_u32 s52, s52, s64
    v_mfma_f32_16x16x32_bf16 v[52:55], v[72:75], a[84:87], v[52:55]
    ds_read_b64_tr_b16 v[66:67], v113 offset:49664
    buffer_load_dwordx4 v118, s[28:31], s52 offen lds
    v_mfma_f32_16x16x32_bf16 v[56:59], v[76:79], a[80:83], v[56:59]
    ds_read_b64_tr_b16 v[68:69], v114 offset:49152
    s_add_u32 m0, s57, 155648
    v_mfma_f32_16x16x32_bf16 v[60:63], v[76:79], a[84:87], v[60:63]
    ds_read_b64_tr_b16 v[70:71], v114 offset:49664
    s_nop 0
    s_waitcnt lgkmcnt(8)
    v_mfma_f32_16x16x32_bf16 v[32:35], v[80:83], a[88:91], v[32:35]
    ds_read_b64_tr_b16 v[72:73], v115 offset:49152
    buffer_load_dwordx4 v118, s[32:35], s52 offen offset:0 lds
    v_mfma_f32_16x16x32_bf16 v[36:39], v[80:83], a[92:95], v[36:39]
    ds_read_b64_tr_b16 v[74:75], v115 offset:49664
    s_add_u32 m0, s57, 16384
    v_mfma_f32_16x16x32_bf16 v[40:43], v[84:87], a[88:91], v[40:43]
    ds_read_b64_tr_b16 v[76:77], v116 offset:49152
    s_add_u32 s52, s96, 7
    v_mfma_f32_16x16x32_bf16 v[44:47], v[84:87], a[92:95], v[44:47]
    ds_read_b64_tr_b16 v[78:79], v116 offset:49664
    s_and_b32 s52, s52, 7
    s_waitcnt lgkmcnt(8)
    v_mfma_f32_16x16x32_bf16 v[48:51], v[88:91], a[88:91], v[48:51]
    ds_read_b64_tr_b16 v[80:81], v113 offset:53248
    s_mul_i32 s52, s52, 229376
    s_add_u32 s53, s96, 2
    s_and_b32 s53, s53, 7
    s_lshl_b32 s53, s53, 12
    s_add_u32 s53, s53, s66
    v_mfma_f32_16x16x32_bf16 v[52:55], v[88:91], a[92:95], v[52:55]
    ds_read_b64_tr_b16 v[82:83], v113 offset:53760
    s_add_u32 s52, s52, s64
    buffer_load_dwordx4 a[32:35], v112, s[8:11], s53 offen offset:0 sc1
    v_mfma_f32_16x16x32_bf16 v[56:59], v[92:95], a[88:91], v[56:59]
    ds_read_b64_tr_b16 v[84:85], v114 offset:53248
    buffer_load_dwordx4 v118, s[28:31], s52 offen lds
    v_mfma_f32_16x16x32_bf16 v[60:63], v[92:95], a[92:95], v[60:63]
    ds_read_b64_tr_b16 v[86:87], v114 offset:53760
    s_add_u32 m0, s57, 24576
    buffer_load_dwordx4 a[36:39], v112, s[8:11], s53 offen offset:1024 sc1
    s_waitcnt lgkmcnt(8)
    v_mfma_f32_16x16x32_bf16 v[32:35], v[64:67], a[96:99], v[32:35]
    ds_read_b64_tr_b16 v[88:89], v115 offset:53248
    s_nop 0
    v_mfma_f32_16x16x32_bf16 v[36:39], v[64:67], a[100:103], v[36:39]
    ds_read_b64_tr_b16 v[90:91], v115 offset:53760
    buffer_load_dwordx4 v118, s[32:35], s52 offen offset:0 lds
    buffer_load_dwordx4 a[40:43], v112, s[8:11], s53 offen offset:2048 sc1
    v_mfma_f32_16x16x32_bf16 v[40:43], v[68:71], a[96:99], v[40:43]
    ds_read_b64_tr_b16 v[92:93], v116 offset:53248
    v_mfma_f32_16x16x32_bf16 v[44:47], v[68:71], a[100:103], v[44:47]
    ds_read_b64_tr_b16 v[94:95], v116 offset:53760
    buffer_load_dwordx4 a[44:47], v112, s[8:11], s53 offen offset:3072 sc1
    s_waitcnt lgkmcnt(8)
    v_mfma_f32_16x16x32_bf16 v[48:51], v[72:75], a[96:99], v[48:51]
    ds_read_b64_tr_b16 v[64:65], v113 offset:57344
    v_mfma_f32_16x16x32_bf16 v[52:55], v[72:75], a[100:103], v[52:55]
    ds_read_b64_tr_b16 v[66:67], v113 offset:57856
    v_mfma_f32_16x16x32_bf16 v[56:59], v[76:79], a[96:99], v[56:59]
    ds_read_b64_tr_b16 v[68:69], v114 offset:57344
    v_mfma_f32_16x16x32_bf16 v[60:63], v[76:79], a[100:103], v[60:63]
    ds_read_b64_tr_b16 v[70:71], v114 offset:57856
    s_waitcnt lgkmcnt(8)
    v_mfma_f32_16x16x32_bf16 v[32:35], v[80:83], a[104:107], v[32:35]
    ds_read_b64_tr_b16 v[72:73], v115 offset:57344
    v_mfma_f32_16x16x32_bf16 v[36:39], v[80:83], a[108:111], v[36:39]
    ds_read_b64_tr_b16 v[74:75], v115 offset:57856
    v_mfma_f32_16x16x32_bf16 v[40:43], v[84:87], a[104:107], v[40:43]
    ds_read_b64_tr_b16 v[76:77], v116 offset:57344
    v_mfma_f32_16x16x32_bf16 v[44:47], v[84:87], a[108:111], v[44:47]
    ds_read_b64_tr_b16 v[78:79], v116 offset:57856
    s_waitcnt lgkmcnt(8)
    v_mfma_f32_16x16x32_bf16 v[48:51], v[88:91], a[104:107], v[48:51]
    ds_read_b64_tr_b16 v[80:81], v113 offset:61440
    v_mfma_f32_16x16x32_bf16 v[52:55], v[88:91], a[108:111], v[52:55]
    ds_read_b64_tr_b16 v[82:83], v113 offset:61952
    v_mfma_f32_16x16x32_bf16 v[56:59], v[92:95], a[104:107], v[56:59]
    ds_read_b64_tr_b16 v[84:85], v114 offset:61440
    v_mfma_f32_16x16x32_bf16 v[60:63], v[92:95], a[108:111], v[60:63]
    ds_read_b64_tr_b16 v[86:87], v114 offset:61952
    s_barrier
    s_waitcnt lgkmcnt(8)
    v_mfma_f32_16x16x32_bf16 v[32:35], v[64:67], a[112:115], v[32:35]
    ds_read_b64_tr_b16 v[88:89], v115 offset:61440
    s_add_u32 m0, s57, 32768
    v_mfma_f32_16x16x32_bf16 v[36:39], v[64:67], a[116:119], v[36:39]
    ds_read_b64_tr_b16 v[90:91], v115 offset:61952
    s_add_u32 s52, s96, 0
    v_mfma_f32_16x16x32_bf16 v[40:43], v[68:71], a[112:115], v[40:43]
    ds_read_b64_tr_b16 v[92:93], v116 offset:61440
    s_and_b32 s52, s52, 7
    v_mfma_f32_16x16x32_bf16 v[44:47], v[68:71], a[116:119], v[44:47]
    ds_read_b64_tr_b16 v[94:95], v116 offset:61952
    s_lshl_b32 s52, s52, 19
    s_waitcnt lgkmcnt(8)
    v_mfma_f32_16x16x32_bf16 v[48:51], v[72:75], a[112:115], v[48:51]
    v_add_u32 v113, 0x10000, v113
    ds_read_b64_tr_b16 v[64:65], v113 offset:0
    s_add_u32 s52, s52, s65
    v_mfma_f32_16x16x32_bf16 v[52:55], v[72:75], a[116:119], v[52:55]
    ds_read_b64_tr_b16 v[66:67], v113 offset:512
    buffer_load_dwordx4 v117, s[24:27], s52 offen lds
    v_mfma_f32_16x16x32_bf16 v[56:59], v[76:79], a[112:115], v[56:59]
    v_add_u32 v114, 0x10000, v114
    ds_read_b64_tr_b16 v[68:69], v114 offset:0
    s_add_u32 m0, s57, 40832
    v_mfma_f32_16x16x32_bf16 v[60:63], v[76:79], a[116:119], v[60:63]
    ds_read_b64_tr_b16 v[70:71], v114 offset:512
    s_nop 0
    s_waitcnt lgkmcnt(8)
    v_mfma_f32_16x16x32_bf16 v[32:35], v[80:83], a[120:123], v[32:35]
    ds_read_b64_tr_b16 v[72:73], v113 offset:8192
    buffer_load_dwordx4 v117, s[24:27], s52 offen offset:128 lds
    v_mfma_f32_16x16x32_bf16 v[36:39], v[80:83], a[124:127], v[36:39]
    ds_read_b64_tr_b16 v[74:75], v113 offset:8704
    v_mfma_f32_16x16x32_bf16 v[40:43], v[84:87], a[120:123], v[40:43]
    ds_read_b64_tr_b16 v[76:77], v114 offset:8192
    v_mfma_f32_16x16x32_bf16 v[44:47], v[84:87], a[124:127], v[44:47]
    ds_read_b64_tr_b16 v[78:79], v114 offset:8704
    s_waitcnt lgkmcnt(8)
    v_mfma_f32_16x16x32_bf16 v[48:51], v[88:91], a[120:123], v[48:51]
    ds_read_b64_tr_b16 v[80:81], v113 offset:4096
    s_add_u32 s53, s96, 3
    s_and_b32 s53, s53, 7
    s_lshl_b32 s53, s53, 12
    s_add_u32 s53, s53, s66
    v_mfma_f32_16x16x32_bf16 v[52:55], v[88:91], a[124:127], v[52:55]
    ds_read_b64_tr_b16 v[82:83], v113 offset:4608
    buffer_load_dwordx4 a[48:51], v112, s[8:11], s53 offen offset:0 sc1
    v_mfma_f32_16x16x32_bf16 v[56:59], v[92:95], a[120:123], v[56:59]
    ds_read_b64_tr_b16 v[84:85], v114 offset:4096
    v_mfma_f32_16x16x32_bf16 v[60:63], v[92:95], a[124:127], v[60:63]
    ds_read_b64_tr_b16 v[86:87], v114 offset:4608
    buffer_load_dwordx4 a[52:55], v112, s[8:11], s53 offen offset:1024 sc1
    s_waitcnt lgkmcnt(8)
    s_waitcnt vmcnt(25)
    v_mfma_f32_16x16x32_bf16 v[0:3], v[64:67], a[0:3], 0
    ds_read_b64_tr_b16 v[88:89], v113 offset:12288
    s_waitcnt vmcnt(24)
    v_mfma_f32_16x16x32_bf16 v[4:7], v[64:67], a[4:7], 0
    ds_read_b64_tr_b16 v[90:91], v113 offset:12800
    buffer_load_dwordx4 a[56:59], v112, s[8:11], s53 offen offset:2048 sc1
    v_mfma_f32_16x16x32_bf16 v[8:11], v[68:71], a[0:3], 0
    ds_read_b64_tr_b16 v[92:93], v114 offset:12288
    v_mfma_f32_16x16x32_bf16 v[12:15], v[68:71], a[4:7], 0
    ds_read_b64_tr_b16 v[94:95], v114 offset:12800
    buffer_load_dwordx4 a[60:63], v112, s[8:11], s53 offen offset:3072 sc1
    s_waitcnt lgkmcnt(8)
    v_mfma_f32_16x16x32_bf16 v[16:19], v[72:75], a[0:3], 0
    ds_read_b64_tr_b16 v[64:65], v113 offset:16384
    v_mfma_f32_16x16x32_bf16 v[20:23], v[72:75], a[4:7], 0
    ds_read_b64_tr_b16 v[66:67], v113 offset:16896
    v_mfma_f32_16x16x32_bf16 v[24:27], v[76:79], a[0:3], 0
    ds_read_b64_tr_b16 v[68:69], v114 offset:16384
    v_mfma_f32_16x16x32_bf16 v[28:31], v[76:79], a[4:7], 0
    ds_read_b64_tr_b16 v[70:71], v114 offset:16896
    s_waitcnt lgkmcnt(8)
    s_waitcnt vmcnt(25)
    v_mfma_f32_16x16x32_bf16 v[0:3], v[80:83], a[8:11], v[0:3]
    ds_read_b64_tr_b16 v[72:73], v113 offset:24576
    s_waitcnt vmcnt(24)
    v_mfma_f32_16x16x32_bf16 v[4:7], v[80:83], a[12:15], v[4:7]
    ds_read_b64_tr_b16 v[74:75], v113 offset:25088
    v_mfma_f32_16x16x32_bf16 v[8:11], v[84:87], a[8:11], v[8:11]
    ds_read_b64_tr_b16 v[76:77], v114 offset:24576
    v_cvt_pk_bf16_f32 v96, v32, v33
    v_mfma_f32_16x16x32_bf16 v[12:15], v[84:87], a[12:15], v[12:15]
    ds_read_b64_tr_b16 v[78:79], v114 offset:25088
    v_cvt_pk_bf16_f32 v97, v34, v35
    s_waitcnt lgkmcnt(8)
    v_mfma_f32_16x16x32_bf16 v[16:19], v[88:91], a[8:11], v[16:19]
    ds_read_b64_tr_b16 v[80:81], v113 offset:20480
    v_cvt_pk_bf16_f32 v98, v40, v41
    v_mfma_f32_16x16x32_bf16 v[20:23], v[88:91], a[12:15], v[20:23]
    ds_read_b64_tr_b16 v[82:83], v113 offset:20992
    v_cvt_pk_bf16_f32 v99, v42, v43
    v_mfma_f32_16x16x32_bf16 v[24:27], v[92:95], a[8:11], v[24:27]
    ds_read_b64_tr_b16 v[84:85], v114 offset:20480
    v_cvt_pk_bf16_f32 v100, v36, v37
    v_mfma_f32_16x16x32_bf16 v[28:31], v[92:95], a[12:15], v[28:31]
    ds_read_b64_tr_b16 v[86:87], v114 offset:20992
    v_cvt_pk_bf16_f32 v101, v38, v39
    s_barrier
    s_waitcnt lgkmcnt(8)
    s_waitcnt vmcnt(22)
    v_mfma_f32_16x16x32_bf16 v[0:3], v[64:67], a[16:19], v[0:3]
    ds_read_b64_tr_b16 v[88:89], v113 offset:28672
    s_add_u32 m0, s57, 49152
    v_cvt_pk_bf16_f32 v102, v44, v45
    s_waitcnt vmcnt(21)
    v_mfma_f32_16x16x32_bf16 v[4:7], v[64:67], a[20:23], v[4:7]
    ds_read_b64_tr_b16 v[90:91], v113 offset:29184
    s_add_u32 s52, s96, 1
    v_cvt_pk_bf16_f32 v103, v46, v47
    v_mfma_f32_16x16x32_bf16 v[8:11], v[68:71], a[16:19], v[8:11]
    ds_read_b64_tr_b16 v[92:93], v114 offset:28672
    s_and_b32 s52, s52, 7
    v_cvt_pk_bf16_f32 v104, v48, v49
    v_mfma_f32_16x16x32_bf16 v[12:15], v[68:71], a[20:23], v[12:15]
    ds_read_b64_tr_b16 v[94:95], v114 offset:29184
    s_lshl_b32 s52, s52, 19
    v_cvt_pk_bf16_f32 v105, v50, v51
    s_waitcnt lgkmcnt(8)
    v_mfma_f32_16x16x32_bf16 v[16:19], v[72:75], a[16:19], v[16:19]
    v_add_u32 v115, 0x10000, v115
    ds_read_b64_tr_b16 v[64:65], v115 offset:0
    s_add_u32 s52, s52, s65
    v_cvt_pk_bf16_f32 v106, v56, v57
    v_mfma_f32_16x16x32_bf16 v[20:23], v[72:75], a[20:23], v[20:23]
    ds_read_b64_tr_b16 v[66:67], v115 offset:512
    buffer_load_dwordx4 v117, s[24:27], s52 offen lds
    v_cvt_pk_bf16_f32 v107, v58, v59
    v_mfma_f32_16x16x32_bf16 v[24:27], v[76:79], a[16:19], v[24:27]
    v_add_u32 v116, 0x10000, v116
    ds_read_b64_tr_b16 v[68:69], v116 offset:0
    s_add_u32 m0, s57, 57216
    v_cvt_pk_bf16_f32 v108, v52, v53
    v_mfma_f32_16x16x32_bf16 v[28:31], v[76:79], a[20:23], v[28:31]
    ds_read_b64_tr_b16 v[70:71], v116 offset:512
    s_nop 0
    v_cvt_pk_bf16_f32 v109, v54, v55
    s_waitcnt lgkmcnt(8)
    s_waitcnt vmcnt(21)
    v_mfma_f32_16x16x32_bf16 v[0:3], v[80:83], a[24:27], v[0:3]
    ds_read_b64_tr_b16 v[72:73], v115 offset:8192
    buffer_load_dwordx4 v117, s[24:27], s52 offen offset:128 lds
    v_cvt_pk_bf16_f32 v110, v60, v61
    s_waitcnt vmcnt(20)
    v_mfma_f32_16x16x32_bf16 v[4:7], v[80:83], a[28:31], v[4:7]
    ds_read_b64_tr_b16 v[74:75], v115 offset:8704
    v_cvt_pk_bf16_f32 v111, v62, v63
    v_mfma_f32_16x16x32_bf16 v[8:11], v[84:87], a[24:27], v[8:11]
    ds_read_b64_tr_b16 v[76:77], v116 offset:8192
    v_mfma_f32_16x16x32_bf16 v[12:15], v[84:87], a[28:31], v[12:15]
    ds_read_b64_tr_b16 v[78:79], v116 offset:8704
    s_waitcnt lgkmcnt(8)
    v_mfma_f32_16x16x32_bf16 v[16:19], v[88:91], a[24:27], v[16:19]
    ds_read_b64_tr_b16 v[80:81], v115 offset:4096
    s_add_u32 s53, s96, 4
    s_and_b32 s53, s53, 7
    s_lshl_b32 s53, s53, 12
    s_add_u32 s53, s53, s66
    v_mfma_f32_16x16x32_bf16 v[20:23], v[88:91], a[28:31], v[20:23]
    ds_read_b64_tr_b16 v[82:83], v115 offset:4608
    buffer_load_dwordx4 a[64:67], v112, s[8:11], s53 offen offset:0 sc1
    v_mfma_f32_16x16x32_bf16 v[24:27], v[92:95], a[24:27], v[24:27]
    ds_read_b64_tr_b16 v[84:85], v116 offset:4096
    v_mfma_f32_16x16x32_bf16 v[28:31], v[92:95], a[28:31], v[28:31]
    ds_read_b64_tr_b16 v[86:87], v116 offset:4608
    buffer_load_dwordx4 a[68:71], v112, s[8:11], s53 offen offset:1024 sc1
    s_waitcnt lgkmcnt(8)
    v_mfma_f32_16x16x32_bf16 v[32:35], v[64:67], a[0:3], 0
    ds_read_b64_tr_b16 v[88:89], v115 offset:12288
    v_mfma_f32_16x16x32_bf16 v[36:39], v[64:67], a[4:7], 0
    ds_read_b64_tr_b16 v[90:91], v115 offset:12800
    buffer_load_dwordx4 a[72:75], v112, s[8:11], s53 offen offset:2048 sc1
    v_mfma_f32_16x16x32_bf16 v[40:43], v[68:71], a[0:3], 0
    ds_read_b64_tr_b16 v[92:93], v116 offset:12288
    v_mfma_f32_16x16x32_bf16 v[44:47], v[68:71], a[4:7], 0
    ds_read_b64_tr_b16 v[94:95], v116 offset:12800
    buffer_load_dwordx4 a[76:79], v112, s[8:11], s53 offen offset:3072 sc1
    s_waitcnt lgkmcnt(8)
    v_mfma_f32_16x16x32_bf16 v[48:51], v[72:75], a[0:3], 0
    ds_read_b64_tr_b16 v[64:65], v115 offset:16384
    v_mfma_f32_16x16x32_bf16 v[52:55], v[72:75], a[4:7], 0
    ds_read_b64_tr_b16 v[66:67], v115 offset:16896
    v_mfma_f32_16x16x32_bf16 v[56:59], v[76:79], a[0:3], 0
    ds_read_b64_tr_b16 v[68:69], v116 offset:16384
    v_mfma_f32_16x16x32_bf16 v[60:63], v[76:79], a[4:7], 0
    ds_read_b64_tr_b16 v[70:71], v116 offset:16896
    s_waitcnt lgkmcnt(8)
    v_mfma_f32_16x16x32_bf16 v[32:35], v[80:83], a[8:11], v[32:35]
    ds_read_b64_tr_b16 v[72:73], v115 offset:24576
    v_mfma_f32_16x16x32_bf16 v[36:39], v[80:83], a[12:15], v[36:39]
    ds_read_b64_tr_b16 v[74:75], v115 offset:25088
    v_mfma_f32_16x16x32_bf16 v[40:43], v[84:87], a[8:11], v[40:43]
    ds_read_b64_tr_b16 v[76:77], v116 offset:24576
    v_mfma_f32_16x16x32_bf16 v[44:47], v[84:87], a[12:15], v[44:47]
    ds_read_b64_tr_b16 v[78:79], v116 offset:25088
    s_waitcnt lgkmcnt(8)
    v_mfma_f32_16x16x32_bf16 v[48:51], v[88:91], a[8:11], v[48:51]
    ds_read_b64_tr_b16 v[80:81], v115 offset:20480
    v_mfma_f32_16x16x32_bf16 v[52:55], v[88:91], a[12:15], v[52:55]
    ds_read_b64_tr_b16 v[82:83], v115 offset:20992
    v_mfma_f32_16x16x32_bf16 v[56:59], v[92:95], a[8:11], v[56:59]
    ds_read_b64_tr_b16 v[84:85], v116 offset:20480
    v_mfma_f32_16x16x32_bf16 v[60:63], v[92:95], a[12:15], v[60:63]
    ds_read_b64_tr_b16 v[86:87], v116 offset:20992
    s_barrier
    s_waitcnt lgkmcnt(8)
    v_mfma_f32_16x16x32_bf16 v[32:35], v[64:67], a[16:19], v[32:35]
    ds_read_b64_tr_b16 v[88:89], v115 offset:28672
    s_add_u32 m0, s57, 65536
    v_mfma_f32_16x16x32_bf16 v[36:39], v[64:67], a[20:23], v[36:39]
    ds_read_b64_tr_b16 v[90:91], v115 offset:29184
    s_add_u32 s52, s96, 2
    v_mfma_f32_16x16x32_bf16 v[40:43], v[68:71], a[16:19], v[40:43]
    ds_read_b64_tr_b16 v[92:93], v116 offset:28672
    s_and_b32 s52, s52, 7
    v_mfma_f32_16x16x32_bf16 v[44:47], v[68:71], a[20:23], v[44:47]
    ds_read_b64_tr_b16 v[94:95], v116 offset:29184
    s_lshl_b32 s52, s52, 19
    s_waitcnt lgkmcnt(8)
    v_mfma_f32_16x16x32_bf16 v[48:51], v[72:75], a[16:19], v[48:51]
    ds_read_b64_tr_b16 v[64:65], v113 offset:32768
    s_add_u32 s52, s52, s65
    v_mfma_f32_16x16x32_bf16 v[52:55], v[72:75], a[20:23], v[52:55]
    ds_read_b64_tr_b16 v[66:67], v113 offset:33280
    buffer_load_dwordx4 v117, s[24:27], s52 offen lds
    v_mfma_f32_16x16x32_bf16 v[56:59], v[76:79], a[16:19], v[56:59]
    ds_read_b64_tr_b16 v[68:69], v114 offset:32768
    s_add_u32 m0, s57, 73600
    v_mfma_f32_16x16x32_bf16 v[60:63], v[76:79], a[20:23], v[60:63]
    ds_read_b64_tr_b16 v[70:71], v114 offset:33280
    s_nop 0
    s_waitcnt lgkmcnt(8)
    v_mfma_f32_16x16x32_bf16 v[32:35], v[80:83], a[24:27], v[32:35]
    ds_read_b64_tr_b16 v[72:73], v113 offset:40960
    buffer_load_dwordx4 v117, s[24:27], s52 offen offset:128 lds
    v_mfma_f32_16x16x32_bf16 v[36:39], v[80:83], a[28:31], v[36:39]
    ds_read_b64_tr_b16 v[74:75], v113 offset:41472
    v_mfma_f32_16x16x32_bf16 v[40:43], v[84:87], a[24:27], v[40:43]
    ds_read_b64_tr_b16 v[76:77], v114 offset:40960
    v_mfma_f32_16x16x32_bf16 v[44:47], v[84:87], a[28:31], v[44:47]
    ds_read_b64_tr_b16 v[78:79], v114 offset:41472
    s_waitcnt lgkmcnt(8)
    v_mfma_f32_16x16x32_bf16 v[48:51], v[88:91], a[24:27], v[48:51]
    ds_read_b64_tr_b16 v[80:81], v113 offset:36864
    s_add_u32 s53, s96, 5
    s_and_b32 s53, s53, 7
    s_lshl_b32 s53, s53, 12
    s_add_u32 s53, s53, s66
    v_mfma_f32_16x16x32_bf16 v[52:55], v[88:91], a[28:31], v[52:55]
    ds_read_b64_tr_b16 v[82:83], v113 offset:37376
    buffer_load_dwordx4 a[80:83], v112, s[8:11], s53 offen offset:0 sc1
    v_mfma_f32_16x16x32_bf16 v[56:59], v[92:95], a[24:27], v[56:59]
    ds_read_b64_tr_b16 v[84:85], v114 offset:36864
    v_mfma_f32_16x16x32_bf16 v[60:63], v[92:95], a[28:31], v[60:63]
    ds_read_b64_tr_b16 v[86:87], v114 offset:37376
    buffer_load_dwordx4 a[84:87], v112, s[8:11], s53 offen offset:1024 sc1
    s_branch P2_M
P1_V:
    s_waitcnt vmcnt(11)
    s_barrier
    ds_read_b128 a[0:3], v121 offset:0
    ds_read_b128 a[4:7], v121 offset:2048
    ds_read_b128 a[8:11], v122 offset:0
    ds_read_b128 a[12:15], v122 offset:2048
    ds_read_b64_tr_b16 v[64:65], v113 offset:0
    ds_read_b64_tr_b16 v[66:67], v113 offset:512
    ds_read_b64_tr_b16 v[68:69], v114 offset:0
    ds_read_b64_tr_b16 v[70:71], v114 offset:512
    ds_read_b64_tr_b16 v[72:73], v115 offset:0
    ds_read_b64_tr_b16 v[74:75], v115 offset:512
    ds_read_b64_tr_b16 v[76:77], v116 offset:0
    ds_read_b64_tr_b16 v[78:79], v116 offset:512
    ds_read_b64_tr_b16 v[80:81], v113 offset:4096
    ds_read_b64_tr_b16 v[82:83], v113 offset:4608
    ds_read_b64_tr_b16 v[84:85], v114 offset:4096
    ds_read_b64_tr_b16 v[86:87], v114 offset:4608
    s_waitcnt lgkmcnt(8)
    v_mfma_f32_16x16x32_bf16 v[0:3], a[0:3], v[64:67], 0
    ds_read_b64_tr_b16 v[88:89], v115 offset:4096
    s_add_u32 m0, s57, 32768
    v_mfma_f32_16x16x32_bf16 v[4:7], a[4:7], v[64:67], 0
    ds_read_b64_tr_b16 v[90:91], v115 offset:4608
    s_nop 0
    v_mfma_f32_16x16x32_bf16 v[8:11], a[0:3], v[68:71], 0
    ds_read_b64_tr_b16 v[92:93], v116 offset:4096
    buffer_load_dwordx4 v117, s[12:15], s92 offen lds
    v_mfma_f32_16x16x32_bf16 v[12:15], a[4:7], v[68:71], 0
    ds_read_b64_tr_b16 v[94:95], v116 offset:4608
    s_add_u32 m0, s57, 40960
    s_waitcnt lgkmcnt(8)
    v_mfma_f32_16x16x32_bf16 v[16:19], a[0:3], v[72:75], 0
    ds_read_b64_tr_b16 v[64:65], v113 offset:8192
    s_nop 0
    v_mfma_f32_16x16x32_bf16 v[20:23], a[4:7], v[72:75], 0
    ds_read_b64_tr_b16 v[66:67], v113 offset:8704
    buffer_load_dwordx4 v117, s[12:15], s93 offen lds
    v_mfma_f32_16x16x32_bf16 v[24:27], a[0:3], v[76:79], 0
    ds_read_b64_tr_b16 v[68:69], v114 offset:8192
    s_waitcnt vmcnt(9)
    ds_read_b128 a[16:19], v121 offset:32768
    ds_read_b128 a[20:23], v121 offset:34816
    ds_read_b128 a[24:27], v122 offset:32768
    ds_read_b128 a[28:31], v122 offset:34816
    v_mfma_f32_16x16x32_bf16 v[28:31], a[4:7], v[76:79], 0
    ds_read_b64_tr_b16 v[70:71], v114 offset:8704
    s_waitcnt lgkmcnt(12)
    v_mfma_f32_16x16x32_bf16 v[0:3], a[8:11], v[80:83], v[0:3]
    ds_read_b64_tr_b16 v[72:73], v115 offset:8192
    v_mfma_f32_16x16x32_bf16 v[4:7], a[12:15], v[80:83], v[4:7]
    ds_read_b64_tr_b16 v[74:75], v115 offset:8704
    v_mfma_f32_16x16x32_bf16 v[8:11], a[8:11], v[84:87], v[8:11]
    ds_read_b64_tr_b16 v[76:77], v116 offset:8192
    s_add_u32 m0, s58, 0
    s_nop 0
    v_mfma_f32_16x16x32_bf16 v[12:15], a[12:15], v[84:87], v[12:15]
    ds_read_b64_tr_b16 v[78:79], v116 offset:8704
    buffer_load_dwordx4 v119, s[16:19], s83 offen offset:0 lds
    s_add_u32 s52, s83, 7168
    s_waitcnt lgkmcnt(12)
    v_mfma_f32_16x16x32_bf16 v[16:19], a[8:11], v[88:91], v[16:19]
    ds_read_b64_tr_b16 v[80:81], v113 offset:12288
    buffer_load_dwordx4 v120, s[16:19], s52 offen offset:1024 lds
    s_add_u32 s52, s83, 14336
    v_mfma_f32_16x16x32_bf16 v[20:23], a[12:15], v[88:91], v[20:23]
    ds_read_b64_tr_b16 v[82:83], v113 offset:12800
    buffer_load_dwordx4 v119, s[16:19], s52 offen offset:2048 lds
    s_add_u32 s52, s83, 21504
    v_mfma_f32_16x16x32_bf16 v[24:27], a[8:11], v[92:95], v[24:27]
    ds_read_b64_tr_b16 v[84:85], v114 offset:12288
    buffer_load_dwordx4 v120, s[16:19], s52 offen offset:3072 lds
    v_mfma_f32_16x16x32_bf16 v[28:31], a[12:15], v[92:95], v[28:31]
    ds_read_b64_tr_b16 v[86:87], v114 offset:12800
    s_waitcnt vmcnt(6)
    s_barrier
    s_waitcnt lgkmcnt(8)
    v_mfma_f32_16x16x32_bf16 v[0:3], a[16:19], v[64:67], v[0:3]
    ds_read_b64_tr_b16 v[88:89], v115 offset:12288
    s_add_u32 m0, s57, 0
    v_mfma_f32_16x16x32_bf16 v[4:7], a[20:23], v[64:67], v[4:7]
    ds_read_b64_tr_b16 v[90:91], v115 offset:12800
    s_add_u32 s52, s88, 128
    v_mfma_f32_16x16x32_bf16 v[8:11], a[16:19], v[68:71], v[8:11]
    ds_read_b64_tr_b16 v[92:93], v116 offset:12288
    buffer_load_dwordx4 v117, s[12:15], s52 offen lds
    v_mfma_f32_16x16x32_bf16 v[12:15], a[20:23], v[68:71], v[12:15]
    ds_read_b64_tr_b16 v[94:95], v116 offset:12800
    s_add_u32 m0, s57, 49152
    s_waitcnt lgkmcnt(8)
    v_mfma_f32_16x16x32_bf16 v[16:19], a[16:19], v[72:75], v[16:19]
    ds_read_b64_tr_b16 v[64:65], v113 offset:16384
    s_nop 0
    v_mfma_f32_16x16x32_bf16 v[20:23], a[20:23], v[72:75], v[20:23]
    ds_read_b64_tr_b16 v[66:67], v113 offset:16896
    buffer_load_dwordx4 v117, s[12:15], s94 offen lds
    v_mfma_f32_16x16x32_bf16 v[24:27], a[16:19], v[76:79], v[24:27]
    ds_read_b64_tr_b16 v[68:69], v114 offset:16384
    v_add_u32 v96, 0x10000, v121
    ds_read_b128 a[32:35], v96 offset:0
    ds_read_b128 a[36:39], v96 offset:2048
    v_add_u32 v97, 0x10000, v122
    ds_read_b128 a[40:43], v97 offset:0
    ds_read_b128 a[44:47], v97 offset:2048
    s_add_u32 m0, s57, 57344
    v_mfma_f32_16x16x32_bf16 v[28:31], a[20:23], v[76:79], v[28:31]
    ds_read_b64_tr_b16 v[70:71], v114 offset:16896
    s_nop 0
    s_waitcnt lgkmcnt(12)
    v_mfma_f32_16x16x32_bf16 v[0:3], a[24:27], v[80:83], v[0:3]
    ds_read_b64_tr_b16 v[72:73], v115 offset:16384
    buffer_load_dwordx4 v117, s[12:15], s95 offen lds
    v_mfma_f32_16x16x32_bf16 v[4:7], a[28:31], v[80:83], v[4:7]
    ds_read_b64_tr_b16 v[74:75], v115 offset:16896
    v_mfma_f32_16x16x32_bf16 v[8:11], a[24:27], v[84:87], v[8:11]
    ds_read_b64_tr_b16 v[76:77], v116 offset:16384
    s_add_u32 m0, s58, 32768
    s_nop 0
    v_mov_b32 v104, 0
    s_lshl_b32 s53, s2, 8
    s_add_u32 s53, s53, 0x5000000
    v_lshrrev_b32 v106, 2, v112
    s_cmp_eq_u32 s3, 0
    s_cselect_b32 s53, s53, 0x20000000
    buffer_store_dword v104, v106, s[8:11], s53 offen sc1
    v_mfma_f32_16x16x32_bf16 v[12:15], a[28:31], v[84:87], v[12:15]
    ds_read_b64_tr_b16 v[78:79], v116 offset:16896
    buffer_load_dwordx4 v119, s[16:19], s84 offen offset:0 lds
    s_add_u32 s52, s84, 7168
    s_waitcnt lgkmcnt(12)
    v_mfma_f32_16x16x32_bf16 v[16:19], a[24:27], v[88:91], v[16:19]
    ds_read_b64_tr_b16 v[80:81], v113 offset:20480
    buffer_load_dwordx4 v120, s[16:19], s52 offen offset:1024 lds
    s_add_u32 s52, s84, 14336
    v_lshlrev_b32 v104, 16, v60
    v_and_b32 v105, 0xffff0000, v60
    v_lshlrev_b32 v106, 16, v61
    v_mfma_f32_16x16x32_bf16 v[20:23], a[28:31], v[88:91], v[20:23]
    ds_read_b64_tr_b16 v[82:83], v113 offset:20992
    buffer_load_dwordx4 v119, s[16:19], s52 offen offset:2048 lds
    s_add_u32 s52, s84, 21504
    v_and_b32 v107, 0xffff0000, v61
    v_lshlrev_b32 v108, 16, v62
    v_and_b32 v109, 0xffff0000, v62
    v_mfma_f32_16x16x32_bf16 v[24:27], a[24:27], v[92:95], v[24:27]
    ds_read_b64_tr_b16 v[84:85], v114 offset:20480
    buffer_load_dwordx4 v120, s[16:19], s52 offen offset:3072 lds
    v_lshlrev_b32 v110, 16, v63
    v_and_b32 v111, 0xffff0000, v63
    v_and_b32 v98, 0x70, v112
    v_mfma_f32_16x16x32_bf16 v[28:31], a[28:31], v[92:95], v[28:31]
    ds_read_b64_tr_b16 v[86:87], v114 offset:20992
    v_lshlrev_b32 v98, 6, v98
    v_lshrrev_b32 v99, 7, v112
    v_lshl_add_u32 v98, v99, 4, v98
    s_waitcnt lgkmcnt(8)
    v_mfma_f32_16x16x32_bf16 v[0:3], a[32:35], v[64:67], v[0:3]
    ds_read_b64_tr_b16 v[88:89], v115 offset:20480
    s_lshl_b32 s71, s2, 13
    s_lshl_b32 s72, s3, 7
    s_add_u32 s71, s71, s72
    v_mfma_f32_16x16x32_bf16 v[4:7], a[36:39], v[64:67], v[4:7]
    ds_read_b64_tr_b16 v[90:91], v115 offset:20992
    buffer_load_dwordx4 v[100:103], v98, s[20:23], s71 offen
    v_add_f32 v125, v104, v105
    v_add_f32 v125, v125, v106
    v_mfma_f32_16x16x32_bf16 v[8:11], a[32:35], v[68:71], v[8:11]
    ds_read_b64_tr_b16 v[92:93], v116 offset:20480
    v_add_f32 v125, v125, v107
    v_add_f32 v125, v125, v108
    v_add_f32 v125, v125, v109
    v_mfma_f32_16x16x32_bf16 v[12:15], a[36:39], v[68:71], v[12:15]
    ds_read_b64_tr_b16 v[94:95], v116 offset:20992
    v_add_f32 v125, v125, v110
    v_add_f32 v125, v125, v111
    s_nop 1
    s_waitcnt lgkmcnt(8)
    v_mfma_f32_16x16x32_bf16 v[16:19], a[32:35], v[72:75], v[16:19]
    ds_read_b64_tr_b16 v[64:65], v113 offset:24576
    v_add_f32_dpp v125, v125, v125 row_shr:1 row_mask:0xf bank_mask:0xf bound_ctrl:0
    s_nop 1
    v_add_f32_dpp v125, v125, v125 row_shr:2 row_mask:0xf bank_mask:0xf bound_ctrl:0
    v_mfma_f32_16x16x32_bf16 v[20:23], a[36:39], v[72:75], v[20:23]
    ds_read_b64_tr_b16 v[66:67], v113 offset:25088
    s_nop 1
    v_add_f32_dpp v125, v125, v125 row_shr:4 row_mask:0xf bank_mask:0xf bound_ctrl:0
    s_nop 1
    v_mfma_f32_16x16x32_bf16 v[24:27], a[32:35], v[76:79], v[24:27]
    ds_read_b64_tr_b16 v[68:69], v114 offset:24576
    s_waitcnt vmcnt(9)
    ds_read_b128 a[48:51], v121 offset:0
    ds_read_b128 a[52:55], v121 offset:2048
    ds_read_b128 a[56:59], v122 offset:0
    ds_read_b128 a[60:63], v122 offset:2048
    v_add_f32_dpp v125, v125, v125 row_shr:8 row_mask:0xf bank_mask:0xf bound_ctrl:0
    s_nop 1
    v_add_f32_dpp v125, v125, v125 row_bcast:15 row_mask:0xa bank_mask:0xf
    v_mfma_f32_16x16x32_bf16 v[28:31], a[36:39], v[76:79], v[28:31]
    ds_read_b64_tr_b16 v[70:71], v114 offset:25088
    s_nop 1
    v_add_f32_dpp v125, v125, v125 row_bcast:31 row_mask:0xc bank_mask:0xf
    s_nop 0
    s_waitcnt lgkmcnt(12)
    v_mfma_f32_16x16x32_bf16 v[0:3], a[40:43], v[80:83], v[0:3]
    ds_read_b64_tr_b16 v[72:73], v115 offset:24576
    v_readlane_b32 s71, v125, 63
    v_mov_b32 v98, 0x3b000000
    s_nop 0
    v_mfma_f32_16x16x32_bf16 v[4:7], a[44:47], v[80:83], v[4:7]
    ds_read_b64_tr_b16 v[74:75], v115 offset:25088
    v_mul_f32 v98, s71, v98
    v_sub_f32 v99, v104, v98
    v_mul_f32 v125, v99, v99
    v_mfma_f32_16x16x32_bf16 v[8:11], a[40:43], v[84:87], v[8:11]
    ds_read_b64_tr_b16 v[76:77], v116 offset:24576
    s_add_u32 m0, s58, 65536
    s_nop 0
    v_sub_f32 v99, v105, v98
    v_fmac_f32 v125, v99, v99
    v_sub_f32 v99, v106, v98
    v_mfma_f32_16x16x32_bf16 v[12:15], a[44:47], v[84:87], v[12:15]
    ds_read_b64_tr_b16 v[78:79], v116 offset:25088
    buffer_load_dwordx4 v119, s[16:19], s85 offen offset:0 lds
    s_add_u32 s52, s85, 7168
    v_fmac_f32 v125, v99, v99
    v_sub_f32 v99, v107, v98
    v_fmac_f32 v125, v99, v99
    s_waitcnt lgkmcnt(12)
    v_mfma_f32_16x16x32_bf16 v[16:19], a[40:43], v[88:91], v[16:19]
    ds_read_b64_tr_b16 v[80:81], v113 offset:28672
    buffer_load_dwordx4 v120, s[16:19], s52 offen offset:1024 lds
    s_add_u32 s52, s85, 14336
    v_sub_f32 v99, v108, v98
    v_fmac_f32 v125, v99, v99
    v_sub_f32 v99, v109, v98
    v_mfma_f32_16x16x32_bf16 v[20:23], a[44:47], v[88:91], v[20:23]
    ds_read_b64_tr_b16 v[82:83], v113 offset:29184
    buffer_load_dwordx4 v119, s[16:19], s52 offen offset:2048 lds
    s_add_u32 s52, s85, 21504
    v_fmac_f32 v125, v99, v99
    v_sub_f32 v99, v110, v98
    v_fmac_f32 v125, v99, v99
    v_mfma_f32_16x16x32_bf16 v[24:27], a[40:43], v[92:95], v[24:27]
    ds_read_b64_tr_b16 v[84:85], v114 offset:28672
    buffer_load_dwordx4 v120, s[16:19], s52 offen offset:3072 lds
    v_sub_f32 v99, v111, v98
    v_fmac_f32 v125, v99, v99
    s_nop 1
    v_mfma_f32_16x16x32_bf16 v[28:31], a[44:47], v[92:95], v[28:31]
    ds_read_b64_tr_b16 v[86:87], v114 offset:29184
    v_add_f32_dpp v125, v125, v125 row_shr:1 row_mask:0xf bank_mask:0xf bound_ctrl:0
    s_nop 1
    v_add_f32_dpp v125, v125, v125 row_shr:2 row_mask:0xf bank_mask:0xf bound_ctrl:0
    s_barrier
    s_waitcnt lgkmcnt(8)
    v_mfma_f32_16x16x32_bf16 v[0:3], a[48:51], v[64:67], v[0:3]
    ds_read_b64_tr_b16 v[88:89], v115 offset:28672
    s_add_u32 m0, s57, 8192
    s_nop 1
    v_add_f32_dpp v125, v125, v125 row_shr:4 row_mask:0xf bank_mask:0xf bound_ctrl:0
    s_nop 1
    v_mfma_f32_16x16x32_bf16 v[4:7], a[52:55], v[64:67], v[4:7]
    ds_read_b64_tr_b16 v[90:91], v115 offset:29184
    s_add_u32 s52, s89, 128
    v_add_f32_dpp v125, v125, v125 row_shr:8 row_mask:0xf bank_mask:0xf bound_ctrl:0
    s_nop 1
    v_add_f32_dpp v125, v125, v125 row_bcast:15 row_mask:0xa bank_mask:0xf
    v_mfma_f32_16x16x32_bf16 v[8:11], a[48:51], v[68:71], v[8:11]
    ds_read_b64_tr_b16 v[92:93], v116 offset:28672
    buffer_load_dwordx4 v117, s[12:15], s52 offen lds
    s_nop 1
    v_add_f32_dpp v125, v125, v125 row_bcast:31 row_mask:0xc bank_mask:0xf
    s_nop 0
    v_mfma_f32_16x16x32_bf16 v[12:15], a[52:55], v[68:71], v[12:15]
    ds_read_b64_tr_b16 v[94:95], v116 offset:29184
    s_add_u32 m0, s57, 16384
    v_readlane_b32 s71, v125, 63
    v_mov_b32 v99, 0x3b000000
    s_nop 0
    s_waitcnt lgkmcnt(8)
    v_mfma_f32_16x16x32_bf16 v[16:19], a[48:51], v[72:75], v[16:19]
    ds_read_b64_tr_b16 v[64:65], v113 offset:32768
    s_add_u32 s52, s90, 128
    v_mul_f32 v99, s71, v99
    v_cvt_pk_bf16_f32 v125, v98, v99
    v_lshlrev_b32 v98, 16, v125
    v_mfma_f32_16x16x32_bf16 v[20:23], a[52:55], v[72:75], v[20:23]
    ds_read_b64_tr_b16 v[66:67], v113 offset:33280
    buffer_load_dwordx4 v117, s[12:15], s52 offen lds
    v_and_b32 v99, 0xffff0000, v125
    v_add_f32 v99, 0x3727c5ac, v99
    v_cvt_pk_bf16_f32 v99, v99, v99
    v_mfma_f32_16x16x32_bf16 v[24:27], a[48:51], v[76:79], v[24:27]
    ds_read_b64_tr_b16 v[68:69], v114 offset:32768
    s_waitcnt vmcnt(7)
    ds_read_b128 a[64:67], v121 offset:32768
    ds_read_b128 a[68:71], v121 offset:34816
    ds_read_b128 a[72:75], v122 offset:32768
    ds_read_b128 a[76:79], v122 offset:34816
    v_lshlrev_b32 v99, 16, v99
    v_sqrt_f32 v99, v99
    s_lshl_b32 s71, s59, 3
    v_mfma_f32_16x16x32_bf16 v[28:31], a[52:55], v[76:79], v[28:31]
    ds_read_b64_tr_b16 v[70:71], v114 offset:33280
    v_cvt_pk_bf16_f32 v99, v99, v99
    v_lshlrev_b32 v99, 16, v99
    s_add_u32 s71, s71, 0x5100000
    s_waitcnt lgkmcnt(12)
    v_mfma_f32_16x16x32_bf16 v[0:3], a[56:59], v[80:83], v[0:3]
    ds_read_b64_tr_b16 v[72:73], v115 offset:32768
    buffer_store_dwordx2 v[98:99], v123, s[8:11], s71 offen sc1
    v_mfma_f32_16x16x32_bf16 v[4:7], a[60:63], v[80:83], v[4:7]
    ds_read_b64_tr_b16 v[74:75], v115 offset:33280
    v_mfma_f32_16x16x32_bf16 v[8:11], a[56:59], v[84:87], v[8:11]
    ds_read_b64_tr_b16 v[76:77], v116 offset:32768
    s_add_u32 m0, s58, 0
    s_nop 0
    v_mfma_f32_16x16x32_bf16 v[12:15], a[60:63], v[84:87], v[12:15]
    ds_read_b64_tr_b16 v[78:79], v116 offset:33280
    buffer_load_dwordx4 v119, s[16:19], s86 offen offset:0 lds
    s_add_u32 s52, s86, 7168
    s_waitcnt lgkmcnt(12)
    v_mfma_f32_16x16x32_bf16 v[16:19], a[56:59], v[88:91], v[16:19]
    ds_read_b64_tr_b16 v[80:81], v113 offset:36864
    buffer_load_dwordx4 v120, s[16:19], s52 offen offset:1024 lds
    s_add_u32 s52, s86, 14336
    v_mfma_f32_16x16x32_bf16 v[20:23], a[60:63], v[88:91], v[20:23]
    ds_read_b64_tr_b16 v[82:83], v113 offset:37376
    buffer_load_dwordx4 v119, s[16:19], s52 offen offset:2048 lds
    s_add_u32 s52, s86, 21504
    v_mfma_f32_16x16x32_bf16 v[24:27], a[56:59], v[92:95], v[24:27]
    ds_read_b64_tr_b16 v[84:85], v114 offset:36864
    buffer_load_dwordx4 v120, s[16:19], s52 offen offset:3072 lds
    v_mfma_f32_16x16x32_bf16 v[28:31], a[60:63], v[92:95], v[28:31]
    ds_read_b64_tr_b16 v[86:87], v114 offset:37376
    s_waitcnt lgkmcnt(8)
    v_mfma_f32_16x16x32_bf16 v[0:3], a[64:67], v[64:67], v[0:3]
    ds_read_b64_tr_b16 v[88:89], v115 offset:36864
    v_mfma_f32_16x16x32_bf16 v[4:7], a[68:71], v[64:67], v[4:7]
    ds_read_b64_tr_b16 v[90:91], v115 offset:37376
    v_mfma_f32_16x16x32_bf16 v[8:11], a[64:67], v[68:71], v[8:11]
    ds_read_b64_tr_b16 v[92:93], v116 offset:36864
    v_mfma_f32_16x16x32_bf16 v[12:15], a[68:71], v[68:71], v[12:15]
    ds_read_b64_tr_b16 v[94:95], v116 offset:37376
    s_waitcnt lgkmcnt(8)
    v_mfma_f32_16x16x32_bf16 v[16:19], a[64:67], v[72:75], v[16:19]
    ds_read_b64_tr_b16 v[64:65], v113 offset:40960
    v_mfma_f32_16x16x32_bf16 v[20:23], a[68:71], v[72:75], v[20:23]
    ds_read_b64_tr_b16 v[66:67], v113 offset:41472
    v_mfma_f32_16x16x32_bf16 v[24:27], a[64:67], v[76:79], v[24:27]
    ds_read_b64_tr_b16 v[68:69], v114 offset:40960
    s_waitcnt vmcnt(7)
    v_add_u32 v96, 0x10000, v121
    ds_read_b128 a[80:83], v96 offset:0
    ds_read_b128 a[84:87], v96 offset:2048
    v_add_u32 v97, 0x10000, v122
    ds_read_b128 a[88:91], v97 offset:0
    ds_read_b128 a[92:95], v97 offset:2048
    v_mfma_f32_16x16x32_bf16 v[28:31], a[68:71], v[76:79], v[28:31]
    ds_read_b64_tr_b16 v[70:71], v114 offset:41472
    s_waitcnt lgkmcnt(12)
    v_mfma_f32_16x16x32_bf16 v[0:3], a[72:75], v[80:83], v[0:3]
    ds_read_b64_tr_b16 v[72:73], v115 offset:40960
    v_mfma_f32_16x16x32_bf16 v[4:7], a[76:79], v[80:83], v[4:7]
    ds_read_b64_tr_b16 v[74:75], v115 offset:41472
    v_mfma_f32_16x16x32_bf16 v[8:11], a[72:75], v[84:87], v[8:11]
    ds_read_b64_tr_b16 v[76:77], v116 offset:40960
    s_add_u32 m0, s58, 32768
    s_nop 0
    v_mfma_f32_16x16x32_bf16 v[12:15], a[76:79], v[84:87], v[12:15]
    ds_read_b64_tr_b16 v[78:79], v116 offset:41472
    buffer_load_dwordx4 v119, s[16:19], s87 offen offset:0 lds
    s_add_u32 s52, s87, 7168
    s_waitcnt lgkmcnt(12)
    v_mfma_f32_16x16x32_bf16 v[16:19], a[72:75], v[88:91], v[16:19]
    ds_read_b64_tr_b16 v[80:81], v113 offset:45056
    buffer_load_dwordx4 v120, s[16:19], s52 offen offset:1024 lds
    s_add_u32 s52, s87, 14336
    v_mfma_f32_16x16x32_bf16 v[20:23], a[76:79], v[88:91], v[20:23]
    ds_read_b64_tr_b16 v[82:83], v113 offset:45568
    buffer_load_dwordx4 v119, s[16:19], s52 offen offset:2048 lds
    s_add_u32 s52, s87, 21504
    v_mfma_f32_16x16x32_bf16 v[24:27], a[72:75], v[92:95], v[24:27]
    ds_read_b64_tr_b16 v[84:85], v114 offset:45056
    buffer_load_dwordx4 v120, s[16:19], s52 offen offset:3072 lds
    v_mfma_f32_16x16x32_bf16 v[28:31], a[76:79], v[92:95], v[28:31]
    ds_read_b64_tr_b16 v[86:87], v114 offset:45568
    s_waitcnt vmcnt(8)
    s_barrier
    s_waitcnt lgkmcnt(8)
    v_mfma_f32_16x16x32_bf16 v[0:3], a[80:83], v[64:67], v[0:3]
    ds_read_b64_tr_b16 v[88:89], v115 offset:45056
    s_add_u32 m0, s57, 24576
    v_and_b32 v104, 0x70, v112
    v_lshrrev_b32 v104, 1, v104
    v_mfma_f32_16x16x32_bf16 v[4:7], a[84:87], v[64:67], v[4:7]
    ds_read_b64_tr_b16 v[90:91], v115 offset:45568
    s_add_u32 s52, s91, 128
    s_lshl_b32 s71, s2, 6
    s_add_u32 s71, s71, 0x5100000
    v_mfma_f32_16x16x32_bf16 v[8:11], a[80:83], v[68:71], v[8:11]
    ds_read_b64_tr_b16 v[92:93], v116 offset:45056
    buffer_load_dwordx4 v117, s[12:15], s52 offen lds
    buffer_load_dwordx2 v[98:99], v104, s[8:11], s71 offen sc1
    v_mfma_f32_16x16x32_bf16 v[12:15], a[84:87], v[68:71], v[12:15]
    ds_read_b64_tr_b16 v[94:95], v116 offset:45568
    s_add_u32 m0, s57, 32768
    s_waitcnt lgkmcnt(8)
    v_mfma_f32_16x16x32_bf16 v[16:19], a[80:83], v[72:75], v[16:19]
    ds_read_b64_tr_b16 v[64:65], v113 offset:49152
    s_add_u32 s52, s92, 128
    v_mfma_f32_16x16x32_bf16 v[20:23], a[84:87], v[72:75], v[20:23]
    ds_read_b64_tr_b16 v[66:67], v113 offset:49664
    buffer_load_dwordx4 v117, s[12:15], s52 offen lds
    v_mfma_f32_16x16x32_bf16 v[24:27], a[80:83], v[76:79], v[24:27]
    ds_read_b64_tr_b16 v[68:69], v114 offset:49152
    s_waitcnt vmcnt(7)
    ds_read_b128 a[96:99], v121 offset:0
    ds_read_b128 a[100:103], v121 offset:2048
    ds_read_b128 a[104:107], v122 offset:0
    ds_read_b128 a[108:111], v122 offset:2048
    v_mfma_f32_16x16x32_bf16 v[28:31], a[84:87], v[76:79], v[28:31]
    ds_read_b64_tr_b16 v[70:71], v114 offset:49664
    s_waitcnt lgkmcnt(12)
    v_mfma_f32_16x16x32_bf16 v[0:3], a[88:91], v[80:83], v[0:3]
    ds_read_b64_tr_b16 v[72:73], v115 offset:49152
    v_mfma_f32_16x16x32_bf16 v[4:7], a[92:95], v[80:83], v[4:7]
    ds_read_b64_tr_b16 v[74:75], v115 offset:49664
    v_mfma_f32_16x16x32_bf16 v[8:11], a[88:91], v[84:87], v[8:11]
    ds_read_b64_tr_b16 v[76:77], v116 offset:49152
    v_mfma_f32_16x16x32_bf16 v[12:15], a[92:95], v[84:87], v[12:15]
    ds_read_b64_tr_b16 v[78:79], v116 offset:49664
    s_waitcnt lgkmcnt(12)
    v_mfma_f32_16x16x32_bf16 v[16:19], a[88:91], v[88:91], v[16:19]
    ds_read_b64_tr_b16 v[80:81], v113 offset:53248
    v_mfma_f32_16x16x32_bf16 v[20:23], a[92:95], v[88:91], v[20:23]
    ds_read_b64_tr_b16 v[82:83], v113 offset:53760
    v_mfma_f32_16x16x32_bf16 v[24:27], a[88:91], v[92:95], v[24:27]
    ds_read_b64_tr_b16 v[84:85], v114 offset:53248
    v_mfma_f32_16x16x32_bf16 v[28:31], a[92:95], v[92:95], v[28:31]
    ds_read_b64_tr_b16 v[86:87], v114 offset:53760
    s_waitcnt lgkmcnt(8)
    v_mfma_f32_16x16x32_bf16 v[0:3], a[96:99], v[64:67], v[0:3]
    ds_read_b64_tr_b16 v[88:89], v115 offset:53248
    v_mfma_f32_16x16x32_bf16 v[4:7], a[100:103], v[64:67], v[4:7]
    ds_read_b64_tr_b16 v[90:91], v115 offset:53760
    v_mfma_f32_16x16x32_bf16 v[8:11], a[96:99], v[68:71], v[8:11]
    ds_read_b64_tr_b16 v[92:93], v116 offset:53248
    v_mfma_f32_16x16x32_bf16 v[12:15], a[100:103], v[68:71], v[12:15]
    ds_read_b64_tr_b16 v[94:95], v116 offset:53760
    s_waitcnt lgkmcnt(8)
    v_mfma_f32_16x16x32_bf16 v[16:19], a[96:99], v[72:75], v[16:19]
    ds_read_b64_tr_b16 v[64:65], v113 offset:57344
    s_waitcnt vmcnt(1)
    v_rcp_f32 v127, v99
    v_lshlrev_b32 v104, 16, v100
    v_and_b32 v105, 0xffff0000, v100
    v_mfma_f32_16x16x32_bf16 v[20:23], a[100:103], v[72:75], v[20:23]
    ds_read_b64_tr_b16 v[66:67], v113 offset:57856
    v_lshlrev_b32 v106, 16, v101
    v_and_b32 v107, 0xffff0000, v101
    v_lshlrev_b32 v108, 16, v102
    v_mfma_f32_16x16x32_bf16 v[24:27], a[96:99], v[76:79], v[24:27]
    ds_read_b64_tr_b16 v[68:69], v114 offset:57344
    ds_read_b128 a[112:115], v121 offset:32768
    ds_read_b128 a[116:119], v121 offset:34816
    ds_read_b128 a[120:123], v122 offset:32768
    ds_read_b128 a[124:127], v122 offset:34816
    v_and_b32 v109, 0xffff0000, v102
    v_lshlrev_b32 v110, 16, v103
    v_and_b32 v111, 0xffff0000, v103
    v_mfma_f32_16x16x32_bf16 v[28:31], a[100:103], v[76:79], v[28:31]
    ds_read_b64_tr_b16 v[70:71], v114 offset:57856
    v_sub_f32 v104, v104, v98
    v_sub_f32 v105, v105, v98
    v_sub_f32 v106, v106, v98
    s_waitcnt lgkmcnt(12)
    v_mfma_f32_16x16x32_bf16 v[0:3], a[104:107], v[80:83], v[0:3]
    ds_read_b64_tr_b16 v[72:73], v115 offset:57344
    v_sub_f32 v107, v107, v98
    v_sub_f32 v108, v108, v98
    v_sub_f32 v109, v109, v98
    v_mfma_f32_16x16x32_bf16 v[4:7], a[108:111], v[80:83], v[4:7]
    ds_read_b64_tr_b16 v[74:75], v115 offset:57856
    v_sub_f32 v110, v110, v98
    v_sub_f32 v111, v111, v98
    v_cvt_pk_bf16_f32 v100, v104, v105
    v_mfma_f32_16x16x32_bf16 v[8:11], a[104:107], v[84:87], v[8:11]
    ds_read_b64_tr_b16 v[76:77], v116 offset:57344
    v_cvt_pk_bf16_f32 v101, v106, v107
    v_cvt_pk_bf16_f32 v102, v108, v109
    v_cvt_pk_bf16_f32 v103, v110, v111
    v_mfma_f32_16x16x32_bf16 v[12:15], a[108:111], v[84:87], v[12:15]
    ds_read_b64_tr_b16 v[78:79], v116 offset:57856
    v_lshlrev_b32 v104, 16, v100
    v_and_b32 v105, 0xffff0000, v100
    v_lshlrev_b32 v106, 16, v101
    s_waitcnt lgkmcnt(12)
    v_mfma_f32_16x16x32_bf16 v[16:19], a[104:107], v[88:91], v[16:19]
    ds_read_b64_tr_b16 v[80:81], v113 offset:61440
    v_and_b32 v107, 0xffff0000, v101
    v_lshlrev_b32 v108, 16, v102
    v_and_b32 v109, 0xffff0000, v102
    v_mfma_f32_16x16x32_bf16 v[20:23], a[108:111], v[88:91], v[20:23]
    ds_read_b64_tr_b16 v[82:83], v113 offset:61952
    v_lshlrev_b32 v110, 16, v103
    v_and_b32 v111, 0xffff0000, v103
    v_mul_f32 v125, v104, v127
    v_mfma_f32_16x16x32_bf16 v[24:27], a[104:107], v[92:95], v[24:27]
    ds_read_b64_tr_b16 v[84:85], v114 offset:61440
    v_fma_f32 v104, -v125, v99, v104
    v_fma_f32 v104, v104, v127, v125
    v_mul_f32 v125, v105, v127
    v_mfma_f32_16x16x32_bf16 v[28:31], a[108:111], v[92:95], v[28:31]
    ds_read_b64_tr_b16 v[86:87], v114 offset:61952
    v_fma_f32 v105, -v125, v99, v105
    v_fma_f32 v105, v105, v127, v125
    v_mul_f32 v125, v106, v127
    s_barrier
    s_waitcnt lgkmcnt(8)
    v_mfma_f32_16x16x32_bf16 v[0:3], a[112:115], v[64:67], v[0:3]
    ds_read_b64_tr_b16 v[88:89], v115 offset:61440
    s_add_u32 m0, s57, 40960
    v_fma_f32 v106, -v125, v99, v106
    v_fma_f32 v106, v106, v127, v125
    v_mul_f32 v125, v107, v127
    v_mfma_f32_16x16x32_bf16 v[4:7], a[116:119], v[64:67], v[4:7]
    ds_read_b64_tr_b16 v[90:91], v115 offset:61952
    s_add_u32 s52, s93, 128
    v_fma_f32 v107, -v125, v99, v107
    v_fma_f32 v107, v107, v127, v125
    v_mul_f32 v125, v108, v127
    v_mfma_f32_16x16x32_bf16 v[8:11], a[112:115], v[68:71], v[8:11]
    ds_read_b64_tr_b16 v[92:93], v116 offset:61440
    buffer_load_dwordx4 v117, s[12:15], s52 offen lds
    v_fma_f32 v108, -v125, v99, v108
    v_fma_f32 v108, v108, v127, v125
    v_mul_f32 v125, v109, v127
    v_mfma_f32_16x16x32_bf16 v[12:15], a[116:119], v[68:71], v[12:15]
    ds_read_b64_tr_b16 v[94:95], v116 offset:61952
    s_add_u32 m0, s57, 49152
    v_fma_f32 v109, -v125, v99, v109
    v_fma_f32 v109, v109, v127, v125
    v_mul_f32 v125, v110, v127
    s_waitcnt lgkmcnt(8)
    v_mfma_f32_16x16x32_bf16 v[16:19], a[112:115], v[72:75], v[16:19]
    ds_read_b64_tr_b16 v[64:65], v113 offset:0
    s_add_u32 s52, s94, 128
    v_fma_f32 v110, -v125, v99, v110
    v_fma_f32 v110, v110, v127, v125
    v_mul_f32 v125, v111, v127
    v_mfma_f32_16x16x32_bf16 v[20:23], a[116:119], v[72:75], v[20:23]
    ds_read_b64_tr_b16 v[66:67], v113 offset:512
    buffer_load_dwordx4 v117, s[12:15], s52 offen lds
    v_fma_f32 v111, -v125, v99, v111
    v_fma_f32 v111, v111, v127, v125
    v_cvt_pk_bf16_f32 v100, v104, v105
    v_mfma_f32_16x16x32_bf16 v[24:27], a[112:115], v[76:79], v[24:27]
    ds_read_b64_tr_b16 v[68:69], v114 offset:0
    v_cvt_pk_bf16_f32 v101, v106, v107
    v_cvt_pk_bf16_f32 v102, v108, v109
    v_cvt_pk_bf16_f32 v103, v110, v111
    v_mfma_f32_16x16x32_bf16 v[28:31], a[116:119], v[76:79], v[28:31]
    ds_read_b64_tr_b16 v[70:71], v114 offset:512
    v_and_b32 v125, 0x200, v112
    v_lshlrev_b32 v125, 2, v125
    v_and_b32 v127, 0x180, v112
    s_waitcnt lgkmcnt(8)
    v_mfma_f32_16x16x32_bf16 v[0:3], a[120:123], v[80:83], v[0:3]
    ds_read_b64_tr_b16 v[72:73], v115 offset:0
    v_lshl_add_u32 v125, v127, 1, v125
    v_and_b32 v127, 0x70, v112
    v_add_u32 v125, v125, v127
    v_mfma_f32_16x16x32_bf16 v[4:7], a[124:127], v[80:83], v[4:7]
    ds_read_b64_tr_b16 v[74:75], v115 offset:512
    s_lshr_b32 s71, s2, 2
    s_lshl_b32 s71, s71, 15
    s_and_b32 s72, s2, 1
    v_mfma_f32_16x16x32_bf16 v[8:11], a[120:123], v[84:87], v[8:11]
    ds_read_b64_tr_b16 v[76:77], v116 offset:0
    s_lshl_b32 s72, s72, 7
    s_add_u32 s71, s71, s72
    s_and_b32 s72, s2, 2
    v_mfma_f32_16x16x32_bf16 v[12:15], a[124:127], v[84:87], v[12:15]
    ds_read_b64_tr_b16 v[78:79], v116 offset:512
    s_lshl_b32 s72, s72, 9
    s_add_u32 s71, s71, s72
    s_lshl_b32 s72, s3, 12
    s_waitcnt lgkmcnt(8)
    v_mfma_f32_16x16x32_bf16 v[16:19], a[120:123], v[88:91], v[16:19]
    ds_read_b64_tr_b16 v[80:81], v113 offset:4096
    s_add_u32 s71, s71, s72
    buffer_store_dwordx4 v[100:103], v125, s[8:11], s71 offen sc1
    v_mfma_f32_16x16x32_bf16 v[20:23], a[124:127], v[88:91], v[20:23]
    ds_read_b64_tr_b16 v[82:83], v113 offset:4608
    v_mfma_f32_16x16x32_bf16 v[24:27], a[120:123], v[92:95], v[24:27]
    ds_read_b64_tr_b16 v[84:85], v114 offset:4096
    v_mfma_f32_16x16x32_bf16 v[28:31], a[124:127], v[92:95], v[28:31]
    ds_read_b64_tr_b16 v[86:87], v114 offset:4608
    s_waitcnt lgkmcnt(8)
    v_mfma_f32_16x16x32_bf16 v[32:35], a[0:3], v[64:67], 0
    ds_read_b64_tr_b16 v[88:89], v115 offset:4096
    v_mfma_f32_16x16x32_bf16 v[36:39], a[4:7], v[64:67], 0
    ds_read_b64_tr_b16 v[90:91], v115 offset:4608
    v_mfma_f32_16x16x32_bf16 v[40:43], a[0:3], v[68:71], 0
    ds_read_b64_tr_b16 v[92:93], v116 offset:4096
    v_mfma_f32_16x16x32_bf16 v[44:47], a[4:7], v[68:71], 0
    ds_read_b64_tr_b16 v[94:95], v116 offset:4608
    s_waitcnt lgkmcnt(8)
    v_mfma_f32_16x16x32_bf16 v[48:51], a[0:3], v[72:75], 0
    ds_read_b64_tr_b16 v[64:65], v113 offset:8192
    v_mfma_f32_16x16x32_bf16 v[52:55], a[4:7], v[72:75], 0
    ds_read_b64_tr_b16 v[66:67], v113 offset:8704
    v_mfma_f32_16x16x32_bf16 v[56:59], a[0:3], v[76:79], 0
    ds_read_b64_tr_b16 v[68:69], v114 offset:8192
    v_mfma_f32_16x16x32_bf16 v[60:63], a[4:7], v[76:79], 0
    ds_read_b64_tr_b16 v[70:71], v114 offset:8704
    s_waitcnt lgkmcnt(8)
    v_mfma_f32_16x16x32_bf16 v[32:35], a[8:11], v[80:83], v[32:35]
    ds_read_b64_tr_b16 v[72:73], v115 offset:8192
    v_cvt_pk_bf16_f32 v96, v0, v1
    v_mfma_f32_16x16x32_bf16 v[36:39], a[12:15], v[80:83], v[36:39]
    ds_read_b64_tr_b16 v[74:75], v115 offset:8704
    v_cvt_pk_bf16_f32 v97, v2, v3
    v_mfma_f32_16x16x32_bf16 v[40:43], a[8:11], v[84:87], v[40:43]
    ds_read_b64_tr_b16 v[76:77], v116 offset:8192
    v_cvt_pk_bf16_f32 v98, v4, v5
    v_mfma_f32_16x16x32_bf16 v[44:47], a[12:15], v[84:87], v[44:47]
    ds_read_b64_tr_b16 v[78:79], v116 offset:8704
    v_cvt_pk_bf16_f32 v99, v6, v7
    s_waitcnt lgkmcnt(8)
    v_mfma_f32_16x16x32_bf16 v[48:51], a[8:11], v[88:91], v[48:51]
    ds_read_b64_tr_b16 v[80:81], v113 offset:12288
    v_mfma_f32_16x16x32_bf16 v[52:55], a[12:15], v[88:91], v[52:55]
    ds_read_b64_tr_b16 v[82:83], v113 offset:12800
    v_mfma_f32_16x16x32_bf16 v[56:59], a[8:11], v[92:95], v[56:59]
    ds_read_b64_tr_b16 v[84:85], v114 offset:12288
    buffer_store_dwordx4 v[96:99], v112, s[8:11], s55 offen offset:0 sc1
    v_mfma_f32_16x16x32_bf16 v[60:63], a[12:15], v[92:95], v[60:63]
    ds_read_b64_tr_b16 v[86:87], v114 offset:12800
    s_barrier
    s_waitcnt lgkmcnt(8)
    v_mfma_f32_16x16x32_bf16 v[32:35], a[16:19], v[64:67], v[32:35]
    ds_read_b64_tr_b16 v[88:89], v115 offset:12288
    s_add_u32 m0, s57, 57344
    v_mfma_f32_16x16x32_bf16 v[36:39], a[20:23], v[64:67], v[36:39]
    ds_read_b64_tr_b16 v[90:91], v115 offset:12800
    s_add_u32 s52, s95, 128
    v_mfma_f32_16x16x32_bf16 v[40:43], a[16:19], v[68:71], v[40:43]
    ds_read_b64_tr_b16 v[92:93], v116 offset:12288
    buffer_load_dwordx4 v117, s[12:15], s52 offen lds
    v_mfma_f32_16x16x32_bf16 v[44:47], a[20:23], v[68:71], v[44:47]
    ds_read_b64_tr_b16 v[94:95], v116 offset:12800
    s_add_u32 m0, s57, 0
    s_waitcnt lgkmcnt(8)
    v_mfma_f32_16x16x32_bf16 v[48:51], a[16:19], v[72:75], v[48:51]
    ds_read_b64_tr_b16 v[64:65], v113 offset:16384
    s_add_u32 s52, s88, 256
    v_mfma_f32_16x16x32_bf16 v[52:55], a[20:23], v[72:75], v[52:55]
    ds_read_b64_tr_b16 v[66:67], v113 offset:16896
    buffer_load_dwordx4 v117, s[12:15], s52 offen lds
    v_mfma_f32_16x16x32_bf16 v[56:59], a[16:19], v[76:79], v[56:59]
    ds_read_b64_tr_b16 v[68:69], v114 offset:16384
    v_mfma_f32_16x16x32_bf16 v[60:63], a[20:23], v[76:79], v[60:63]
    ds_read_b64_tr_b16 v[70:71], v114 offset:16896
    s_waitcnt lgkmcnt(8)
    v_mfma_f32_16x16x32_bf16 v[32:35], a[24:27], v[80:83], v[32:35]
    ds_read_b64_tr_b16 v[72:73], v115 offset:16384
    v_mfma_f32_16x16x32_bf16 v[36:39], a[28:31], v[80:83], v[36:39]
    ds_read_b64_tr_b16 v[74:75], v115 offset:16896
    v_mfma_f32_16x16x32_bf16 v[40:43], a[24:27], v[84:87], v[40:43]
    ds_read_b64_tr_b16 v[76:77], v116 offset:16384
    v_mfma_f32_16x16x32_bf16 v[44:47], a[28:31], v[84:87], v[44:47]
    ds_read_b64_tr_b16 v[78:79], v116 offset:16896
    s_waitcnt lgkmcnt(8)
    v_mfma_f32_16x16x32_bf16 v[48:51], a[24:27], v[88:91], v[48:51]
    ds_read_b64_tr_b16 v[80:81], v113 offset:20480
    v_mfma_f32_16x16x32_bf16 v[52:55], a[28:31], v[88:91], v[52:55]
    ds_read_b64_tr_b16 v[82:83], v113 offset:20992
    v_mfma_f32_16x16x32_bf16 v[56:59], a[24:27], v[92:95], v[56:59]
    ds_read_b64_tr_b16 v[84:85], v114 offset:20480
    v_mfma_f32_16x16x32_bf16 v[60:63], a[28:31], v[92:95], v[60:63]
    ds_read_b64_tr_b16 v[86:87], v114 offset:20992
    s_waitcnt lgkmcnt(8)
    v_mfma_f32_16x16x32_bf16 v[32:35], a[32:35], v[64:67], v[32:35]
    ds_read_b64_tr_b16 v[88:89], v115 offset:20480
    v_mfma_f32_16x16x32_bf16 v[36:39], a[36:39], v[64:67], v[36:39]
    ds_read_b64_tr_b16 v[90:91], v115 offset:20992
    v_mfma_f32_16x16x32_bf16 v[40:43], a[32:35], v[68:71], v[40:43]
    ds_read_b64_tr_b16 v[92:93], v116 offset:20480
    v_mfma_f32_16x16x32_bf16 v[44:47], a[36:39], v[68:71], v[44:47]
    ds_read_b64_tr_b16 v[94:95], v116 offset:20992
    s_waitcnt lgkmcnt(8)
    v_mfma_f32_16x16x32_bf16 v[48:51], a[32:35], v[72:75], v[48:51]
    ds_read_b64_tr_b16 v[64:65], v113 offset:24576
    v_cvt_pk_bf16_f32 v100, v8, v9
    v_mfma_f32_16x16x32_bf16 v[52:55], a[36:39], v[72:75], v[52:55]
    ds_read_b64_tr_b16 v[66:67], v113 offset:25088
    v_cvt_pk_bf16_f32 v101, v10, v11
    v_mfma_f32_16x16x32_bf16 v[56:59], a[32:35], v[76:79], v[56:59]
    ds_read_b64_tr_b16 v[68:69], v114 offset:24576
    v_cvt_pk_bf16_f32 v102, v12, v13
    v_mfma_f32_16x16x32_bf16 v[60:63], a[36:39], v[76:79], v[60:63]
    ds_read_b64_tr_b16 v[70:71], v114 offset:25088
    v_cvt_pk_bf16_f32 v103, v14, v15
    s_waitcnt lgkmcnt(8)
    v_mfma_f32_16x16x32_bf16 v[32:35], a[40:43], v[80:83], v[32:35]
    ds_read_b64_tr_b16 v[72:73], v115 offset:24576
    v_mfma_f32_16x16x32_bf16 v[36:39], a[44:47], v[80:83], v[36:39]
    ds_read_b64_tr_b16 v[74:75], v115 offset:25088
    v_mfma_f32_16x16x32_bf16 v[40:43], a[40:43], v[84:87], v[40:43]
    ds_read_b64_tr_b16 v[76:77], v116 offset:24576
    buffer_store_dwordx4 v[100:103], v112, s[8:11], s55 offen offset:1024 sc1
    v_mfma_f32_16x16x32_bf16 v[44:47], a[44:47], v[84:87], v[44:47]
    ds_read_b64_tr_b16 v[78:79], v116 offset:25088
    s_waitcnt lgkmcnt(8)
    v_mfma_f32_16x16x32_bf16 v[48:51], a[40:43], v[88:91], v[48:51]
    ds_read_b64_tr_b16 v[80:81], v113 offset:28672
    v_mfma_f32_16x16x32_bf16 v[52:55], a[44:47], v[88:91], v[52:55]
    ds_read_b64_tr_b16 v[82:83], v113 offset:29184
    v_mfma_f32_16x16x32_bf16 v[56:59], a[40:43], v[92:95], v[56:59]
    ds_read_b64_tr_b16 v[84:85], v114 offset:28672
    v_mfma_f32_16x16x32_bf16 v[60:63], a[44:47], v[92:95], v[60:63]
    ds_read_b64_tr_b16 v[86:87], v114 offset:29184
    s_waitcnt vmcnt(4)
    s_barrier
    s_cmp_lg_u32 s3, 0
    s_cbranch_scc1 SG_5
    v_mov_b32 v127, 1
    buffer_atomic_add v127, v123, s[48:51], 0 offen offset:0 sc1
SG_5:
    s_waitcnt lgkmcnt(8)
    v_mfma_f32_16x16x32_bf16 v[32:35], a[48:51], v[64:67], v[32:35]
    ds_read_b64_tr_b16 v[88:89], v115 offset:28672
    s_add_u32 m0, s57, 8192
    v_mfma_f32_16x16x32_bf16 v[36:39], a[52:55], v[64:67], v[36:39]
    ds_read_b64_tr_b16 v[90:91], v115 offset:29184
    s_add_u32 s52, s89, 256
    v_mfma_f32_16x16x32_bf16 v[40:43], a[48:51], v[68:71], v[40:43]
    ds_read_b64_tr_b16 v[92:93], v116 offset:28672
    buffer_load_dwordx4 v117, s[12:15], s52 offen lds
    v_mfma_f32_16x16x32_bf16 v[44:47], a[52:55], v[68:71], v[44:47]
    ds_read_b64_tr_b16 v[94:95], v116 offset:29184
    s_add_u32 m0, s57, 16384
    s_waitcnt lgkmcnt(8)
    v_mfma_f32_16x16x32_bf16 v[48:51], a[48:51], v[72:75], v[48:51]
    ds_read_b64_tr_b16 v[64:65], v113 offset:32768
    s_add_u32 s52, s90, 256
    v_mfma_f32_16x16x32_bf16 v[52:55], a[52:55], v[72:75], v[52:55]
    ds_read_b64_tr_b16 v[66:67], v113 offset:33280
    buffer_load_dwordx4 v117, s[12:15], s52 offen lds
    v_mfma_f32_16x16x32_bf16 v[56:59], a[48:51], v[76:79], v[56:59]
    ds_read_b64_tr_b16 v[68:69], v114 offset:32768
    v_mfma_f32_16x16x32_bf16 v[60:63], a[52:55], v[76:79], v[60:63]
    ds_read_b64_tr_b16 v[70:71], v114 offset:33280
    s_waitcnt lgkmcnt(8)
    v_mfma_f32_16x16x32_bf16 v[32:35], a[56:59], v[80:83], v[32:35]
    ds_read_b64_tr_b16 v[72:73], v115 offset:32768
    v_mfma_f32_16x16x32_bf16 v[36:39], a[60:63], v[80:83], v[36:39]
    ds_read_b64_tr_b16 v[74:75], v115 offset:33280
    v_mfma_f32_16x16x32_bf16 v[40:43], a[56:59], v[84:87], v[40:43]
    ds_read_b64_tr_b16 v[76:77], v116 offset:32768
    v_mfma_f32_16x16x32_bf16 v[44:47], a[60:63], v[84:87], v[44:47]
    ds_read_b64_tr_b16 v[78:79], v116 offset:33280
    s_waitcnt lgkmcnt(8)
    v_mfma_f32_16x16x32_bf16 v[48:51], a[56:59], v[88:91], v[48:51]
    ds_read_b64_tr_b16 v[80:81], v113 offset:36864
    v_mfma_f32_16x16x32_bf16 v[52:55], a[60:63], v[88:91], v[52:55]
    ds_read_b64_tr_b16 v[82:83], v113 offset:37376
    v_mfma_f32_16x16x32_bf16 v[56:59], a[56:59], v[92:95], v[56:59]
    ds_read_b64_tr_b16 v[84:85], v114 offset:36864
    v_mfma_f32_16x16x32_bf16 v[60:63], a[60:63], v[92:95], v[60:63]
    ds_read_b64_tr_b16 v[86:87], v114 offset:37376
    s_waitcnt lgkmcnt(8)
    v_mfma_f32_16x16x32_bf16 v[32:35], a[64:67], v[64:67], v[32:35]
    ds_read_b64_tr_b16 v[88:89], v115 offset:36864
    v_cvt_pk_bf16_f32 v104, v16, v17
    v_mfma_f32_16x16x32_bf16 v[36:39], a[68:71], v[64:67], v[36:39]
    ds_read_b64_tr_b16 v[90:91], v115 offset:37376
    v_cvt_pk_bf16_f32 v105, v18, v19
    v_mfma_f32_16x16x32_bf16 v[40:43], a[64:67], v[68:71], v[40:43]
    ds_read_b64_tr_b16 v[92:93], v116 offset:36864
    v_cvt_pk_bf16_f32 v106, v20, v21
    v_mfma_f32_16x16x32_bf16 v[44:47], a[68:71], v[68:71], v[44:47]
    ds_read_b64_tr_b16 v[94:95], v116 offset:37376
    v_cvt_pk_bf16_f32 v107, v22, v23
    s_waitcnt lgkmcnt(8)
    v_mfma_f32_16x16x32_bf16 v[48:51], a[64:67], v[72:75], v[48:51]
    ds_read_b64_tr_b16 v[64:65], v113 offset:40960
    v_mfma_f32_16x16x32_bf16 v[52:55], a[68:71], v[72:75], v[52:55]
    ds_read_b64_tr_b16 v[66:67], v113 offset:41472
    v_mfma_f32_16x16x32_bf16 v[56:59], a[64:67], v[76:79], v[56:59]
    ds_read_b64_tr_b16 v[68:69], v114 offset:40960
    buffer_store_dwordx4 v[104:107], v112, s[8:11], s55 offen offset:2048 sc1
    v_mfma_f32_16x16x32_bf16 v[60:63], a[68:71], v[76:79], v[60:63]
    ds_read_b64_tr_b16 v[70:71], v114 offset:41472
    s_waitcnt lgkmcnt(8)
    v_mfma_f32_16x16x32_bf16 v[32:35], a[72:75], v[80:83], v[32:35]
    ds_read_b64_tr_b16 v[72:73], v115 offset:40960
    v_mfma_f32_16x16x32_bf16 v[36:39], a[76:79], v[80:83], v[36:39]
    ds_read_b64_tr_b16 v[74:75], v115 offset:41472
    v_mfma_f32_16x16x32_bf16 v[40:43], a[72:75], v[84:87], v[40:43]
    ds_read_b64_tr_b16 v[76:77], v116 offset:40960
    v_mfma_f32_16x16x32_bf16 v[44:47], a[76:79], v[84:87], v[44:47]
    ds_read_b64_tr_b16 v[78:79], v116 offset:41472
    s_waitcnt lgkmcnt(8)
    v_mfma_f32_16x16x32_bf16 v[48:51], a[72:75], v[88:91], v[48:51]
    ds_read_b64_tr_b16 v[80:81], v113 offset:45056
    v_mfma_f32_16x16x32_bf16 v[52:55], a[76:79], v[88:91], v[52:55]
    ds_read_b64_tr_b16 v[82:83], v113 offset:45568
    v_mfma_f32_16x16x32_bf16 v[56:59], a[72:75], v[92:95], v[56:59]
    ds_read_b64_tr_b16 v[84:85], v114 offset:45056
    v_mfma_f32_16x16x32_bf16 v[60:63], a[76:79], v[92:95], v[60:63]
    ds_read_b64_tr_b16 v[86:87], v114 offset:45568
    s_waitcnt vmcnt(5)
    s_barrier
    s_waitcnt lgkmcnt(8)
    v_mfma_f32_16x16x32_bf16 v[32:35], a[80:83], v[64:67], v[32:35]
    ds_read_b64_tr_b16 v[88:89], v115 offset:45056
    s_add_u32 m0, s57, 24576
    v_mfma_f32_16x16x32_bf16 v[36:39], a[84:87], v[64:67], v[36:39]
    ds_read_b64_tr_b16 v[90:91], v115 offset:45568
    s_add_u32 s52, s91, 256
    v_mfma_f32_16x16x32_bf16 v[40:43], a[80:83], v[68:71], v[40:43]
    ds_read_b64_tr_b16 v[92:93], v116 offset:45056
    buffer_load_dwordx4 v117, s[12:15], s52 offen lds
    v_mfma_f32_16x16x32_bf16 v[44:47], a[84:87], v[68:71], v[44:47]
    ds_read_b64_tr_b16 v[94:95], v116 offset:45568
    s_add_u32 m0, s57, 32768
    s_waitcnt lgkmcnt(8)
    v_mfma_f32_16x16x32_bf16 v[48:51], a[80:83], v[72:75], v[48:51]
    ds_read_b64_tr_b16 v[64:65], v113 offset:49152
    s_add_u32 s52, s92, 256
    v_mfma_f32_16x16x32_bf16 v[52:55], a[84:87], v[72:75], v[52:55]
    ds_read_b64_tr_b16 v[66:67], v113 offset:49664
    buffer_load_dwordx4 v117, s[12:15], s52 offen lds
    v_mfma_f32_16x16x32_bf16 v[56:59], a[80:83], v[76:79], v[56:59]
    ds_read_b64_tr_b16 v[68:69], v114 offset:49152
    v_mfma_f32_16x16x32_bf16 v[60:63], a[84:87], v[76:79], v[60:63]
    ds_read_b64_tr_b16 v[70:71], v114 offset:49664
    s_waitcnt lgkmcnt(8)
    v_mfma_f32_16x16x32_bf16 v[32:35], a[88:91], v[80:83], v[32:35]
    ds_read_b64_tr_b16 v[72:73], v115 offset:49152
    v_mfma_f32_16x16x32_bf16 v[36:39], a[92:95], v[80:83], v[36:39]
    ds_read_b64_tr_b16 v[74:75], v115 offset:49664
    v_mfma_f32_16x16x32_bf16 v[40:43], a[88:91], v[84:87], v[40:43]
    ds_read_b64_tr_b16 v[76:77], v116 offset:49152
    v_mfma_f32_16x16x32_bf16 v[44:47], a[92:95], v[84:87], v[44:47]
    ds_read_b64_tr_b16 v[78:79], v116 offset:49664
    s_waitcnt lgkmcnt(8)
    v_mfma_f32_16x16x32_bf16 v[48:51], a[88:91], v[88:91], v[48:51]
    ds_read_b64_tr_b16 v[80:81], v113 offset:53248
    v_cvt_pk_bf16_f32 v108, v24, v25
    v_mfma_f32_16x16x32_bf16 v[52:55], a[92:95], v[88:91], v[52:55]
    ds_read_b64_tr_b16 v[82:83], v113 offset:53760
    v_cvt_pk_bf16_f32 v109, v26, v27
    v_mfma_f32_16x16x32_bf16 v[56:59], a[88:91], v[92:95], v[56:59]
    ds_read_b64_tr_b16 v[84:85], v114 offset:53248
    v_cvt_pk_bf16_f32 v110, v28, v29
    v_mfma_f32_16x16x32_bf16 v[60:63], a[92:95], v[92:95], v[60:63]
    ds_read_b64_tr_b16 v[86:87], v114 offset:53760
    v_cvt_pk_bf16_f32 v111, v30, v31
    s_waitcnt lgkmcnt(8)
    v_mfma_f32_16x16x32_bf16 v[32:35], a[96:99], v[64:67], v[32:35]
    ds_read_b64_tr_b16 v[88:89], v115 offset:53248
    v_mfma_f32_16x16x32_bf16 v[36:39], a[100:103], v[64:67], v[36:39]
    ds_read_b64_tr_b16 v[90:91], v115 offset:53760
    v_mfma_f32_16x16x32_bf16 v[40:43], a[96:99], v[68:71], v[40:43]
    ds_read_b64_tr_b16 v[92:93], v116 offset:53248
    buffer_store_dwordx4 v[108:111], v112, s[8:11], s55 offen offset:3072 sc1
    v_mfma_f32_16x16x32_bf16 v[44:47], a[100:103], v[68:71], v[44:47]
    ds_read_b64_tr_b16 v[94:95], v116 offset:53760
    s_waitcnt lgkmcnt(8)
    v_mfma_f32_16x16x32_bf16 v[48:51], a[96:99], v[72:75], v[48:51]
    ds_read_b64_tr_b16 v[64:65], v113 offset:57344
    v_mfma_f32_16x16x32_bf16 v[52:55], a[100:103], v[72:75], v[52:55]
    ds_read_b64_tr_b16 v[66:67], v113 offset:57856
    v_mfma_f32_16x16x32_bf16 v[56:59], a[96:99], v[76:79], v[56:59]
    ds_read_b64_tr_b16 v[68:69], v114 offset:57344
    v_mfma_f32_16x16x32_bf16 v[60:63], a[100:103], v[76:79], v[60:63]
    ds_read_b64_tr_b16 v[70:71], v114 offset:57856
    s_waitcnt lgkmcnt(8)
    v_mfma_f32_16x16x32_bf16 v[32:35], a[104:107], v[80:83], v[32:35]
    ds_read_b64_tr_b16 v[72:73], v115 offset:57344
    v_mfma_f32_16x16x32_bf16 v[36:39], a[108:111], v[80:83], v[36:39]
    ds_read_b64_tr_b16 v[74:75], v115 offset:57856
    v_mfma_f32_16x16x32_bf16 v[40:43], a[104:107], v[84:87], v[40:43]
    ds_read_b64_tr_b16 v[76:77], v116 offset:57344
    v_mfma_f32_16x16x32_bf16 v[44:47], a[108:111], v[84:87], v[44:47]
    ds_read_b64_tr_b16 v[78:79], v116 offset:57856
    s_waitcnt lgkmcnt(8)
    v_mfma_f32_16x16x32_bf16 v[48:51], a[104:107], v[88:91], v[48:51]
    ds_read_b64_tr_b16 v[80:81], v113 offset:61440
    v_mfma_f32_16x16x32_bf16 v[52:55], a[108:111], v[88:91], v[52:55]
    ds_read_b64_tr_b16 v[82:83], v113 offset:61952
    v_mfma_f32_16x16x32_bf16 v[56:59], a[104:107], v[92:95], v[56:59]
    ds_read_b64_tr_b16 v[84:85], v114 offset:61440
    v_mfma_f32_16x16x32_bf16 v[60:63], a[108:111], v[92:95], v[60:63]
    ds_read_b64_tr_b16 v[86:87], v114 offset:61952
    s_waitcnt vmcnt(5)
    s_barrier
    s_waitcnt lgkmcnt(8)
    v_mfma_f32_16x16x32_bf16 v[32:35], a[112:115], v[64:67], v[32:35]
    ds_read_b64_tr_b16 v[88:89], v115 offset:61440
    s_add_u32 m0, s57, 40960
    v_mfma_f32_16x16x32_bf16 v[36:39], a[116:119], v[64:67], v[36:39]
    ds_read_b64_tr_b16 v[90:91], v115 offset:61952
    s_add_u32 s52, s93, 256
    v_mfma_f32_16x16x32_bf16 v[40:43], a[112:115], v[68:71], v[40:43]
    ds_read_b64_tr_b16 v[92:93], v116 offset:61440
    buffer_load_dwordx4 v117, s[12:15], s52 offen lds
    v_mfma_f32_16x16x32_bf16 v[44:47], a[116:119], v[68:71], v[44:47]
    ds_read_b64_tr_b16 v[94:95], v116 offset:61952
    s_add_u32 m0, s57, 49152
    s_waitcnt lgkmcnt(8)
    v_mfma_f32_16x16x32_bf16 v[48:51], a[112:115], v[72:75], v[48:51]
    ds_read_b64_tr_b16 v[64:65], v113 offset:0
    s_add_u32 s52, s94, 256
    v_mfma_f32_16x16x32_bf16 v[52:55], a[116:119], v[72:75], v[52:55]
    ds_read_b64_tr_b16 v[66:67], v113 offset:512
    buffer_load_dwordx4 v117, s[12:15], s52 offen lds
    v_mfma_f32_16x16x32_bf16 v[56:59], a[112:115], v[76:79], v[56:59]
    ds_read_b64_tr_b16 v[68:69], v114 offset:0
    v_mfma_f32_16x16x32_bf16 v[60:63], a[116:119], v[76:79], v[60:63]
    ds_read_b64_tr_b16 v[70:71], v114 offset:512
    s_waitcnt lgkmcnt(8)
    v_mfma_f32_16x16x32_bf16 v[32:35], a[120:123], v[80:83], v[32:35]
    ds_read_b64_tr_b16 v[72:73], v115 offset:0
    v_mfma_f32_16x16x32_bf16 v[36:39], a[124:127], v[80:83], v[36:39]
    ds_read_b64_tr_b16 v[74:75], v115 offset:512
    v_mfma_f32_16x16x32_bf16 v[40:43], a[120:123], v[84:87], v[40:43]
    ds_read_b64_tr_b16 v[76:77], v116 offset:0
    s_add_u32 s55, s55, 0x80000
    v_mfma_f32_16x16x32_bf16 v[44:47], a[124:127], v[84:87], v[44:47]
    ds_read_b64_tr_b16 v[78:79], v116 offset:512
    s_waitcnt lgkmcnt(8)
    v_mfma_f32_16x16x32_bf16 v[48:51], a[120:123], v[88:91], v[48:51]
    ds_read_b64_tr_b16 v[80:81], v113 offset:4096
    v_mfma_f32_16x16x32_bf16 v[52:55], a[124:127], v[88:91], v[52:55]
    ds_read_b64_tr_b16 v[82:83], v113 offset:4608
    v_mfma_f32_16x16x32_bf16 v[56:59], a[120:123], v[92:95], v[56:59]
    ds_read_b64_tr_b16 v[84:85], v114 offset:4096
    v_mfma_f32_16x16x32_bf16 v[60:63], a[124:127], v[92:95], v[60:63]
    ds_read_b64_tr_b16 v[86:87], v114 offset:4608
    s_waitcnt lgkmcnt(8)
    v_mfma_f32_16x16x32_bf16 v[0:3], a[0:3], v[64:67], 0
    ds_read_b64_tr_b16 v[88:89], v115 offset:4096
    v_mfma_f32_16x16x32_bf16 v[4:7], a[4:7], v[64:67], 0
    ds_read_b64_tr_b16 v[90:91], v115 offset:4608
    v_mfma_f32_16x16x32_bf16 v[8:11], a[0:3], v[68:71], 0
    ds_read_b64_tr_b16 v[92:93], v116 offset:4096
    v_mfma_f32_16x16x32_bf16 v[12:15], a[4:7], v[68:71], 0
    ds_read_b64_tr_b16 v[94:95], v116 offset:4608
    s_waitcnt lgkmcnt(8)
    v_mfma_f32_16x16x32_bf16 v[16:19], a[0:3], v[72:75], 0
    ds_read_b64_tr_b16 v[64:65], v113 offset:8192
    v_mfma_f32_16x16x32_bf16 v[20:23], a[4:7], v[72:75], 0
    ds_read_b64_tr_b16 v[66:67], v113 offset:8704
    v_mfma_f32_16x16x32_bf16 v[24:27], a[0:3], v[76:79], 0
    ds_read_b64_tr_b16 v[68:69], v114 offset:8192
    v_mfma_f32_16x16x32_bf16 v[28:31], a[4:7], v[76:79], 0
    ds_read_b64_tr_b16 v[70:71], v114 offset:8704
    s_waitcnt lgkmcnt(8)
    v_mfma_f32_16x16x32_bf16 v[0:3], a[8:11], v[80:83], v[0:3]
    ds_read_b64_tr_b16 v[72:73], v115 offset:8192
    v_cvt_pk_bf16_f32 v96, v32, v33
    v_mfma_f32_16x16x32_bf16 v[4:7], a[12:15], v[80:83], v[4:7]
    ds_read_b64_tr_b16 v[74:75], v115 offset:8704
    v_cvt_pk_bf16_f32 v97, v34, v35
    v_mfma_f32_16x16x32_bf16 v[8:11], a[8:11], v[84:87], v[8:11]
    ds_read_b64_tr_b16 v[76:77], v116 offset:8192
    v_cvt_pk_bf16_f32 v98, v36, v37
    v_mfma_f32_16x16x32_bf16 v[12:15], a[12:15], v[84:87], v[12:15]
    ds_read_b64_tr_b16 v[78:79], v116 offset:8704
    v_cvt_pk_bf16_f32 v99, v38, v39
    s_waitcnt lgkmcnt(8)
    v_mfma_f32_16x16x32_bf16 v[16:19], a[8:11], v[88:91], v[16:19]
    ds_read_b64_tr_b16 v[80:81], v113 offset:12288
    v_mfma_f32_16x16x32_bf16 v[20:23], a[12:15], v[88:91], v[20:23]
    ds_read_b64_tr_b16 v[82:83], v113 offset:12800
    v_mfma_f32_16x16x32_bf16 v[24:27], a[8:11], v[92:95], v[24:27]
    ds_read_b64_tr_b16 v[84:85], v114 offset:12288
    buffer_store_dwordx4 v[96:99], v112, s[8:11], s56 offen offset:0 sc1
    v_mfma_f32_16x16x32_bf16 v[28:31], a[12:15], v[92:95], v[28:31]
    ds_read_b64_tr_b16 v[86:87], v114 offset:12800
    s_waitcnt vmcnt(5)
    s_barrier
    s_waitcnt lgkmcnt(8)
    v_mfma_f32_16x16x32_bf16 v[0:3], a[16:19], v[64:67], v[0:3]
    ds_read_b64_tr_b16 v[88:89], v115 offset:12288
    s_add_u32 m0, s57, 57344
    v_mfma_f32_16x16x32_bf16 v[4:7], a[20:23], v[64:67], v[4:7]
    ds_read_b64_tr_b16 v[90:91], v115 offset:12800
    s_add_u32 s52, s95, 256
    v_mfma_f32_16x16x32_bf16 v[8:11], a[16:19], v[68:71], v[8:11]
    ds_read_b64_tr_b16 v[92:93], v116 offset:12288
    buffer_load_dwordx4 v117, s[12:15], s52 offen lds
    v_mfma_f32_16x16x32_bf16 v[12:15], a[20:23], v[68:71], v[12:15]
    ds_read_b64_tr_b16 v[94:95], v116 offset:12800
    s_add_u32 m0, s57, 0
    s_waitcnt lgkmcnt(8)
    v_mfma_f32_16x16x32_bf16 v[16:19], a[16:19], v[72:75], v[16:19]
    ds_read_b64_tr_b16 v[64:65], v113 offset:16384
    s_add_u32 s52, s88, 384
    v_mfma_f32_16x16x32_bf16 v[20:23], a[20:23], v[72:75], v[20:23]
    ds_read_b64_tr_b16 v[66:67], v113 offset:16896
    buffer_load_dwordx4 v117, s[12:15], s52 offen lds
    v_mfma_f32_16x16x32_bf16 v[24:27], a[16:19], v[76:79], v[24:27]
    ds_read_b64_tr_b16 v[68:69], v114 offset:16384
    v_mfma_f32_16x16x32_bf16 v[28:31], a[20:23], v[76:79], v[28:31]
    ds_read_b64_tr_b16 v[70:71], v114 offset:16896
    s_waitcnt lgkmcnt(8)
    v_mfma_f32_16x16x32_bf16 v[0:3], a[24:27], v[80:83], v[0:3]
    ds_read_b64_tr_b16 v[72:73], v115 offset:16384
    v_mfma_f32_16x16x32_bf16 v[4:7], a[28:31], v[80:83], v[4:7]
    ds_read_b64_tr_b16 v[74:75], v115 offset:16896
    v_mfma_f32_16x16x32_bf16 v[8:11], a[24:27], v[84:87], v[8:11]
    ds_read_b64_tr_b16 v[76:77], v116 offset:16384
    v_mfma_f32_16x16x32_bf16 v[12:15], a[28:31], v[84:87], v[12:15]
    ds_read_b64_tr_b16 v[78:79], v116 offset:16896
    s_waitcnt lgkmcnt(8)
    v_mfma_f32_16x16x32_bf16 v[16:19], a[24:27], v[88:91], v[16:19]
    ds_read_b64_tr_b16 v[80:81], v113 offset:20480
    v_mfma_f32_16x16x32_bf16 v[20:23], a[28:31], v[88:91], v[20:23]
    ds_read_b64_tr_b16 v[82:83], v113 offset:20992
    v_mfma_f32_16x16x32_bf16 v[24:27], a[24:27], v[92:95], v[24:27]
    ds_read_b64_tr_b16 v[84:85], v114 offset:20480
    v_mfma_f32_16x16x32_bf16 v[28:31], a[28:31], v[92:95], v[28:31]
    ds_read_b64_tr_b16 v[86:87], v114 offset:20992
    s_waitcnt lgkmcnt(8)
    v_mfma_f32_16x16x32_bf16 v[0:3], a[32:35], v[64:67], v[0:3]
    ds_read_b64_tr_b16 v[88:89], v115 offset:20480
    v_mfma_f32_16x16x32_bf16 v[4:7], a[36:39], v[64:67], v[4:7]
    ds_read_b64_tr_b16 v[90:91], v115 offset:20992
    v_mfma_f32_16x16x32_bf16 v[8:11], a[32:35], v[68:71], v[8:11]
    ds_read_b64_tr_b16 v[92:93], v116 offset:20480
    v_mfma_f32_16x16x32_bf16 v[12:15], a[36:39], v[68:71], v[12:15]
    ds_read_b64_tr_b16 v[94:95], v116 offset:20992
    s_waitcnt lgkmcnt(8)
    v_mfma_f32_16x16x32_bf16 v[16:19], a[32:35], v[72:75], v[16:19]
    ds_read_b64_tr_b16 v[64:65], v113 offset:24576
    v_cvt_pk_bf16_f32 v100, v40, v41
    v_mfma_f32_16x16x32_bf16 v[20:23], a[36:39], v[72:75], v[20:23]
    ds_read_b64_tr_b16 v[66:67], v113 offset:25088
    v_cvt_pk_bf16_f32 v101, v42, v43
    v_mfma_f32_16x16x32_bf16 v[24:27], a[32:35], v[76:79], v[24:27]
    ds_read_b64_tr_b16 v[68:69], v114 offset:24576
    v_cvt_pk_bf16_f32 v102, v44, v45
    v_mfma_f32_16x16x32_bf16 v[28:31], a[36:39], v[76:79], v[28:31]
    ds_read_b64_tr_b16 v[70:71], v114 offset:25088
    v_cvt_pk_bf16_f32 v103, v46, v47
    s_waitcnt lgkmcnt(8)
    v_mfma_f32_16x16x32_bf16 v[0:3], a[40:43], v[80:83], v[0:3]
    ds_read_b64_tr_b16 v[72:73], v115 offset:24576
    v_mfma_f32_16x16x32_bf16 v[4:7], a[44:47], v[80:83], v[4:7]
    ds_read_b64_tr_b16 v[74:75], v115 offset:25088
    v_mfma_f32_16x16x32_bf16 v[8:11], a[40:43], v[84:87], v[8:11]
    ds_read_b64_tr_b16 v[76:77], v116 offset:24576
    buffer_store_dwordx4 v[100:103], v112, s[8:11], s56 offen offset:1024 sc1
    v_mfma_f32_16x16x32_bf16 v[12:15], a[44:47], v[84:87], v[12:15]
    ds_read_b64_tr_b16 v[78:79], v116 offset:25088
    s_waitcnt lgkmcnt(8)
    v_mfma_f32_16x16x32_bf16 v[16:19], a[40:43], v[88:91], v[16:19]
    ds_read_b64_tr_b16 v[80:81], v113 offset:28672
    v_mfma_f32_16x16x32_bf16 v[20:23], a[44:47], v[88:91], v[20:23]
    ds_read_b64_tr_b16 v[82:83], v113 offset:29184
    v_mfma_f32_16x16x32_bf16 v[24:27], a[40:43], v[92:95], v[24:27]
    ds_read_b64_tr_b16 v[84:85], v114 offset:28672
    v_mfma_f32_16x16x32_bf16 v[28:31], a[44:47], v[92:95], v[28:31]
    ds_read_b64_tr_b16 v[86:87], v114 offset:29184
    s_waitcnt vmcnt(5)
    s_barrier
    s_waitcnt lgkmcnt(8)
    v_mfma_f32_16x16x32_bf16 v[0:3], a[48:51], v[64:67], v[0:3]
    ds_read_b64_tr_b16 v[88:89], v115 offset:28672
    s_add_u32 m0, s57, 8192
    v_mfma_f32_16x16x32_bf16 v[4:7], a[52:55], v[64:67], v[4:7]
    ds_read_b64_tr_b16 v[90:91], v115 offset:29184
    s_add_u32 s52, s89, 384
    v_mfma_f32_16x16x32_bf16 v[8:11], a[48:51], v[68:71], v[8:11]
    ds_read_b64_tr_b16 v[92:93], v116 offset:28672
    buffer_load_dwordx4 v117, s[12:15], s52 offen lds
    v_mfma_f32_16x16x32_bf16 v[12:15], a[52:55], v[68:71], v[12:15]
    ds_read_b64_tr_b16 v[94:95], v116 offset:29184
    s_add_u32 m0, s57, 16384
    s_waitcnt lgkmcnt(8)
    v_mfma_f32_16x16x32_bf16 v[16:19], a[48:51], v[72:75], v[16:19]
    ds_read_b64_tr_b16 v[64:65], v113 offset:32768
    s_add_u32 s52, s90, 384
    v_mfma_f32_16x16x32_bf16 v[20:23], a[52:55], v[72:75], v[20:23]
    ds_read_b64_tr_b16 v[66:67], v113 offset:33280
    buffer_load_dwordx4 v117, s[12:15], s52 offen lds
    v_mfma_f32_16x16x32_bf16 v[24:27], a[48:51], v[76:79], v[24:27]
    ds_read_b64_tr_b16 v[68:69], v114 offset:32768
    s_add_u32 m0, s57, 65536
    v_mfma_f32_16x16x32_bf16 v[28:31], a[52:55], v[76:79], v[28:31]
    ds_read_b64_tr_b16 v[70:71], v114 offset:33280
    s_add_u32 s52, s96, 0
    s_waitcnt lgkmcnt(8)
    v_mfma_f32_16x16x32_bf16 v[0:3], a[56:59], v[80:83], v[0:3]
    ds_read_b64_tr_b16 v[72:73], v115 offset:32768
    s_and_b32 s52, s52, 7
    v_mfma_f32_16x16x32_bf16 v[4:7], a[60:63], v[80:83], v[4:7]
    ds_read_b64_tr_b16 v[74:75], v115 offset:33280
    s_mul_i32 s52, s52, 229376
    v_mfma_f32_16x16x32_bf16 v[8:11], a[56:59], v[84:87], v[8:11]
    ds_read_b64_tr_b16 v[76:77], v116 offset:32768
    s_add_u32 s52, s52, s64
    v_mfma_f32_16x16x32_bf16 v[12:15], a[60:63], v[84:87], v[12:15]
    ds_read_b64_tr_b16 v[78:79], v116 offset:33280
    buffer_load_dwordx4 v118, s[28:31], s52 offen lds
    s_waitcnt lgkmcnt(8)
    v_mfma_f32_16x16x32_bf16 v[16:19], a[56:59], v[88:91], v[16:19]
    ds_read_b64_tr_b16 v[80:81], v113 offset:36864
    s_add_u32 m0, s57, 73728
    v_mfma_f32_16x16x32_bf16 v[20:23], a[60:63], v[88:91], v[20:23]
    ds_read_b64_tr_b16 v[82:83], v113 offset:37376
    s_nop 0
    v_mfma_f32_16x16x32_bf16 v[24:27], a[56:59], v[92:95], v[24:27]
    ds_read_b64_tr_b16 v[84:85], v114 offset:36864
    buffer_load_dwordx4 v118, s[32:35], s52 offen offset:0 lds
    v_mfma_f32_16x16x32_bf16 v[28:31], a[60:63], v[92:95], v[28:31]
    ds_read_b64_tr_b16 v[86:87], v114 offset:37376
    s_waitcnt lgkmcnt(8)
    v_mfma_f32_16x16x32_bf16 v[0:3], a[64:67], v[64:67], v[0:3]
    ds_read_b64_tr_b16 v[88:89], v115 offset:36864
    v_cvt_pk_bf16_f32 v104, v48, v49
    v_mfma_f32_16x16x32_bf16 v[4:7], a[68:71], v[64:67], v[4:7]
    ds_read_b64_tr_b16 v[90:91], v115 offset:37376
    v_cvt_pk_bf16_f32 v105, v50, v51
    v_mfma_f32_16x16x32_bf16 v[8:11], a[64:67], v[68:71], v[8:11]
    ds_read_b64_tr_b16 v[92:93], v116 offset:36864
    v_cvt_pk_bf16_f32 v106, v52, v53
    v_mfma_f32_16x16x32_bf16 v[12:15], a[68:71], v[68:71], v[12:15]
    ds_read_b64_tr_b16 v[94:95], v116 offset:37376
    v_cvt_pk_bf16_f32 v107, v54, v55
    s_waitcnt lgkmcnt(8)
    v_mfma_f32_16x16x32_bf16 v[16:19], a[64:67], v[72:75], v[16:19]
    ds_read_b64_tr_b16 v[64:65], v113 offset:40960
    v_mfma_f32_16x16x32_bf16 v[20:23], a[68:71], v[72:75], v[20:23]
    ds_read_b64_tr_b16 v[66:67], v113 offset:41472
    v_mfma_f32_16x16x32_bf16 v[24:27], a[64:67], v[76:79], v[24:27]
    ds_read_b64_tr_b16 v[68:69], v114 offset:40960
    buffer_store_dwordx4 v[104:107], v112, s[8:11], s56 offen offset:2048 sc1
    v_mfma_f32_16x16x32_bf16 v[28:31], a[68:71], v[76:79], v[28:31]
    ds_read_b64_tr_b16 v[70:71], v114 offset:41472
    s_waitcnt lgkmcnt(8)
    v_mfma_f32_16x16x32_bf16 v[0:3], a[72:75], v[80:83], v[0:3]
    ds_read_b64_tr_b16 v[72:73], v115 offset:40960
    v_mfma_f32_16x16x32_bf16 v[4:7], a[76:79], v[80:83], v[4:7]
    ds_read_b64_tr_b16 v[74:75], v115 offset:41472
    v_mfma_f32_16x16x32_bf16 v[8:11], a[72:75], v[84:87], v[8:11]
    ds_read_b64_tr_b16 v[76:77], v116 offset:40960
    v_mfma_f32_16x16x32_bf16 v[12:15], a[76:79], v[84:87], v[12:15]
    ds_read_b64_tr_b16 v[78:79], v116 offset:41472
    s_waitcnt lgkmcnt(8)
    v_mfma_f32_16x16x32_bf16 v[16:19], a[72:75], v[88:91], v[16:19]
    ds_read_b64_tr_b16 v[80:81], v113 offset:45056
    v_mfma_f32_16x16x32_bf16 v[20:23], a[76:79], v[88:91], v[20:23]
    ds_read_b64_tr_b16 v[82:83], v113 offset:45568
    v_mfma_f32_16x16x32_bf16 v[24:27], a[72:75], v[92:95], v[24:27]
    ds_read_b64_tr_b16 v[84:85], v114 offset:45056
    v_mfma_f32_16x16x32_bf16 v[28:31], a[76:79], v[92:95], v[28:31]
    ds_read_b64_tr_b16 v[86:87], v114 offset:45568
    s_waitcnt vmcnt(7)
    s_barrier
    s_waitcnt lgkmcnt(8)
    v_mfma_f32_16x16x32_bf16 v[0:3], a[80:83], v[64:67], v[0:3]
    ds_read_b64_tr_b16 v[88:89], v115 offset:45056
    s_add_u32 m0, s57, 24576
    v_mfma_f32_16x16x32_bf16 v[4:7], a[84:87], v[64:67], v[4:7]
    ds_read_b64_tr_b16 v[90:91], v115 offset:45568
    s_add_u32 s52, s91, 384
    v_mfma_f32_16x16x32_bf16 v[8:11], a[80:83], v[68:71], v[8:11]
    ds_read_b64_tr_b16 v[92:93], v116 offset:45056
    buffer_load_dwordx4 v117, s[12:15], s52 offen lds
    v_mfma_f32_16x16x32_bf16 v[12:15], a[84:87], v[68:71], v[12:15]
    ds_read_b64_tr_b16 v[94:95], v116 offset:45568
    s_add_u32 m0, s57, 32768
    s_waitcnt lgkmcnt(8)
    v_mfma_f32_16x16x32_bf16 v[16:19], a[80:83], v[72:75], v[16:19]
    ds_read_b64_tr_b16 v[64:65], v113 offset:49152
    s_add_u32 s52, s92, 384
    v_mfma_f32_16x16x32_bf16 v[20:23], a[84:87], v[72:75], v[20:23]
    ds_read_b64_tr_b16 v[66:67], v113 offset:49664
    buffer_load_dwordx4 v117, s[12:15], s52 offen lds
    v_mfma_f32_16x16x32_bf16 v[24:27], a[80:83], v[76:79], v[24:27]
    ds_read_b64_tr_b16 v[68:69], v114 offset:49152
    s_add_u32 m0, s57, 81920
    v_mfma_f32_16x16x32_bf16 v[28:31], a[84:87], v[76:79], v[28:31]
    ds_read_b64_tr_b16 v[70:71], v114 offset:49664
    s_add_u32 s52, s96, 1
    s_waitcnt lgkmcnt(8)
    v_mfma_f32_16x16x32_bf16 v[0:3], a[88:91], v[80:83], v[0:3]
    ds_read_b64_tr_b16 v[72:73], v115 offset:49152
    s_and_b32 s52, s52, 7
    s_cmp_lg_u32 s3, 0
    s_cbranch_scc1 PI_6
    buffer_load_dword v125, off, s[48:51], 0 offset:0 sc1
PI_6:
    v_mfma_f32_16x16x32_bf16 v[4:7], a[92:95], v[80:83], v[4:7]
    ds_read_b64_tr_b16 v[74:75], v115 offset:49664
    s_mul_i32 s52, s52, 229376
    v_mfma_f32_16x16x32_bf16 v[8:11], a[88:91], v[84:87], v[8:11]
    ds_read_b64_tr_b16 v[76:77], v116 offset:49152
    s_add_u32 s52, s52, s64
    v_mfma_f32_16x16x32_bf16 v[12:15], a[92:95], v[84:87], v[12:15]
    ds_read_b64_tr_b16 v[78:79], v116 offset:49664
    buffer_load_dwordx4 v118, s[28:31], s52 offen lds
    s_waitcnt lgkmcnt(8)
    v_mfma_f32_16x16x32_bf16 v[16:19], a[88:91], v[88:91], v[16:19]
    ds_read_b64_tr_b16 v[80:81], v113 offset:53248
    s_add_u32 m0, s57, 90112
    v_cvt_pk_bf16_f32 v108, v56, v57
    v_mfma_f32_16x16x32_bf16 v[20:23], a[92:95], v[88:91], v[20:23]
    ds_read_b64_tr_b16 v[82:83], v113 offset:53760
    s_nop 0
    v_cvt_pk_bf16_f32 v109, v58, v59
    v_mfma_f32_16x16x32_bf16 v[24:27], a[88:91], v[92:95], v[24:27]
    ds_read_b64_tr_b16 v[84:85], v114 offset:53248
    buffer_load_dwordx4 v118, s[32:35], s52 offen offset:0 lds
    v_cvt_pk_bf16_f32 v110, v60, v61
    v_mfma_f32_16x16x32_bf16 v[28:31], a[92:95], v[92:95], v[28:31]
    ds_read_b64_tr_b16 v[86:87], v114 offset:53760
    v_cvt_pk_bf16_f32 v111, v62, v63
    s_waitcnt lgkmcnt(8)
    v_mfma_f32_16x16x32_bf16 v[0:3], a[96:99], v[64:67], v[0:3]
    ds_read_b64_tr_b16 v[88:89], v115 offset:53248
    v_mfma_f32_16x16x32_bf16 v[4:7], a[100:103], v[64:67], v[4:7]
    ds_read_b64_tr_b16 v[90:91], v115 offset:53760
    v_mfma_f32_16x16x32_bf16 v[8:11], a[96:99], v[68:71], v[8:11]
    ds_read_b64_tr_b16 v[92:93], v116 offset:53248
    buffer_store_dwordx4 v[108:111], v112, s[8:11], s56 offen offset:3072 sc1
    v_mfma_f32_16x16x32_bf16 v[12:15], a[100:103], v[68:71], v[12:15]
    ds_read_b64_tr_b16 v[94:95], v116 offset:53760
    s_waitcnt lgkmcnt(8)
    v_mfma_f32_16x16x32_bf16 v[16:19], a[96:99], v[72:75], v[16:19]
    ds_read_b64_tr_b16 v[64:65], v113 offset:57344
    v_mfma_f32_16x16x32_bf16 v[20:23], a[100:103], v[72:75], v[20:23]
    ds_read_b64_tr_b16 v[66:67], v113 offset:57856
    v_mfma_f32_16x16x32_bf16 v[24:27], a[96:99], v[76:79], v[24:27]
    ds_read_b64_tr_b16 v[68:69], v114 offset:57344
    v_mfma_f32_16x16x32_bf16 v[28:31], a[100:103], v[76:79], v[28:31]
    ds_read_b64_tr_b16 v[70:71], v114 offset:57856
    s_waitcnt lgkmcnt(8)
    v_mfma_f32_16x16x32_bf16 v[0:3], a[104:107], v[80:83], v[0:3]
    ds_read_b64_tr_b16 v[72:73], v115 offset:57344
    v_mfma_f32_16x16x32_bf16 v[4:7], a[108:111], v[80:83], v[4:7]
    ds_read_b64_tr_b16 v[74:75], v115 offset:57856
    v_mfma_f32_16x16x32_bf16 v[8:11], a[104:107], v[84:87], v[8:11]
    ds_read_b64_tr_b16 v[76:77], v116 offset:57344
    v_mfma_f32_16x16x32_bf16 v[12:15], a[108:111], v[84:87], v[12:15]
    ds_read_b64_tr_b16 v[78:79], v116 offset:57856
    s_waitcnt lgkmcnt(8)
    v_mfma_f32_16x16x32_bf16 v[16:19], a[104:107], v[88:91], v[16:19]
    ds_read_b64_tr_b16 v[80:81], v113 offset:61440
    v_mfma_f32_16x16x32_bf16 v[20:23], a[108:111], v[88:91], v[20:23]
    ds_read_b64_tr_b16 v[82:83], v113 offset:61952
    v_mfma_f32_16x16x32_bf16 v[24:27], a[104:107], v[92:95], v[24:27]
    ds_read_b64_tr_b16 v[84:85], v114 offset:61440
    v_mfma_f32_16x16x32_bf16 v[28:31], a[108:111], v[92:95], v[28:31]
    ds_read_b64_tr_b16 v[86:87], v114 offset:61952
    s_cmp_lg_u32 s3, 0
    s_cbranch_scc1 PK_7
    s_waitcnt vmcnt(3)
    v_readfirstlane_b32 s6, v125
    s_mov_b32 s7, 0
    s_cmp_ge_u32 s6, 256
    s_cbranch_scc1 PK_7
PL_8:
    s_sleep 4
    buffer_load_dword v125, off, s[48:51], 0 offset:0 sc1
    s_add_u32 s7, s7, 1
    s_waitcnt vmcnt(0)
    v_readfirstlane_b32 s6, v125
    s_cmp_ge_u32 s7, 0x40000
    s_cbranch_scc1 PK_7
    s_cmp_lt_u32 s6, 256
    s_cbranch_scc1 PL_8
PK_7:
    s_waitcnt vmcnt(9)
    s_barrier
    s_waitcnt lgkmcnt(8)
    v_mfma_f32_16x16x32_bf16 v[0:3], a[112:115], v[64:67], v[0:3]
    ds_read_b64_tr_b16 v[88:89], v115 offset:61440
    s_add_u32 m0, s57, 40960
    v_mfma_f32_16x16x32_bf16 v[4:7], a[116:119], v[64:67], v[4:7]
    ds_read_b64_tr_b16 v[90:91], v115 offset:61952
    s_add_u32 s52, s93, 384
    v_mfma_f32_16x16x32_bf16 v[8:11], a[112:115], v[68:71], v[8:11]
    ds_read_b64_tr_b16 v[92:93], v116 offset:61440
    buffer_load_dwordx4 v117, s[12:15], s52 offen lds
    v_mfma_f32_16x16x32_bf16 v[12:15], a[116:119], v[68:71], v[12:15]
    ds_read_b64_tr_b16 v[94:95], v116 offset:61952
    s_add_u32 m0, s57, 49152
    s_waitcnt lgkmcnt(8)
    v_mfma_f32_16x16x32_bf16 v[16:19], a[112:115], v[72:75], v[16:19]
    ds_read_b64_tr_b16 v[64:65], v113 offset:0
    s_add_u32 s52, s94, 384
    v_mfma_f32_16x16x32_bf16 v[20:23], a[116:119], v[72:75], v[20:23]
    ds_read_b64_tr_b16 v[66:67], v113 offset:512
    buffer_load_dwordx4 v117, s[12:15], s52 offen lds
    v_mfma_f32_16x16x32_bf16 v[24:27], a[112:115], v[76:79], v[24:27]
    ds_read_b64_tr_b16 v[68:69], v114 offset:0
    s_add_u32 m0, s57, 98304
    v_mfma_f32_16x16x32_bf16 v[28:31], a[116:119], v[76:79], v[28:31]
    ds_read_b64_tr_b16 v[70:71], v114 offset:512
    s_add_u32 s52, s96, 2
    s_waitcnt lgkmcnt(8)
    v_mfma_f32_16x16x32_bf16 v[0:3], a[120:123], v[80:83], v[0:3]
    ds_read_b64_tr_b16 v[72:73], v115 offset:0
    s_and_b32 s52, s52, 7
    v_mfma_f32_16x16x32_bf16 v[4:7], a[124:127], v[80:83], v[4:7]
    ds_read_b64_tr_b16 v[74:75], v115 offset:512
    s_mul_i32 s52, s52, 229376
    v_mfma_f32_16x16x32_bf16 v[8:11], a[120:123], v[84:87], v[8:11]
    ds_read_b64_tr_b16 v[76:77], v116 offset:0
    s_add_u32 s52, s52, s64
    s_add_u32 s56, s56, 0x80000
    v_mfma_f32_16x16x32_bf16 v[12:15], a[124:127], v[84:87], v[12:15]
    ds_read_b64_tr_b16 v[78:79], v116 offset:512
    buffer_load_dwordx4 v118, s[28:31], s52 offen lds
    s_waitcnt lgkmcnt(8)
    v_mfma_f32_16x16x32_bf16 v[16:19], a[120:123], v[88:91], v[16:19]
    ds_read_b64_tr_b16 v[80:81], v113 offset:4096
    s_add_u32 m0, s57, 106496
    v_mfma_f32_16x16x32_bf16 v[20:23], a[124:127], v[88:91], v[20:23]
    ds_read_b64_tr_b16 v[82:83], v113 offset:4608
    s_nop 0
    v_mfma_f32_16x16x32_bf16 v[24:27], a[120:123], v[92:95], v[24:27]
    ds_read_b64_tr_b16 v[84:85], v114 offset:4096
    buffer_load_dwordx4 v118, s[32:35], s52 offen offset:0 lds
    v_mfma_f32_16x16x32_bf16 v[28:31], a[124:127], v[92:95], v[28:31]
    ds_read_b64_tr_b16 v[86:87], v114 offset:4608
    s_waitcnt lgkmcnt(8)
    v_mfma_f32_16x16x32_bf16 v[32:35], a[0:3], v[64:67], 0
    ds_read_b64_tr_b16 v[88:89], v115 offset:4096
    v_mfma_f32_16x16x32_bf16 v[36:39], a[4:7], v[64:67], 0
    ds_read_b64_tr_b16 v[90:91], v115 offset:4608
    v_mfma_f32_16x16x32_bf16 v[40:43], a[0:3], v[68:71], 0
    ds_read_b64_tr_b16 v[92:93], v116 offset:4096
    v_mfma_f32_16x16x32_bf16 v[44:47], a[4:7], v[68:71], 0
    ds_read_b64_tr_b16 v[94:95], v116 offset:4608
    s_waitcnt lgkmcnt(8)
    v_mfma_f32_16x16x32_bf16 v[48:51], a[0:3], v[72:75], 0
    ds_read_b64_tr_b16 v[64:65], v113 offset:8192
    v_mfma_f32_16x16x32_bf16 v[52:55], a[4:7], v[72:75], 0
    ds_read_b64_tr_b16 v[66:67], v113 offset:8704
    v_mfma_f32_16x16x32_bf16 v[56:59], a[0:3], v[76:79], 0
    ds_read_b64_tr_b16 v[68:69], v114 offset:8192
    v_mfma_f32_16x16x32_bf16 v[60:63], a[4:7], v[76:79], 0
    ds_read_b64_tr_b16 v[70:71], v114 offset:8704
    s_waitcnt lgkmcnt(8)
    v_mfma_f32_16x16x32_bf16 v[32:35], a[8:11], v[80:83], v[32:35]
    ds_read_b64_tr_b16 v[72:73], v115 offset:8192
    v_cvt_pk_bf16_f32 v96, v0, v1
    v_mfma_f32_16x16x32_bf16 v[36:39], a[12:15], v[80:83], v[36:39]
    ds_read_b64_tr_b16 v[74:75], v115 offset:8704
    v_cvt_pk_bf16_f32 v97, v2, v3
    v_mfma_f32_16x16x32_bf16 v[40:43], a[8:11], v[84:87], v[40:43]
    ds_read_b64_tr_b16 v[76:77], v116 offset:8192
    v_cvt_pk_bf16_f32 v98, v4, v5
    v_mfma_f32_16x16x32_bf16 v[44:47], a[12:15], v[84:87], v[44:47]
    ds_read_b64_tr_b16 v[78:79], v116 offset:8704
    v_cvt_pk_bf16_f32 v99, v6, v7
    s_waitcnt lgkmcnt(8)
    v_mfma_f32_16x16x32_bf16 v[48:51], a[8:11], v[88:91], v[48:51]
    ds_read_b64_tr_b16 v[80:81], v113 offset:12288
    v_mfma_f32_16x16x32_bf16 v[52:55], a[12:15], v[88:91], v[52:55]
    ds_read_b64_tr_b16 v[82:83], v113 offset:12800
    v_mfma_f32_16x16x32_bf16 v[56:59], a[8:11], v[92:95], v[56:59]
    ds_read_b64_tr_b16 v[84:85], v114 offset:12288
    buffer_store_dwordx4 v[96:99], v112, s[8:11], s55 offen offset:0 sc1
    v_mfma_f32_16x16x32_bf16 v[60:63], a[12:15], v[92:95], v[60:63]
    ds_read_b64_tr_b16 v[86:87], v114 offset:12800
    s_waitcnt vmcnt(9)
    s_barrier
    s_waitcnt lgkmcnt(8)
    v_mfma_f32_16x16x32_bf16 v[32:35], a[16:19], v[64:67], v[32:35]
    ds_read_b64_tr_b16 v[88:89], v115 offset:12288
    s_add_u32 m0, s57, 57344
    v_mfma_f32_16x16x32_bf16 v[36:39], a[20:23], v[64:67], v[36:39]
    ds_read_b64_tr_b16 v[90:91], v115 offset:12800
    s_add_u32 s52, s95, 384
    v_mfma_f32_16x16x32_bf16 v[40:43], a[16:19], v[68:71], v[40:43]
    ds_read_b64_tr_b16 v[92:93], v116 offset:12288
    buffer_load_dwordx4 v117, s[12:15], s52 offen lds
    v_mfma_f32_16x16x32_bf16 v[44:47], a[20:23], v[68:71], v[44:47]
    ds_read_b64_tr_b16 v[94:95], v116 offset:12800
    s_add_u32 m0, s57, 114688
    s_waitcnt lgkmcnt(8)
    v_mfma_f32_16x16x32_bf16 v[48:51], a[16:19], v[72:75], v[48:51]
    ds_read_b64_tr_b16 v[64:65], v113 offset:16384
    s_add_u32 s52, s96, 3
    v_cvt_pk_bf16_f32 v100, v8, v9
    v_mfma_f32_16x16x32_bf16 v[52:55], a[20:23], v[72:75], v[52:55]
    ds_read_b64_tr_b16 v[66:67], v113 offset:16896
    s_and_b32 s52, s52, 7
    v_cvt_pk_bf16_f32 v101, v10, v11
    v_mfma_f32_16x16x32_bf16 v[56:59], a[16:19], v[76:79], v[56:59]
    ds_read_b64_tr_b16 v[68:69], v114 offset:16384
    s_mul_i32 s52, s52, 229376
    v_cvt_pk_bf16_f32 v102, v12, v13
    v_mfma_f32_16x16x32_bf16 v[60:63], a[20:23], v[76:79], v[60:63]
    ds_read_b64_tr_b16 v[70:71], v114 offset:16896
    s_add_u32 s52, s52, s64
    v_cvt_pk_bf16_f32 v103, v14, v15
    s_waitcnt lgkmcnt(8)
    v_mfma_f32_16x16x32_bf16 v[32:35], a[24:27], v[80:83], v[32:35]
    ds_read_b64_tr_b16 v[72:73], v115 offset:16384
    buffer_load_dwordx4 v118, s[28:31], s52 offen lds
    v_mfma_f32_16x16x32_bf16 v[36:39], a[28:31], v[80:83], v[36:39]
    ds_read_b64_tr_b16 v[74:75], v115 offset:16896
    s_add_u32 m0, s57, 122880
    v_mfma_f32_16x16x32_bf16 v[40:43], a[24:27], v[84:87], v[40:43]
    ds_read_b64_tr_b16 v[76:77], v116 offset:16384
    s_nop 0
    buffer_store_dwordx4 v[100:103], v112, s[8:11], s55 offen offset:1024 sc1
    v_mfma_f32_16x16x32_bf16 v[44:47], a[28:31], v[84:87], v[44:47]
    ds_read_b64_tr_b16 v[78:79], v116 offset:16896
    buffer_load_dwordx4 v118, s[32:35], s52 offen offset:0 lds
    s_waitcnt lgkmcnt(8)
    v_mfma_f32_16x16x32_bf16 v[48:51], a[24:27], v[88:91], v[48:51]
    ds_read_b64_tr_b16 v[80:81], v113 offset:20480
    s_add_u32 s53, s96, 0
    s_and_b32 s53, s53, 7
    s_lshl_b32 s53, s53, 12
    s_add_u32 s53, s53, s66
    v_mfma_f32_16x16x32_bf16 v[52:55], a[28:31], v[88:91], v[52:55]
    ds_read_b64_tr_b16 v[82:83], v113 offset:20992
    buffer_load_dwordx4 a[0:3], v112, s[8:11], s53 offen offset:0 sc1
    v_mfma_f32_16x16x32_bf16 v[56:59], a[24:27], v[92:95], v[56:59]
    ds_read_b64_tr_b16 v[84:85], v114 offset:20480
    v_mfma_f32_16x16x32_bf16 v[60:63], a[28:31], v[92:95], v[60:63]
    ds_read_b64_tr_b16 v[86:87], v114 offset:20992
    buffer_load_dwordx4 a[4:7], v112, s[8:11], s53 offen offset:1024 sc1
    s_waitcnt lgkmcnt(8)
    v_mfma_f32_16x16x32_bf16 v[32:35], a[32:35], v[64:67], v[32:35]
    ds_read_b64_tr_b16 v[88:89], v115 offset:20480
    v_cvt_pk_bf16_f32 v104, v16, v17
    v_mfma_f32_16x16x32_bf16 v[36:39], a[36:39], v[64:67], v[36:39]
    ds_read_b64_tr_b16 v[90:91], v115 offset:20992
    v_cvt_pk_bf16_f32 v105, v18, v19
    buffer_load_dwordx4 a[8:11], v112, s[8:11], s53 offen offset:2048 sc1
    v_mfma_f32_16x16x32_bf16 v[40:43], a[32:35], v[68:71], v[40:43]
    ds_read_b64_tr_b16 v[92:93], v116 offset:20480
    v_cvt_pk_bf16_f32 v106, v20, v21
    v_mfma_f32_16x16x32_bf16 v[44:47], a[36:39], v[68:71], v[44:47]
    ds_read_b64_tr_b16 v[94:95], v116 offset:20992
    v_cvt_pk_bf16_f32 v107, v22, v23
    buffer_load_dwordx4 a[12:15], v112, s[8:11], s53 offen offset:3072 sc1
    s_waitcnt lgkmcnt(8)
    v_mfma_f32_16x16x32_bf16 v[48:51], a[32:35], v[72:75], v[48:51]
    ds_read_b64_tr_b16 v[64:65], v113 offset:24576
    v_mfma_f32_16x16x32_bf16 v[52:55], a[36:39], v[72:75], v[52:55]
    ds_read_b64_tr_b16 v[66:67], v113 offset:25088
    v_mfma_f32_16x16x32_bf16 v[56:59], a[32:35], v[76:79], v[56:59]
    ds_read_b64_tr_b16 v[68:69], v114 offset:24576
    buffer_store_dwordx4 v[104:107], v112, s[8:11], s55 offen offset:2048 sc1
    v_mfma_f32_16x16x32_bf16 v[60:63], a[36:39], v[76:79], v[60:63]
    ds_read_b64_tr_b16 v[70:71], v114 offset:25088
    s_waitcnt lgkmcnt(8)
    v_mfma_f32_16x16x32_bf16 v[32:35], a[40:43], v[80:83], v[32:35]
    ds_read_b64_tr_b16 v[72:73], v115 offset:24576
    v_mfma_f32_16x16x32_bf16 v[36:39], a[44:47], v[80:83], v[36:39]
    ds_read_b64_tr_b16 v[74:75], v115 offset:25088
    v_mfma_f32_16x16x32_bf16 v[40:43], a[40:43], v[84:87], v[40:43]
    ds_read_b64_tr_b16 v[76:77], v116 offset:24576
    v_mfma_f32_16x16x32_bf16 v[44:47], a[44:47], v[84:87], v[44:47]
    ds_read_b64_tr_b16 v[78:79], v116 offset:25088
    s_waitcnt lgkmcnt(8)
    v_mfma_f32_16x16x32_bf16 v[48:51], a[40:43], v[88:91], v[48:51]
    ds_read_b64_tr_b16 v[80:81], v113 offset:28672
    v_cvt_pk_bf16_f32 v108, v24, v25
    s_add_u32 s53, s96, 1
    s_and_b32 s53, s53, 7
    s_lshl_b32 s53, s53, 12
    s_add_u32 s53, s53, s66
    v_mfma_f32_16x16x32_bf16 v[52:55], a[44:47], v[88:91], v[52:55]
    ds_read_b64_tr_b16 v[82:83], v113 offset:29184
    v_cvt_pk_bf16_f32 v109, v26, v27
    buffer_load_dwordx4 a[16:19], v112, s[8:11], s53 offen offset:0 sc1
    v_mfma_f32_16x16x32_bf16 v[56:59], a[40:43], v[92:95], v[56:59]
    ds_read_b64_tr_b16 v[84:85], v114 offset:28672
    v_cvt_pk_bf16_f32 v110, v28, v29
    v_mfma_f32_16x16x32_bf16 v[60:63], a[44:47], v[92:95], v[60:63]
    ds_read_b64_tr_b16 v[86:87], v114 offset:29184
    v_cvt_pk_bf16_f32 v111, v30, v31
    buffer_load_dwordx4 a[20:23], v112, s[8:11], s53 offen offset:1024 sc1
    s_waitcnt vmcnt(15)
    s_barrier
    s_waitcnt lgkmcnt(8)
    v_mfma_f32_16x16x32_bf16 v[32:35], a[48:51], v[64:67], v[32:35]
    ds_read_b64_tr_b16 v[88:89], v115 offset:28672
    s_add_u32 m0, s57, 131072
    v_mfma_f32_16x16x32_bf16 v[36:39], a[52:55], v[64:67], v[36:39]
    ds_read_b64_tr_b16 v[90:91], v115 offset:29184
    s_add_u32 s52, s96, 4
    buffer_load_dwordx4 a[24:27], v112, s[8:11], s53 offen offset:2048 sc1
    v_mfma_f32_16x16x32_bf16 v[40:43], a[48:51], v[68:71], v[40:43]
    ds_read_b64_tr_b16 v[92:93], v116 offset:28672
    s_and_b32 s52, s52, 7
    buffer_store_dwordx4 v[108:111], v112, s[8:11], s55 offen offset:3072 sc1
    v_mfma_f32_16x16x32_bf16 v[44:47], a[52:55], v[68:71], v[44:47]
    ds_read_b64_tr_b16 v[94:95], v116 offset:29184
    s_mul_i32 s52, s52, 229376
    buffer_load_dwordx4 a[28:31], v112, s[8:11], s53 offen offset:3072 sc1
    s_waitcnt lgkmcnt(8)
    v_mfma_f32_16x16x32_bf16 v[48:51], a[48:51], v[72:75], v[48:51]
    ds_read_b64_tr_b16 v[64:65], v113 offset:32768
    s_add_u32 s52, s52, s64
    v_mfma_f32_16x16x32_bf16 v[52:55], a[52:55], v[72:75], v[52:55]
    ds_read_b64_tr_b16 v[66:67], v113 offset:33280
    buffer_load_dwordx4 v118, s[28:31], s52 offen lds
    v_mfma_f32_16x16x32_bf16 v[56:59], a[48:51], v[76:79], v[56:59]
    ds_read_b64_tr_b16 v[68:69], v114 offset:32768
    s_add_u32 m0, s57, 139264
    v_mfma_f32_16x16x32_bf16 v[60:63], a[52:55], v[76:79], v[60:63]
    ds_read_b64_tr_b16 v[70:71], v114 offset:33280
    s_nop 0
    s_waitcnt lgkmcnt(8)
    v_mfma_f32_16x16x32_bf16 v[32:35], a[56:59], v[80:83], v[32:35]
    ds_read_b64_tr_b16 v[72:73], v115 offset:32768
    buffer_load_dwordx4 v118, s[32:35], s52 offen offset:0 lds
    v_mfma_f32_16x16x32_bf16 v[36:39], a[60:63], v[80:83], v[36:39]
    ds_read_b64_tr_b16 v[74:75], v115 offset:33280
    s_add_u32 m0, s57, 0
    v_mfma_f32_16x16x32_bf16 v[40:43], a[56:59], v[84:87], v[40:43]
    ds_read_b64_tr_b16 v[76:77], v116 offset:32768
    s_add_u32 s52, s96, 6
    v_mfma_f32_16x16x32_bf16 v[44:47], a[60:63], v[84:87], v[44:47]
    ds_read_b64_tr_b16 v[78:79], v116 offset:33280
    s_and_b32 s52, s52, 7
    s_waitcnt lgkmcnt(8)
    v_mfma_f32_16x16x32_bf16 v[48:51], a[56:59], v[88:91], v[48:51]
    ds_read_b64_tr_b16 v[80:81], v113 offset:36864
    s_mul_i32 s52, s52, 229376
    v_mfma_f32_16x16x32_bf16 v[52:55], a[60:63], v[88:91], v[52:55]
    ds_read_b64_tr_b16 v[82:83], v113 offset:37376
    s_add_u32 s52, s52, s64
    v_mfma_f32_16x16x32_bf16 v[56:59], a[56:59], v[92:95], v[56:59]
    ds_read_b64_tr_b16 v[84:85], v114 offset:36864
    buffer_load_dwordx4 v118, s[28:31], s52 offen lds
    v_mfma_f32_16x16x32_bf16 v[60:63], a[60:63], v[92:95], v[60:63]
    ds_read_b64_tr_b16 v[86:87], v114 offset:37376
    s_add_u32 m0, s57, 8192
    s_waitcnt lgkmcnt(8)
    v_mfma_f32_16x16x32_bf16 v[32:35], a[64:67], v[64:67], v[32:35]
    ds_read_b64_tr_b16 v[88:89], v115 offset:36864
    s_nop 0
    v_mfma_f32_16x16x32_bf16 v[36:39], a[68:71], v[64:67], v[36:39]
    ds_read_b64_tr_b16 v[90:91], v115 offset:37376
    buffer_load_dwordx4 v118, s[32:35], s52 offen offset:0 lds
    v_mfma_f32_16x16x32_bf16 v[40:43], a[64:67], v[68:71], v[40:43]
    ds_read_b64_tr_b16 v[92:93], v116 offset:36864
    v_mfma_f32_16x16x32_bf16 v[44:47], a[68:71], v[68:71], v[44:47]
    ds_read_b64_tr_b16 v[94:95], v116 offset:37376
    s_waitcnt lgkmcnt(8)
    v_mfma_f32_16x16x32_bf16 v[48:51], a[64:67], v[72:75], v[48:51]
    ds_read_b64_tr_b16 v[64:65], v113 offset:40960
    v_mfma_f32_16x16x32_bf16 v[52:55], a[68:71], v[72:75], v[52:55]
    ds_read_b64_tr_b16 v[66:67], v113 offset:41472
    v_mfma_f32_16x16x32_bf16 v[56:59], a[64:67], v[76:79], v[56:59]
    ds_read_b64_tr_b16 v[68:69], v114 offset:40960
    v_mfma_f32_16x16x32_bf16 v[60:63], a[68:71], v[76:79], v[60:63]
    ds_read_b64_tr_b16 v[70:71], v114 offset:41472
    s_waitcnt lgkmcnt(8)
    v_mfma_f32_16x16x32_bf16 v[32:35], a[72:75], v[80:83], v[32:35]
    ds_read_b64_tr_b16 v[72:73], v115 offset:40960
    v_mfma_f32_16x16x32_bf16 v[36:39], a[76:79], v[80:83], v[36:39]
    ds_read_b64_tr_b16 v[74:75], v115 offset:41472
    v_mfma_f32_16x16x32_bf16 v[40:43], a[72:75], v[84:87], v[40:43]
    ds_read_b64_tr_b16 v[76:77], v116 offset:40960
    v_mfma_f32_16x16x32_bf16 v[44:47], a[76:79], v[84:87], v[44:47]
    ds_read_b64_tr_b16 v[78:79], v116 offset:41472
    s_waitcnt lgkmcnt(8)
    v_mfma_f32_16x16x32_bf16 v[48:51], a[72:75], v[88:91], v[48:51]
    ds_read_b64_tr_b16 v[80:81], v113 offset:45056
    v_mfma_f32_16x16x32_bf16 v[52:55], a[76:79], v[88:91], v[52:55]
    ds_read_b64_tr_b16 v[82:83], v113 offset:45568
    v_mfma_f32_16x16x32_bf16 v[56:59], a[72:75], v[92:95], v[56:59]
    ds_read_b64_tr_b16 v[84:85], v114 offset:45056
    v_mfma_f32_16x16x32_bf16 v[60:63], a[76:79], v[92:95], v[60:63]
    ds_read_b64_tr_b16 v[86:87], v114 offset:45568
    s_waitcnt vmcnt(17)
    s_barrier
    s_waitcnt lgkmcnt(8)
    v_mfma_f32_16x16x32_bf16 v[32:35], a[80:83], v[64:67], v[32:35]
    ds_read_b64_tr_b16 v[88:89], v115 offset:45056
    s_add_u32 m0, s57, 147456
    v_mfma_f32_16x16x32_bf16 v[36:39], a[84:87], v[64:67], v[36:39]
    ds_read_b64_tr_b16 v[90:91], v115 offset:45568
    s_add_u32 s52, s96, 5
    v_mfma_f32_16x16x32_bf16 v[40:43], a[80:83], v[68:71], v[40:43]
    ds_read_b64_tr_b16 v[92:93], v116 offset:45056
    s_and_b32 s52, s52, 7
    v_mfma_f32_16x16x32_bf16 v[44:47], a[84:87], v[68:71], v[44:47]
    ds_read_b64_tr_b16 v[94:95], v116 offset:45568
    s_mul_i32 s52, s52, 229376
    s_waitcnt lgkmcnt(8)
    v_mfma_f32_16x16x32_bf16 v[48:51], a[80:83], v[72:75], v[48:51]
    ds_read_b64_tr_b16 v[64:65], v113 offset:49152
    s_add_u32 s52, s52, s64
    v_mfma_f32_16x16x32_bf16 v[52:55], a[84:87], v[72:75], v[52:55]
    ds_read_b64_tr_b16 v[66:67], v113 offset:49664
    buffer_load_dwordx4 v118, s[28:31], s52 offen lds
    v_mfma_f32_16x16x32_bf16 v[56:59], a[80:83], v[76:79], v[56:59]
    ds_read_b64_tr_b16 v[68:69], v114 offset:49152
    s_add_u32 m0, s57, 155648
    v_mfma_f32_16x16x32_bf16 v[60:63], a[84:87], v[76:79], v[60:63]
    ds_read_b64_tr_b16 v[70:71], v114 offset:49664
    s_nop 0
    s_waitcnt lgkmcnt(8)
    v_mfma_f32_16x16x32_bf16 v[32:35], a[88:91], v[80:83], v[32:35]
    ds_read_b64_tr_b16 v[72:73], v115 offset:49152
    buffer_load_dwordx4 v118, s[32:35], s52 offen offset:0 lds
    v_mfma_f32_16x16x32_bf16 v[36:39], a[92:95], v[80:83], v[36:39]
    ds_read_b64_tr_b16 v[74:75], v115 offset:49664
    s_add_u32 m0, s57, 16384
    v_mfma_f32_16x16x32_bf16 v[40:43], a[88:91], v[84:87], v[40:43]
    ds_read_b64_tr_b16 v[76:77], v116 offset:49152
    s_add_u32 s52, s96, 7
    v_mfma_f32_16x16x32_bf16 v[44:47], a[92:95], v[84:87], v[44:47]
    ds_read_b64_tr_b16 v[78:79], v116 offset:49664
    s_and_b32 s52, s52, 7
    s_waitcnt lgkmcnt(8)
    v_mfma_f32_16x16x32_bf16 v[48:51], a[88:91], v[88:91], v[48:51]
    ds_read_b64_tr_b16 v[80:81], v113 offset:53248
    s_mul_i32 s52, s52, 229376
    s_add_u32 s53, s96, 2
    s_and_b32 s53, s53, 7
    s_lshl_b32 s53, s53, 12
    s_add_u32 s53, s53, s66
    v_mfma_f32_16x16x32_bf16 v[52:55], a[92:95], v[88:91], v[52:55]
    ds_read_b64_tr_b16 v[82:83], v113 offset:53760
    s_add_u32 s52, s52, s64
    buffer_load_dwordx4 a[32:35], v112, s[8:11], s53 offen offset:0 sc1
    v_mfma_f32_16x16x32_bf16 v[56:59], a[88:91], v[92:95], v[56:59]
    ds_read_b64_tr_b16 v[84:85], v114 offset:53248
    buffer_load_dwordx4 v118, s[28:31], s52 offen lds
    v_mfma_f32_16x16x32_bf16 v[60:63], a[92:95], v[92:95], v[60:63]
    ds_read_b64_tr_b16 v[86:87], v114 offset:53760
    s_add_u32 m0, s57, 24576
    buffer_load_dwordx4 a[36:39], v112, s[8:11], s53 offen offset:1024 sc1
    s_waitcnt lgkmcnt(8)
    v_mfma_f32_16x16x32_bf16 v[32:35], a[96:99], v[64:67], v[32:35]
    ds_read_b64_tr_b16 v[88:89], v115 offset:53248
    s_nop 0
    v_mfma_f32_16x16x32_bf16 v[36:39], a[100:103], v[64:67], v[36:39]
    ds_read_b64_tr_b16 v[90:91], v115 offset:53760
    buffer_load_dwordx4 v118, s[32:35], s52 offen offset:0 lds
    buffer_load_dwordx4 a[40:43], v112, s[8:11], s53 offen offset:2048 sc1
    v_mfma_f32_16x16x32_bf16 v[40:43], a[96:99], v[68:71], v[40:43]
    ds_read_b64_tr_b16 v[92:93], v116 offset:53248
    v_mfma_f32_16x16x32_bf16 v[44:47], a[100:103], v[68:71], v[44:47]
    ds_read_b64_tr_b16 v[94:95], v116 offset:53760
    buffer_load_dwordx4 a[44:47], v112, s[8:11], s53 offen offset:3072 sc1
    s_waitcnt lgkmcnt(8)
    v_mfma_f32_16x16x32_bf16 v[48:51], a[96:99], v[72:75], v[48:51]
    ds_read_b64_tr_b16 v[64:65], v113 offset:57344
    v_mfma_f32_16x16x32_bf16 v[52:55], a[100:103], v[72:75], v[52:55]
    ds_read_b64_tr_b16 v[66:67], v113 offset:57856
    v_mfma_f32_16x16x32_bf16 v[56:59], a[96:99], v[76:79], v[56:59]
    ds_read_b64_tr_b16 v[68:69], v114 offset:57344
    v_mfma_f32_16x16x32_bf16 v[60:63], a[100:103], v[76:79], v[60:63]
    ds_read_b64_tr_b16 v[70:71], v114 offset:57856
    s_waitcnt lgkmcnt(8)
    v_mfma_f32_16x16x32_bf16 v[32:35], a[104:107], v[80:83], v[32:35]
    ds_read_b64_tr_b16 v[72:73], v115 offset:57344
    v_mfma_f32_16x16x32_bf16 v[36:39], a[108:111], v[80:83], v[36:39]
    ds_read_b64_tr_b16 v[74:75], v115 offset:57856
    v_mfma_f32_16x16x32_bf16 v[40:43], a[104:107], v[84:87], v[40:43]
    ds_read_b64_tr_b16 v[76:77], v116 offset:57344
    v_mfma_f32_16x16x32_bf16 v[44:47], a[108:111], v[84:87], v[44:47]
    ds_read_b64_tr_b16 v[78:79], v116 offset:57856
    s_waitcnt lgkmcnt(8)
    v_mfma_f32_16x16x32_bf16 v[48:51], a[104:107], v[88:91], v[48:51]
    ds_read_b64_tr_b16 v[80:81], v113 offset:61440
    v_mfma_f32_16x16x32_bf16 v[52:55], a[108:111], v[88:91], v[52:55]
    ds_read_b64_tr_b16 v[82:83], v113 offset:61952
    v_mfma_f32_16x16x32_bf16 v[56:59], a[104:107], v[92:95], v[56:59]
    ds_read_b64_tr_b16 v[84:85], v114 offset:61440
    v_mfma_f32_16x16x32_bf16 v[60:63], a[108:111], v[92:95], v[60:63]
    ds_read_b64_tr_b16 v[86:87], v114 offset:61952
    s_barrier
    s_waitcnt lgkmcnt(8)
    v_mfma_f32_16x16x32_bf16 v[32:35], a[112:115], v[64:67], v[32:35]
    ds_read_b64_tr_b16 v[88:89], v115 offset:61440
    s_add_u32 m0, s57, 32768
    v_mfma_f32_16x16x32_bf16 v[36:39], a[116:119], v[64:67], v[36:39]
    ds_read_b64_tr_b16 v[90:91], v115 offset:61952
    s_add_u32 s52, s96, 0
    v_mfma_f32_16x16x32_bf16 v[40:43], a[112:115], v[68:71], v[40:43]
    ds_read_b64_tr_b16 v[92:93], v116 offset:61440
    s_and_b32 s52, s52, 7
    v_mfma_f32_16x16x32_bf16 v[44:47], a[116:119], v[68:71], v[44:47]
    ds_read_b64_tr_b16 v[94:95], v116 offset:61952
    s_lshl_b32 s52, s52, 19
    s_waitcnt lgkmcnt(8)
    v_mfma_f32_16x16x32_bf16 v[48:51], a[112:115], v[72:75], v[48:51]
    v_add_u32 v113, 0x10000, v113
    ds_read_b64_tr_b16 v[64:65], v113 offset:0
    s_add_u32 s52, s52, s65
    v_mfma_f32_16x16x32_bf16 v[52:55], a[116:119], v[72:75], v[52:55]
    ds_read_b64_tr_b16 v[66:67], v113 offset:512
    buffer_load_dwordx4 v117, s[24:27], s52 offen lds
    v_mfma_f32_16x16x32_bf16 v[56:59], a[112:115], v[76:79], v[56:59]
    v_add_u32 v114, 0x10000, v114
    ds_read_b64_tr_b16 v[68:69], v114 offset:0
    s_add_u32 m0, s57, 40832
    v_mfma_f32_16x16x32_bf16 v[60:63], a[116:119], v[76:79], v[60:63]
    ds_read_b64_tr_b16 v[70:71], v114 offset:512
    s_nop 0
    s_waitcnt lgkmcnt(8)
    v_mfma_f32_16x16x32_bf16 v[32:35], a[120:123], v[80:83], v[32:35]
    ds_read_b64_tr_b16 v[72:73], v113 offset:8192
    buffer_load_dwordx4 v117, s[24:27], s52 offen offset:128 lds
    v_mfma_f32_16x16x32_bf16 v[36:39], a[124:127], v[80:83], v[36:39]
    ds_read_b64_tr_b16 v[74:75], v113 offset:8704
    v_mfma_f32_16x16x32_bf16 v[40:43], a[120:123], v[84:87], v[40:43]
    ds_read_b64_tr_b16 v[76:77], v114 offset:8192
    v_mfma_f32_16x16x32_bf16 v[44:47], a[124:127], v[84:87], v[44:47]
    ds_read_b64_tr_b16 v[78:79], v114 offset:8704
    s_waitcnt lgkmcnt(8)
    v_mfma_f32_16x16x32_bf16 v[48:51], a[120:123], v[88:91], v[48:51]
    ds_read_b64_tr_b16 v[80:81], v113 offset:4096
    s_add_u32 s53, s96, 3
    s_and_b32 s53, s53, 7
    s_lshl_b32 s53, s53, 12
    s_add_u32 s53, s53, s66
    v_mfma_f32_16x16x32_bf16 v[52:55], a[124:127], v[88:91], v[52:55]
    ds_read_b64_tr_b16 v[82:83], v113 offset:4608
    buffer_load_dwordx4 a[48:51], v112, s[8:11], s53 offen offset:0 sc1
    v_mfma_f32_16x16x32_bf16 v[56:59], a[120:123], v[92:95], v[56:59]
    ds_read_b64_tr_b16 v[84:85], v114 offset:4096
    v_mfma_f32_16x16x32_bf16 v[60:63], a[124:127], v[92:95], v[60:63]
    ds_read_b64_tr_b16 v[86:87], v114 offset:4608
    buffer_load_dwordx4 a[52:55], v112, s[8:11], s53 offen offset:1024 sc1
    s_waitcnt lgkmcnt(8)
    s_waitcnt vmcnt(25)
    v_mfma_f32_16x16x32_bf16 v[0:3], v[64:67], a[0:3], 0
    ds_read_b64_tr_b16 v[88:89], v113 offset:12288
    s_waitcnt vmcnt(24)
    v_mfma_f32_16x16x32_bf16 v[4:7], v[64:67], a[4:7], 0
    ds_read_b64_tr_b16 v[90:91], v113 offset:12800
    buffer_load_dwordx4 a[56:59], v112, s[8:11], s53 offen offset:2048 sc1
    v_mfma_f32_16x16x32_bf16 v[8:11], v[68:71], a[0:3], 0
    ds_read_b64_tr_b16 v[92:93], v114 offset:12288
    v_mfma_f32_16x16x32_bf16 v[12:15], v[68:71], a[4:7], 0
    ds_read_b64_tr_b16 v[94:95], v114 offset:12800
    buffer_load_dwordx4 a[60:63], v112, s[8:11], s53 offen offset:3072 sc1
    s_waitcnt lgkmcnt(8)
    v_mfma_f32_16x16x32_bf16 v[16:19], v[72:75], a[0:3], 0
    ds_read_b64_tr_b16 v[64:65], v113 offset:16384
    v_mfma_f32_16x16x32_bf16 v[20:23], v[72:75], a[4:7], 0
    ds_read_b64_tr_b16 v[66:67], v113 offset:16896
    v_mfma_f32_16x16x32_bf16 v[24:27], v[76:79], a[0:3], 0
    ds_read_b64_tr_b16 v[68:69], v114 offset:16384
    v_mfma_f32_16x16x32_bf16 v[28:31], v[76:79], a[4:7], 0
    ds_read_b64_tr_b16 v[70:71], v114 offset:16896
    s_waitcnt lgkmcnt(8)
    s_waitcnt vmcnt(25)
    v_mfma_f32_16x16x32_bf16 v[0:3], v[80:83], a[8:11], v[0:3]
    ds_read_b64_tr_b16 v[72:73], v113 offset:24576
    s_waitcnt vmcnt(24)
    v_mfma_f32_16x16x32_bf16 v[4:7], v[80:83], a[12:15], v[4:7]
    ds_read_b64_tr_b16 v[74:75], v113 offset:25088
    v_mfma_f32_16x16x32_bf16 v[8:11], v[84:87], a[8:11], v[8:11]
    ds_read_b64_tr_b16 v[76:77], v114 offset:24576
    v_cvt_pk_bf16_f32 v96, v32, v33
    v_mfma_f32_16x16x32_bf16 v[12:15], v[84:87], a[12:15], v[12:15]
    ds_read_b64_tr_b16 v[78:79], v114 offset:25088
    v_cvt_pk_bf16_f32 v97, v34, v35
    s_waitcnt lgkmcnt(8)
    v_mfma_f32_16x16x32_bf16 v[16:19], v[88:91], a[8:11], v[16:19]
    ds_read_b64_tr_b16 v[80:81], v113 offset:20480
    v_cvt_pk_bf16_f32 v98, v36, v37
    v_mfma_f32_16x16x32_bf16 v[20:23], v[88:91], a[12:15], v[20:23]
    ds_read_b64_tr_b16 v[82:83], v113 offset:20992
    v_cvt_pk_bf16_f32 v99, v38, v39
    v_mfma_f32_16x16x32_bf16 v[24:27], v[92:95], a[8:11], v[24:27]
    ds_read_b64_tr_b16 v[84:85], v114 offset:20480
    v_cvt_pk_bf16_f32 v100, v40, v41
    v_mfma_f32_16x16x32_bf16 v[28:31], v[92:95], a[12:15], v[28:31]
    ds_read_b64_tr_b16 v[86:87], v114 offset:20992
    v_cvt_pk_bf16_f32 v101, v42, v43
    s_barrier
    s_waitcnt lgkmcnt(8)
    s_waitcnt vmcnt(22)
    v_mfma_f32_16x16x32_bf16 v[0:3], v[64:67], a[16:19], v[0:3]
    ds_read_b64_tr_b16 v[88:89], v113 offset:28672
    s_add_u32 m0, s57, 49152
    v_cvt_pk_bf16_f32 v102, v44, v45
    s_waitcnt vmcnt(21)
    v_mfma_f32_16x16x32_bf16 v[4:7], v[64:67], a[20:23], v[4:7]
    ds_read_b64_tr_b16 v[90:91], v113 offset:29184
    s_add_u32 s52, s96, 1
    v_cvt_pk_bf16_f32 v103, v46, v47
    v_mfma_f32_16x16x32_bf16 v[8:11], v[68:71], a[16:19], v[8:11]
    ds_read_b64_tr_b16 v[92:93], v114 offset:28672
    s_and_b32 s52, s52, 7
    v_cvt_pk_bf16_f32 v104, v48, v49
    v_mfma_f32_16x16x32_bf16 v[12:15], v[68:71], a[20:23], v[12:15]
    ds_read_b64_tr_b16 v[94:95], v114 offset:29184
    s_lshl_b32 s52, s52, 19
    v_cvt_pk_bf16_f32 v105, v50, v51
    s_waitcnt lgkmcnt(8)
    v_mfma_f32_16x16x32_bf16 v[16:19], v[72:75], a[16:19], v[16:19]
    v_add_u32 v115, 0x10000, v115
    ds_read_b64_tr_b16 v[64:65], v115 offset:0
    s_add_u32 s52, s52, s65
    v_cvt_pk_bf16_f32 v106, v52, v53
    v_mfma_f32_16x16x32_bf16 v[20:23], v[72:75], a[20:23], v[20:23]
    ds_read_b64_tr_b16 v[66:67], v115 offset:512
    buffer_load_dwordx4 v117, s[24:27], s52 offen lds
    v_cvt_pk_bf16_f32 v107, v54, v55
    v_mfma_f32_16x16x32_bf16 v[24:27], v[76:79], a[16:19], v[24:27]
    v_add_u32 v116, 0x10000, v116
    ds_read_b64_tr_b16 v[68:69], v116 offset:0
    s_add_u32 m0, s57, 57216
    v_cvt_pk_bf16_f32 v108, v56, v57
    v_mfma_f32_16x16x32_bf16 v[28:31], v[76:79], a[20:23], v[28:31]
    ds_read_b64_tr_b16 v[70:71], v116 offset:512
    s_nop 0
    v_cvt_pk_bf16_f32 v109, v58, v59
    s_waitcnt lgkmcnt(8)
    s_waitcnt vmcnt(21)
    v_mfma_f32_16x16x32_bf16 v[0:3], v[80:83], a[24:27], v[0:3]
    ds_read_b64_tr_b16 v[72:73], v115 offset:8192
    buffer_load_dwordx4 v117, s[24:27], s52 offen offset:128 lds
    v_cvt_pk_bf16_f32 v110, v60, v61
    s_waitcnt vmcnt(20)
    v_mfma_f32_16x16x32_bf16 v[4:7], v[80:83], a[28:31], v[4:7]
    ds_read_b64_tr_b16 v[74:75], v115 offset:8704
    v_cvt_pk_bf16_f32 v111, v62, v63
    v_mfma_f32_16x16x32_bf16 v[8:11], v[84:87], a[24:27], v[8:11]
    ds_read_b64_tr_b16 v[76:77], v116 offset:8192
    v_mfma_f32_16x16x32_bf16 v[12:15], v[84:87], a[28:31], v[12:15]
    ds_read_b64_tr_b16 v[78:79], v116 offset:8704
    s_waitcnt lgkmcnt(8)
    v_mfma_f32_16x16x32_bf16 v[16:19], v[88:91], a[24:27], v[16:19]
    ds_read_b64_tr_b16 v[80:81], v115 offset:4096
    s_add_u32 s53, s96, 4
    s_and_b32 s53, s53, 7
    s_lshl_b32 s53, s53, 12
    s_add_u32 s53, s53, s66
    v_mfma_f32_16x16x32_bf16 v[20:23], v[88:91], a[28:31], v[20:23]
    ds_read_b64_tr_b16 v[82:83], v115 offset:4608
    buffer_load_dwordx4 a[64:67], v112, s[8:11], s53 offen offset:0 sc1
    v_mfma_f32_16x16x32_bf16 v[24:27], v[92:95], a[24:27], v[24:27]
    ds_read_b64_tr_b16 v[84:85], v116 offset:4096
    v_mfma_f32_16x16x32_bf16 v[28:31], v[92:95], a[28:31], v[28:31]
    ds_read_b64_tr_b16 v[86:87], v116 offset:4608
    buffer_load_dwordx4 a[68:71], v112, s[8:11], s53 offen offset:1024 sc1
    s_waitcnt lgkmcnt(8)
    v_mfma_f32_16x16x32_bf16 v[32:35], v[64:67], a[0:3], 0
    ds_read_b64_tr_b16 v[88:89], v115 offset:12288
    v_mfma_f32_16x16x32_bf16 v[36:39], v[64:67], a[4:7], 0
    ds_read_b64_tr_b16 v[90:91], v115 offset:12800
    buffer_load_dwordx4 a[72:75], v112, s[8:11], s53 offen offset:2048 sc1
    v_mfma_f32_16x16x32_bf16 v[40:43], v[68:71], a[0:3], 0
    ds_read_b64_tr_b16 v[92:93], v116 offset:12288
    v_mfma_f32_16x16x32_bf16 v[44:47], v[68:71], a[4:7], 0
    ds_read_b64_tr_b16 v[94:95], v116 offset:12800
    buffer_load_dwordx4 a[76:79], v112, s[8:11], s53 offen offset:3072 sc1
    s_waitcnt lgkmcnt(8)
    v_mfma_f32_16x16x32_bf16 v[48:51], v[72:75], a[0:3], 0
    ds_read_b64_tr_b16 v[64:65], v115 offset:16384
    v_mfma_f32_16x16x32_bf16 v[52:55], v[72:75], a[4:7], 0
    ds_read_b64_tr_b16 v[66:67], v115 offset:16896
    v_mfma_f32_16x16x32_bf16 v[56:59], v[76:79], a[0:3], 0
    ds_read_b64_tr_b16 v[68:69], v116 offset:16384
    v_mfma_f32_16x16x32_bf16 v[60:63], v[76:79], a[4:7], 0
    ds_read_b64_tr_b16 v[70:71], v116 offset:16896
    s_waitcnt lgkmcnt(8)
    v_mfma_f32_16x16x32_bf16 v[32:35], v[80:83], a[8:11], v[32:35]
    ds_read_b64_tr_b16 v[72:73], v115 offset:24576
    v_mfma_f32_16x16x32_bf16 v[36:39], v[80:83], a[12:15], v[36:39]
    ds_read_b64_tr_b16 v[74:75], v115 offset:25088
    v_mfma_f32_16x16x32_bf16 v[40:43], v[84:87], a[8:11], v[40:43]
    ds_read_b64_tr_b16 v[76:77], v116 offset:24576
    v_mfma_f32_16x16x32_bf16 v[44:47], v[84:87], a[12:15], v[44:47]
    ds_read_b64_tr_b16 v[78:79], v116 offset:25088
    s_waitcnt lgkmcnt(8)
    v_mfma_f32_16x16x32_bf16 v[48:51], v[88:91], a[8:11], v[48:51]
    ds_read_b64_tr_b16 v[80:81], v115 offset:20480
    v_mfma_f32_16x16x32_bf16 v[52:55], v[88:91], a[12:15], v[52:55]
    ds_read_b64_tr_b16 v[82:83], v115 offset:20992
    v_mfma_f32_16x16x32_bf16 v[56:59], v[92:95], a[8:11], v[56:59]
    ds_read_b64_tr_b16 v[84:85], v116 offset:20480
    v_mfma_f32_16x16x32_bf16 v[60:63], v[92:95], a[12:15], v[60:63]
    ds_read_b64_tr_b16 v[86:87], v116 offset:20992
    s_barrier
    s_waitcnt lgkmcnt(8)
    v_mfma_f32_16x16x32_bf16 v[32:35], v[64:67], a[16:19], v[32:35]
    ds_read_b64_tr_b16 v[88:89], v115 offset:28672
    s_add_u32 m0, s57, 65536
    v_mfma_f32_16x16x32_bf16 v[36:39], v[64:67], a[20:23], v[36:39]
    ds_read_b64_tr_b16 v[90:91], v115 offset:29184
    s_add_u32 s52, s96, 2
    v_mfma_f32_16x16x32_bf16 v[40:43], v[68:71], a[16:19], v[40:43]
    ds_read_b64_tr_b16 v[92:93], v116 offset:28672
    s_and_b32 s52, s52, 7
    v_mfma_f32_16x16x32_bf16 v[44:47], v[68:71], a[20:23], v[44:47]
    ds_read_b64_tr_b16 v[94:95], v116 offset:29184
    s_lshl_b32 s52, s52, 19
    s_waitcnt lgkmcnt(8)
    v_mfma_f32_16x16x32_bf16 v[48:51], v[72:75], a[16:19], v[48:51]
    ds_read_b64_tr_b16 v[64:65], v113 offset:32768
    s_add_u32 s52, s52, s65
    v_mfma_f32_16x16x32_bf16 v[52:55], v[72:75], a[20:23], v[52:55]
    ds_read_b64_tr_b16 v[66:67], v113 offset:33280
    buffer_load_dwordx4 v117, s[24:27], s52 offen lds
    v_mfma_f32_16x16x32_bf16 v[56:59], v[76:79], a[16:19], v[56:59]
    ds_read_b64_tr_b16 v[68:69], v114 offset:32768
    s_add_u32 m0, s57, 73600
    v_mfma_f32_16x16x32_bf16 v[60:63], v[76:79], a[20:23], v[60:63]
    ds_read_b64_tr_b16 v[70:71], v114 offset:33280
    s_nop 0
    s_waitcnt lgkmcnt(8)
    v_mfma_f32_16x16x32_bf16 v[32:35], v[80:83], a[24:27], v[32:35]
    ds_read_b64_tr_b16 v[72:73], v113 offset:40960
    buffer_load_dwordx4 v117, s[24:27], s52 offen offset:128 lds
    v_mfma_f32_16x16x32_bf16 v[36:39], v[80:83], a[28:31], v[36:39]
    ds_read_b64_tr_b16 v[74:75], v113 offset:41472
    v_mfma_f32_16x16x32_bf16 v[40:43], v[84:87], a[24:27], v[40:43]
    ds_read_b64_tr_b16 v[76:77], v114 offset:40960
    v_mfma_f32_16x16x32_bf16 v[44:47], v[84:87], a[28:31], v[44:47]
    ds_read_b64_tr_b16 v[78:79], v114 offset:41472
    s_waitcnt lgkmcnt(8)
    v_mfma_f32_16x16x32_bf16 v[48:51], v[88:91], a[24:27], v[48:51]
    ds_read_b64_tr_b16 v[80:81], v113 offset:36864
    s_add_u32 s53, s96, 5
    s_and_b32 s53, s53, 7
    s_lshl_b32 s53, s53, 12
    s_add_u32 s53, s53, s66
    v_mfma_f32_16x16x32_bf16 v[52:55], v[88:91], a[28:31], v[52:55]
    ds_read_b64_tr_b16 v[82:83], v113 offset:37376
    buffer_load_dwordx4 a[80:83], v112, s[8:11], s53 offen offset:0 sc1
    v_mfma_f32_16x16x32_bf16 v[56:59], v[92:95], a[24:27], v[56:59]
    ds_read_b64_tr_b16 v[84:85], v114 offset:36864
    v_mfma_f32_16x16x32_bf16 v[60:63], v[92:95], a[28:31], v[60:63]
    ds_read_b64_tr_b16 v[86:87], v114 offset:37376
    buffer_load_dwordx4 a[84:87], v112, s[8:11], s53 offen offset:1024 sc1
P2_M:
    s_waitcnt lgkmcnt(8)
    s_waitcnt vmcnt(21)
    v_mfma_f32_16x16x32_bf16 v[0:3], v[64:67], a[32:35], v[0:3]
    ds_read_b64_tr_b16 v[88:89], v113 offset:45056
    s_waitcnt vmcnt(19)
    v_mfma_f32_16x16x32_bf16 v[4:7], v[64:67], a[36:39], v[4:7]
    ds_read_b64_tr_b16 v[90:91], v113 offset:45568
    buffer_load_dwordx4 a[88:91], v112, s[8:11], s53 offen offset:2048 sc1
    v_mfma_f32_16x16x32_bf16 v[8:11], v[68:71], a[32:35], v[8:11]
    ds_read_b64_tr_b16 v[92:93], v114 offset:45056
    v_mfma_f32_16x16x32_bf16 v[12:15], v[68:71], a[36:39], v[12:15]
    ds_read_b64_tr_b16 v[94:95], v114 offset:45568
    buffer_load_dwordx4 a[92:95], v112, s[8:11], s53 offen offset:3072 sc1
    s_waitcnt lgkmcnt(8)
    v_mfma_f32_16x16x32_bf16 v[16:19], v[72:75], a[32:35], v[16:19]
    ds_read_b64_tr_b16 v[64:65], v115 offset:32768
    v_mfma_f32_16x16x32_bf16 v[20:23], v[72:75], a[36:39], v[20:23]
    ds_read_b64_tr_b16 v[66:67], v115 offset:33280
    v_mfma_f32_16x16x32_bf16 v[24:27], v[76:79], a[32:35], v[24:27]
    ds_read_b64_tr_b16 v[68:69], v116 offset:32768
    v_mfma_f32_16x16x32_bf16 v[28:31], v[76:79], a[36:39], v[28:31]
    ds_read_b64_tr_b16 v[70:71], v116 offset:33280
    s_waitcnt lgkmcnt(8)
    s_waitcnt vmcnt(19)
    v_mfma_f32_16x16x32_bf16 v[0:3], v[80:83], a[40:43], v[0:3]
    ds_read_b64_tr_b16 v[72:73], v115 offset:40960
    s_waitcnt vmcnt(18)
    v_mfma_f32_16x16x32_bf16 v[4:7], v[80:83], a[44:47], v[4:7]
    ds_read_b64_tr_b16 v[74:75], v115 offset:41472
    v_mfma_f32_16x16x32_bf16 v[8:11], v[84:87], a[40:43], v[8:11]
    ds_read_b64_tr_b16 v[76:77], v116 offset:40960
    v_mfma_f32_16x16x32_bf16 v[12:15], v[84:87], a[44:47], v[12:15]
    ds_read_b64_tr_b16 v[78:79], v116 offset:41472
    s_waitcnt lgkmcnt(8)
    v_mfma_f32_16x16x32_bf16 v[16:19], v[88:91], a[40:43], v[16:19]
    ds_read_b64_tr_b16 v[80:81], v115 offset:36864
    v_mfma_f32_16x16x32_bf16 v[20:23], v[88:91], a[44:47], v[20:23]
    ds_read_b64_tr_b16 v[82:83], v115 offset:37376
    v_mfma_f32_16x16x32_bf16 v[24:27], v[92:95], a[40:43], v[24:27]
    ds_read_b64_tr_b16 v[84:85], v116 offset:36864
    v_mfma_f32_16x16x32_bf16 v[28:31], v[92:95], a[44:47], v[28:31]
    ds_read_b64_tr_b16 v[86:87], v116 offset:37376
    s_barrier
    s_waitcnt lgkmcnt(8)
    v_mfma_f32_16x16x32_bf16 v[32:35], v[64:67], a[32:35], v[32:35]
    ds_read_b64_tr_b16 v[88:89], v115 offset:45056
    s_add_u32 m0, s57, 81920
    v_mfma_f32_16x16x32_bf16 v[36:39], v[64:67], a[36:39], v[36:39]
    ds_read_b64_tr_b16 v[90:91], v115 offset:45568
    s_add_u32 s52, s96, 3
    v_mfma_f32_16x16x32_bf16 v[40:43], v[68:71], a[32:35], v[40:43]
    ds_read_b64_tr_b16 v[92:93], v116 offset:45056
    s_and_b32 s52, s52, 7
    v_mfma_f32_16x16x32_bf16 v[44:47], v[68:71], a[36:39], v[44:47]
    ds_read_b64_tr_b16 v[94:95], v116 offset:45568
    s_lshl_b32 s52, s52, 19
    s_waitcnt lgkmcnt(8)
    v_mfma_f32_16x16x32_bf16 v[48:51], v[72:75], a[32:35], v[48:51]
    ds_read_b64_tr_b16 v[64:65], v113 offset:49152
    s_add_u32 s52, s52, s65
    v_mfma_f32_16x16x32_bf16 v[52:55], v[72:75], a[36:39], v[52:55]
    ds_read_b64_tr_b16 v[66:67], v113 offset:49664
    buffer_load_dwordx4 v117, s[24:27], s52 offen lds
    v_mfma_f32_16x16x32_bf16 v[56:59], v[76:79], a[32:35], v[56:59]
    ds_read_b64_tr_b16 v[68:69], v114 offset:49152
    s_add_u32 m0, s57, 89984
    v_mfma_f32_16x16x32_bf16 v[60:63], v[76:79], a[36:39], v[60:63]
    ds_read_b64_tr_b16 v[70:71], v114 offset:49664
    s_nop 0
    s_waitcnt lgkmcnt(8)
    v_mfma_f32_16x16x32_bf16 v[32:35], v[80:83], a[40:43], v[32:35]
    ds_read_b64_tr_b16 v[72:73], v113 offset:57344
    buffer_load_dwordx4 v117, s[24:27], s52 offen offset:128 lds
    v_mfma_f32_16x16x32_bf16 v[36:39], v[80:83], a[44:47], v[36:39]
    ds_read_b64_tr_b16 v[74:75], v113 offset:57856
    v_mfma_f32_16x16x32_bf16 v[40:43], v[84:87], a[40:43], v[40:43]
    ds_read_b64_tr_b16 v[76:77], v114 offset:57344
    v_mfma_f32_16x16x32_bf16 v[44:47], v[84:87], a[44:47], v[44:47]
    ds_read_b64_tr_b16 v[78:79], v114 offset:57856
    s_waitcnt lgkmcnt(8)
    v_mfma_f32_16x16x32_bf16 v[48:51], v[88:91], a[40:43], v[48:51]
    ds_read_b64_tr_b16 v[80:81], v113 offset:53248
    s_add_u32 s53, s96, 6
    s_and_b32 s53, s53, 7
    s_lshl_b32 s53, s53, 12
    s_add_u32 s53, s53, s66
    v_mfma_f32_16x16x32_bf16 v[52:55], v[88:91], a[44:47], v[52:55]
    ds_read_b64_tr_b16 v[82:83], v113 offset:53760
    buffer_load_dwordx4 a[96:99], v112, s[8:11], s53 offen offset:0 sc1
    v_mfma_f32_16x16x32_bf16 v[56:59], v[92:95], a[40:43], v[56:59]
    ds_read_b64_tr_b16 v[84:85], v114 offset:53248
    v_mfma_f32_16x16x32_bf16 v[60:63], v[92:95], a[44:47], v[60:63]
    ds_read_b64_tr_b16 v[86:87], v114 offset:53760
    buffer_load_dwordx4 a[100:103], v112, s[8:11], s53 offen offset:1024 sc1
    s_waitcnt lgkmcnt(8)
    s_waitcnt vmcnt(19)
    v_mfma_f32_16x16x32_bf16 v[0:3], v[64:67], a[48:51], v[0:3]
    ds_read_b64_tr_b16 v[88:89], v113 offset:61440
    s_waitcnt vmcnt(18)
    v_mfma_f32_16x16x32_bf16 v[4:7], v[64:67], a[52:55], v[4:7]
    ds_read_b64_tr_b16 v[90:91], v113 offset:61952
    buffer_load_dwordx4 a[104:107], v112, s[8:11], s53 offen offset:2048 sc1
    v_mfma_f32_16x16x32_bf16 v[8:11], v[68:71], a[48:51], v[8:11]
    ds_read_b64_tr_b16 v[92:93], v114 offset:61440
    v_mfma_f32_16x16x32_bf16 v[12:15], v[68:71], a[52:55], v[12:15]
    ds_read_b64_tr_b16 v[94:95], v114 offset:61952
    buffer_load_dwordx4 a[108:111], v112, s[8:11], s53 offen offset:3072 sc1
    s_waitcnt lgkmcnt(8)
    v_mfma_f32_16x16x32_bf16 v[16:19], v[72:75], a[48:51], v[16:19]
    ds_read_b64_tr_b16 v[64:65], v115 offset:49152
    v_mfma_f32_16x16x32_bf16 v[20:23], v[72:75], a[52:55], v[20:23]
    ds_read_b64_tr_b16 v[66:67], v115 offset:49664
    v_mfma_f32_16x16x32_bf16 v[24:27], v[76:79], a[48:51], v[24:27]
    ds_read_b64_tr_b16 v[68:69], v116 offset:49152
    v_mfma_f32_16x16x32_bf16 v[28:31], v[76:79], a[52:55], v[28:31]
    ds_read_b64_tr_b16 v[70:71], v116 offset:49664
    s_waitcnt lgkmcnt(8)
    s_waitcnt vmcnt(19)
    v_mfma_f32_16x16x32_bf16 v[0:3], v[80:83], a[56:59], v[0:3]
    ds_read_b64_tr_b16 v[72:73], v115 offset:57344
    s_waitcnt vmcnt(18)
    v_mfma_f32_16x16x32_bf16 v[4:7], v[80:83], a[60:63], v[4:7]
    ds_read_b64_tr_b16 v[74:75], v115 offset:57856
    v_mfma_f32_16x16x32_bf16 v[8:11], v[84:87], a[56:59], v[8:11]
    ds_read_b64_tr_b16 v[76:77], v116 offset:57344
    v_mfma_f32_16x16x32_bf16 v[12:15], v[84:87], a[60:63], v[12:15]
    ds_read_b64_tr_b16 v[78:79], v116 offset:57856
    s_waitcnt lgkmcnt(8)
    v_mfma_f32_16x16x32_bf16 v[16:19], v[88:91], a[56:59], v[16:19]
    ds_read_b64_tr_b16 v[80:81], v115 offset:53248
    v_mfma_f32_16x16x32_bf16 v[20:23], v[88:91], a[60:63], v[20:23]
    ds_read_b64_tr_b16 v[82:83], v115 offset:53760
    v_mfma_f32_16x16x32_bf16 v[24:27], v[92:95], a[56:59], v[24:27]
    ds_read_b64_tr_b16 v[84:85], v116 offset:53248
    v_mfma_f32_16x16x32_bf16 v[28:31], v[92:95], a[60:63], v[28:31]
    ds_read_b64_tr_b16 v[86:87], v116 offset:53760
    s_barrier
    s_waitcnt lgkmcnt(8)
    v_mfma_f32_16x16x32_bf16 v[32:35], v[64:67], a[48:51], v[32:35]
    ds_read_b64_tr_b16 v[88:89], v115 offset:61440
    s_add_u32 m0, s57, 98304
    v_mfma_f32_16x16x32_bf16 v[36:39], v[64:67], a[52:55], v[36:39]
    ds_read_b64_tr_b16 v[90:91], v115 offset:61952
    s_add_u32 s52, s96, 4
    v_mfma_f32_16x16x32_bf16 v[40:43], v[68:71], a[48:51], v[40:43]
    ds_read_b64_tr_b16 v[92:93], v116 offset:61440
    s_and_b32 s52, s52, 7
    v_mfma_f32_16x16x32_bf16 v[44:47], v[68:71], a[52:55], v[44:47]
    ds_read_b64_tr_b16 v[94:95], v116 offset:61952
    s_lshl_b32 s52, s52, 19
    s_waitcnt lgkmcnt(8)
    v_mfma_f32_16x16x32_bf16 v[48:51], v[72:75], a[48:51], v[48:51]
    v_add_u32 v113, 0x10000, v113
    ds_read_b64_tr_b16 v[64:65], v113 offset:0
    s_add_u32 s52, s52, s65
    v_mfma_f32_16x16x32_bf16 v[52:55], v[72:75], a[52:55], v[52:55]
    ds_read_b64_tr_b16 v[66:67], v113 offset:512
    buffer_load_dwordx4 v117, s[24:27], s52 offen lds
    v_mfma_f32_16x16x32_bf16 v[56:59], v[76:79], a[48:51], v[56:59]
    v_add_u32 v114, 0x10000, v114
    ds_read_b64_tr_b16 v[68:69], v114 offset:0
    s_add_u32 m0, s57, 106368
    v_mfma_f32_16x16x32_bf16 v[60:63], v[76:79], a[52:55], v[60:63]
    ds_read_b64_tr_b16 v[70:71], v114 offset:512
    s_nop 0
    s_waitcnt lgkmcnt(8)
    v_mfma_f32_16x16x32_bf16 v[32:35], v[80:83], a[56:59], v[32:35]
    ds_read_b64_tr_b16 v[72:73], v113 offset:8192
    buffer_load_dwordx4 v117, s[24:27], s52 offen offset:128 lds
    v_mfma_f32_16x16x32_bf16 v[36:39], v[80:83], a[60:63], v[36:39]
    ds_read_b64_tr_b16 v[74:75], v113 offset:8704
    v_mfma_f32_16x16x32_bf16 v[40:43], v[84:87], a[56:59], v[40:43]
    ds_read_b64_tr_b16 v[76:77], v114 offset:8192
    v_mfma_f32_16x16x32_bf16 v[44:47], v[84:87], a[60:63], v[44:47]
    ds_read_b64_tr_b16 v[78:79], v114 offset:8704
    s_waitcnt lgkmcnt(8)
    v_mfma_f32_16x16x32_bf16 v[48:51], v[88:91], a[56:59], v[48:51]
    ds_read_b64_tr_b16 v[80:81], v113 offset:4096
    s_add_u32 s53, s96, 7
    s_and_b32 s53, s53, 7
    s_lshl_b32 s53, s53, 12
    s_add_u32 s53, s53, s66
    v_mfma_f32_16x16x32_bf16 v[52:55], v[88:91], a[60:63], v[52:55]
    ds_read_b64_tr_b16 v[82:83], v113 offset:4608
    buffer_load_dwordx4 a[112:115], v112, s[8:11], s53 offen offset:0 sc1
    v_mfma_f32_16x16x32_bf16 v[56:59], v[92:95], a[56:59], v[56:59]
    ds_read_b64_tr_b16 v[84:85], v114 offset:4096
    v_mfma_f32_16x16x32_bf16 v[60:63], v[92:95], a[60:63], v[60:63]
    ds_read_b64_tr_b16 v[86:87], v114 offset:4608
    buffer_load_dwordx4 a[116:119], v112, s[8:11], s53 offen offset:1024 sc1
    s_waitcnt lgkmcnt(8)
    s_waitcnt vmcnt(19)
    v_mfma_f32_16x16x32_bf16 v[0:3], v[64:67], a[64:67], v[0:3]
    ds_read_b64_tr_b16 v[88:89], v113 offset:12288
    s_waitcnt vmcnt(18)
    v_mfma_f32_16x16x32_bf16 v[4:7], v[64:67], a[68:71], v[4:7]
    ds_read_b64_tr_b16 v[90:91], v113 offset:12800
    buffer_load_dwordx4 a[120:123], v112, s[8:11], s53 offen offset:2048 sc1
    v_mfma_f32_16x16x32_bf16 v[8:11], v[68:71], a[64:67], v[8:11]
    ds_read_b64_tr_b16 v[92:93], v114 offset:12288
    v_mfma_f32_16x16x32_bf16 v[12:15], v[68:71], a[68:71], v[12:15]
    ds_read_b64_tr_b16 v[94:95], v114 offset:12800
    buffer_load_dwordx4 a[124:127], v112, s[8:11], s53 offen offset:3072 sc1
    s_waitcnt lgkmcnt(8)
    v_mfma_f32_16x16x32_bf16 v[16:19], v[72:75], a[64:67], v[16:19]
    v_add_u32 v115, 0x10000, v115
    ds_read_b64_tr_b16 v[64:65], v115 offset:0
    v_mfma_f32_16x16x32_bf16 v[20:23], v[72:75], a[68:71], v[20:23]
    ds_read_b64_tr_b16 v[66:67], v115 offset:512
    v_mfma_f32_16x16x32_bf16 v[24:27], v[76:79], a[64:67], v[24:27]
    v_add_u32 v116, 0x10000, v116
    ds_read_b64_tr_b16 v[68:69], v116 offset:0
    v_mfma_f32_16x16x32_bf16 v[28:31], v[76:79], a[68:71], v[28:31]
    ds_read_b64_tr_b16 v[70:71], v116 offset:512
    s_waitcnt lgkmcnt(8)
    s_waitcnt vmcnt(19)
    v_mfma_f32_16x16x32_bf16 v[0:3], v[80:83], a[72:75], v[0:3]
    ds_read_b64_tr_b16 v[72:73], v115 offset:8192
    s_waitcnt vmcnt(18)
    v_mfma_f32_16x16x32_bf16 v[4:7], v[80:83], a[76:79], v[4:7]
    ds_read_b64_tr_b16 v[74:75], v115 offset:8704
    v_mfma_f32_16x16x32_bf16 v[8:11], v[84:87], a[72:75], v[8:11]
    ds_read_b64_tr_b16 v[76:77], v116 offset:8192
    v_mfma_f32_16x16x32_bf16 v[12:15], v[84:87], a[76:79], v[12:15]
    ds_read_b64_tr_b16 v[78:79], v116 offset:8704
    s_waitcnt lgkmcnt(8)
    v_mfma_f32_16x16x32_bf16 v[16:19], v[88:91], a[72:75], v[16:19]
    ds_read_b64_tr_b16 v[80:81], v115 offset:4096
    v_mfma_f32_16x16x32_bf16 v[20:23], v[88:91], a[76:79], v[20:23]
    ds_read_b64_tr_b16 v[82:83], v115 offset:4608
    v_mfma_f32_16x16x32_bf16 v[24:27], v[92:95], a[72:75], v[24:27]
    ds_read_b64_tr_b16 v[84:85], v116 offset:4096
    v_mfma_f32_16x16x32_bf16 v[28:31], v[92:95], a[76:79], v[28:31]
    ds_read_b64_tr_b16 v[86:87], v116 offset:4608
    s_barrier
    s_waitcnt lgkmcnt(8)
    v_mfma_f32_16x16x32_bf16 v[32:35], v[64:67], a[64:67], v[32:35]
    ds_read_b64_tr_b16 v[88:89], v115 offset:12288
    s_add_u32 m0, s57, 114688
    v_mfma_f32_16x16x32_bf16 v[36:39], v[64:67], a[68:71], v[36:39]
    ds_read_b64_tr_b16 v[90:91], v115 offset:12800
    s_add_u32 s52, s96, 5
    v_mfma_f32_16x16x32_bf16 v[40:43], v[68:71], a[64:67], v[40:43]
    ds_read_b64_tr_b16 v[92:93], v116 offset:12288
    s_and_b32 s52, s52, 7
    v_mfma_f32_16x16x32_bf16 v[44:47], v[68:71], a[68:71], v[44:47]
    ds_read_b64_tr_b16 v[94:95], v116 offset:12800
    s_lshl_b32 s52, s52, 19
    s_waitcnt lgkmcnt(8)
    v_mfma_f32_16x16x32_bf16 v[48:51], v[72:75], a[64:67], v[48:51]
    ds_read_b64_tr_b16 v[64:65], v113 offset:16384
    s_add_u32 s52, s52, s65
    buffer_store_dwordx4 v[96:99], v112, s[8:11], s56 offen offset:0 sc1
    v_mfma_f32_16x16x32_bf16 v[52:55], v[72:75], a[68:71], v[52:55]
    ds_read_b64_tr_b16 v[66:67], v113 offset:16896
    buffer_load_dwordx4 v117, s[24:27], s52 offen lds
    v_mfma_f32_16x16x32_bf16 v[56:59], v[76:79], a[64:67], v[56:59]
    ds_read_b64_tr_b16 v[68:69], v114 offset:16384
    s_add_u32 m0, s57, 122752
    v_mfma_f32_16x16x32_bf16 v[60:63], v[76:79], a[68:71], v[60:63]
    ds_read_b64_tr_b16 v[70:71], v114 offset:16896
    s_nop 0
    s_waitcnt lgkmcnt(8)
    v_mfma_f32_16x16x32_bf16 v[32:35], v[80:83], a[72:75], v[32:35]
    ds_read_b64_tr_b16 v[72:73], v113 offset:24576
    buffer_load_dwordx4 v117, s[24:27], s52 offen offset:128 lds
    v_mfma_f32_16x16x32_bf16 v[36:39], v[80:83], a[76:79], v[36:39]
    ds_read_b64_tr_b16 v[74:75], v113 offset:25088
    v_mfma_f32_16x16x32_bf16 v[40:43], v[84:87], a[72:75], v[40:43]
    ds_read_b64_tr_b16 v[76:77], v114 offset:24576
    v_mfma_f32_16x16x32_bf16 v[44:47], v[84:87], a[76:79], v[44:47]
    ds_read_b64_tr_b16 v[78:79], v114 offset:25088
    s_waitcnt lgkmcnt(8)
    v_mfma_f32_16x16x32_bf16 v[48:51], v[88:91], a[72:75], v[48:51]
    ds_read_b64_tr_b16 v[80:81], v113 offset:20480
    v_mfma_f32_16x16x32_bf16 v[52:55], v[88:91], a[76:79], v[52:55]
    ds_read_b64_tr_b16 v[82:83], v113 offset:20992
    v_mfma_f32_16x16x32_bf16 v[56:59], v[92:95], a[72:75], v[56:59]
    ds_read_b64_tr_b16 v[84:85], v114 offset:20480
    v_mfma_f32_16x16x32_bf16 v[60:63], v[92:95], a[76:79], v[60:63]
    ds_read_b64_tr_b16 v[86:87], v114 offset:20992
    s_waitcnt lgkmcnt(8)
    s_waitcnt vmcnt(18)
    v_mfma_f32_16x16x32_bf16 v[0:3], v[64:67], a[80:83], v[0:3]
    ds_read_b64_tr_b16 v[88:89], v113 offset:28672
    s_waitcnt vmcnt(17)
    v_mfma_f32_16x16x32_bf16 v[4:7], v[64:67], a[84:87], v[4:7]
    ds_read_b64_tr_b16 v[90:91], v113 offset:29184
    v_mfma_f32_16x16x32_bf16 v[8:11], v[68:71], a[80:83], v[8:11]
    ds_read_b64_tr_b16 v[92:93], v114 offset:28672
    v_mfma_f32_16x16x32_bf16 v[12:15], v[68:71], a[84:87], v[12:15]
    ds_read_b64_tr_b16 v[94:95], v114 offset:29184
    s_waitcnt lgkmcnt(8)
    v_mfma_f32_16x16x32_bf16 v[16:19], v[72:75], a[80:83], v[16:19]
    ds_read_b64_tr_b16 v[64:65], v115 offset:16384
    v_mfma_f32_16x16x32_bf16 v[20:23], v[72:75], a[84:87], v[20:23]
    ds_read_b64_tr_b16 v[66:67], v115 offset:16896
    v_mfma_f32_16x16x32_bf16 v[24:27], v[76:79], a[80:83], v[24:27]
    ds_read_b64_tr_b16 v[68:69], v116 offset:16384
    v_mfma_f32_16x16x32_bf16 v[28:31], v[76:79], a[84:87], v[28:31]
    ds_read_b64_tr_b16 v[70:71], v116 offset:16896
    s_waitcnt lgkmcnt(8)
    s_waitcnt vmcnt(16)
    v_mfma_f32_16x16x32_bf16 v[0:3], v[80:83], a[88:91], v[0:3]
    ds_read_b64_tr_b16 v[72:73], v115 offset:24576
    buffer_store_dwordx4 v[100:103], v112, s[8:11], s56 offen offset:1024 sc1
    s_waitcnt vmcnt(16)
    v_mfma_f32_16x16x32_bf16 v[4:7], v[80:83], a[92:95], v[4:7]
    ds_read_b64_tr_b16 v[74:75], v115 offset:25088
    v_mfma_f32_16x16x32_bf16 v[8:11], v[84:87], a[88:91], v[8:11]
    ds_read_b64_tr_b16 v[76:77], v116 offset:24576
    v_mfma_f32_16x16x32_bf16 v[12:15], v[84:87], a[92:95], v[12:15]
    ds_read_b64_tr_b16 v[78:79], v116 offset:25088
    s_waitcnt lgkmcnt(8)
    v_mfma_f32_16x16x32_bf16 v[16:19], v[88:91], a[88:91], v[16:19]
    ds_read_b64_tr_b16 v[80:81], v115 offset:20480
    v_mfma_f32_16x16x32_bf16 v[20:23], v[88:91], a[92:95], v[20:23]
    ds_read_b64_tr_b16 v[82:83], v115 offset:20992
    v_mfma_f32_16x16x32_bf16 v[24:27], v[92:95], a[88:91], v[24:27]
    ds_read_b64_tr_b16 v[84:85], v116 offset:20480
    v_mfma_f32_16x16x32_bf16 v[28:31], v[92:95], a[92:95], v[28:31]
    ds_read_b64_tr_b16 v[86:87], v116 offset:20992
    s_barrier
    s_waitcnt lgkmcnt(8)
    v_mfma_f32_16x16x32_bf16 v[32:35], v[64:67], a[80:83], v[32:35]
    ds_read_b64_tr_b16 v[88:89], v115 offset:28672
    s_add_u32 m0, s57, 131072
    v_mfma_f32_16x16x32_bf16 v[36:39], v[64:67], a[84:87], v[36:39]
    ds_read_b64_tr_b16 v[90:91], v115 offset:29184
    s_add_u32 s52, s96, 6
    v_mfma_f32_16x16x32_bf16 v[40:43], v[68:71], a[80:83], v[40:43]
    ds_read_b64_tr_b16 v[92:93], v116 offset:28672
    s_and_b32 s52, s52, 7
    v_mfma_f32_16x16x32_bf16 v[44:47], v[68:71], a[84:87], v[44:47]
    ds_read_b64_tr_b16 v[94:95], v116 offset:29184
    s_lshl_b32 s52, s52, 19
    s_waitcnt lgkmcnt(8)
    v_mfma_f32_16x16x32_bf16 v[48:51], v[72:75], a[80:83], v[48:51]
    v_add_u32 v113, 0xfffe0000, v113
    ds_read_b64_tr_b16 v[64:65], v113 offset:0
    s_add_u32 s52, s52, s65
    v_mfma_f32_16x16x32_bf16 v[52:55], v[72:75], a[84:87], v[52:55]
    ds_read_b64_tr_b16 v[66:67], v113 offset:512
    buffer_load_dwordx4 v117, s[24:27], s52 offen lds
    v_mfma_f32_16x16x32_bf16 v[56:59], v[76:79], a[80:83], v[56:59]
    v_add_u32 v114, 0xfffe0000, v114
    ds_read_b64_tr_b16 v[68:69], v114 offset:0
    s_add_u32 m0, s57, 139136
    v_mfma_f32_16x16x32_bf16 v[60:63], v[76:79], a[84:87], v[60:63]
    ds_read_b64_tr_b16 v[70:71], v114 offset:512
    s_nop 0
    s_waitcnt lgkmcnt(8)
    v_mfma_f32_16x16x32_bf16 v[32:35], v[80:83], a[88:91], v[32:35]
    ds_read_b64_tr_b16 v[72:73], v113 offset:8192
    buffer_load_dwordx4 v117, s[24:27], s52 offen offset:128 lds
    v_mfma_f32_16x16x32_bf16 v[36:39], v[80:83], a[92:95], v[36:39]
    ds_read_b64_tr_b16 v[74:75], v113 offset:8704
    v_mfma_f32_16x16x32_bf16 v[40:43], v[84:87], a[88:91], v[40:43]
    ds_read_b64_tr_b16 v[76:77], v114 offset:8192
    v_mfma_f32_16x16x32_bf16 v[44:47], v[84:87], a[92:95], v[44:47]
    ds_read_b64_tr_b16 v[78:79], v114 offset:8704
    s_waitcnt lgkmcnt(8)
    v_mfma_f32_16x16x32_bf16 v[48:51], v[88:91], a[88:91], v[48:51]
    ds_read_b64_tr_b16 v[80:81], v113 offset:4096
    buffer_store_dwordx4 v[104:107], v112, s[8:11], s56 offen offset:2048 sc1
    v_mfma_f32_16x16x32_bf16 v[52:55], v[88:91], a[92:95], v[52:55]
    ds_read_b64_tr_b16 v[82:83], v113 offset:4608
    v_mfma_f32_16x16x32_bf16 v[56:59], v[92:95], a[88:91], v[56:59]
    ds_read_b64_tr_b16 v[84:85], v114 offset:4096
    v_mfma_f32_16x16x32_bf16 v[60:63], v[92:95], a[92:95], v[60:63]
    ds_read_b64_tr_b16 v[86:87], v114 offset:4608
    s_waitcnt lgkmcnt(8)
    s_waitcnt vmcnt(16)
    v_mfma_f32_16x16x32_bf16 v[0:3], v[64:67], a[96:99], v[0:3]
    ds_read_b64_tr_b16 v[88:89], v113 offset:12288
    s_waitcnt vmcnt(15)
    v_mfma_f32_16x16x32_bf16 v[4:7], v[64:67], a[100:103], v[4:7]
    ds_read_b64_tr_b16 v[90:91], v113 offset:12800
    v_mfma_f32_16x16x32_bf16 v[8:11], v[68:71], a[96:99], v[8:11]
    ds_read_b64_tr_b16 v[92:93], v114 offset:12288
    v_mfma_f32_16x16x32_bf16 v[12:15], v[68:71], a[100:103], v[12:15]
    ds_read_b64_tr_b16 v[94:95], v114 offset:12800
    s_waitcnt lgkmcnt(8)
    v_mfma_f32_16x16x32_bf16 v[16:19], v[72:75], a[96:99], v[16:19]
    ds_read_b64_tr_b16 v[64:65], v113 offset:16384
    v_mfma_f32_16x16x32_bf16 v[20:23], v[72:75], a[100:103], v[20:23]
    ds_read_b64_tr_b16 v[66:67], v113 offset:16896
    v_mfma_f32_16x16x32_bf16 v[24:27], v[76:79], a[96:99], v[24:27]
    ds_read_b64_tr_b16 v[68:69], v114 offset:16384
    v_mfma_f32_16x16x32_bf16 v[28:31], v[76:79], a[100:103], v[28:31]
    ds_read_b64_tr_b16 v[70:71], v114 offset:16896
    s_waitcnt lgkmcnt(8)
    s_waitcnt vmcnt(14)
    v_mfma_f32_16x16x32_bf16 v[0:3], v[80:83], a[104:107], v[0:3]
    ds_read_b64_tr_b16 v[72:73], v113 offset:24576
    s_waitcnt vmcnt(13)
    v_mfma_f32_16x16x32_bf16 v[4:7], v[80:83], a[108:111], v[4:7]
    ds_read_b64_tr_b16 v[74:75], v113 offset:25088
    v_mfma_f32_16x16x32_bf16 v[8:11], v[84:87], a[104:107], v[8:11]
    ds_read_b64_tr_b16 v[76:77], v114 offset:24576
    v_mfma_f32_16x16x32_bf16 v[12:15], v[84:87], a[108:111], v[12:15]
    ds_read_b64_tr_b16 v[78:79], v114 offset:25088
    s_waitcnt lgkmcnt(8)
    v_mfma_f32_16x16x32_bf16 v[16:19], v[88:91], a[104:107], v[16:19]
    ds_read_b64_tr_b16 v[80:81], v113 offset:20480
    v_mfma_f32_16x16x32_bf16 v[20:23], v[88:91], a[108:111], v[20:23]
    ds_read_b64_tr_b16 v[82:83], v113 offset:20992
    v_mfma_f32_16x16x32_bf16 v[24:27], v[92:95], a[104:107], v[24:27]
    ds_read_b64_tr_b16 v[84:85], v114 offset:20480
    v_mfma_f32_16x16x32_bf16 v[28:31], v[92:95], a[108:111], v[28:31]
    ds_read_b64_tr_b16 v[86:87], v114 offset:20992
    s_barrier
    s_waitcnt lgkmcnt(8)
    s_waitcnt vmcnt(10)
    v_mfma_f32_16x16x32_bf16 v[0:3], v[64:67], a[112:115], v[0:3]
    ds_read_b64_tr_b16 v[88:89], v113 offset:28672
    s_add_u32 m0, s57, 147456
    buffer_store_dwordx4 v[108:111], v112, s[8:11], s56 offen offset:3072 sc1
    s_waitcnt vmcnt(10)
    v_mfma_f32_16x16x32_bf16 v[4:7], v[64:67], a[116:119], v[4:7]
    ds_read_b64_tr_b16 v[90:91], v113 offset:29184
    s_add_u32 s52, s96, 7
    v_mfma_f32_16x16x32_bf16 v[8:11], v[68:71], a[112:115], v[8:11]
    ds_read_b64_tr_b16 v[92:93], v114 offset:28672
    s_and_b32 s52, s52, 7
    v_mfma_f32_16x16x32_bf16 v[12:15], v[68:71], a[116:119], v[12:15]
    ds_read_b64_tr_b16 v[94:95], v114 offset:29184
    s_lshl_b32 s52, s52, 19
    s_waitcnt lgkmcnt(8)
    v_mfma_f32_16x16x32_bf16 v[16:19], v[72:75], a[112:115], v[16:19]
    v_add_u32 v115, 0xfffe0000, v115
    ds_read_b64_tr_b16 v[64:65], v115 offset:0
    s_add_u32 s52, s52, s65
    v_mfma_f32_16x16x32_bf16 v[20:23], v[72:75], a[116:119], v[20:23]
    ds_read_b64_tr_b16 v[66:67], v115 offset:512
    buffer_load_dwordx4 v117, s[24:27], s52 offen lds
    v_mfma_f32_16x16x32_bf16 v[24:27], v[76:79], a[112:115], v[24:27]
    v_add_u32 v116, 0xfffe0000, v116
    ds_read_b64_tr_b16 v[68:69], v116 offset:0
    s_add_u32 m0, s57, 155520
    v_mfma_f32_16x16x32_bf16 v[28:31], v[76:79], a[116:119], v[28:31]
    ds_read_b64_tr_b16 v[70:71], v116 offset:512
    s_nop 0
    s_waitcnt lgkmcnt(8)
    s_waitcnt vmcnt(10)
    v_mfma_f32_16x16x32_bf16 v[0:3], v[80:83], a[120:123], v[0:3]
    ds_read_b64_tr_b16 v[72:73], v115 offset:8192
    buffer_load_dwordx4 v117, s[24:27], s52 offen offset:128 lds
    s_waitcnt vmcnt(10)
    v_mfma_f32_16x16x32_bf16 v[4:7], v[80:83], a[124:127], v[4:7]
    ds_read_b64_tr_b16 v[74:75], v115 offset:8704
    v_mfma_f32_16x16x32_bf16 v[8:11], v[84:87], a[120:123], v[8:11]
    ds_read_b64_tr_b16 v[76:77], v116 offset:8192
    v_mfma_f32_16x16x32_bf16 v[12:15], v[84:87], a[124:127], v[12:15]
    ds_read_b64_tr_b16 v[78:79], v116 offset:8704
    s_waitcnt lgkmcnt(8)
    v_mfma_f32_16x16x32_bf16 v[16:19], v[88:91], a[120:123], v[16:19]
    ds_read_b64_tr_b16 v[80:81], v115 offset:4096
    v_mfma_f32_16x16x32_bf16 v[20:23], v[88:91], a[124:127], v[20:23]
    ds_read_b64_tr_b16 v[82:83], v115 offset:4608
    v_mfma_f32_16x16x32_bf16 v[24:27], v[92:95], a[120:123], v[24:27]
    ds_read_b64_tr_b16 v[84:85], v116 offset:4096
    v_mfma_f32_16x16x32_bf16 v[28:31], v[92:95], a[124:127], v[28:31]
    ds_read_b64_tr_b16 v[86:87], v116 offset:4608
    s_waitcnt lgkmcnt(8)
    v_mfma_f32_16x16x32_bf16 v[32:35], v[64:67], a[96:99], v[32:35]
    ds_read_b64_tr_b16 v[88:89], v115 offset:12288
    v_mfma_f32_16x16x32_bf16 v[36:39], v[64:67], a[100:103], v[36:39]
    ds_read_b64_tr_b16 v[90:91], v115 offset:12800
    v_mfma_f32_16x16x32_bf16 v[40:43], v[68:71], a[96:99], v[40:43]
    ds_read_b64_tr_b16 v[92:93], v116 offset:12288
    v_mfma_f32_16x16x32_bf16 v[44:47], v[68:71], a[100:103], v[44:47]
    ds_read_b64_tr_b16 v[94:95], v116 offset:12800
    s_waitcnt lgkmcnt(8)
    v_mfma_f32_16x16x32_bf16 v[48:51], v[72:75], a[96:99], v[48:51]
    ds_read_b64_tr_b16 v[64:65], v115 offset:16384
    v_mfma_f32_16x16x32_bf16 v[52:55], v[72:75], a[100:103], v[52:55]
    ds_read_b64_tr_b16 v[66:67], v115 offset:16896
    v_mul_f32 v104, 0xbfb8aa3b, v0
    v_mul_f32 v105, 0xbfb8aa3b, v1
    v_mul_f32 v106, 0xbfb8aa3b, v2
    v_mul_f32 v107, 0xbfb8aa3b, v3
    v_mfma_f32_16x16x32_bf16 v[56:59], v[76:79], a[96:99], v[56:59]
    ds_read_b64_tr_b16 v[68:69], v116 offset:16384
    v_mul_f32 v108, 0xbfb8aa3b, v8
    v_mul_f32 v109, 0xbfb8aa3b, v9
    v_mul_f32 v110, 0xbfb8aa3b, v10
    v_mul_f32 v111, 0xbfb8aa3b, v11
    v_mfma_f32_16x16x32_bf16 v[60:63], v[76:79], a[100:103], v[60:63]
    ds_read_b64_tr_b16 v[70:71], v116 offset:16896
    v_exp_f32 v104, v104
    v_exp_f32 v105, v105
    v_exp_f32 v106, v106
    v_exp_f32 v107, v107
    s_waitcnt lgkmcnt(8)
    v_mfma_f32_16x16x32_bf16 v[32:35], v[80:83], a[104:107], v[32:35]
    ds_read_b64_tr_b16 v[72:73], v115 offset:24576
    v_exp_f32 v108, v108
    v_exp_f32 v109, v109
    v_exp_f32 v110, v110
    v_exp_f32 v111, v111
    v_mfma_f32_16x16x32_bf16 v[36:39], v[80:83], a[108:111], v[36:39]
    ds_read_b64_tr_b16 v[74:75], v115 offset:25088
    v_mul_f32 v0, v0, v16
    v_mul_f32 v1, v1, v17
    v_mul_f32 v2, v2, v18
    v_mul_f32 v3, v3, v19
    v_mfma_f32_16x16x32_bf16 v[40:43], v[84:87], a[104:107], v[40:43]
    ds_read_b64_tr_b16 v[76:77], v116 offset:24576
    v_mul_f32 v8, v8, v24
    v_mul_f32 v9, v9, v25
    v_mul_f32 v10, v10, v26
    v_mul_f32 v11, v11, v27
    v_mfma_f32_16x16x32_bf16 v[44:47], v[84:87], a[108:111], v[44:47]
    ds_read_b64_tr_b16 v[78:79], v116 offset:25088
    v_add_f32 v104, 1.0, v104
    v_add_f32 v105, 1.0, v105
    v_add_f32 v106, 1.0, v106
    v_add_f32 v107, 1.0, v107
    s_waitcnt lgkmcnt(8)
    v_mfma_f32_16x16x32_bf16 v[48:51], v[88:91], a[104:107], v[48:51]
    ds_read_b64_tr_b16 v[80:81], v115 offset:20480
    v_add_f32 v108, 1.0, v108
    v_add_f32 v109, 1.0, v109
    v_add_f32 v110, 1.0, v110
    v_add_f32 v111, 1.0, v111
    v_mfma_f32_16x16x32_bf16 v[52:55], v[88:91], a[108:111], v[52:55]
    ds_read_b64_tr_b16 v[82:83], v115 offset:20992
    v_rcp_f32 v104, v104
    v_rcp_f32 v105, v105
    v_rcp_f32 v106, v106
    v_rcp_f32 v107, v107
    v_mfma_f32_16x16x32_bf16 v[56:59], v[92:95], a[104:107], v[56:59]
    ds_read_b64_tr_b16 v[84:85], v116 offset:20480
    v_rcp_f32 v108, v108
    v_rcp_f32 v109, v109
    v_rcp_f32 v110, v110
    v_rcp_f32 v111, v111
    v_mfma_f32_16x16x32_bf16 v[60:63], v[92:95], a[108:111], v[60:63]
    ds_read_b64_tr_b16 v[86:87], v116 offset:20992
    s_nop 0
    v_mul_f32 v0, v0, v104
    v_mul_f32 v1, v1, v105
    v_mul_f32 v2, v2, v106
    s_waitcnt vmcnt(2)
    s_barrier
    s_cmp_lg_u32 s3, 0
    s_cbranch_scc1 SG_9
    v_mov_b32 v127, 1
    buffer_atomic_add v127, v123, s[48:51], 0 offen offset:64 sc1
SG_9:
    s_waitcnt lgkmcnt(8)
    v_mfma_f32_16x16x32_bf16 v[32:35], v[64:67], a[112:115], v[32:35]
    ds_read_b64_tr_b16 v[88:89], v115 offset:28672
    v_mul_f32 v3, v3, v107
    v_mul_f32 v8, v8, v108
    v_mul_f32 v9, v9, v109
    v_mul_f32 v10, v10, v110
    v_mfma_f32_16x16x32_bf16 v[36:39], v[64:67], a[116:119], v[36:39]
    ds_read_b64_tr_b16 v[90:91], v115 offset:29184
    v_mul_f32 v11, v11, v111
    v_cvt_pk_bf16_f32 v96, v0, v1
    v_cvt_pk_bf16_f32 v97, v2, v3
    v_cvt_pk_bf16_f32 v98, v8, v9
    v_mfma_f32_16x16x32_bf16 v[40:43], v[68:71], a[112:115], v[40:43]
    ds_read_b64_tr_b16 v[92:93], v116 offset:28672
    v_cvt_pk_bf16_f32 v99, v10, v11
    buffer_store_dwordx4 v[96:99], v112, s[8:11], s67 offen offset:0 sc1
    v_mul_f32 v104, 0xbfb8aa3b, v4
    v_mul_f32 v105, 0xbfb8aa3b, v5
    v_mfma_f32_16x16x32_bf16 v[44:47], v[68:71], a[116:119], v[44:47]
    ds_read_b64_tr_b16 v[94:95], v116 offset:29184
    v_mul_f32 v106, 0xbfb8aa3b, v6
    v_mul_f32 v107, 0xbfb8aa3b, v7
    v_mul_f32 v108, 0xbfb8aa3b, v12
    v_mul_f32 v109, 0xbfb8aa3b, v13
    s_waitcnt lgkmcnt(8)
    v_mfma_f32_16x16x32_bf16 v[48:51], v[72:75], a[112:115], v[48:51]
    ds_read_b64_tr_b16 v[64:65], v113 offset:32768
    v_mul_f32 v110, 0xbfb8aa3b, v14
    v_mul_f32 v111, 0xbfb8aa3b, v15
    v_exp_f32 v104, v104
    v_exp_f32 v105, v105
    v_mfma_f32_16x16x32_bf16 v[52:55], v[72:75], a[116:119], v[52:55]
    ds_read_b64_tr_b16 v[66:67], v113 offset:33280
    v_exp_f32 v106, v106
    v_exp_f32 v107, v107
    v_exp_f32 v108, v108
    v_exp_f32 v109, v109
    v_mfma_f32_16x16x32_bf16 v[56:59], v[76:79], a[112:115], v[56:59]
    ds_read_b64_tr_b16 v[68:69], v114 offset:32768
    v_exp_f32 v110, v110
    v_exp_f32 v111, v111
    v_mul_f32 v4, v4, v20
    v_mul_f32 v5, v5, v21
    v_mfma_f32_16x16x32_bf16 v[60:63], v[76:79], a[116:119], v[60:63]
    ds_read_b64_tr_b16 v[70:71], v114 offset:33280
    v_mul_f32 v6, v6, v22
    v_mul_f32 v7, v7, v23
    v_mul_f32 v12, v12, v28
    v_mul_f32 v13, v13, v29
    s_waitcnt lgkmcnt(8)
    v_mfma_f32_16x16x32_bf16 v[32:35], v[80:83], a[120:123], v[32:35]
    ds_read_b64_tr_b16 v[72:73], v115 offset:32768
    v_mul_f32 v14, v14, v30
    v_mul_f32 v15, v15, v31
    v_add_f32 v104, 1.0, v104
    v_add_f32 v105, 1.0, v105
    v_mfma_f32_16x16x32_bf16 v[36:39], v[80:83], a[124:127], v[36:39]
    ds_read_b64_tr_b16 v[74:75], v115 offset:33280
    v_add_f32 v106, 1.0, v106
    v_add_f32 v107, 1.0, v107
    v_add_f32 v108, 1.0, v108
    v_add_f32 v109, 1.0, v109
    v_mfma_f32_16x16x32_bf16 v[40:43], v[84:87], a[120:123], v[40:43]
    ds_read_b64_tr_b16 v[76:77], v116 offset:32768
    v_add_f32 v110, 1.0, v110
    v_add_f32 v111, 1.0, v111
    v_rcp_f32 v104, v104
    v_rcp_f32 v105, v105
    v_mfma_f32_16x16x32_bf16 v[44:47], v[84:87], a[124:127], v[44:47]
    ds_read_b64_tr_b16 v[78:79], v116 offset:33280
    v_rcp_f32 v106, v106
    v_rcp_f32 v107, v107
    v_rcp_f32 v108, v108
    v_rcp_f32 v109, v109
    s_waitcnt lgkmcnt(8)
    v_mfma_f32_16x16x32_bf16 v[48:51], v[88:91], a[120:123], v[48:51]
    ds_read_b64_tr_b16 v[80:81], v113 offset:36864
    v_rcp_f32 v110, v110
    v_rcp_f32 v111, v111
    s_nop 0
    v_mul_f32 v4, v4, v104
    v_mfma_f32_16x16x32_bf16 v[52:55], v[88:91], a[124:127], v[52:55]
    ds_read_b64_tr_b16 v[82:83], v113 offset:37376
    v_mul_f32 v5, v5, v105
    v_mul_f32 v6, v6, v106
    v_mul_f32 v7, v7, v107
    v_mul_f32 v12, v12, v108
    v_mfma_f32_16x16x32_bf16 v[56:59], v[92:95], a[120:123], v[56:59]
    ds_read_b64_tr_b16 v[84:85], v114 offset:36864
    v_mul_f32 v13, v13, v109
    v_mul_f32 v14, v14, v110
    v_mul_f32 v15, v15, v111
    v_cvt_pk_bf16_f32 v100, v4, v5
    v_mfma_f32_16x16x32_bf16 v[60:63], v[92:95], a[124:127], v[60:63]
    ds_read_b64_tr_b16 v[86:87], v114 offset:37376
    v_cvt_pk_bf16_f32 v101, v6, v7
    v_cvt_pk_bf16_f32 v102, v12, v13
    v_cvt_pk_bf16_f32 v103, v14, v15
    buffer_store_dwordx4 v[100:103], v112, s[8:11], s67 offen offset:1024 sc1
    s_waitcnt lgkmcnt(8)
    v_mfma_f32_16x16x32_bf16 v[0:3], v[64:67], a[0:3], 0
    ds_read_b64_tr_b16 v[88:89], v115 offset:36864
    v_mfma_f32_16x16x32_bf16 v[4:7], v[64:67], a[4:7], 0
    ds_read_b64_tr_b16 v[90:91], v115 offset:37376
    v_mfma_f32_16x16x32_bf16 v[8:11], v[68:71], a[0:3], 0
    ds_read_b64_tr_b16 v[92:93], v116 offset:36864
    v_mfma_f32_16x16x32_bf16 v[12:15], v[68:71], a[4:7], 0
    ds_read_b64_tr_b16 v[94:95], v116 offset:37376
    s_waitcnt lgkmcnt(8)
    v_mfma_f32_16x16x32_bf16 v[16:19], v[72:75], a[0:3], 0
    ds_read_b64_tr_b16 v[64:65], v113 offset:49152
    v_mfma_f32_16x16x32_bf16 v[20:23], v[72:75], a[4:7], 0
    ds_read_b64_tr_b16 v[66:67], v113 offset:49664
    v_mul_f32 v104, 0xbfb8aa3b, v32
    v_mul_f32 v105, 0xbfb8aa3b, v33
    v_mul_f32 v106, 0xbfb8aa3b, v34
    v_mul_f32 v107, 0xbfb8aa3b, v35
    v_mfma_f32_16x16x32_bf16 v[24:27], v[76:79], a[0:3], 0
    ds_read_b64_tr_b16 v[68:69], v114 offset:49152
    v_mul_f32 v108, 0xbfb8aa3b, v40
    v_mul_f32 v109, 0xbfb8aa3b, v41
    v_mul_f32 v110, 0xbfb8aa3b, v42
    v_mul_f32 v111, 0xbfb8aa3b, v43
    v_mfma_f32_16x16x32_bf16 v[28:31], v[76:79], a[4:7], 0
    ds_read_b64_tr_b16 v[70:71], v114 offset:49664
    v_exp_f32 v104, v104
    v_exp_f32 v105, v105
    v_exp_f32 v106, v106
    v_exp_f32 v107, v107
    s_waitcnt lgkmcnt(8)
    v_mfma_f32_16x16x32_bf16 v[0:3], v[80:83], a[8:11], v[0:3]
    ds_read_b64_tr_b16 v[72:73], v115 offset:49152
    v_exp_f32 v108, v108
    v_exp_f32 v109, v109
    v_exp_f32 v110, v110
    v_exp_f32 v111, v111
    v_mfma_f32_16x16x32_bf16 v[4:7], v[80:83], a[12:15], v[4:7]
    ds_read_b64_tr_b16 v[74:75], v115 offset:49664
    v_mul_f32 v32, v32, v48
    v_mul_f32 v33, v33, v49
    v_mul_f32 v34, v34, v50
    v_mul_f32 v35, v35, v51
    v_mfma_f32_16x16x32_bf16 v[8:11], v[84:87], a[8:11], v[8:11]
    ds_read_b64_tr_b16 v[76:77], v116 offset:49152
    v_mul_f32 v40, v40, v56
    v_mul_f32 v41, v41, v57
    v_mul_f32 v42, v42, v58
    v_mul_f32 v43, v43, v59
    v_mfma_f32_16x16x32_bf16 v[12:15], v[84:87], a[12:15], v[12:15]
    ds_read_b64_tr_b16 v[78:79], v116 offset:49664
    v_add_f32 v104, 1.0, v104
    v_add_f32 v105, 1.0, v105
    v_add_f32 v106, 1.0, v106
    v_add_f32 v107, 1.0, v107
    s_waitcnt lgkmcnt(8)
    v_mfma_f32_16x16x32_bf16 v[16:19], v[88:91], a[8:11], v[16:19]
    ds_read_b64_tr_b16 v[80:81], v113 offset:53248
    v_add_f32 v108, 1.0, v108
    v_add_f32 v109, 1.0, v109
    v_add_f32 v110, 1.0, v110
    v_add_f32 v111, 1.0, v111
    v_mfma_f32_16x16x32_bf16 v[20:23], v[88:91], a[12:15], v[20:23]
    ds_read_b64_tr_b16 v[82:83], v113 offset:53760
    v_rcp_f32 v104, v104
    v_rcp_f32 v105, v105
    v_rcp_f32 v106, v106
    v_rcp_f32 v107, v107
    v_mfma_f32_16x16x32_bf16 v[24:27], v[92:95], a[8:11], v[24:27]
    ds_read_b64_tr_b16 v[84:85], v114 offset:53248
    v_rcp_f32 v108, v108
    v_rcp_f32 v109, v109
    v_rcp_f32 v110, v110
    v_rcp_f32 v111, v111
    v_mfma_f32_16x16x32_bf16 v[28:31], v[92:95], a[12:15], v[28:31]
    ds_read_b64_tr_b16 v[86:87], v114 offset:53760
    s_nop 0
    v_mul_f32 v32, v32, v104
    v_mul_f32 v33, v33, v105
    v_mul_f32 v34, v34, v106
    s_waitcnt lgkmcnt(8)
    v_mfma_f32_16x16x32_bf16 v[0:3], v[64:67], a[16:19], v[0:3]
    ds_read_b64_tr_b16 v[88:89], v115 offset:53248
    v_mul_f32 v35, v35, v107
    v_mul_f32 v40, v40, v108
    v_mul_f32 v41, v41, v109
    v_mul_f32 v42, v42, v110
    v_mfma_f32_16x16x32_bf16 v[4:7], v[64:67], a[20:23], v[4:7]
    ds_read_b64_tr_b16 v[90:91], v115 offset:53760
    v_mul_f32 v43, v43, v111
    v_cvt_pk_bf16_f32 v96, v32, v33
    v_cvt_pk_bf16_f32 v97, v34, v35
    v_cvt_pk_bf16_f32 v98, v40, v41
    v_mfma_f32_16x16x32_bf16 v[8:11], v[68:71], a[16:19], v[8:11]
    ds_read_b64_tr_b16 v[92:93], v116 offset:53248
    v_cvt_pk_bf16_f32 v99, v42, v43
    buffer_store_dwordx4 v[96:99], v112, s[8:11], s68 offen offset:0 sc1
    v_mul_f32 v104, 0xbfb8aa3b, v36
    v_mul_f32 v105, 0xbfb8aa3b, v37
    v_mfma_f32_16x16x32_bf16 v[12:15], v[68:71], a[20:23], v[12:15]
    ds_read_b64_tr_b16 v[94:95], v116 offset:53760
    v_mul_f32 v106, 0xbfb8aa3b, v38
    v_mul_f32 v107, 0xbfb8aa3b, v39
    v_mul_f32 v108, 0xbfb8aa3b, v44
    v_mul_f32 v109, 0xbfb8aa3b, v45
    s_waitcnt lgkmcnt(8)
    v_mfma_f32_16x16x32_bf16 v[16:19], v[72:75], a[16:19], v[16:19]
    ds_read_b64_tr_b16 v[64:65], v113 offset:40960
    v_mul_f32 v110, 0xbfb8aa3b, v46
    v_mul_f32 v111, 0xbfb8aa3b, v47
    v_exp_f32 v104, v104
    v_exp_f32 v105, v105
    v_mfma_f32_16x16x32_bf16 v[20:23], v[72:75], a[20:23], v[20:23]
    ds_read_b64_tr_b16 v[66:67], v113 offset:41472
    v_exp_f32 v106, v106
    v_exp_f32 v107, v107
    v_exp_f32 v108, v108
    v_exp_f32 v109, v109
    v_mfma_f32_16x16x32_bf16 v[24:27], v[76:79], a[16:19], v[24:27]
    ds_read_b64_tr_b16 v[68:69], v114 offset:40960
    v_exp_f32 v110, v110
    v_exp_f32 v111, v111
    v_mul_f32 v36, v36, v52
    v_mul_f32 v37, v37, v53
    v_mfma_f32_16x16x32_bf16 v[28:31], v[76:79], a[20:23], v[28:31]
    ds_read_b64_tr_b16 v[70:71], v114 offset:41472
    v_mul_f32 v38, v38, v54
    v_mul_f32 v39, v39, v55
    v_mul_f32 v44, v44, v60
    v_mul_f32 v45, v45, v61
    s_waitcnt lgkmcnt(8)
    v_mfma_f32_16x16x32_bf16 v[0:3], v[80:83], a[24:27], v[0:3]
    ds_read_b64_tr_b16 v[72:73], v115 offset:40960
    v_mul_f32 v46, v46, v62
    v_mul_f32 v47, v47, v63
    v_add_f32 v104, 1.0, v104
    v_add_f32 v105, 1.0, v105
    v_mfma_f32_16x16x32_bf16 v[4:7], v[80:83], a[28:31], v[4:7]
    ds_read_b64_tr_b16 v[74:75], v115 offset:41472
    v_add_f32 v106, 1.0, v106
    v_add_f32 v107, 1.0, v107
    v_add_f32 v108, 1.0, v108
    v_add_f32 v109, 1.0, v109
    v_mfma_f32_16x16x32_bf16 v[8:11], v[84:87], a[24:27], v[8:11]
    ds_read_b64_tr_b16 v[76:77], v116 offset:40960
    v_add_f32 v110, 1.0, v110
    v_add_f32 v111, 1.0, v111
    v_rcp_f32 v104, v104
    v_rcp_f32 v105, v105
    v_mfma_f32_16x16x32_bf16 v[12:15], v[84:87], a[28:31], v[12:15]
    ds_read_b64_tr_b16 v[78:79], v116 offset:41472
    v_rcp_f32 v106, v106
    v_rcp_f32 v107, v107
    v_rcp_f32 v108, v108
    v_rcp_f32 v109, v109
    s_waitcnt lgkmcnt(8)
    v_mfma_f32_16x16x32_bf16 v[16:19], v[88:91], a[24:27], v[16:19]
    ds_read_b64_tr_b16 v[80:81], v113 offset:45056
    v_rcp_f32 v110, v110
    v_rcp_f32 v111, v111
    s_nop 0
    v_mul_f32 v36, v36, v104
    v_mfma_f32_16x16x32_bf16 v[20:23], v[88:91], a[28:31], v[20:23]
    ds_read_b64_tr_b16 v[82:83], v113 offset:45568
    v_mul_f32 v37, v37, v105
    v_mul_f32 v38, v38, v106
    v_mul_f32 v39, v39, v107
    v_mul_f32 v44, v44, v108
    v_mfma_f32_16x16x32_bf16 v[24:27], v[92:95], a[24:27], v[24:27]
    ds_read_b64_tr_b16 v[84:85], v114 offset:45056
    v_mul_f32 v45, v45, v109
    v_mul_f32 v46, v46, v110
    v_mul_f32 v47, v47, v111
    v_cvt_pk_bf16_f32 v100, v36, v37
    v_mfma_f32_16x16x32_bf16 v[28:31], v[92:95], a[28:31], v[28:31]
    ds_read_b64_tr_b16 v[86:87], v114 offset:45568
    v_cvt_pk_bf16_f32 v101, v38, v39
    v_cvt_pk_bf16_f32 v102, v44, v45
    v_cvt_pk_bf16_f32 v103, v46, v47
    buffer_store_dwordx4 v[100:103], v112, s[8:11], s68 offen offset:1024 sc1
    s_waitcnt lgkmcnt(8)
    v_mfma_f32_16x16x32_bf16 v[32:35], v[64:67], a[0:3], 0
    ds_read_b64_tr_b16 v[88:89], v115 offset:45056
    v_mfma_f32_16x16x32_bf16 v[36:39], v[64:67], a[4:7], 0
    ds_read_b64_tr_b16 v[90:91], v115 offset:45568
    v_mfma_f32_16x16x32_bf16 v[40:43], v[68:71], a[0:3], 0
    ds_read_b64_tr_b16 v[92:93], v116 offset:45056
    v_mfma_f32_16x16x32_bf16 v[44:47], v[68:71], a[4:7], 0
    ds_read_b64_tr_b16 v[94:95], v116 offset:45568
    s_waitcnt lgkmcnt(8)
    v_mfma_f32_16x16x32_bf16 v[48:51], v[72:75], a[0:3], 0
    ds_read_b64_tr_b16 v[64:65], v113 offset:57344
    v_mfma_f32_16x16x32_bf16 v[52:55], v[72:75], a[4:7], 0
    ds_read_b64_tr_b16 v[66:67], v113 offset:57856
    v_mfma_f32_16x16x32_bf16 v[56:59], v[76:79], a[0:3], 0
    ds_read_b64_tr_b16 v[68:69], v114 offset:57344
    v_mfma_f32_16x16x32_bf16 v[60:63], v[76:79], a[4:7], 0
    ds_read_b64_tr_b16 v[70:71], v114 offset:57856
    s_waitcnt lgkmcnt(8)
    v_mfma_f32_16x16x32_bf16 v[32:35], v[80:83], a[8:11], v[32:35]
    ds_read_b64_tr_b16 v[72:73], v115 offset:57344
    v_mfma_f32_16x16x32_bf16 v[36:39], v[80:83], a[12:15], v[36:39]
    ds_read_b64_tr_b16 v[74:75], v115 offset:57856
    v_mfma_f32_16x16x32_bf16 v[40:43], v[84:87], a[8:11], v[40:43]
    ds_read_b64_tr_b16 v[76:77], v116 offset:57344
    v_mfma_f32_16x16x32_bf16 v[44:47], v[84:87], a[12:15], v[44:47]
    ds_read_b64_tr_b16 v[78:79], v116 offset:57856
    s_waitcnt lgkmcnt(8)
    v_mfma_f32_16x16x32_bf16 v[48:51], v[88:91], a[8:11], v[48:51]
    ds_read_b64_tr_b16 v[80:81], v113 offset:61440
    v_mfma_f32_16x16x32_bf16 v[52:55], v[88:91], a[12:15], v[52:55]
    ds_read_b64_tr_b16 v[82:83], v113 offset:61952
    v_mfma_f32_16x16x32_bf16 v[56:59], v[92:95], a[8:11], v[56:59]
    ds_read_b64_tr_b16 v[84:85], v114 offset:61440
    v_mfma_f32_16x16x32_bf16 v[60:63], v[92:95], a[12:15], v[60:63]
    ds_read_b64_tr_b16 v[86:87], v114 offset:61952
    s_barrier
    s_waitcnt lgkmcnt(8)
    v_mfma_f32_16x16x32_bf16 v[32:35], v[64:67], a[16:19], v[32:35]
    ds_read_b64_tr_b16 v[88:89], v115 offset:61440
    v_mfma_f32_16x16x32_bf16 v[36:39], v[64:67], a[20:23], v[36:39]
    ds_read_b64_tr_b16 v[90:91], v115 offset:61952
    v_mfma_f32_16x16x32_bf16 v[40:43], v[68:71], a[16:19], v[40:43]
    ds_read_b64_tr_b16 v[92:93], v116 offset:61440
    v_mfma_f32_16x16x32_bf16 v[44:47], v[68:71], a[20:23], v[44:47]
    ds_read_b64_tr_b16 v[94:95], v116 offset:61952
    s_waitcnt lgkmcnt(8)
    v_mfma_f32_16x16x32_bf16 v[48:51], v[72:75], a[16:19], v[48:51]
    v_add_u32 v113, 0x10000, v113
    ds_read_b64_tr_b16 v[64:65], v113 offset:0
    v_mfma_f32_16x16x32_bf16 v[52:55], v[72:75], a[20:23], v[52:55]
    ds_read_b64_tr_b16 v[66:67], v113 offset:512
    v_mfma_f32_16x16x32_bf16 v[56:59], v[76:79], a[16:19], v[56:59]
    v_add_u32 v114, 0x10000, v114
    ds_read_b64_tr_b16 v[68:69], v114 offset:0
    v_mfma_f32_16x16x32_bf16 v[60:63], v[76:79], a[20:23], v[60:63]
    ds_read_b64_tr_b16 v[70:71], v114 offset:512
    s_waitcnt lgkmcnt(8)
    v_mfma_f32_16x16x32_bf16 v[32:35], v[80:83], a[24:27], v[32:35]
    v_add_u32 v115, 0x10000, v115
    ds_read_b64_tr_b16 v[72:73], v115 offset:0
    v_mfma_f32_16x16x32_bf16 v[36:39], v[80:83], a[28:31], v[36:39]
    ds_read_b64_tr_b16 v[74:75], v115 offset:512
    v_mfma_f32_16x16x32_bf16 v[40:43], v[84:87], a[24:27], v[40:43]
    v_add_u32 v116, 0x10000, v116
    ds_read_b64_tr_b16 v[76:77], v116 offset:0
    v_mfma_f32_16x16x32_bf16 v[44:47], v[84:87], a[28:31], v[44:47]
    ds_read_b64_tr_b16 v[78:79], v116 offset:512
    s_waitcnt lgkmcnt(8)
    v_mfma_f32_16x16x32_bf16 v[48:51], v[88:91], a[24:27], v[48:51]
    ds_read_b64_tr_b16 v[80:81], v113 offset:4096
    v_mfma_f32_16x16x32_bf16 v[52:55], v[88:91], a[28:31], v[52:55]
    ds_read_b64_tr_b16 v[82:83], v113 offset:4608
    v_mfma_f32_16x16x32_bf16 v[56:59], v[92:95], a[24:27], v[56:59]
    ds_read_b64_tr_b16 v[84:85], v114 offset:4096
    v_mfma_f32_16x16x32_bf16 v[60:63], v[92:95], a[28:31], v[60:63]
    ds_read_b64_tr_b16 v[86:87], v114 offset:4608
    s_waitcnt lgkmcnt(8)
    v_mfma_f32_16x16x32_bf16 v[0:3], v[64:67], a[32:35], v[0:3]
    ds_read_b64_tr_b16 v[88:89], v115 offset:4096
    v_mfma_f32_16x16x32_bf16 v[4:7], v[64:67], a[36:39], v[4:7]
    ds_read_b64_tr_b16 v[90:91], v115 offset:4608
    v_mfma_f32_16x16x32_bf16 v[8:11], v[68:71], a[32:35], v[8:11]
    ds_read_b64_tr_b16 v[92:93], v116 offset:4096
    v_mfma_f32_16x16x32_bf16 v[12:15], v[68:71], a[36:39], v[12:15]
    ds_read_b64_tr_b16 v[94:95], v116 offset:4608
    s_waitcnt lgkmcnt(8)
    v_mfma_f32_16x16x32_bf16 v[16:19], v[72:75], a[32:35], v[16:19]
    ds_read_b64_tr_b16 v[64:65], v113 offset:8192
    v_mfma_f32_16x16x32_bf16 v[20:23], v[72:75], a[36:39], v[20:23]
    ds_read_b64_tr_b16 v[66:67], v113 offset:8704
    v_mfma_f32_16x16x32_bf16 v[24:27], v[76:79], a[32:35], v[24:27]
    ds_read_b64_tr_b16 v[68:69], v114 offset:8192
    v_mfma_f32_16x16x32_bf16 v[28:31], v[76:79], a[36:39], v[28:31]
    ds_read_b64_tr_b16 v[70:71], v114 offset:8704
    s_waitcnt lgkmcnt(8)
    v_mfma_f32_16x16x32_bf16 v[0:3], v[80:83], a[40:43], v[0:3]
    ds_read_b64_tr_b16 v[72:73], v115 offset:8192
    v_mfma_f32_16x16x32_bf16 v[4:7], v[80:83], a[44:47], v[4:7]
    ds_read_b64_tr_b16 v[74:75], v115 offset:8704
    v_mfma_f32_16x16x32_bf16 v[8:11], v[84:87], a[40:43], v[8:11]
    ds_read_b64_tr_b16 v[76:77], v116 offset:8192
    v_mfma_f32_16x16x32_bf16 v[12:15], v[84:87], a[44:47], v[12:15]
    ds_read_b64_tr_b16 v[78:79], v116 offset:8704
    s_waitcnt lgkmcnt(8)
    v_mfma_f32_16x16x32_bf16 v[16:19], v[88:91], a[40:43], v[16:19]
    ds_read_b64_tr_b16 v[80:81], v113 offset:12288
    v_mfma_f32_16x16x32_bf16 v[20:23], v[88:91], a[44:47], v[20:23]
    ds_read_b64_tr_b16 v[82:83], v113 offset:12800
    v_mfma_f32_16x16x32_bf16 v[24:27], v[92:95], a[40:43], v[24:27]
    ds_read_b64_tr_b16 v[84:85], v114 offset:12288
    v_mfma_f32_16x16x32_bf16 v[28:31], v[92:95], a[44:47], v[28:31]
    ds_read_b64_tr_b16 v[86:87], v114 offset:12800
    s_barrier
    s_waitcnt lgkmcnt(8)
    v_mfma_f32_16x16x32_bf16 v[32:35], v[64:67], a[32:35], v[32:35]
    ds_read_b64_tr_b16 v[88:89], v115 offset:12288
    v_mfma_f32_16x16x32_bf16 v[36:39], v[64:67], a[36:39], v[36:39]
    ds_read_b64_tr_b16 v[90:91], v115 offset:12800
    v_mfma_f32_16x16x32_bf16 v[40:43], v[68:71], a[32:35], v[40:43]
    ds_read_b64_tr_b16 v[92:93], v116 offset:12288
    v_mfma_f32_16x16x32_bf16 v[44:47], v[68:71], a[36:39], v[44:47]
    ds_read_b64_tr_b16 v[94:95], v116 offset:12800
    s_waitcnt lgkmcnt(8)
    v_mfma_f32_16x16x32_bf16 v[48:51], v[72:75], a[32:35], v[48:51]
    ds_read_b64_tr_b16 v[64:65], v113 offset:16384
    v_mfma_f32_16x16x32_bf16 v[52:55], v[72:75], a[36:39], v[52:55]
    ds_read_b64_tr_b16 v[66:67], v113 offset:16896
    v_mfma_f32_16x16x32_bf16 v[56:59], v[76:79], a[32:35], v[56:59]
    ds_read_b64_tr_b16 v[68:69], v114 offset:16384
    v_mfma_f32_16x16x32_bf16 v[60:63], v[76:79], a[36:39], v[60:63]
    ds_read_b64_tr_b16 v[70:71], v114 offset:16896
    s_waitcnt lgkmcnt(8)
    v_mfma_f32_16x16x32_bf16 v[32:35], v[80:83], a[40:43], v[32:35]
    ds_read_b64_tr_b16 v[72:73], v115 offset:16384
    v_mfma_f32_16x16x32_bf16 v[36:39], v[80:83], a[44:47], v[36:39]
    ds_read_b64_tr_b16 v[74:75], v115 offset:16896
    v_mfma_f32_16x16x32_bf16 v[40:43], v[84:87], a[40:43], v[40:43]
    ds_read_b64_tr_b16 v[76:77], v116 offset:16384
    v_mfma_f32_16x16x32_bf16 v[44:47], v[84:87], a[44:47], v[44:47]
    ds_read_b64_tr_b16 v[78:79], v116 offset:16896
    s_waitcnt lgkmcnt(8)
    v_mfma_f32_16x16x32_bf16 v[48:51], v[88:91], a[40:43], v[48:51]
    ds_read_b64_tr_b16 v[80:81], v113 offset:20480
    v_mfma_f32_16x16x32_bf16 v[52:55], v[88:91], a[44:47], v[52:55]
    ds_read_b64_tr_b16 v[82:83], v113 offset:20992
    v_mfma_f32_16x16x32_bf16 v[56:59], v[92:95], a[40:43], v[56:59]
    ds_read_b64_tr_b16 v[84:85], v114 offset:20480
    v_mfma_f32_16x16x32_bf16 v[60:63], v[92:95], a[44:47], v[60:63]
    ds_read_b64_tr_b16 v[86:87], v114 offset:20992
    s_waitcnt lgkmcnt(8)
    v_mfma_f32_16x16x32_bf16 v[0:3], v[64:67], a[48:51], v[0:3]
    ds_read_b64_tr_b16 v[88:89], v115 offset:20480
    v_mfma_f32_16x16x32_bf16 v[4:7], v[64:67], a[52:55], v[4:7]
    ds_read_b64_tr_b16 v[90:91], v115 offset:20992
    v_mfma_f32_16x16x32_bf16 v[8:11], v[68:71], a[48:51], v[8:11]
    ds_read_b64_tr_b16 v[92:93], v116 offset:20480
    v_mfma_f32_16x16x32_bf16 v[12:15], v[68:71], a[52:55], v[12:15]
    ds_read_b64_tr_b16 v[94:95], v116 offset:20992
    s_waitcnt lgkmcnt(8)
    v_mfma_f32_16x16x32_bf16 v[16:19], v[72:75], a[48:51], v[16:19]
    ds_read_b64_tr_b16 v[64:65], v113 offset:24576
    v_mfma_f32_16x16x32_bf16 v[20:23], v[72:75], a[52:55], v[20:23]
    ds_read_b64_tr_b16 v[66:67], v113 offset:25088
    v_mfma_f32_16x16x32_bf16 v[24:27], v[76:79], a[48:51], v[24:27]
    ds_read_b64_tr_b16 v[68:69], v114 offset:24576
    v_mfma_f32_16x16x32_bf16 v[28:31], v[76:79], a[52:55], v[28:31]
    ds_read_b64_tr_b16 v[70:71], v114 offset:25088
    s_waitcnt lgkmcnt(8)
    v_mfma_f32_16x16x32_bf16 v[0:3], v[80:83], a[56:59], v[0:3]
    ds_read_b64_tr_b16 v[72:73], v115 offset:24576
    v_mfma_f32_16x16x32_bf16 v[4:7], v[80:83], a[60:63], v[4:7]
    ds_read_b64_tr_b16 v[74:75], v115 offset:25088
    v_mfma_f32_16x16x32_bf16 v[8:11], v[84:87], a[56:59], v[8:11]
    ds_read_b64_tr_b16 v[76:77], v116 offset:24576
    v_mfma_f32_16x16x32_bf16 v[12:15], v[84:87], a[60:63], v[12:15]
    ds_read_b64_tr_b16 v[78:79], v116 offset:25088
    s_waitcnt lgkmcnt(8)
    v_mfma_f32_16x16x32_bf16 v[16:19], v[88:91], a[56:59], v[16:19]
    ds_read_b64_tr_b16 v[80:81], v113 offset:28672
    v_mfma_f32_16x16x32_bf16 v[20:23], v[88:91], a[60:63], v[20:23]
    ds_read_b64_tr_b16 v[82:83], v113 offset:29184
    v_mfma_f32_16x16x32_bf16 v[24:27], v[92:95], a[56:59], v[24:27]
    ds_read_b64_tr_b16 v[84:85], v114 offset:28672
    v_mfma_f32_16x16x32_bf16 v[28:31], v[92:95], a[60:63], v[28:31]
    ds_read_b64_tr_b16 v[86:87], v114 offset:29184
    s_waitcnt vmcnt(0)
    s_barrier
    s_cmp_lg_u32 s3, 0
    s_cbranch_scc1 SG_10
    v_mov_b32 v127, 1
    buffer_atomic_add v127, v123, s[48:51], 0 offen offset:128 sc1
SG_10:
    s_waitcnt lgkmcnt(8)
    v_mfma_f32_16x16x32_bf16 v[32:35], v[64:67], a[48:51], v[32:35]
    ds_read_b64_tr_b16 v[88:89], v115 offset:28672
    v_mfma_f32_16x16x32_bf16 v[36:39], v[64:67], a[52:55], v[36:39]
    ds_read_b64_tr_b16 v[90:91], v115 offset:29184
    v_mfma_f32_16x16x32_bf16 v[40:43], v[68:71], a[48:51], v[40:43]
    ds_read_b64_tr_b16 v[92:93], v116 offset:28672
    v_mfma_f32_16x16x32_bf16 v[44:47], v[68:71], a[52:55], v[44:47]
    ds_read_b64_tr_b16 v[94:95], v116 offset:29184
    s_waitcnt lgkmcnt(8)
    v_mfma_f32_16x16x32_bf16 v[48:51], v[72:75], a[48:51], v[48:51]
    ds_read_b64_tr_b16 v[64:65], v113 offset:32768
    s_and_b32 s12, s2, 3
    s_and_b32 s13, s4, 3
    v_mfma_f32_16x16x32_bf16 v[52:55], v[72:75], a[52:55], v[52:55]
    ds_read_b64_tr_b16 v[66:67], v113 offset:33280
    s_lshr_b32 s14, s4, 2
    s_and_b32 s6, s2, 4
    v_mfma_f32_16x16x32_bf16 v[56:59], v[76:79], a[48:51], v[56:59]
    ds_read_b64_tr_b16 v[68:69], v114 offset:32768
    s_lshl_b32 s6, s6, 1
    s_add_u32 s14, s14, s6
    v_mfma_f32_16x16x32_bf16 v[60:63], v[76:79], a[52:55], v[60:63]
    ds_read_b64_tr_b16 v[70:71], v114 offset:33280
    s_lshr_b32 s15, s3, 2
    s_lshl_b32 s16, s14, 2
    s_waitcnt lgkmcnt(8)
    v_mfma_f32_16x16x32_bf16 v[32:35], v[80:83], a[56:59], v[32:35]
    ds_read_b64_tr_b16 v[72:73], v115 offset:32768
    s_add_u32 s16, s16, s63
    v_lshrrev_b32 v99, 4, v112
    v_mfma_f32_16x16x32_bf16 v[36:39], v[80:83], a[60:63], v[36:39]
    ds_read_b64_tr_b16 v[74:75], v115 offset:33280
    v_lshrrev_b32 v98, 2, v99
    v_lshlrev_b32 v98, 7, v98
    v_mfma_f32_16x16x32_bf16 v[40:43], v[84:87], a[56:59], v[40:43]
    ds_read_b64_tr_b16 v[76:77], v116 offset:32768
    v_and_b32 v97, 3, v99
    v_lshl_add_u32 v98, v97, 3, v98
    v_mfma_f32_16x16x32_bf16 v[44:47], v[84:87], a[60:63], v[44:47]
    ds_read_b64_tr_b16 v[78:79], v116 offset:33280
    s_lshl_b32 s6, s15, 14
    v_add_u32 v98, s6, v98
    s_waitcnt lgkmcnt(8)
    v_mfma_f32_16x16x32_bf16 v[48:51], v[88:91], a[56:59], v[48:51]
    ds_read_b64_tr_b16 v[80:81], v113 offset:36864
    v_bfe_u32 v96, v99, 3, 2
    v_lshl_add_u32 v121, v96, 5, v98
    v_mfma_f32_16x16x32_bf16 v[52:55], v[88:91], a[60:63], v[52:55]
    ds_read_b64_tr_b16 v[82:83], v113 offset:37376
    v_bfe_u32 v96, v99, 1, 2
    v_lshrrev_b32 v97, 4, v99
    v_mfma_f32_16x16x32_bf16 v[56:59], v[92:95], a[56:59], v[56:59]
    ds_read_b64_tr_b16 v[84:85], v114 offset:36864
    v_xor_b32 v96, v96, v97
    v_and_b32 v97, 1, v99
    v_mfma_f32_16x16x32_bf16 v[60:63], v[92:95], a[60:63], v[60:63]
    ds_read_b64_tr_b16 v[86:87], v114 offset:37376
    v_lshlrev_b32 v97, 4, v97
    v_lshl_add_u32 v96, v96, 5, v97
    s_waitcnt lgkmcnt(8)
    v_mfma_f32_16x16x32_bf16 v[0:3], v[64:67], a[64:67], v[0:3]
    ds_read_b64_tr_b16 v[88:89], v115 offset:36864
    v_lshrrev_b32 v97, 3, v99
    v_lshl_add_u32 v117, v97, 10, v96
    v_mfma_f32_16x16x32_bf16 v[4:7], v[64:67], a[68:71], v[4:7]
    ds_read_b64_tr_b16 v[90:91], v115 offset:37376
    s_lshl_b32 s6, s3, 13
    v_add_u32 v118, s6, v117
    v_mfma_f32_16x16x32_bf16 v[8:11], v[68:71], a[64:67], v[8:11]
    ds_read_b64_tr_b16 v[92:93], v116 offset:36864
    v_and_b32 v96, 15, v99
    v_lshrrev_b32 v97, 4, v99
    v_mfma_f32_16x16x32_bf16 v[12:15], v[68:71], a[68:71], v[12:15]
    ds_read_b64_tr_b16 v[94:95], v116 offset:37376
    v_lshlrev_b32 v97, 3, v97
    v_lshl_add_u32 v119, v96, 10, v97
    s_waitcnt lgkmcnt(8)
    v_mfma_f32_16x16x32_bf16 v[16:19], v[72:75], a[64:67], v[16:19]
    ds_read_b64_tr_b16 v[64:65], v113 offset:40960
    v_accvgpr_write_b32 a0, 0
    v_add_u32 v120, 16384, v119
    s_lshl_b32 s17, s16, 15
    v_mfma_f32_16x16x32_bf16 v[20:23], v[72:75], a[68:71], v[20:23]
    ds_read_b64_tr_b16 v[66:67], v113 offset:41472
    v_accvgpr_write_b32 a1, 0
    s_lshl_b32 s6, s13, 8
    s_add_u32 s17, s17, s6
    v_mfma_f32_16x16x32_bf16 v[24:27], v[76:79], a[64:67], v[24:27]
    ds_read_b64_tr_b16 v[68:69], v114 offset:40960
    v_accvgpr_write_b32 a2, 0
    s_lshl_b32 s7, s12, 6
    s_add_u32 s17, s17, s7
    v_mfma_f32_16x16x32_bf16 v[28:31], v[76:79], a[68:71], v[28:31]
    ds_read_b64_tr_b16 v[70:71], v114 offset:41472
    v_accvgpr_write_b32 a3, 0
    s_mul_i32 s26, s12, 7
    s_and_b32 s7, s12, 1
    s_waitcnt lgkmcnt(8)
    v_mfma_f32_16x16x32_bf16 v[0:3], v[80:83], a[72:75], v[0:3]
    ds_read_b64_tr_b16 v[72:73], v115 offset:40960
    v_accvgpr_write_b32 a4, 0
    s_add_u32 s26, s26, s7
    s_lshl_b32 s18, s26, 16
    v_mfma_f32_16x16x32_bf16 v[4:7], v[80:83], a[76:79], v[4:7]
    ds_read_b64_tr_b16 v[74:75], v115 offset:41472
    v_accvgpr_write_b32 a5, 0
    s_add_u32 s18, s18, s6
    s_lshl_b32 s19, s12, 20
    v_mfma_f32_16x16x32_bf16 v[8:11], v[84:87], a[72:75], v[8:11]
    ds_read_b64_tr_b16 v[76:77], v116 offset:40960
    v_accvgpr_write_b32 a6, 0
    s_add_u32 s19, s19, s6
    s_mul_i32 s7, s16, 376832
    v_mfma_f32_16x16x32_bf16 v[12:15], v[84:87], a[76:79], v[12:15]
    ds_read_b64_tr_b16 v[78:79], v116 offset:41472
    v_accvgpr_write_b32 a7, 0
    s_add_u32 s7, s7, 0x2200000
    s_lshl_b32 s24, s26, 12
    s_waitcnt lgkmcnt(8)
    v_mfma_f32_16x16x32_bf16 v[16:19], v[88:91], a[72:75], v[16:19]
    ds_read_b64_tr_b16 v[80:81], v113 offset:45056
    v_accvgpr_write_b32 a8, 0
    s_add_u32 s24, s24, s7
    s_add_u32 s24, s24, 262144
    v_mfma_f32_16x16x32_bf16 v[20:23], v[88:91], a[76:79], v[20:23]
    ds_read_b64_tr_b16 v[82:83], v113 offset:45568
    v_accvgpr_write_b32 a9, 0
    s_lshl_b32 s25, s12, 16
    s_add_u32 s25, s25, s7
    v_mfma_f32_16x16x32_bf16 v[24:27], v[92:95], a[72:75], v[24:27]
    ds_read_b64_tr_b16 v[84:85], v114 offset:45056
    v_accvgpr_write_b32 a10, 0
    s_lshl_b32 s6, s15, 12
    s_add_u32 s24, s24, s6
    v_mfma_f32_16x16x32_bf16 v[28:31], v[92:95], a[76:79], v[28:31]
    ds_read_b64_tr_b16 v[86:87], v114 offset:45568
    v_accvgpr_write_b32 a11, 0
    s_add_u32 s25, s25, s6
    s_cmp_ge_u32 s62, 99
    s_barrier
    s_waitcnt lgkmcnt(8)
    v_mfma_f32_16x16x32_bf16 v[32:35], v[64:67], a[64:67], v[32:35]
    ds_read_b64_tr_b16 v[88:89], v115 offset:45056
    v_accvgpr_write_b32 a12, 0
    s_cselect_b32 s30, 1, 0
    s_and_b32 s31, s30, s15
    v_mfma_f32_16x16x32_bf16 v[36:39], v[64:67], a[68:71], v[36:39]
    ds_read_b64_tr_b16 v[90:91], v115 offset:45568
    v_accvgpr_write_b32 a13, 0
    s_lshl_b32 s27, s16, 10
    s_lshl_b32 s6, s12, 8
    v_mfma_f32_16x16x32_bf16 v[40:43], v[68:71], a[64:67], v[40:43]
    ds_read_b64_tr_b16 v[92:93], v116 offset:45056
    v_accvgpr_write_b32 a14, 0
    s_add_u32 s27, s27, s6
    s_add_u32 s27, s27, 0x5000000
    v_mfma_f32_16x16x32_bf16 v[44:47], v[68:71], a[68:71], v[44:47]
    ds_read_b64_tr_b16 v[94:95], v116 offset:45568
    v_accvgpr_write_b32 a15, 0
    s_lshl_b32 s6, s61, 10
    s_lshr_b32 s7, s60, 3
    s_waitcnt lgkmcnt(8)
    v_mfma_f32_16x16x32_bf16 v[48:51], v[72:75], a[64:67], v[48:51]
    ds_read_b64_tr_b16 v[64:65], v113 offset:49152
    v_accvgpr_write_b32 a16, 0
    s_lshl_b32 s7, s7, 8
    s_add_u32 s78, s6, s7
    v_mfma_f32_16x16x32_bf16 v[52:55], v[72:75], a[68:71], v[52:55]
    ds_read_b64_tr_b16 v[66:67], v113 offset:49664
    v_accvgpr_write_b32 a17, 0
    s_add_u32 s78, s78, 0x5000000
    s_lshl_b32 s6, s14, 2
    v_mfma_f32_16x16x32_bf16 v[56:59], v[76:79], a[64:67], v[56:59]
    ds_read_b64_tr_b16 v[68:69], v114 offset:49152
    v_accvgpr_write_b32 a18, 0
    s_add_u32 s6, s6, s13
    s_lshl_b32 s28, s6, 17
    v_mfma_f32_16x16x32_bf16 v[60:63], v[76:79], a[68:71], v[60:63]
    ds_read_b64_tr_b16 v[70:71], v114 offset:49664
    v_accvgpr_write_b32 a19, 0
    s_add_u32 s28, s28, 0x4000000
    s_lshl_b32 s7, s63, 11
    s_waitcnt lgkmcnt(8)
    v_mfma_f32_16x16x32_bf16 v[32:35], v[80:83], a[72:75], v[32:35]
    ds_read_b64_tr_b16 v[72:73], v115 offset:49152
    v_accvgpr_write_b32 a20, 0
    s_add_u32 s28, s28, s7
    s_lshl_b32 s29, s6, 10
    v_mfma_f32_16x16x32_bf16 v[36:39], v[80:83], a[76:79], v[36:39]
    ds_read_b64_tr_b16 v[74:75], v115 offset:49664
    v_accvgpr_write_b32 a21, 0
    s_add_u32 s29, s29, 0x5000080
    s_lshl_b32 s7, s63, 2
    v_mfma_f32_16x16x32_bf16 v[40:43], v[84:87], a[72:75], v[40:43]
    ds_read_b64_tr_b16 v[76:77], v116 offset:49152
    v_accvgpr_write_b32 a22, 0
    s_add_u32 s29, s29, s7
    v_mov_b32 v104, v112
    v_mfma_f32_16x16x32_bf16 v[44:47], v[84:87], a[76:79], v[44:47]
    ds_read_b64_tr_b16 v[78:79], v116 offset:49664
    v_accvgpr_write_b32 a23, 0
    v_add_u32 v105, 16384, v112
    v_mov_b32 v106, v112
    s_waitcnt lgkmcnt(8)
    v_mfma_f32_16x16x32_bf16 v[48:51], v[88:91], a[72:75], v[48:51]
    ds_read_b64_tr_b16 v[80:81], v113 offset:53248
    v_accvgpr_write_b32 a24, 0
    v_bfe_u32 v107, v112, 4, 4
    v_lshrrev_b32 v108, 8, v112
    v_mfma_f32_16x16x32_bf16 v[52:55], v[88:91], a[76:79], v[52:55]
    ds_read_b64_tr_b16 v[82:83], v113 offset:53760
    v_accvgpr_write_b32 a25, 0
    v_lshlrev_b32 v108, 2, v108
    v_sub_u32 v107, v107, v108
    v_mfma_f32_16x16x32_bf16 v[56:59], v[92:95], a[72:75], v[56:59]
    ds_read_b64_tr_b16 v[84:85], v114 offset:53248
    v_accvgpr_write_b32 a26, 0
    v_mov_b32 v108, 0xff800000
    v_cmp_gt_i32 s[80:81], 0, v107
    v_mfma_f32_16x16x32_bf16 v[60:63], v[92:95], a[76:79], v[60:63]
    ds_read_b64_tr_b16 v[86:87], v114 offset:53760
    v_accvgpr_write_b32 a27, 0
    v_cmp_gt_i32 s[82:83], 1, v107
    v_cmp_gt_i32 s[84:85], 2, v107
    s_waitcnt lgkmcnt(8)
    v_mfma_f32_16x16x32_bf16 v[0:3], v[64:67], a[80:83], v[0:3]
    ds_read_b64_tr_b16 v[88:89], v115 offset:53248
    v_accvgpr_write_b32 a28, 0
    v_cmp_gt_i32 s[86:87], 3, v107
    v_mov_b32 v102, 0
    v_mfma_f32_16x16x32_bf16 v[4:7], v[64:67], a[84:87], v[4:7]
    ds_read_b64_tr_b16 v[90:91], v115 offset:53760
    v_accvgpr_write_b32 a29, 0
    v_mov_b32 v103, 0
    s_mov_b32 s76, 0x49800000
    v_mfma_f32_16x16x32_bf16 v[8:11], v[68:71], a[80:83], v[8:11]
    ds_read_b64_tr_b16 v[92:93], v116 offset:53248
    v_accvgpr_write_b32 a30, 0
    s_cmp_lg_u32 s3, 0
    s_cbranch_scc1 PI_11
    buffer_load_dword v125, off, s[48:51], 0 offset:64 sc1
PI_11:
    s_max_u32 s75, s61, 2
    s_sub_u32 s75, s75, 2
    v_mfma_f32_16x16x32_bf16 v[12:15], v[68:71], a[84:87], v[12:15]
    ds_read_b64_tr_b16 v[94:95], v116 offset:53760
    v_accvgpr_write_b32 a31, 0
    s_lshr_b32 s75, s75, 1
    s_lshl_b32 s77, s75, 1
    s_waitcnt lgkmcnt(8)
    v_mfma_f32_16x16x32_bf16 v[16:19], v[72:75], a[80:83], v[16:19]
    ds_read_b64_tr_b16 v[64:65], v113 offset:57344
    v_accvgpr_write_b32 a32, 0
    s_add_u32 s77, s77, 1
    s_mov_b32 s79, 0
    v_mfma_f32_16x16x32_bf16 v[20:23], v[72:75], a[84:87], v[20:23]
    ds_read_b64_tr_b16 v[66:67], v113 offset:57856
    v_accvgpr_write_b32 a33, 0
    v_mfma_f32_16x16x32_bf16 v[24:27], v[76:79], a[80:83], v[24:27]
    ds_read_b64_tr_b16 v[68:69], v114 offset:57344
    v_accvgpr_write_b32 a34, 0
    v_mfma_f32_16x16x32_bf16 v[28:31], v[76:79], a[84:87], v[28:31]
    ds_read_b64_tr_b16 v[70:71], v114 offset:57856
    v_accvgpr_write_b32 a35, 0
    s_waitcnt lgkmcnt(8)
    v_mfma_f32_16x16x32_bf16 v[0:3], v[80:83], a[88:91], v[0:3]
    ds_read_b64_tr_b16 v[72:73], v115 offset:57344
    v_accvgpr_write_b32 a36, 0
    v_mfma_f32_16x16x32_bf16 v[4:7], v[80:83], a[92:95], v[4:7]
    ds_read_b64_tr_b16 v[74:75], v115 offset:57856
    v_accvgpr_write_b32 a37, 0
    v_mfma_f32_16x16x32_bf16 v[8:11], v[84:87], a[88:91], v[8:11]
    ds_read_b64_tr_b16 v[76:77], v116 offset:57344
    v_accvgpr_write_b32 a38, 0
    v_mfma_f32_16x16x32_bf16 v[12:15], v[84:87], a[92:95], v[12:15]
    ds_read_b64_tr_b16 v[78:79], v116 offset:57856
    v_accvgpr_write_b32 a39, 0
    s_waitcnt lgkmcnt(8)
    v_mfma_f32_16x16x32_bf16 v[16:19], v[88:91], a[88:91], v[16:19]
    ds_read_b64_tr_b16 v[80:81], v113 offset:61440
    v_accvgpr_write_b32 a40, 0
    v_mfma_f32_16x16x32_bf16 v[20:23], v[88:91], a[92:95], v[20:23]
    ds_read_b64_tr_b16 v[82:83], v113 offset:61952
    v_accvgpr_write_b32 a41, 0
    v_mfma_f32_16x16x32_bf16 v[24:27], v[92:95], a[88:91], v[24:27]
    ds_read_b64_tr_b16 v[84:85], v114 offset:61440
    v_accvgpr_write_b32 a42, 0
    v_mfma_f32_16x16x32_bf16 v[28:31], v[92:95], a[92:95], v[28:31]
    ds_read_b64_tr_b16 v[86:87], v114 offset:61952
    v_accvgpr_write_b32 a43, 0
    s_cmp_lg_u32 s3, 0
    s_cbranch_scc1 PK_12
    s_waitcnt vmcnt(0)
    v_readfirstlane_b32 s6, v125
    s_mov_b32 s7, 0
    s_cmp_ge_u32 s6, 256
    s_cbranch_scc1 PK_12
PL_13:
    s_sleep 4
    buffer_load_dword v125, off, s[48:51], 0 offset:64 sc1
    s_add_u32 s7, s7, 1
    s_waitcnt vmcnt(0)
    v_readfirstlane_b32 s6, v125
    s_cmp_ge_u32 s7, 0x40000
    s_cbranch_scc1 PK_12
    s_cmp_lt_u32 s6, 256
    s_cbranch_scc1 PL_13
PK_12:
    s_barrier
    s_waitcnt lgkmcnt(8)
    v_mfma_f32_16x16x32_bf16 v[32:35], v[64:67], a[80:83], v[32:35]
    ds_read_b64_tr_b16 v[88:89], v115 offset:61440
    v_accvgpr_write_b32 a44, 0
    v_mfma_f32_16x16x32_bf16 v[36:39], v[64:67], a[84:87], v[36:39]
    ds_read_b64_tr_b16 v[90:91], v115 offset:61952
    v_accvgpr_write_b32 a45, 0
    v_mfma_f32_16x16x32_bf16 v[40:43], v[68:71], a[80:83], v[40:43]
    ds_read_b64_tr_b16 v[92:93], v116 offset:61440
    v_accvgpr_write_b32 a46, 0
    v_mfma_f32_16x16x32_bf16 v[44:47], v[68:71], a[84:87], v[44:47]
    ds_read_b64_tr_b16 v[94:95], v116 offset:61952
    v_accvgpr_write_b32 a47, 0
    s_waitcnt lgkmcnt(8)
    v_mfma_f32_16x16x32_bf16 v[48:51], v[72:75], a[80:83], v[48:51]
    v_add_u32 v113, 0x10000, v113
    ds_read_b64_tr_b16 v[64:65], v113 offset:0
    v_accvgpr_write_b32 a48, 0
    v_mfma_f32_16x16x32_bf16 v[52:55], v[72:75], a[84:87], v[52:55]
    ds_read_b64_tr_b16 v[66:67], v113 offset:512
    v_accvgpr_write_b32 a49, 0
    v_mfma_f32_16x16x32_bf16 v[56:59], v[76:79], a[80:83], v[56:59]
    v_add_u32 v114, 0x10000, v114
    ds_read_b64_tr_b16 v[68:69], v114 offset:0
    v_accvgpr_write_b32 a50, 0
    v_mfma_f32_16x16x32_bf16 v[60:63], v[76:79], a[84:87], v[60:63]
    ds_read_b64_tr_b16 v[70:71], v114 offset:512
    v_accvgpr_write_b32 a51, 0
    s_waitcnt lgkmcnt(8)
    v_mfma_f32_16x16x32_bf16 v[32:35], v[80:83], a[88:91], v[32:35]
    v_add_u32 v115, 0x10000, v115
    ds_read_b64_tr_b16 v[72:73], v115 offset:0
    v_accvgpr_write_b32 a52, 0
    s_lshl_b32 s6, s3, 13
    s_add_u32 s7, s70, s6
    s_add_u32 s7, s7, 0x200000
    s_add_u32 s53, s7, 0xff4000
    s_add_u32 s71, s6, 16384
    s_cmp_ge_u32 s3, 6
    s_cselect_b32 s7, s53, s7
    s_cselect_b32 s6, s71, s6
    v_mfma_f32_16x16x32_bf16 v[36:39], v[80:83], a[92:95], v[36:39]
    ds_read_b64_tr_b16 v[74:75], v115 offset:512
    v_accvgpr_write_b32 a53, 0
    s_add_u32 m0, s6, 0
    v_mfma_f32_16x16x32_bf16 v[40:43], v[84:87], a[88:91], v[40:43]
    v_add_u32 v116, 0x10000, v116
    ds_read_b64_tr_b16 v[76:77], v116 offset:0
    v_accvgpr_write_b32 a54, 0
    v_mfma_f32_16x16x32_bf16 v[44:47], v[84:87], a[92:95], v[44:47]
    ds_read_b64_tr_b16 v[78:79], v116 offset:512
    v_accvgpr_write_b32 a55, 0
    s_add_u32 s53, s7, 0
    s_waitcnt lgkmcnt(8)
    v_mfma_f32_16x16x32_bf16 v[48:51], v[88:91], a[88:91], v[48:51]
    ds_read_b64_tr_b16 v[80:81], v113 offset:4096
    v_accvgpr_write_b32 a56, 0
    v_mfma_f32_16x16x32_bf16 v[52:55], v[88:91], a[92:95], v[52:55]
    ds_read_b64_tr_b16 v[82:83], v113 offset:4608
    v_accvgpr_write_b32 a57, 0
    buffer_load_dwordx4 v112, s[8:11], s53 offen offset:0 sc1 lds
    v_mfma_f32_16x16x32_bf16 v[56:59], v[92:95], a[88:91], v[56:59]
    ds_read_b64_tr_b16 v[84:85], v114 offset:4096
    v_accvgpr_write_b32 a58, 0
    v_mfma_f32_16x16x32_bf16 v[60:63], v[92:95], a[92:95], v[60:63]
    ds_read_b64_tr_b16 v[86:87], v114 offset:4608
    v_accvgpr_write_b32 a59, 0
    buffer_load_dwordx4 v112, s[8:11], s53 offen offset:1024 sc1 lds
    s_waitcnt lgkmcnt(8)
    v_mfma_f32_16x16x32_bf16 v[0:3], v[64:67], a[96:99], v[0:3]
    ds_read_b64_tr_b16 v[88:89], v115 offset:4096
    v_accvgpr_write_b32 a60, 0
    v_mfma_f32_16x16x32_bf16 v[4:7], v[64:67], a[100:103], v[4:7]
    ds_read_b64_tr_b16 v[90:91], v115 offset:4608
    v_accvgpr_write_b32 a61, 0
    buffer_load_dwordx4 v112, s[8:11], s53 offen offset:2048 sc1 lds
    v_mfma_f32_16x16x32_bf16 v[8:11], v[68:71], a[96:99], v[8:11]
    ds_read_b64_tr_b16 v[92:93], v116 offset:4096
    v_accvgpr_write_b32 a62, 0
    v_mfma_f32_16x16x32_bf16 v[12:15], v[68:71], a[100:103], v[12:15]
    ds_read_b64_tr_b16 v[94:95], v116 offset:4608
    v_accvgpr_write_b32 a63, 0
    buffer_load_dwordx4 v112, s[8:11], s53 offen offset:3072 sc1 lds
    s_waitcnt lgkmcnt(8)
    v_mfma_f32_16x16x32_bf16 v[16:19], v[72:75], a[96:99], v[16:19]
    ds_read_b64_tr_b16 v[64:65], v113 offset:8192
    v_mfma_f32_16x16x32_bf16 v[20:23], v[72:75], a[100:103], v[20:23]
    ds_read_b64_tr_b16 v[66:67], v113 offset:8704
    s_add_u32 m0, s6, 4096
    v_mfma_f32_16x16x32_bf16 v[24:27], v[76:79], a[96:99], v[24:27]
    ds_read_b64_tr_b16 v[68:69], v114 offset:8192
    v_mfma_f32_16x16x32_bf16 v[28:31], v[76:79], a[100:103], v[28:31]
    ds_read_b64_tr_b16 v[70:71], v114 offset:8704
    s_add_u32 s53, s7, 4096
    s_waitcnt lgkmcnt(8)
    v_mfma_f32_16x16x32_bf16 v[0:3], v[80:83], a[104:107], v[0:3]
    ds_read_b64_tr_b16 v[72:73], v115 offset:8192
    v_mfma_f32_16x16x32_bf16 v[4:7], v[80:83], a[108:111], v[4:7]
    ds_read_b64_tr_b16 v[74:75], v115 offset:8704
    buffer_load_dwordx4 v112, s[8:11], s53 offen offset:0 sc1 lds
    v_mfma_f32_16x16x32_bf16 v[8:11], v[84:87], a[104:107], v[8:11]
    ds_read_b64_tr_b16 v[76:77], v116 offset:8192
    v_mfma_f32_16x16x32_bf16 v[12:15], v[84:87], a[108:111], v[12:15]
    ds_read_b64_tr_b16 v[78:79], v116 offset:8704
    buffer_load_dwordx4 v112, s[8:11], s53 offen offset:1024 sc1 lds
    s_waitcnt lgkmcnt(8)
    v_mfma_f32_16x16x32_bf16 v[16:19], v[88:91], a[104:107], v[16:19]
    ds_read_b64_tr_b16 v[80:81], v113 offset:12288
    v_mfma_f32_16x16x32_bf16 v[20:23], v[88:91], a[108:111], v[20:23]
    ds_read_b64_tr_b16 v[82:83], v113 offset:12800
    buffer_load_dwordx4 v112, s[8:11], s53 offen offset:2048 sc1 lds
    v_mfma_f32_16x16x32_bf16 v[24:27], v[92:95], a[104:107], v[24:27]
    ds_read_b64_tr_b16 v[84:85], v114 offset:12288
    v_mfma_f32_16x16x32_bf16 v[28:31], v[92:95], a[108:111], v[28:31]
    ds_read_b64_tr_b16 v[86:87], v114 offset:12800
    buffer_load_dwordx4 v112, s[8:11], s53 offen offset:3072 sc1 lds
    s_barrier
    s_waitcnt lgkmcnt(8)
    v_mfma_f32_16x16x32_bf16 v[32:35], v[64:67], a[96:99], v[32:35]
    ds_read_b64_tr_b16 v[88:89], v115 offset:12288
    v_mfma_f32_16x16x32_bf16 v[36:39], v[64:67], a[100:103], v[36:39]
    ds_read_b64_tr_b16 v[90:91], v115 offset:12800
    v_mfma_f32_16x16x32_bf16 v[40:43], v[68:71], a[96:99], v[40:43]
    ds_read_b64_tr_b16 v[92:93], v116 offset:12288
    v_mfma_f32_16x16x32_bf16 v[44:47], v[68:71], a[100:103], v[44:47]
    ds_read_b64_tr_b16 v[94:95], v116 offset:12800
    s_waitcnt lgkmcnt(8)
    v_mfma_f32_16x16x32_bf16 v[48:51], v[72:75], a[96:99], v[48:51]
    ds_read_b64_tr_b16 v[64:65], v113 offset:16384
    s_cmp_ge_u32 s63, 2
    v_mfma_f32_16x16x32_bf16 v[52:55], v[72:75], a[100:103], v[52:55]
    ds_read_b64_tr_b16 v[66:67], v113 offset:16896
    s_mov_b32 s71, 0x20c000
    v_mfma_f32_16x16x32_bf16 v[56:59], v[76:79], a[96:99], v[56:59]
    ds_read_b64_tr_b16 v[68:69], v114 offset:16384
    s_cselect_b32 s71, 0x1200000, s71
    v_mfma_f32_16x16x32_bf16 v[60:63], v[76:79], a[100:103], v[60:63]
    ds_read_b64_tr_b16 v[70:71], v114 offset:16896
    s_mov_b32 s73, 0x200000
    s_waitcnt lgkmcnt(8)
    v_mfma_f32_16x16x32_bf16 v[32:35], v[80:83], a[104:107], v[32:35]
    ds_read_b64_tr_b16 v[72:73], v115 offset:16384
    s_cselect_b32 s73, 0x1200000, s73
    v_mfma_f32_16x16x32_bf16 v[36:39], v[80:83], a[108:111], v[36:39]
    ds_read_b64_tr_b16 v[74:75], v115 offset:16896
    s_mov_b32 s74, 0
    v_mfma_f32_16x16x32_bf16 v[40:43], v[84:87], a[104:107], v[40:43]
    ds_read_b64_tr_b16 v[76:77], v116 offset:16384
    s_cselect_b32 s74, 0x10000, s74
    v_mfma_f32_16x16x32_bf16 v[44:47], v[84:87], a[108:111], v[44:47]
    ds_read_b64_tr_b16 v[78:79], v116 offset:16896
    s_mov_b32 s72, 49152
    s_waitcnt lgkmcnt(8)
    v_mfma_f32_16x16x32_bf16 v[48:51], v[88:91], a[104:107], v[48:51]
    ds_read_b64_tr_b16 v[80:81], v113 offset:20480
    s_cselect_b32 s72, 0, s72
    v_mfma_f32_16x16x32_bf16 v[52:55], v[88:91], a[108:111], v[52:55]
    ds_read_b64_tr_b16 v[82:83], v113 offset:20992
    s_lshl_b32 s6, s63, 13
    v_mfma_f32_16x16x32_bf16 v[56:59], v[92:95], a[104:107], v[56:59]
    ds_read_b64_tr_b16 v[84:85], v114 offset:20480
    s_add_u32 s71, s71, s6
    v_mfma_f32_16x16x32_bf16 v[60:63], v[92:95], a[108:111], v[60:63]
    ds_read_b64_tr_b16 v[86:87], v114 offset:20992
    s_add_u32 s71, s71, s70
    s_waitcnt lgkmcnt(8)
    v_mfma_f32_16x16x32_bf16 v[0:3], v[64:67], a[112:115], v[0:3]
    ds_read_b64_tr_b16 v[88:89], v115 offset:20480
    s_add_u32 s72, s72, s6
    v_mfma_f32_16x16x32_bf16 v[4:7], v[64:67], a[116:119], v[4:7]
    ds_read_b64_tr_b16 v[90:91], v115 offset:20992
    s_lshl_b32 s6, s62, 13
    v_mfma_f32_16x16x32_bf16 v[8:11], v[68:71], a[112:115], v[8:11]
    ds_read_b64_tr_b16 v[92:93], v116 offset:20480
    s_add_u32 s73, s73, s6
    v_mfma_f32_16x16x32_bf16 v[12:15], v[68:71], a[116:119], v[12:15]
    ds_read_b64_tr_b16 v[94:95], v116 offset:20992
    s_add_u32 s73, s73, s70
    s_waitcnt lgkmcnt(8)
    v_mfma_f32_16x16x32_bf16 v[16:19], v[72:75], a[112:115], v[16:19]
    ds_read_b64_tr_b16 v[64:65], v113 offset:24576
    v_mfma_f32_16x16x32_bf16 v[20:23], v[72:75], a[116:119], v[20:23]
    ds_read_b64_tr_b16 v[66:67], v113 offset:25088
    v_mfma_f32_16x16x32_bf16 v[24:27], v[76:79], a[112:115], v[24:27]
    ds_read_b64_tr_b16 v[68:69], v114 offset:24576
    v_mfma_f32_16x16x32_bf16 v[28:31], v[76:79], a[116:119], v[28:31]
    ds_read_b64_tr_b16 v[70:71], v114 offset:25088
    s_waitcnt lgkmcnt(8)
    v_mfma_f32_16x16x32_bf16 v[0:3], v[80:83], a[120:123], v[0:3]
    ds_read_b64_tr_b16 v[72:73], v115 offset:24576
    v_mfma_f32_16x16x32_bf16 v[4:7], v[80:83], a[124:127], v[4:7]
    ds_read_b64_tr_b16 v[74:75], v115 offset:25088
    v_mfma_f32_16x16x32_bf16 v[8:11], v[84:87], a[120:123], v[8:11]
    ds_read_b64_tr_b16 v[76:77], v116 offset:24576
    v_mfma_f32_16x16x32_bf16 v[12:15], v[84:87], a[124:127], v[12:15]
    ds_read_b64_tr_b16 v[78:79], v116 offset:25088
    s_waitcnt lgkmcnt(8)
    v_mfma_f32_16x16x32_bf16 v[16:19], v[88:91], a[120:123], v[16:19]
    ds_read_b64_tr_b16 v[80:81], v113 offset:28672
    v_mfma_f32_16x16x32_bf16 v[20:23], v[88:91], a[124:127], v[20:23]
    ds_read_b64_tr_b16 v[82:83], v113 offset:29184
    v_mfma_f32_16x16x32_bf16 v[24:27], v[92:95], a[120:123], v[24:27]
    ds_read_b64_tr_b16 v[84:85], v114 offset:28672
    v_mfma_f32_16x16x32_bf16 v[28:31], v[92:95], a[124:127], v[28:31]
    ds_read_b64_tr_b16 v[86:87], v114 offset:29184
    s_waitcnt vmcnt(0)
    s_barrier
    s_waitcnt lgkmcnt(8)
    v_mfma_f32_16x16x32_bf16 v[32:35], v[64:67], a[112:115], v[32:35]
    ds_read_b64_tr_b16 v[88:89], v115 offset:28672
    v_mfma_f32_16x16x32_bf16 v[36:39], v[64:67], a[116:119], v[36:39]
    ds_read_b64_tr_b16 v[90:91], v115 offset:29184
    ds_read_b128 a[64:67], v104 offset:0
    v_mfma_f32_16x16x32_bf16 v[40:43], v[68:71], a[112:115], v[40:43]
    ds_read_b64_tr_b16 v[92:93], v116 offset:28672
    v_mfma_f32_16x16x32_bf16 v[44:47], v[68:71], a[116:119], v[44:47]
    ds_read_b64_tr_b16 v[94:95], v116 offset:29184
    ds_read_b128 a[68:71], v104 offset:1024
    s_waitcnt lgkmcnt(10)
    v_mfma_f32_16x16x32_bf16 v[48:51], v[72:75], a[112:115], v[48:51]
    v_mfma_f32_16x16x32_bf16 v[52:55], v[72:75], a[116:119], v[52:55]
    v_mul_f32 v0, 0x3e0293ee, v0
    v_mul_f32 v1, 0x3e0293ee, v1
    v_mul_f32 v2, 0x3e0293ee, v2
    v_mul_f32 v3, 0x3e0293ee, v3
    v_mul_f32 v4, 0x3e0293ee, v4
    ds_read_b128 a[72:75], v104 offset:2048
    v_mfma_f32_16x16x32_bf16 v[56:59], v[76:79], a[112:115], v[56:59]
    v_mul_f32 v5, 0x3e0293ee, v5
    v_mul_f32 v6, 0x3e0293ee, v6
    v_mul_f32 v7, 0x3e0293ee, v7
    v_mul_f32 v8, 0x3e0293ee, v8
    v_mul_f32 v9, 0x3e0293ee, v9
    v_mfma_f32_16x16x32_bf16 v[60:63], v[76:79], a[116:119], v[60:63]
    v_mul_f32 v10, 0x3e0293ee, v10
    v_mul_f32 v11, 0x3e0293ee, v11
    v_mul_f32 v12, 0x3e0293ee, v12
    v_mul_f32 v13, 0x3e0293ee, v13
    v_mul_f32 v14, 0x3e0293ee, v14
    ds_read_b128 a[76:79], v104 offset:3072
    s_waitcnt lgkmcnt(8)
    v_mfma_f32_16x16x32_bf16 v[32:35], v[80:83], a[120:123], v[32:35]
    v_mul_f32 v15, 0x3e0293ee, v15
    v_cvt_pk_bf16_f32 v0, v0, v1
    v_cvt_pk_bf16_f32 v1, v2, v3
    v_cvt_pk_bf16_f32 v2, v8, v9
    v_cvt_pk_bf16_f32 v3, v10, v11
    v_mfma_f32_16x16x32_bf16 v[36:39], v[80:83], a[124:127], v[36:39]
    v_cvt_pk_bf16_f32 v4, v4, v5
    v_cvt_pk_bf16_f32 v5, v6, v7
    v_cvt_pk_bf16_f32 v6, v12, v13
    v_cvt_pk_bf16_f32 v7, v14, v15
    v_mul_f32 v16, 0x3e0293ee, v16
    ds_read_b128 a[80:83], v104 offset:4096
    v_mfma_f32_16x16x32_bf16 v[40:43], v[84:87], a[120:123], v[40:43]
    v_mul_f32 v17, 0x3e0293ee, v17
    v_mul_f32 v18, 0x3e0293ee, v18
    v_mul_f32 v19, 0x3e0293ee, v19
    v_mul_f32 v20, 0x3e0293ee, v20
    v_mul_f32 v21, 0x3e0293ee, v21
    v_mfma_f32_16x16x32_bf16 v[44:47], v[84:87], a[124:127], v[44:47]
    v_mul_f32 v22, 0x3e0293ee, v22
    v_mul_f32 v23, 0x3e0293ee, v23
    v_mul_f32 v24, 0x3e0293ee, v24
    v_mul_f32 v25, 0x3e0293ee, v25
    v_mul_f32 v26, 0x3e0293ee, v26
    ds_read_b128 a[84:87], v104 offset:5120
    s_waitcnt lgkmcnt(5)
    v_mfma_f32_16x16x32_bf16 v[48:51], v[88:91], a[120:123], v[48:51]
    v_mul_f32 v27, 0x3e0293ee, v27
    v_mul_f32 v28, 0x3e0293ee, v28
    v_mul_f32 v29, 0x3e0293ee, v29
    v_mul_f32 v30, 0x3e0293ee, v30
    v_mul_f32 v31, 0x3e0293ee, v31
    v_mfma_f32_16x16x32_bf16 v[52:55], v[88:91], a[124:127], v[52:55]
    v_cvt_pk_bf16_f32 v16, v16, v17
    v_cvt_pk_bf16_f32 v17, v18, v19
    v_cvt_pk_bf16_f32 v18, v24, v25
    v_cvt_pk_bf16_f32 v19, v26, v27
    v_cvt_pk_bf16_f32 v20, v20, v21
    ds_read_b128 a[88:91], v104 offset:6144
    v_mfma_f32_16x16x32_bf16 v[56:59], v[92:95], a[120:123], v[56:59]
    v_cvt_pk_bf16_f32 v21, v22, v23
    v_cvt_pk_bf16_f32 v22, v28, v29
    v_cvt_pk_bf16_f32 v23, v30, v31
    v_mfma_f32_16x16x32_bf16 v[60:63], v[92:95], a[124:127], v[60:63]
    s_cmp_lg_u32 s3, 0
    s_cbranch_scc1 PI_14
    buffer_load_dword v125, off, s[48:51], 0 offset:128 sc1
PI_14:
    s_cmp_ge_u32 s3, 4
    s_cbranch_scc1 AT_RE0
    s_cmp_lt_u32 s3, 2
    s_cbranch_scc1 AT_R00
    s_min_u32 s6, s71, s73
    s_and_b32 s7, s72, 0xffff
    s_add_u32 m0, s7, s74
    s_add_u32 s52, s6, 4096
    buffer_load_dwordx4 v112, s[8:11], s6 offen offset:0 sc1 lds
    buffer_load_dwordx4 v112, s[8:11], s6 offen offset:1024 sc1 lds
    buffer_load_dwordx4 v112, s[8:11], s6 offen offset:2048 sc1 lds
    buffer_load_dwordx4 v112, s[8:11], s6 offen offset:3072 sc1 lds
    s_add_u32 m0, m0, 4096
    s_add_u32 s71, s71, 16384
    buffer_load_dwordx4 v112, s[8:11], s52 offen offset:0 sc1 lds
    buffer_load_dwordx4 v112, s[8:11], s52 offen offset:1024 sc1 lds
    buffer_load_dwordx4 v112, s[8:11], s52 offen offset:2048 sc1 lds
    buffer_load_dwordx4 v112, s[8:11], s52 offen offset:3072 sc1 lds
    s_add_u32 s72, s72, 16384
AT_R00:
    s_min_u32 s6, s71, s73
    s_and_b32 s7, s72, 0xffff
    s_add_u32 m0, s7, s74
    s_add_u32 s52, s6, 4096
    buffer_load_dwordx4 v112, s[8:11], s6 offen offset:0 sc1 lds
    buffer_load_dwordx4 v112, s[8:11], s6 offen offset:1024 sc1 lds
    buffer_load_dwordx4 v112, s[8:11], s6 offen offset:2048 sc1 lds
    buffer_load_dwordx4 v112, s[8:11], s6 offen offset:3072 sc1 lds
    s_add_u32 m0, m0, 4096
    s_add_u32 s71, s71, 16384
    buffer_load_dwordx4 v112, s[8:11], s52 offen offset:0 sc1 lds
    buffer_load_dwordx4 v112, s[8:11], s52 offen offset:1024 sc1 lds
    buffer_load_dwordx4 v112, s[8:11], s52 offen offset:2048 sc1 lds
    buffer_load_dwordx4 v112, s[8:11], s52 offen offset:3072 sc1 lds
    s_add_u32 s72, s72, 16384
AT_RE0:
    v_mfma_f32_16x16x32_bf16 v[8:11], a[64:67], v[0:3], 0
    ds_read_b128 a[92:95], v104 offset:7168
    v_mul_f32 v32, 0x3e0293ee, v32
    v_mul_f32 v33, 0x3e0293ee, v33
    v_mul_f32 v34, 0x3e0293ee, v34
    v_mul_f32 v35, 0x3e0293ee, v35
    v_mfma_f32_16x16x32_bf16 v[24:27], a[64:67], v[4:7], 0
    v_mul_f32 v36, 0x3e0293ee, v36
    v_mul_f32 v37, 0x3e0293ee, v37
    v_mul_f32 v38, 0x3e0293ee, v38
    v_mul_f32 v39, 0x3e0293ee, v39
    s_waitcnt lgkmcnt(6)
    v_mfma_f32_16x16x32_bf16 v[12:15], a[68:71], v[0:3], 0
    ds_read_b128 a[64:67], v104 offset:8192
    v_mul_f32 v40, 0x3e0293ee, v40
    v_mul_f32 v41, 0x3e0293ee, v41
    v_mul_f32 v42, 0x3e0293ee, v42
    v_mul_f32 v43, 0x3e0293ee, v43
    v_mfma_f32_16x16x32_bf16 v[28:31], a[68:71], v[4:7], 0
    v_mul_f32 v44, 0x3e0293ee, v44
    v_mul_f32 v45, 0x3e0293ee, v45
    v_mul_f32 v46, 0x3e0293ee, v46
    v_mul_f32 v47, 0x3e0293ee, v47
    s_waitcnt lgkmcnt(6)
    v_mfma_f32_16x16x32_bf16 v[8:11], a[72:75], v[16:19], v[8:11]
    ds_read_b128 a[68:71], v104 offset:9216
    v_cvt_pk_bf16_f32 v32, v32, v33
    v_cvt_pk_bf16_f32 v33, v34, v35
    v_cvt_pk_bf16_f32 v34, v40, v41
    v_cvt_pk_bf16_f32 v35, v42, v43
    v_mfma_f32_16x16x32_bf16 v[24:27], a[72:75], v[20:23], v[24:27]
    v_cvt_pk_bf16_f32 v36, v36, v37
    v_cvt_pk_bf16_f32 v37, v38, v39
    v_cvt_pk_bf16_f32 v38, v44, v45
    v_cvt_pk_bf16_f32 v39, v46, v47
    s_waitcnt lgkmcnt(6)
    v_mfma_f32_16x16x32_bf16 v[12:15], a[76:79], v[16:19], v[12:15]
    ds_read_b128 a[72:75], v104 offset:10240
    v_mul_f32 v48, 0x3e0293ee, v48
    v_mul_f32 v49, 0x3e0293ee, v49
    v_mul_f32 v50, 0x3e0293ee, v50
    v_mul_f32 v51, 0x3e0293ee, v51
    v_mfma_f32_16x16x32_bf16 v[28:31], a[76:79], v[20:23], v[28:31]
    v_mul_f32 v52, 0x3e0293ee, v52
    v_mul_f32 v53, 0x3e0293ee, v53
    v_mul_f32 v54, 0x3e0293ee, v54
    v_mul_f32 v55, 0x3e0293ee, v55
    s_waitcnt lgkmcnt(6)
    v_mfma_f32_16x16x32_bf16 v[8:11], a[80:83], v[32:35], v[8:11]
    ds_read_b128 a[76:79], v104 offset:11264
    v_mul_f32 v56, 0x3e0293ee, v56
    v_mul_f32 v57, 0x3e0293ee, v57
    v_mul_f32 v58, 0x3e0293ee, v58
    v_mul_f32 v59, 0x3e0293ee, v59
    v_mfma_f32_16x16x32_bf16 v[24:27], a[80:83], v[36:39], v[24:27]
    v_mul_f32 v60, 0x3e0293ee, v60
    v_mul_f32 v61, 0x3e0293ee, v61
    v_mul_f32 v62, 0x3e0293ee, v62
    v_mul_f32 v63, 0x3e0293ee, v63
    s_waitcnt lgkmcnt(6)
    v_mfma_f32_16x16x32_bf16 v[12:15], a[84:87], v[32:35], v[12:15]
    ds_read_b128 a[80:83], v104 offset:12288
    v_cvt_pk_bf16_f32 v48, v48, v49
    v_cvt_pk_bf16_f32 v49, v50, v51
    v_cvt_pk_bf16_f32 v50, v56, v57
    v_cvt_pk_bf16_f32 v51, v58, v59
    v_mfma_f32_16x16x32_bf16 v[28:31], a[84:87], v[36:39], v[28:31]
    v_cvt_pk_bf16_f32 v52, v52, v53
    v_cvt_pk_bf16_f32 v53, v54, v55
    v_cvt_pk_bf16_f32 v54, v60, v61
    v_cvt_pk_bf16_f32 v55, v62, v63
    s_waitcnt lgkmcnt(6)
    v_mfma_f32_16x16x32_bf16 v[8:11], a[88:91], v[48:51], v[8:11]
    ds_read_b128 a[84:87], v104 offset:13312
    v_xor_b32 v113, 0, v121
    v_mfma_f32_16x16x32_bf16 v[24:27], a[88:91], v[52:55], v[24:27]
    v_xor_b32 v114, 32, v121
    s_waitcnt lgkmcnt(6)
    v_mfma_f32_16x16x32_bf16 v[12:15], a[92:95], v[48:51], v[12:15]
    ds_read_b128 a[88:91], v104 offset:14336
    v_xor_b32 v115, 64, v121
    v_mfma_f32_16x16x32_bf16 v[28:31], a[92:95], v[52:55], v[28:31]
    v_xor_b32 v116, 96, v121
    s_nop 5
    s_cmp_lg_u32 s61, 0
    s_cbranch_scc1 AT_NM0
    v_mov_b32 v12, v108
    v_cndmask_b32 v8, v8, v108, s[80:81]
    v_cndmask_b32 v28, v28, v108, s[80:81]
    v_mov_b32 v13, v108
    v_cndmask_b32 v9, v9, v108, s[82:83]
    v_cndmask_b32 v29, v29, v108, s[82:83]
    v_mov_b32 v14, v108
    v_cndmask_b32 v10, v10, v108, s[84:85]
    v_cndmask_b32 v30, v30, v108, s[84:85]
    v_mov_b32 v15, v108
    v_cndmask_b32 v11, v11, v108, s[86:87]
    v_cndmask_b32 v31, v31, v108, s[86:87]
    s_nop 1
AT_NM0:
    v_max3_f32 v97, v8, v9, v10
    v_max3_f32 v97, v97, v11, v12
    v_max3_f32 v97, v97, v13, v14
    v_max_f32 v97, v97, v15
    v_mov_b32 v98, v97
    s_nop 1
    v_permlane16_swap_b32 v98, v97
    s_nop 1
    v_max_f32 v97, v97, v98
    v_mov_b32 v98, v97
    s_nop 1
    v_permlane32_swap_b32 v98, v97
    s_nop 1
    v_max_f32 v97, v97, v98
    v_sub_f32 v64, 0, v97
    v_sub_f32 v65, 0, v97
    v_sub_f32 v66, 0, v97
    v_sub_f32 v67, 0, v97
    v_sub_f32 v68, 0, v97
    v_sub_f32 v69, 0, v97
    v_sub_f32 v70, 0, v97
    v_sub_f32 v71, 0, v97
    v_sub_f32 v8, v8, v97
    v_sub_f32 v9, v9, v97
    v_sub_f32 v10, v10, v97
    v_sub_f32 v11, v11, v97
    v_sub_f32 v12, v12, v97
    v_sub_f32 v13, v13, v97
    v_sub_f32 v14, v14, v97
    v_sub_f32 v15, v15, v97
    v_max3_f32 v97, v24, v25, v26
    v_max3_f32 v97, v97, v27, v28
    v_max3_f32 v97, v97, v29, v30
    v_max_f32 v97, v97, v31
    v_mov_b32 v98, v97
    s_nop 1
    v_permlane16_swap_b32 v98, v97
    s_nop 1
    v_max_f32 v97, v97, v98
    v_mov_b32 v98, v97
    s_nop 1
    v_permlane32_swap_b32 v98, v97
    s_nop 1
    v_max_f32 v97, v97, v98
    v_sub_f32 v72, 0, v97
    v_sub_f32 v73, 0, v97
    v_sub_f32 v74, 0, v97
    v_sub_f32 v75, 0, v97
    v_sub_f32 v76, 0, v97
    v_sub_f32 v77, 0, v97
    v_sub_f32 v78, 0, v97
    v_sub_f32 v79, 0, v97
    v_sub_f32 v24, v24, v97
    v_sub_f32 v25, v25, v97
    v_sub_f32 v26, v26, v97
    v_sub_f32 v27, v27, v97
    v_sub_f32 v28, v28, v97
    v_sub_f32 v29, v29, v97
    v_sub_f32 v30, v30, v97
    v_sub_f32 v31, v31, v97
    v_exp_f32 v96, v8
    s_cmp_lg_u32 s61, 1
    s_cbranch_scc1 AT_NM1
    v_mov_b32 v68, v108
    v_cndmask_b32 v64, v64, v108, s[80:81]
    v_cndmask_b32 v76, v76, v108, s[80:81]
    v_mov_b32 v69, v108
    v_cndmask_b32 v65, v65, v108, s[82:83]
    v_cndmask_b32 v77, v77, v108, s[82:83]
    v_mov_b32 v70, v108
    v_cndmask_b32 v66, v66, v108, s[84:85]
    v_cndmask_b32 v78, v78, v108, s[84:85]
    v_mov_b32 v71, v108
    v_cndmask_b32 v67, v67, v108, s[86:87]
    v_cndmask_b32 v79, v79, v108, s[86:87]
    s_nop 1
AT_NM1:
    s_waitcnt lgkmcnt(5)
    v_mfma_f32_16x16x32_bf16 v[40:43], a[64:67], v[0:3], v[64:67]
    ds_read_b128 a[92:95], v104 offset:15360
    v_add_f32 v100, v102, v96
    v_exp_f32 v97, v9
    v_mfma_f32_16x16x32_bf16 v[56:59], a[64:67], v[4:7], v[72:75]
    v_add_f32 v100, v100, v97
    v_cvt_pk_bf16_f32 v80, v96, v97
    v_exp_f32 v98, v10
    v_mfma_f32_16x16x32_bf16 v[44:47], a[68:71], v[0:3], v[68:71]
    ds_read_b128 a[64:67], v105 offset:0
    v_add_f32 v100, v100, v98
    v_exp_f32 v99, v11
    v_mfma_f32_16x16x32_bf16 v[60:63], a[68:71], v[4:7], v[76:79]
    v_add_f32 v100, v100, v99
    v_cvt_pk_bf16_f32 v81, v98, v99
    v_exp_f32 v96, v12
    s_waitcnt lgkmcnt(5)
    v_mfma_f32_16x16x32_bf16 v[40:43], a[72:75], v[16:19], v[40:43]
    ds_read_b128 a[68:71], v105 offset:1024
    v_add_f32 v100, v100, v96
    v_exp_f32 v97, v13
    v_mfma_f32_16x16x32_bf16 v[56:59], a[72:75], v[20:23], v[56:59]
    v_add_f32 v100, v100, v97
    v_cvt_pk_bf16_f32 v82, v96, v97
    v_exp_f32 v98, v14
    v_mfma_f32_16x16x32_bf16 v[44:47], a[76:79], v[16:19], v[44:47]
    ds_read_b128 a[72:75], v105 offset:2048
    v_add_f32 v100, v100, v98
    v_exp_f32 v99, v15
    v_mfma_f32_16x16x32_bf16 v[60:63], a[76:79], v[20:23], v[60:63]
    v_add_f32 v100, v100, v99
    v_cvt_pk_bf16_f32 v83, v98, v99
    v_exp_f32 v96, v24
    s_waitcnt lgkmcnt(5)
    v_mfma_f32_16x16x32_bf16 v[40:43], a[80:83], v[32:35], v[40:43]
    ds_read_b128 a[76:79], v105 offset:3072
    v_add_f32 v101, v103, v96
    v_exp_f32 v97, v25
    v_mfma_f32_16x16x32_bf16 v[56:59], a[80:83], v[36:39], v[56:59]
    v_add_f32 v101, v101, v97
    v_cvt_pk_bf16_f32 v84, v96, v97
    v_exp_f32 v98, v26
    v_mfma_f32_16x16x32_bf16 v[44:47], a[84:87], v[32:35], v[44:47]
    ds_read_b128 a[80:83], v105 offset:4096
    v_add_f32 v101, v101, v98
    v_exp_f32 v99, v27
    v_mfma_f32_16x16x32_bf16 v[60:63], a[84:87], v[36:39], v[60:63]
    v_add_f32 v101, v101, v99
    v_cvt_pk_bf16_f32 v85, v98, v99
    v_exp_f32 v96, v28
    s_waitcnt lgkmcnt(5)
    v_mfma_f32_16x16x32_bf16 v[40:43], a[88:91], v[48:51], v[40:43]
    ds_read_b128 a[84:87], v105 offset:5120
    v_add_f32 v101, v101, v96
    v_exp_f32 v97, v29
    v_mfma_f32_16x16x32_bf16 v[56:59], a[88:91], v[52:55], v[56:59]
    v_add_f32 v101, v101, v97
    v_cvt_pk_bf16_f32 v86, v96, v97
    v_exp_f32 v98, v30
    v_mfma_f32_16x16x32_bf16 v[44:47], a[92:95], v[48:51], v[44:47]
    ds_read_b128 a[88:91], v105 offset:6144
    v_add_f32 v101, v101, v98
    v_exp_f32 v99, v31
    v_mfma_f32_16x16x32_bf16 v[60:63], a[92:95], v[52:55], v[60:63]
    v_add_f32 v101, v101, v99
    v_cvt_pk_bf16_f32 v87, v98, v99
    s_nop 7
    v_exp_f32 v96, v40
    s_cmp_lg_u32 s3, 0
    s_cbranch_scc1 PK_15
    s_waitcnt vmcnt(8)
    v_readfirstlane_b32 s6, v125
    s_mov_b32 s7, 0
    s_cmp_ge_u32 s6, 256
    s_cbranch_scc1 PK_15
PL_16:
    s_sleep 4
    buffer_load_dword v125, off, s[48:51], 0 offset:128 sc1
    s_add_u32 s7, s7, 1
    s_waitcnt vmcnt(0)
    v_readfirstlane_b32 s6, v125
    s_cmp_ge_u32 s7, 0x40000
    s_cbranch_scc1 PK_15
    s_cmp_lt_u32 s6, 256
    s_cbranch_scc1 PL_16
PK_15:
    s_cmp_eq_u32 s75, 0
    s_cbranch_scc1 AT_STEPEND
    v_add_u32 v106, 0x10000, v104
    v_mov_b32 v104, v105
    s_mov_b32 s79, 2
    s_cmp_ge_u32 s3, 4
    s_cbranch_scc1 AT_FB
    s_mov_b32 s79, 1
AT_FA:
    s_waitcnt lgkmcnt(5)
    v_mfma_f32_16x16x32_bf16 v[8:11], a[64:67], v[0:3], v[64:67]
    ds_read_b128 a[92:95], v104 offset:7168
    v_add_f32 v102, v100, v96
    v_mfma_f32_16x16x32_bf16 v[24:27], a[64:67], v[4:7], v[72:75]
    v_exp_f32 v97, v41
    s_nop 0
    v_add_f32 v102, v102, v97
    v_cvt_pk_bf16_f32 v88, v96, v97
    v_exp_f32 v98, v42
    v_add_u32 v105, 16384, v104
    v_mfma_f32_16x16x32_bf16 v[12:15], a[68:71], v[0:3], v[68:71]
    ds_read_b128 a[96:99], v106 offset:0
    v_add_f32 v102, v102, v98
    v_mfma_f32_16x16x32_bf16 v[28:31], a[68:71], v[4:7], v[76:79]
    v_exp_f32 v99, v43
    s_waitcnt lgkmcnt(5)
    v_mfma_f32_16x16x32_bf16 v[8:11], a[72:75], v[16:19], v[8:11]
    ds_read_b128 a[100:103], v106 offset:1024
    v_add_f32 v102, v102, v99
    v_mfma_f32_16x16x32_bf16 v[24:27], a[72:75], v[20:23], v[24:27]
    v_cvt_pk_bf16_f32 v89, v98, v99
    v_exp_f32 v96, v44
    v_and_b32 v105, 0xffff, v105
    v_mfma_f32_16x16x32_bf16 v[12:15], a[76:79], v[16:19], v[12:15]
    ds_read_b128 a[104:107], v106 offset:2048
    v_add_f32 v102, v102, v96
    v_mfma_f32_16x16x32_bf16 v[28:31], a[76:79], v[20:23], v[28:31]
    v_exp_f32 v97, v45
    s_waitcnt lgkmcnt(5)
    v_mfma_f32_16x16x32_bf16 v[8:11], a[80:83], v[32:35], v[8:11]
    ds_read_b128 a[108:111], v106 offset:3072
    v_add_f32 v102, v102, v97
    s_waitcnt vmcnt(8)
    s_barrier
    v_mfma_f32_16x16x32_bf16 v[24:27], a[80:83], v[36:39], v[24:27]
    v_cvt_pk_bf16_f32 v90, v96, v97
    v_exp_f32 v98, v46
    s_min_u32 s6, s71, s73
    v_mfma_f32_16x16x32_bf16 v[12:15], a[84:87], v[32:35], v[12:15]
    ds_read_b128 a[112:115], v106 offset:4096
    v_add_f32 v102, v102, v98
    s_and_b32 s7, s72, 0xffff
    v_mfma_f32_16x16x32_bf16 v[28:31], a[84:87], v[36:39], v[28:31]
    v_exp_f32 v99, v47
    s_add_u32 m0, s7, s74
    s_waitcnt lgkmcnt(5)
    v_mfma_f32_16x16x32_bf16 v[8:11], a[88:91], v[48:51], v[8:11]
    ds_read_b128 a[116:119], v106 offset:5120
    v_add_f32 v102, v102, v99
    s_add_u32 s52, s6, 4096
    v_mfma_f32_16x16x32_bf16 v[24:27], a[88:91], v[52:55], v[24:27]
    v_cvt_pk_bf16_f32 v91, v98, v99
    v_exp_f32 v96, v56
    buffer_load_dwordx4 v112, s[8:11], s6 offen offset:0 sc1 lds
    v_mfma_f32_16x16x32_bf16 v[12:15], a[92:95], v[48:51], v[12:15]
    ds_read_b128 a[120:123], v106 offset:6144
    v_add_f32 v103, v101, v96
    buffer_load_dwordx4 v112, s[8:11], s6 offen offset:1024 sc1 lds
    v_mfma_f32_16x16x32_bf16 v[28:31], a[92:95], v[52:55], v[28:31]
    v_exp_f32 v97, v57
    buffer_load_dwordx4 v112, s[8:11], s6 offen offset:2048 sc1 lds
    s_waitcnt lgkmcnt(5)
    v_mfma_f32_16x16x32_bf16 a[0:3], a[96:99], v[80:83], a[0:3]
    ds_read_b128 a[124:127], v106 offset:7168
    v_add_f32 v103, v103, v97
    buffer_load_dwordx4 v112, s[8:11], s6 offen offset:3072 sc1 lds
    v_mfma_f32_16x16x32_bf16 a[4:7], a[96:99], v[84:87], a[4:7]
    v_cvt_pk_bf16_f32 v92, v96, v97
    v_exp_f32 v98, v58
    s_add_u32 m0, m0, 4096
    v_mfma_f32_16x16x32_bf16 a[8:11], a[100:103], v[80:83], a[8:11]
    ds_read_b128 a[64:67], v104 offset:8192
    v_add_f32 v103, v103, v98
    s_add_u32 s71, s71, 16384
    v_mfma_f32_16x16x32_bf16 a[12:15], a[100:103], v[84:87], a[12:15]
    v_exp_f32 v99, v59
    buffer_load_dwordx4 v112, s[8:11], s52 offen offset:0 sc1 lds
    s_waitcnt lgkmcnt(5)
    v_mfma_f32_16x16x32_bf16 a[16:19], a[104:107], v[80:83], a[16:19]
    ds_read_b128 a[68:71], v104 offset:9216
    v_add_f32 v103, v103, v99
    buffer_load_dwordx4 v112, s[8:11], s52 offen offset:1024 sc1 lds
    v_mfma_f32_16x16x32_bf16 a[20:23], a[104:107], v[84:87], a[20:23]
    v_cvt_pk_bf16_f32 v93, v98, v99
    v_exp_f32 v96, v60
    buffer_load_dwordx4 v112, s[8:11], s52 offen offset:2048 sc1 lds
    v_mfma_f32_16x16x32_bf16 a[24:27], a[108:111], v[80:83], a[24:27]
    ds_read_b128 a[72:75], v104 offset:10240
    v_add_f32 v103, v103, v96
    buffer_load_dwordx4 v112, s[8:11], s52 offen offset:3072 sc1 lds
    v_mfma_f32_16x16x32_bf16 a[28:31], a[108:111], v[84:87], a[28:31]
    v_exp_f32 v97, v61
    s_add_u32 s72, s72, 16384
    s_waitcnt lgkmcnt(5)
    v_mfma_f32_16x16x32_bf16 a[32:35], a[112:115], v[80:83], a[32:35]
    ds_read_b128 a[76:79], v104 offset:11264
    v_add_f32 v103, v103, v97
    v_mfma_f32_16x16x32_bf16 a[36:39], a[112:115], v[84:87], a[36:39]
    v_cvt_pk_bf16_f32 v94, v96, v97
    v_exp_f32 v98, v62
    v_mfma_f32_16x16x32_bf16 a[40:43], a[116:119], v[80:83], a[40:43]
    ds_read_b128 a[80:83], v104 offset:12288
    v_add_f32 v103, v103, v98
    v_mfma_f32_16x16x32_bf16 a[44:47], a[116:119], v[84:87], a[44:47]
    v_exp_f32 v99, v63
    s_waitcnt lgkmcnt(5)
    v_mfma_f32_16x16x32_bf16 a[48:51], a[120:123], v[80:83], a[48:51]
    ds_read_b128 a[84:87], v104 offset:13312
    v_add_f32 v103, v103, v99
    v_mfma_f32_16x16x32_bf16 a[52:55], a[120:123], v[84:87], a[52:55]
    v_cvt_pk_bf16_f32 v95, v98, v99
    v_mfma_f32_16x16x32_bf16 a[56:59], a[124:127], v[80:83], a[56:59]
    ds_read_b128 a[88:91], v104 offset:14336
    v_max_f32 v109, v102, v103
    v_cmp_lt_f32 vcc, s76, v109
    v_mfma_f32_16x16x32_bf16 a[60:63], a[124:127], v[84:87], a[60:63]
    v_exp_f32 v96, v8
    s_cbranch_vccnz AT_FIX1
AT_FA_B1:
    s_waitcnt lgkmcnt(5)
    v_mfma_f32_16x16x32_bf16 v[40:43], a[64:67], v[0:3], v[64:67]
    ds_read_b128 a[92:95], v104 offset:15360
    v_add_f32 v100, v102, v96
    v_mfma_f32_16x16x32_bf16 v[56:59], a[64:67], v[4:7], v[72:75]
    v_exp_f32 v97, v9
    s_nop 0
    v_add_f32 v100, v100, v97
    v_cvt_pk_bf16_f32 v80, v96, v97
    v_exp_f32 v98, v10
    v_mfma_f32_16x16x32_bf16 v[44:47], a[68:71], v[0:3], v[68:71]
    ds_read_b128 a[96:99], v106 offset:8192
    v_add_f32 v100, v100, v98
    v_mfma_f32_16x16x32_bf16 v[60:63], a[68:71], v[4:7], v[76:79]
    v_exp_f32 v99, v11
    s_waitcnt lgkmcnt(5)
    v_mfma_f32_16x16x32_bf16 v[40:43], a[72:75], v[16:19], v[40:43]
    ds_read_b128 a[100:103], v106 offset:9216
    v_add_f32 v100, v100, v99
    v_mfma_f32_16x16x32_bf16 v[56:59], a[72:75], v[20:23], v[56:59]
    v_cvt_pk_bf16_f32 v81, v98, v99
    v_exp_f32 v96, v12
    v_mfma_f32_16x16x32_bf16 v[44:47], a[76:79], v[16:19], v[44:47]
    ds_read_b128 a[104:107], v106 offset:10240
    v_add_f32 v100, v100, v96
    v_mfma_f32_16x16x32_bf16 v[60:63], a[76:79], v[20:23], v[60:63]
    v_exp_f32 v97, v13
    s_waitcnt lgkmcnt(5)
    v_mfma_f32_16x16x32_bf16 v[40:43], a[80:83], v[32:35], v[40:43]
    ds_read_b128 a[108:111], v106 offset:11264
    v_add_f32 v100, v100, v97
    v_mfma_f32_16x16x32_bf16 v[56:59], a[80:83], v[36:39], v[56:59]
    v_cvt_pk_bf16_f32 v82, v96, v97
    v_exp_f32 v98, v14
    v_mfma_f32_16x16x32_bf16 v[44:47], a[84:87], v[32:35], v[44:47]
    ds_read_b128 a[112:115], v106 offset:12288
    v_add_f32 v100, v100, v98
    v_mfma_f32_16x16x32_bf16 v[60:63], a[84:87], v[36:39], v[60:63]
    v_exp_f32 v99, v15
    s_waitcnt lgkmcnt(5)
    v_mfma_f32_16x16x32_bf16 v[40:43], a[88:91], v[48:51], v[40:43]
    ds_read_b128 a[116:119], v106 offset:13312
    v_add_f32 v100, v100, v99
    v_mfma_f32_16x16x32_bf16 v[56:59], a[88:91], v[52:55], v[56:59]
    v_cvt_pk_bf16_f32 v83, v98, v99
    v_exp_f32 v96, v24
    v_mfma_f32_16x16x32_bf16 v[44:47], a[92:95], v[48:51], v[44:47]
    ds_read_b128 a[120:123], v106 offset:14336
    v_add_f32 v101, v103, v96
    v_mfma_f32_16x16x32_bf16 v[60:63], a[92:95], v[52:55], v[60:63]
    v_exp_f32 v97, v25
    s_waitcnt lgkmcnt(5)
    v_mfma_f32_16x16x32_bf16 a[0:3], a[96:99], v[88:91], a[0:3]
    ds_read_b128 a[124:127], v106 offset:15360
    v_add_f32 v101, v101, v97
    v_mfma_f32_16x16x32_bf16 a[4:7], a[96:99], v[92:95], a[4:7]
    v_cvt_pk_bf16_f32 v84, v96, v97
    v_exp_f32 v98, v26
    v_add_u32 v106, 0x10000, v104
    v_mfma_f32_16x16x32_bf16 a[8:11], a[100:103], v[88:91], a[8:11]
    ds_read_b128 a[64:67], v105 offset:0
    v_add_f32 v101, v101, v98
    v_mfma_f32_16x16x32_bf16 a[12:15], a[100:103], v[92:95], a[12:15]
    v_exp_f32 v99, v27
    s_waitcnt lgkmcnt(5)
    v_mfma_f32_16x16x32_bf16 a[16:19], a[104:107], v[88:91], a[16:19]
    ds_read_b128 a[68:71], v105 offset:1024
    v_add_f32 v101, v101, v99
    v_mfma_f32_16x16x32_bf16 a[20:23], a[104:107], v[92:95], a[20:23]
    v_cvt_pk_bf16_f32 v85, v98, v99
    v_exp_f32 v96, v28
    v_mov_b32 v104, v105
    v_mfma_f32_16x16x32_bf16 a[24:27], a[108:111], v[88:91], a[24:27]
    ds_read_b128 a[72:75], v105 offset:2048
    v_add_f32 v101, v101, v96
    v_mfma_f32_16x16x32_bf16 a[28:31], a[108:111], v[92:95], a[28:31]
    v_exp_f32 v97, v29
    s_waitcnt lgkmcnt(5)
    v_mfma_f32_16x16x32_bf16 a[32:35], a[112:115], v[88:91], a[32:35]
    ds_read_b128 a[76:79], v105 offset:3072
    v_add_f32 v101, v101, v97
    v_mfma_f32_16x16x32_bf16 a[36:39], a[112:115], v[92:95], a[36:39]
    v_cvt_pk_bf16_f32 v86, v96, v97
    v_exp_f32 v98, v30
    s_sub_u32 s75, s75, 1
    v_mfma_f32_16x16x32_bf16 a[40:43], a[116:119], v[88:91], a[40:43]
    ds_read_b128 a[80:83], v105 offset:4096
    v_add_f32 v101, v101, v98
    v_mfma_f32_16x16x32_bf16 a[44:47], a[116:119], v[92:95], a[44:47]
    v_exp_f32 v99, v31
    s_waitcnt lgkmcnt(5)
    v_mfma_f32_16x16x32_bf16 a[48:51], a[120:123], v[88:91], a[48:51]
    ds_read_b128 a[84:87], v105 offset:5120
    v_add_f32 v101, v101, v99
    v_mfma_f32_16x16x32_bf16 a[52:55], a[120:123], v[92:95], a[52:55]
    v_cvt_pk_bf16_f32 v87, v98, v99
    s_cmp_lg_u32 s75, 0
    v_mfma_f32_16x16x32_bf16 a[56:59], a[124:127], v[88:91], a[56:59]
    ds_read_b128 a[88:91], v105 offset:6144
    v_max_f32 v109, v100, v101
    v_cmp_lt_f32 vcc, s76, v109
    v_mfma_f32_16x16x32_bf16 a[60:63], a[124:127], v[92:95], a[60:63]
    v_exp_f32 v96, v40
    s_cbranch_vccnz AT_FIX0
AT_FA_B0:
    s_cbranch_scc1 AT_FA
    s_mov_b32 s79, 0
    s_branch AT_STEPEND2
.p2align 6
AT_FB:
    s_waitcnt lgkmcnt(6)
    v_mfma_f32_16x16x32_bf16 v[8:11], a[64:67], v[0:3], v[64:67]
    ds_read_b128 a[92:95], v104 offset:7168
    v_add_f32 v102, v100, v96
    v_mfma_f32_16x16x32_bf16 v[24:27], a[64:67], v[4:7], v[72:75]
    v_exp_f32 v97, v41
    s_nop 0
    v_add_f32 v102, v102, v97
    v_cvt_pk_bf16_f32 v88, v96, v97
    v_exp_f32 v98, v42
    v_add_u32 v105, 16384, v104
    s_waitcnt lgkmcnt(6)
    v_mfma_f32_16x16x32_bf16 v[12:15], a[68:71], v[0:3], v[68:71]
    ds_read_b128 a[96:99], v106 offset:0
    v_add_f32 v102, v102, v98
    v_mfma_f32_16x16x32_bf16 v[28:31], a[68:71], v[4:7], v[76:79]
    v_exp_f32 v99, v43
    s_waitcnt lgkmcnt(6)
    v_mfma_f32_16x16x32_bf16 v[8:11], a[72:75], v[16:19], v[8:11]
    ds_read_b128 a[100:103], v106 offset:1024
    v_add_f32 v102, v102, v99
    v_mfma_f32_16x16x32_bf16 v[24:27], a[72:75], v[20:23], v[24:27]
    v_cvt_pk_bf16_f32 v89, v98, v99
    v_exp_f32 v96, v44
    v_and_b32 v105, 0xffff, v105
    s_waitcnt lgkmcnt(6)
    v_mfma_f32_16x16x32_bf16 v[12:15], a[76:79], v[16:19], v[12:15]
    ds_read_b128 a[104:107], v106 offset:2048
    v_add_f32 v102, v102, v96
    v_mfma_f32_16x16x32_bf16 v[28:31], a[76:79], v[20:23], v[28:31]
    v_exp_f32 v97, v45
    s_waitcnt lgkmcnt(6)
    v_mfma_f32_16x16x32_bf16 v[8:11], a[80:83], v[32:35], v[8:11]
    ds_read_b128 a[108:111], v106 offset:3072
    v_add_f32 v102, v102, v97
    s_barrier
    v_mfma_f32_16x16x32_bf16 v[24:27], a[80:83], v[36:39], v[24:27]
    v_cvt_pk_bf16_f32 v90, v96, v97
    v_exp_f32 v98, v46
    s_waitcnt lgkmcnt(6)
    v_mfma_f32_16x16x32_bf16 v[12:15], a[84:87], v[32:35], v[12:15]
    ds_read_b128 a[112:115], v106 offset:4096
    v_add_f32 v102, v102, v98
    v_mfma_f32_16x16x32_bf16 v[28:31], a[84:87], v[36:39], v[28:31]
    v_exp_f32 v99, v47
    s_waitcnt lgkmcnt(5)
    v_mfma_f32_16x16x32_bf16 v[8:11], a[88:91], v[48:51], v[8:11]
    ds_read_b128 a[116:119], v106 offset:5120
    v_add_f32 v102, v102, v99
    v_mfma_f32_16x16x32_bf16 v[24:27], a[88:91], v[52:55], v[24:27]
    v_cvt_pk_bf16_f32 v91, v98, v99
    v_exp_f32 v96, v56
    v_mfma_f32_16x16x32_bf16 v[12:15], a[92:95], v[48:51], v[12:15]
    ds_read_b128 a[120:123], v106 offset:6144
    v_add_f32 v103, v101, v96
    v_mfma_f32_16x16x32_bf16 v[28:31], a[92:95], v[52:55], v[28:31]
    v_exp_f32 v97, v57
    s_waitcnt lgkmcnt(5)
    v_mfma_f32_16x16x32_bf16 a[0:3], a[96:99], v[80:83], a[0:3]
    ds_read_b128 a[124:127], v106 offset:7168
    v_add_f32 v103, v103, v97
    v_mfma_f32_16x16x32_bf16 a[4:7], a[96:99], v[84:87], a[4:7]
    v_cvt_pk_bf16_f32 v92, v96, v97
    v_exp_f32 v98, v58
    v_mfma_f32_16x16x32_bf16 a[8:11], a[100:103], v[80:83], a[8:11]
    ds_read_b128 a[64:67], v104 offset:8192
    v_add_f32 v103, v103, v98
    v_mfma_f32_16x16x32_bf16 a[12:15], a[100:103], v[84:87], a[12:15]
    v_exp_f32 v99, v59
    s_waitcnt lgkmcnt(5)
    v_mfma_f32_16x16x32_bf16 a[16:19], a[104:107], v[80:83], a[16:19]
    ds_read_b128 a[68:71], v104 offset:9216
    v_add_f32 v103, v103, v99
    v_mfma_f32_16x16x32_bf16 a[20:23], a[104:107], v[84:87], a[20:23]
    v_cvt_pk_bf16_f32 v93, v98, v99
    v_exp_f32 v96, v60
    v_mfma_f32_16x16x32_bf16 a[24:27], a[108:111], v[80:83], a[24:27]
    ds_read_b128 a[72:75], v104 offset:10240
    v_add_f32 v103, v103, v96
    v_mfma_f32_16x16x32_bf16 a[28:31], a[108:111], v[84:87], a[28:31]
    v_exp_f32 v97, v61
    s_waitcnt lgkmcnt(5)
    v_mfma_f32_16x16x32_bf16 a[32:35], a[112:115], v[80:83], a[32:35]
    ds_read_b128 a[76:79], v104 offset:11264
    v_add_f32 v103, v103, v97
    v_mfma_f32_16x16x32_bf16 a[36:39], a[112:115], v[84:87], a[36:39]
    v_cvt_pk_bf16_f32 v94, v96, v97
    v_exp_f32 v98, v62
    v_mfma_f32_16x16x32_bf16 a[40:43], a[116:119], v[80:83], a[40:43]
    ds_read_b128 a[80:83], v104 offset:12288
    v_add_f32 v103, v103, v98
    v_mfma_f32_16x16x32_bf16 a[44:47], a[116:119], v[84:87], a[44:47]
    v_exp_f32 v99, v63
    s_waitcnt lgkmcnt(5)
    v_mfma_f32_16x16x32_bf16 a[48:51], a[120:123], v[80:83], a[48:51]
    ds_read_b128 a[84:87], v104 offset:13312
    v_add_f32 v103, v103, v99
    v_mfma_f32_16x16x32_bf16 a[52:55], a[120:123], v[84:87], a[52:55]
    v_cvt_pk_bf16_f32 v95, v98, v99
    v_mfma_f32_16x16x32_bf16 a[56:59], a[124:127], v[80:83], a[56:59]
    ds_read_b128 a[88:91], v104 offset:14336
    v_max_f32 v109, v102, v103
    v_cmp_lt_f32 vcc, s76, v109
    v_mfma_f32_16x16x32_bf16 a[60:63], a[124:127], v[84:87], a[60:63]
    v_exp_f32 v96, v8
    s_cbranch_vccnz AT_FIX1
AT_FB_B1:
    s_waitcnt lgkmcnt(5)
    v_mfma_f32_16x16x32_bf16 v[40:43], a[64:67], v[0:3], v[64:67]
    ds_read_b128 a[92:95], v104 offset:15360
    v_add_f32 v100, v102, v96
    v_mfma_f32_16x16x32_bf16 v[56:59], a[64:67], v[4:7], v[72:75]
    v_exp_f32 v97, v9
    s_nop 0
    v_add_f32 v100, v100, v97
    v_cvt_pk_bf16_f32 v80, v96, v97
    v_exp_f32 v98, v10
    v_mfma_f32_16x16x32_bf16 v[44:47], a[68:71], v[0:3], v[68:71]
    ds_read_b128 a[96:99], v106 offset:8192
    v_add_f32 v100, v100, v98
    v_mfma_f32_16x16x32_bf16 v[60:63], a[68:71], v[4:7], v[76:79]
    v_exp_f32 v99, v11
    s_waitcnt lgkmcnt(5)
    v_mfma_f32_16x16x32_bf16 v[40:43], a[72:75], v[16:19], v[40:43]
    ds_read_b128 a[100:103], v106 offset:9216
    v_add_f32 v100, v100, v99
    v_mfma_f32_16x16x32_bf16 v[56:59], a[72:75], v[20:23], v[56:59]
    v_cvt_pk_bf16_f32 v81, v98, v99
    v_exp_f32 v96, v12
    v_mfma_f32_16x16x32_bf16 v[44:47], a[76:79], v[16:19], v[44:47]
    ds_read_b128 a[104:107], v106 offset:10240
    v_add_f32 v100, v100, v96
    v_mfma_f32_16x16x32_bf16 v[60:63], a[76:79], v[20:23], v[60:63]
    v_exp_f32 v97, v13
    s_waitcnt lgkmcnt(5)
    v_mfma_f32_16x16x32_bf16 v[40:43], a[80:83], v[32:35], v[40:43]
    ds_read_b128 a[108:111], v106 offset:11264
    v_add_f32 v100, v100, v97
    v_mfma_f32_16x16x32_bf16 v[56:59], a[80:83], v[36:39], v[56:59]
    v_cvt_pk_bf16_f32 v82, v96, v97
    v_exp_f32 v98, v14
    v_mfma_f32_16x16x32_bf16 v[44:47], a[84:87], v[32:35], v[44:47]
    ds_read_b128 a[112:115], v106 offset:12288
    v_add_f32 v100, v100, v98
    v_mfma_f32_16x16x32_bf16 v[60:63], a[84:87], v[36:39], v[60:63]
    v_exp_f32 v99, v15
    s_waitcnt lgkmcnt(5)
    v_mfma_f32_16x16x32_bf16 v[40:43], a[88:91], v[48:51], v[40:43]
    ds_read_b128 a[116:119], v106 offset:13312
    v_add_f32 v100, v100, v99
    v_mfma_f32_16x16x32_bf16 v[56:59], a[88:91], v[52:55], v[56:59]
    v_cvt_pk_bf16_f32 v83, v98, v99
    v_exp_f32 v96, v24
    v_mfma_f32_16x16x32_bf16 v[44:47], a[92:95], v[48:51], v[44:47]
    ds_read_b128 a[120:123], v106 offset:14336
    v_add_f32 v101, v103, v96
    v_mfma_f32_16x16x32_bf16 v[60:63], a[92:95], v[52:55], v[60:63]
    v_exp_f32 v97, v25
    s_waitcnt lgkmcnt(5)
    v_mfma_f32_16x16x32_bf16 a[0:3], a[96:99], v[88:91], a[0:3]
    ds_read_b128 a[124:127], v106 offset:15360
    v_add_f32 v101, v101, v97
    v_mfma_f32_16x16x32_bf16 a[4:7], a[96:99], v[92:95], a[4:7]
    v_cvt_pk_bf16_f32 v84, v96, v97
    v_exp_f32 v98, v26
    v_add_u32 v106, 0x10000, v104
    v_mfma_f32_16x16x32_bf16 a[8:11], a[100:103], v[88:91], a[8:11]
    ds_read_b128 a[64:67], v105 offset:0
    v_add_f32 v101, v101, v98
    v_mfma_f32_16x16x32_bf16 a[12:15], a[100:103], v[92:95], a[12:15]
    v_exp_f32 v99, v27
    s_waitcnt lgkmcnt(5)
    v_mfma_f32_16x16x32_bf16 a[16:19], a[104:107], v[88:91], a[16:19]
    ds_read_b128 a[68:71], v105 offset:1024
    v_add_f32 v101, v101, v99
    v_mfma_f32_16x16x32_bf16 a[20:23], a[104:107], v[92:95], a[20:23]
    v_cvt_pk_bf16_f32 v85, v98, v99
    v_exp_f32 v96, v28
    v_mov_b32 v104, v105
    v_mfma_f32_16x16x32_bf16 a[24:27], a[108:111], v[88:91], a[24:27]
    ds_read_b128 a[72:75], v105 offset:2048
    v_add_f32 v101, v101, v96
    v_mfma_f32_16x16x32_bf16 a[28:31], a[108:111], v[92:95], a[28:31]
    v_exp_f32 v97, v29
    s_waitcnt lgkmcnt(5)
    v_mfma_f32_16x16x32_bf16 a[32:35], a[112:115], v[88:91], a[32:35]
    ds_read_b128 a[76:79], v105 offset:3072
    v_add_f32 v101, v101, v97
    v_mfma_f32_16x16x32_bf16 a[36:39], a[112:115], v[92:95], a[36:39]
    v_cvt_pk_bf16_f32 v86, v96, v97
    v_exp_f32 v98, v30
    s_sub_u32 s75, s75, 1
    v_mfma_f32_16x16x32_bf16 a[40:43], a[116:119], v[88:91], a[40:43]
    ds_read_b128 a[80:83], v105 offset:4096
    v_add_f32 v101, v101, v98
    v_mfma_f32_16x16x32_bf16 a[44:47], a[116:119], v[92:95], a[44:47]
    v_exp_f32 v99, v31
    s_waitcnt lgkmcnt(5)
    v_mfma_f32_16x16x32_bf16 a[48:51], a[120:123], v[88:91], a[48:51]
    ds_read_b128 a[84:87], v105 offset:5120
    v_add_f32 v101, v101, v99
    v_mfma_f32_16x16x32_bf16 a[52:55], a[120:123], v[92:95], a[52:55]
    v_cvt_pk_bf16_f32 v87, v98, v99
    s_cmp_lg_u32 s75, 0
    v_mfma_f32_16x16x32_bf16 a[56:59], a[124:127], v[88:91], a[56:59]
    ds_read_b128 a[88:91], v105 offset:6144
    v_max_f32 v109, v100, v101
    v_cmp_lt_f32 vcc, s76, v109
    v_mfma_f32_16x16x32_bf16 a[60:63], a[124:127], v[92:95], a[60:63]
    v_exp_f32 v96, v40
    s_cbranch_vccnz AT_FIX0
AT_FB_B0:
    s_cbranch_scc1 AT_FB
    s_mov_b32 s79, 0
    s_branch AT_STEPEND2
AT_STEPEND:
    v_add_u32 v106, 0x10000, v104
    v_mov_b32 v104, v105
AT_STEPEND2:
    v_add_u32 v105, 16384, v104
    v_and_b32 v105, 0xffff, v105
    s_waitcnt vmcnt(8)
    s_barrier
    s_cmp_ge_u32 s3, 4
    s_cbranch_scc1 AT_RE1
    s_min_u32 s6, s71, s73
    s_and_b32 s7, s72, 0xffff
    s_add_u32 m0, s7, s74
    s_add_u32 s52, s6, 4096
    buffer_load_dwordx4 v112, s[8:11], s6 offen offset:0 sc1 lds
    buffer_load_dwordx4 v112, s[8:11], s6 offen offset:1024 sc1 lds
    buffer_load_dwordx4 v112, s[8:11], s6 offen offset:2048 sc1 lds
    buffer_load_dwordx4 v112, s[8:11], s6 offen offset:3072 sc1 lds
    s_add_u32 m0, m0, 4096
    s_add_u32 s71, s71, 16384
    buffer_load_dwordx4 v112, s[8:11], s52 offen offset:0 sc1 lds
    buffer_load_dwordx4 v112, s[8:11], s52 offen offset:1024 sc1 lds
    buffer_load_dwordx4 v112, s[8:11], s52 offen offset:2048 sc1 lds
    buffer_load_dwordx4 v112, s[8:11], s52 offen offset:3072 sc1 lds
    s_add_u32 s72, s72, 16384
AT_RE1:
    s_add_u32 s77, s77, 1
    s_cmp_ge_u32 s77, s61
    s_cbranch_scc1 AT_H1
AT_P1:
    s_waitcnt lgkmcnt(6)
    v_mfma_f32_16x16x32_bf16 v[8:11], a[64:67], v[0:3], v[64:67]
    ds_read_b128 a[92:95], v104 offset:7168
    v_add_f32 v102, v100, v96
    v_mfma_f32_16x16x32_bf16 v[24:27], a[64:67], v[4:7], v[72:75]
    v_exp_f32 v97, v41
    s_nop 0
    v_add_f32 v102, v102, v97
    v_cvt_pk_bf16_f32 v88, v96, v97
    v_exp_f32 v98, v42
    s_waitcnt lgkmcnt(6)
    v_mfma_f32_16x16x32_bf16 v[12:15], a[68:71], v[0:3], v[68:71]
    ds_read_b128 a[96:99], v106 offset:0
    v_add_f32 v102, v102, v98
    v_mfma_f32_16x16x32_bf16 v[28:31], a[68:71], v[4:7], v[76:79]
    v_exp_f32 v99, v43
    s_waitcnt lgkmcnt(6)
    v_mfma_f32_16x16x32_bf16 v[8:11], a[72:75], v[16:19], v[8:11]
    ds_read_b128 a[100:103], v106 offset:1024
    v_add_f32 v102, v102, v99
    v_mfma_f32_16x16x32_bf16 v[24:27], a[72:75], v[20:23], v[24:27]
    v_cvt_pk_bf16_f32 v89, v98, v99
    v_exp_f32 v96, v44
    s_waitcnt lgkmcnt(6)
    v_mfma_f32_16x16x32_bf16 v[12:15], a[76:79], v[16:19], v[12:15]
    ds_read_b128 a[104:107], v106 offset:2048
    v_add_f32 v102, v102, v96
    v_mfma_f32_16x16x32_bf16 v[28:31], a[76:79], v[20:23], v[28:31]
    v_exp_f32 v97, v45
    s_waitcnt lgkmcnt(6)
    v_mfma_f32_16x16x32_bf16 v[8:11], a[80:83], v[32:35], v[8:11]
    ds_read_b128 a[108:111], v106 offset:3072
    v_add_f32 v102, v102, v97
    v_mfma_f32_16x16x32_bf16 v[24:27], a[80:83], v[36:39], v[24:27]
    v_cvt_pk_bf16_f32 v90, v96, v97
    v_exp_f32 v98, v46
    s_waitcnt lgkmcnt(6)
    v_mfma_f32_16x16x32_bf16 v[12:15], a[84:87], v[32:35], v[12:15]
    ds_read_b128 a[112:115], v106 offset:4096
    v_add_f32 v102, v102, v98
    v_mfma_f32_16x16x32_bf16 v[28:31], a[84:87], v[36:39], v[28:31]
    v_exp_f32 v99, v47
    s_waitcnt lgkmcnt(5)
    v_mfma_f32_16x16x32_bf16 v[8:11], a[88:91], v[48:51], v[8:11]
    ds_read_b128 a[116:119], v106 offset:5120
    v_add_f32 v102, v102, v99
    v_mfma_f32_16x16x32_bf16 v[24:27], a[88:91], v[52:55], v[24:27]
    v_cvt_pk_bf16_f32 v91, v98, v99
    v_exp_f32 v96, v56
    v_mfma_f32_16x16x32_bf16 v[12:15], a[92:95], v[48:51], v[12:15]
    ds_read_b128 a[120:123], v106 offset:6144
    v_add_f32 v103, v101, v96
    v_mfma_f32_16x16x32_bf16 v[28:31], a[92:95], v[52:55], v[28:31]
    v_exp_f32 v97, v57
    s_waitcnt lgkmcnt(5)
    v_mfma_f32_16x16x32_bf16 a[0:3], a[96:99], v[80:83], a[0:3]
    ds_read_b128 a[124:127], v106 offset:7168
    v_add_f32 v103, v103, v97
    v_mfma_f32_16x16x32_bf16 a[4:7], a[96:99], v[84:87], a[4:7]
    v_cvt_pk_bf16_f32 v92, v96, v97
    v_exp_f32 v98, v58
    v_mfma_f32_16x16x32_bf16 a[8:11], a[100:103], v[80:83], a[8:11]
    ds_read_b128 a[64:67], v104 offset:8192
    v_add_f32 v103, v103, v98
    v_mfma_f32_16x16x32_bf16 a[12:15], a[100:103], v[84:87], a[12:15]
    v_exp_f32 v99, v59
    s_waitcnt lgkmcnt(5)
    v_mfma_f32_16x16x32_bf16 a[16:19], a[104:107], v[80:83], a[16:19]
    ds_read_b128 a[68:71], v104 offset:9216
    v_add_f32 v103, v103, v99
    v_mfma_f32_16x16x32_bf16 a[20:23], a[104:107], v[84:87], a[20:23]
    v_cvt_pk_bf16_f32 v93, v98, v99
    v_exp_f32 v96, v60
    v_mfma_f32_16x16x32_bf16 a[24:27], a[108:111], v[80:83], a[24:27]
    ds_read_b128 a[72:75], v104 offset:10240
    v_add_f32 v103, v103, v96
    v_mfma_f32_16x16x32_bf16 a[28:31], a[108:111], v[84:87], a[28:31]
    v_exp_f32 v97, v61
    s_waitcnt lgkmcnt(5)
    v_mfma_f32_16x16x32_bf16 a[32:35], a[112:115], v[80:83], a[32:35]
    ds_read_b128 a[76:79], v104 offset:11264
    v_add_f32 v103, v103, v97
    v_mfma_f32_16x16x32_bf16 a[36:39], a[112:115], v[84:87], a[36:39]
    v_cvt_pk_bf16_f32 v94, v96, v97
    v_exp_f32 v98, v62
    v_mfma_f32_16x16x32_bf16 a[40:43], a[116:119], v[80:83], a[40:43]
    ds_read_b128 a[80:83], v104 offset:12288
    v_add_f32 v103, v103, v98
    v_mfma_f32_16x16x32_bf16 a[44:47], a[116:119], v[84:87], a[44:47]
    v_exp_f32 v99, v63
    s_waitcnt lgkmcnt(5)
    v_mfma_f32_16x16x32_bf16 a[48:51], a[120:123], v[80:83], a[48:51]
    ds_read_b128 a[84:87], v104 offset:13312
    v_add_f32 v103, v103, v99
    v_mfma_f32_16x16x32_bf16 a[52:55], a[120:123], v[84:87], a[52:55]
    v_cvt_pk_bf16_f32 v95, v98, v99
    v_mfma_f32_16x16x32_bf16 a[56:59], a[124:127], v[80:83], a[56:59]
    ds_read_b128 a[88:91], v104 offset:14336
    v_max_f32 v109, v102, v103
    v_cmp_lt_f32 vcc, s76, v109
    v_mfma_f32_16x16x32_bf16 a[60:63], a[124:127], v[84:87], a[60:63]
    v_exp_f32 v96, v8
    s_cbranch_vccnz AT_FIX1
AT_B1:
    s_add_u32 s77, s77, 1
    s_cmp_ge_u32 s77, s61
    s_cbranch_scc1 AT_H0
AT_P0:
    s_waitcnt lgkmcnt(5)
    v_mfma_f32_16x16x32_bf16 v[40:43], a[64:67], v[0:3], v[64:67]
    ds_read_b128 a[92:95], v104 offset:15360
    v_add_f32 v100, v102, v96
    v_mfma_f32_16x16x32_bf16 v[56:59], a[64:67], v[4:7], v[72:75]
    v_exp_f32 v97, v9
    s_nop 0
    v_add_f32 v100, v100, v97
    v_cvt_pk_bf16_f32 v80, v96, v97
    v_exp_f32 v98, v10
    v_mfma_f32_16x16x32_bf16 v[44:47], a[68:71], v[0:3], v[68:71]
    ds_read_b128 a[96:99], v106 offset:8192
    v_add_f32 v100, v100, v98
    v_mfma_f32_16x16x32_bf16 v[60:63], a[68:71], v[4:7], v[76:79]
    v_exp_f32 v99, v11
    s_waitcnt lgkmcnt(5)
    v_mfma_f32_16x16x32_bf16 v[40:43], a[72:75], v[16:19], v[40:43]
    ds_read_b128 a[100:103], v106 offset:9216
    v_add_f32 v100, v100, v99
    v_mfma_f32_16x16x32_bf16 v[56:59], a[72:75], v[20:23], v[56:59]
    v_cvt_pk_bf16_f32 v81, v98, v99
    v_exp_f32 v96, v12
    v_mfma_f32_16x16x32_bf16 v[44:47], a[76:79], v[16:19], v[44:47]
    ds_read_b128 a[104:107], v106 offset:10240
    v_add_f32 v100, v100, v96
    v_mfma_f32_16x16x32_bf16 v[60:63], a[76:79], v[20:23], v[60:63]
    v_exp_f32 v97, v13
    s_waitcnt lgkmcnt(5)
    v_mfma_f32_16x16x32_bf16 v[40:43], a[80:83], v[32:35], v[40:43]
    ds_read_b128 a[108:111], v106 offset:11264
    v_add_f32 v100, v100, v97
    v_mfma_f32_16x16x32_bf16 v[56:59], a[80:83], v[36:39], v[56:59]
    v_cvt_pk_bf16_f32 v82, v96, v97
    v_exp_f32 v98, v14
    v_mfma_f32_16x16x32_bf16 v[44:47], a[84:87], v[32:35], v[44:47]
    ds_read_b128 a[112:115], v106 offset:12288
    v_add_f32 v100, v100, v98
    v_mfma_f32_16x16x32_bf16 v[60:63], a[84:87], v[36:39], v[60:63]
    v_exp_f32 v99, v15
    s_waitcnt lgkmcnt(5)
    v_mfma_f32_16x16x32_bf16 v[40:43], a[88:91], v[48:51], v[40:43]
    ds_read_b128 a[116:119], v106 offset:13312
    v_add_f32 v100, v100, v99
    v_mfma_f32_16x16x32_bf16 v[56:59], a[88:91], v[52:55], v[56:59]
    v_cvt_pk_bf16_f32 v83, v98, v99
    v_exp_f32 v96, v24
    v_mfma_f32_16x16x32_bf16 v[44:47], a[92:95], v[48:51], v[44:47]
    ds_read_b128 a[120:123], v106 offset:14336
    v_add_f32 v101, v103, v96
    v_mfma_f32_16x16x32_bf16 v[60:63], a[92:95], v[52:55], v[60:63]
    v_exp_f32 v97, v25
    s_waitcnt lgkmcnt(5)
    v_mfma_f32_16x16x32_bf16 a[0:3], a[96:99], v[88:91], a[0:3]
    ds_read_b128 a[124:127], v106 offset:15360
    v_add_f32 v101, v101, v97
    v_mfma_f32_16x16x32_bf16 a[4:7], a[96:99], v[92:95], a[4:7]
    v_cvt_pk_bf16_f32 v84, v96, v97
    v_exp_f32 v98, v26
    v_mfma_f32_16x16x32_bf16 a[8:11], a[100:103], v[88:91], a[8:11]
    ds_read_b128 a[64:67], v105 offset:0
    v_add_f32 v101, v101, v98
    v_mfma_f32_16x16x32_bf16 a[12:15], a[100:103], v[92:95], a[12:15]
    v_exp_f32 v99, v27
    s_waitcnt lgkmcnt(5)
    v_mfma_f32_16x16x32_bf16 a[16:19], a[104:107], v[88:91], a[16:19]
    ds_read_b128 a[68:71], v105 offset:1024
    v_add_f32 v101, v101, v99
    v_mfma_f32_16x16x32_bf16 a[20:23], a[104:107], v[92:95], a[20:23]
    v_cvt_pk_bf16_f32 v85, v98, v99
    v_exp_f32 v96, v28
    v_mfma_f32_16x16x32_bf16 a[24:27], a[108:111], v[88:91], a[24:27]
    ds_read_b128 a[72:75], v105 offset:2048
    v_add_f32 v101, v101, v96
    v_mfma_f32_16x16x32_bf16 a[28:31], a[108:111], v[92:95], a[28:31]
    v_exp_f32 v97, v29
    s_waitcnt lgkmcnt(5)
    v_mfma_f32_16x16x32_bf16 a[32:35], a[112:115], v[88:91], a[32:35]
    ds_read_b128 a[76:79], v105 offset:3072
    v_add_f32 v101, v101, v97
    v_mfma_f32_16x16x32_bf16 a[36:39], a[112:115], v[92:95], a[36:39]
    v_cvt_pk_bf16_f32 v86, v96, v97
    v_exp_f32 v98, v30
    v_mfma_f32_16x16x32_bf16 a[40:43], a[116:119], v[88:91], a[40:43]
    ds_read_b128 a[80:83], v105 offset:4096
    v_add_f32 v101, v101, v98
    v_mfma_f32_16x16x32_bf16 a[44:47], a[116:119], v[92:95], a[44:47]
    v_exp_f32 v99, v31
    s_waitcnt lgkmcnt(5)
    v_mfma_f32_16x16x32_bf16 a[48:51], a[120:123], v[88:91], a[48:51]
    ds_read_b128 a[84:87], v105 offset:5120
    v_add_f32 v101, v101, v99
    v_mfma_f32_16x16x32_bf16 a[52:55], a[120:123], v[92:95], a[52:55]
    v_cvt_pk_bf16_f32 v87, v98, v99
    v_mfma_f32_16x16x32_bf16 a[56:59], a[124:127], v[88:91], a[56:59]
    ds_read_b128 a[88:91], v105 offset:6144
    v_max_f32 v109, v100, v101
    v_cmp_lt_f32 vcc, s76, v109
    v_mfma_f32_16x16x32_bf16 a[60:63], a[124:127], v[92:95], a[60:63]
    v_exp_f32 v96, v40
    s_cbranch_vccnz AT_FIX0
AT_B0:
    s_branch AT_STEPEND
AT_FIX1:
    s_nop 7
    v_log_f32 v110, v100
    v_max3_f32 v109, v40, v41, v42
    v_max3_f32 v109, v109, v43, v44
    v_max3_f32 v109, v109, v45, v46
    v_max_f32 v109, v109, v47
    v_add_f32 v110, 0xc1400000, v110
    v_max_f32 v109, v109, v110
    v_mov_b32 v110, v109
    s_nop 1
    v_permlane16_swap_b32 v110, v109
    s_nop 1
    v_max_f32 v109, v109, v110
    v_mov_b32 v110, v109
    s_nop 1
    v_permlane32_swap_b32 v110, v109
    s_nop 1
    v_max_f32 v109, v109, v110
    v_ceil_f32 v109, v109
    v_max_f32 v109, 0, v109
    v_exp_f32 v110, -v109
    v_sub_f32 v40, v40, v109
    v_sub_f32 v8, v8, v109
    v_sub_f32 v64, v64, v109
    v_sub_f32 v41, v41, v109
    v_sub_f32 v9, v9, v109
    v_sub_f32 v65, v65, v109
    v_sub_f32 v42, v42, v109
    v_sub_f32 v10, v10, v109
    v_sub_f32 v66, v66, v109
    v_sub_f32 v43, v43, v109
    v_sub_f32 v11, v11, v109
    v_sub_f32 v67, v67, v109
    v_sub_f32 v44, v44, v109
    v_sub_f32 v12, v12, v109
    v_sub_f32 v68, v68, v109
    v_sub_f32 v45, v45, v109
    v_sub_f32 v13, v13, v109
    v_sub_f32 v69, v69, v109
    v_sub_f32 v46, v46, v109
    v_sub_f32 v14, v14, v109
    v_sub_f32 v70, v70, v109
    v_sub_f32 v47, v47, v109
    v_sub_f32 v15, v15, v109
    v_sub_f32 v71, v71, v109
    v_accvgpr_read_b32 v96, a0
    v_mul_f32 v96, v96, v110
    v_accvgpr_write_b32 a0, v96
    v_accvgpr_read_b32 v97, a1
    v_mul_f32 v97, v97, v110
    v_accvgpr_write_b32 a1, v97
    v_accvgpr_read_b32 v98, a2
    v_mul_f32 v98, v98, v110
    v_accvgpr_write_b32 a2, v98
    v_accvgpr_read_b32 v99, a3
    v_mul_f32 v99, v99, v110
    v_accvgpr_write_b32 a3, v99
    v_accvgpr_read_b32 v96, a8
    v_mul_f32 v96, v96, v110
    v_accvgpr_write_b32 a8, v96
    v_accvgpr_read_b32 v97, a9
    v_mul_f32 v97, v97, v110
    v_accvgpr_write_b32 a9, v97
    v_accvgpr_read_b32 v98, a10
    v_mul_f32 v98, v98, v110
    v_accvgpr_write_b32 a10, v98
    v_accvgpr_read_b32 v99, a11
    v_mul_f32 v99, v99, v110
    v_accvgpr_write_b32 a11, v99
    v_accvgpr_read_b32 v96, a16
    v_mul_f32 v96, v96, v110
    v_accvgpr_write_b32 a16, v96
    v_accvgpr_read_b32 v97, a17
    v_mul_f32 v97, v97, v110
    v_accvgpr_write_b32 a17, v97
    v_accvgpr_read_b32 v98, a18
    v_mul_f32 v98, v98, v110
    v_accvgpr_write_b32 a18, v98
    v_accvgpr_read_b32 v99, a19
    v_mul_f32 v99, v99, v110
    v_accvgpr_write_b32 a19, v99
    v_accvgpr_read_b32 v96, a24
    v_mul_f32 v96, v96, v110
    v_accvgpr_write_b32 a24, v96
    v_accvgpr_read_b32 v97, a25
    v_mul_f32 v97, v97, v110
    v_accvgpr_write_b32 a25, v97
    v_accvgpr_read_b32 v98, a26
    v_mul_f32 v98, v98, v110
    v_accvgpr_write_b32 a26, v98
    v_accvgpr_read_b32 v99, a27
    v_mul_f32 v99, v99, v110
    v_accvgpr_write_b32 a27, v99
    v_accvgpr_read_b32 v96, a32
    v_mul_f32 v96, v96, v110
    v_accvgpr_write_b32 a32, v96
    v_accvgpr_read_b32 v97, a33
    v_mul_f32 v97, v97, v110
    v_accvgpr_write_b32 a33, v97
    v_accvgpr_read_b32 v98, a34
    v_mul_f32 v98, v98, v110
    v_accvgpr_write_b32 a34, v98
    v_accvgpr_read_b32 v99, a35
    v_mul_f32 v99, v99, v110
    v_accvgpr_write_b32 a35, v99
    v_accvgpr_read_b32 v96, a40
    v_mul_f32 v96, v96, v110
    v_accvgpr_write_b32 a40, v96
    v_accvgpr_read_b32 v97, a41
    v_mul_f32 v97, v97, v110
    v_accvgpr_write_b32 a41, v97
    v_accvgpr_read_b32 v98, a42
    v_mul_f32 v98, v98, v110
    v_accvgpr_write_b32 a42, v98
    v_accvgpr_read_b32 v99, a43
    v_mul_f32 v99, v99, v110
    v_accvgpr_write_b32 a43, v99
    v_accvgpr_read_b32 v96, a48
    v_mul_f32 v96, v96, v110
    v_accvgpr_write_b32 a48, v96
    v_accvgpr_read_b32 v97, a49
    v_mul_f32 v97, v97, v110
    v_accvgpr_write_b32 a49, v97
    v_accvgpr_read_b32 v98, a50
    v_mul_f32 v98, v98, v110
    v_accvgpr_write_b32 a50, v98
    v_accvgpr_read_b32 v99, a51
    v_mul_f32 v99, v99, v110
    v_accvgpr_write_b32 a51, v99
    v_accvgpr_read_b32 v96, a56
    v_mul_f32 v96, v96, v110
    v_accvgpr_write_b32 a56, v96
    v_accvgpr_read_b32 v97, a57
    v_mul_f32 v97, v97, v110
    v_accvgpr_write_b32 a57, v97
    v_accvgpr_read_b32 v98, a58
    v_mul_f32 v98, v98, v110
    v_accvgpr_write_b32 a58, v98
    v_accvgpr_read_b32 v99, a59
    v_mul_f32 v99, v99, v110
    v_accvgpr_write_b32 a59, v99
    v_mul_f32 v102, v100, v110
    v_exp_f32 v96, v40
    v_exp_f32 v97, v41
    s_nop 0
    v_add_f32 v102, v102, v96
    v_add_f32 v102, v102, v97
    v_cvt_pk_bf16_f32 v88, v96, v97
    v_exp_f32 v96, v42
    v_exp_f32 v97, v43
    s_nop 0
    v_add_f32 v102, v102, v96
    v_add_f32 v102, v102, v97
    v_cvt_pk_bf16_f32 v89, v96, v97
    v_exp_f32 v96, v44
    v_exp_f32 v97, v45
    s_nop 0
    v_add_f32 v102, v102, v96
    v_add_f32 v102, v102, v97
    v_cvt_pk_bf16_f32 v90, v96, v97
    v_exp_f32 v96, v46
    v_exp_f32 v97, v47
    s_nop 0
    v_add_f32 v102, v102, v96
    v_add_f32 v102, v102, v97
    v_cvt_pk_bf16_f32 v91, v96, v97
    v_log_f32 v110, v101
    v_max3_f32 v109, v56, v57, v58
    v_max3_f32 v109, v109, v59, v60
    v_max3_f32 v109, v109, v61, v62
    v_max_f32 v109, v109, v63
    v_add_f32 v110, 0xc1400000, v110
    v_max_f32 v109, v109, v110
    v_mov_b32 v110, v109
    s_nop 1
    v_permlane16_swap_b32 v110, v109
    s_nop 1
    v_max_f32 v109, v109, v110
    v_mov_b32 v110, v109
    s_nop 1
    v_permlane32_swap_b32 v110, v109
    s_nop 1
    v_max_f32 v109, v109, v110
    v_ceil_f32 v109, v109
    v_max_f32 v109, 0, v109
    v_exp_f32 v110, -v109
    v_sub_f32 v56, v56, v109
    v_sub_f32 v24, v24, v109
    v_sub_f32 v72, v72, v109
    v_sub_f32 v57, v57, v109
    v_sub_f32 v25, v25, v109
    v_sub_f32 v73, v73, v109
    v_sub_f32 v58, v58, v109
    v_sub_f32 v26, v26, v109
    v_sub_f32 v74, v74, v109
    v_sub_f32 v59, v59, v109
    v_sub_f32 v27, v27, v109
    v_sub_f32 v75, v75, v109
    v_sub_f32 v60, v60, v109
    v_sub_f32 v28, v28, v109
    v_sub_f32 v76, v76, v109
    v_sub_f32 v61, v61, v109
    v_sub_f32 v29, v29, v109
    v_sub_f32 v77, v77, v109
    v_sub_f32 v62, v62, v109
    v_sub_f32 v30, v30, v109
    v_sub_f32 v78, v78, v109
    v_sub_f32 v63, v63, v109
    v_sub_f32 v31, v31, v109
    v_sub_f32 v79, v79, v109
    v_accvgpr_read_b32 v96, a4
    v_mul_f32 v96, v96, v110
    v_accvgpr_write_b32 a4, v96
    v_accvgpr_read_b32 v97, a5
    v_mul_f32 v97, v97, v110
    v_accvgpr_write_b32 a5, v97
    v_accvgpr_read_b32 v98, a6
    v_mul_f32 v98, v98, v110
    v_accvgpr_write_b32 a6, v98
    v_accvgpr_read_b32 v99, a7
    v_mul_f32 v99, v99, v110
    v_accvgpr_write_b32 a7, v99
    v_accvgpr_read_b32 v96, a12
    v_mul_f32 v96, v96, v110
    v_accvgpr_write_b32 a12, v96
    v_accvgpr_read_b32 v97, a13
    v_mul_f32 v97, v97, v110
    v_accvgpr_write_b32 a13, v97
    v_accvgpr_read_b32 v98, a14
    v_mul_f32 v98, v98, v110
    v_accvgpr_write_b32 a14, v98
    v_accvgpr_read_b32 v99, a15
    v_mul_f32 v99, v99, v110
    v_accvgpr_write_b32 a15, v99
    v_accvgpr_read_b32 v96, a20
    v_mul_f32 v96, v96, v110
    v_accvgpr_write_b32 a20, v96
    v_accvgpr_read_b32 v97, a21
    v_mul_f32 v97, v97, v110
    v_accvgpr_write_b32 a21, v97
    v_accvgpr_read_b32 v98, a22
    v_mul_f32 v98, v98, v110
    v_accvgpr_write_b32 a22, v98
    v_accvgpr_read_b32 v99, a23
    v_mul_f32 v99, v99, v110
    v_accvgpr_write_b32 a23, v99
    v_accvgpr_read_b32 v96, a28
    v_mul_f32 v96, v96, v110
    v_accvgpr_write_b32 a28, v96
    v_accvgpr_read_b32 v97, a29
    v_mul_f32 v97, v97, v110
    v_accvgpr_write_b32 a29, v97
    v_accvgpr_read_b32 v98, a30
    v_mul_f32 v98, v98, v110
    v_accvgpr_write_b32 a30, v98
    v_accvgpr_read_b32 v99, a31
    v_mul_f32 v99, v99, v110
    v_accvgpr_write_b32 a31, v99
    v_accvgpr_read_b32 v96, a36
    v_mul_f32 v96, v96, v110
    v_accvgpr_write_b32 a36, v96
    v_accvgpr_read_b32 v97, a37
    v_mul_f32 v97, v97, v110
    v_accvgpr_write_b32 a37, v97
    v_accvgpr_read_b32 v98, a38
    v_mul_f32 v98, v98, v110
    v_accvgpr_write_b32 a38, v98
    v_accvgpr_read_b32 v99, a39
    v_mul_f32 v99, v99, v110
    v_accvgpr_write_b32 a39, v99
    v_accvgpr_read_b32 v96, a44
    v_mul_f32 v96, v96, v110
    v_accvgpr_write_b32 a44, v96
    v_accvgpr_read_b32 v97, a45
    v_mul_f32 v97, v97, v110
    v_accvgpr_write_b32 a45, v97
    v_accvgpr_read_b32 v98, a46
    v_mul_f32 v98, v98, v110
    v_accvgpr_write_b32 a46, v98
    v_accvgpr_read_b32 v99, a47
    v_mul_f32 v99, v99, v110
    v_accvgpr_write_b32 a47, v99
    v_accvgpr_read_b32 v96, a52
    v_mul_f32 v96, v96, v110
    v_accvgpr_write_b32 a52, v96
    v_accvgpr_read_b32 v97, a53
    v_mul_f32 v97, v97, v110
    v_accvgpr_write_b32 a53, v97
    v_accvgpr_read_b32 v98, a54
    v_mul_f32 v98, v98, v110
    v_accvgpr_write_b32 a54, v98
    v_accvgpr_read_b32 v99, a55
    v_mul_f32 v99, v99, v110
    v_accvgpr_write_b32 a55, v99
    v_accvgpr_read_b32 v96, a60
    v_mul_f32 v96, v96, v110
    v_accvgpr_write_b32 a60, v96
    v_accvgpr_read_b32 v97, a61
    v_mul_f32 v97, v97, v110
    v_accvgpr_write_b32 a61, v97
    v_accvgpr_read_b32 v98, a62
    v_mul_f32 v98, v98, v110
    v_accvgpr_write_b32 a62, v98
    v_accvgpr_read_b32 v99, a63
    v_mul_f32 v99, v99, v110
    v_accvgpr_write_b32 a63, v99
    v_mul_f32 v103, v101, v110
    v_exp_f32 v96, v56
    v_exp_f32 v97, v57
    s_nop 0
    v_add_f32 v103, v103, v96
    v_add_f32 v103, v103, v97
    v_cvt_pk_bf16_f32 v92, v96, v97
    v_exp_f32 v96, v58
    v_exp_f32 v97, v59
    s_nop 0
    v_add_f32 v103, v103, v96
    v_add_f32 v103, v103, v97
    v_cvt_pk_bf16_f32 v93, v96, v97
    v_exp_f32 v96, v60
    v_exp_f32 v97, v61
    s_nop 0
    v_add_f32 v103, v103, v96
    v_add_f32 v103, v103, v97
    v_cvt_pk_bf16_f32 v94, v96, v97
    v_exp_f32 v96, v62
    v_exp_f32 v97, v63
    s_nop 0
    v_add_f32 v103, v103, v96
    v_add_f32 v103, v103, v97
    v_cvt_pk_bf16_f32 v95, v96, v97
    v_exp_f32 v96, v8
    s_cmp_eq_u32 s79, 0
    s_cbranch_scc1 AT_B1
    s_cmp_eq_u32 s79, 2
    s_cbranch_scc1 FXB_17
    s_cmp_lg_u32 s75, 0
    s_branch AT_FA_B1
FXB_17:
    s_cmp_lg_u32 s75, 0
    s_branch AT_FB_B1
AT_H1:
    s_sub_u32 s6, s77, s61
    s_cmp_eq_u32 s6, 1
    s_cbranch_scc1 AT_N1
    s_cmp_eq_u32 s6, 2
    s_cbranch_scc1 AT_T1
    v_mov_b32 v68, v108
    v_cndmask_b32 v64, v64, v108, s[80:81]
    v_cndmask_b32 v76, v76, v108, s[80:81]
    v_mov_b32 v69, v108
    v_cndmask_b32 v65, v65, v108, s[82:83]
    v_cndmask_b32 v77, v77, v108, s[82:83]
    v_mov_b32 v70, v108
    v_cndmask_b32 v66, v66, v108, s[84:85]
    v_cndmask_b32 v78, v78, v108, s[84:85]
    v_mov_b32 v71, v108
    v_cndmask_b32 v67, v67, v108, s[86:87]
    v_cndmask_b32 v79, v79, v108, s[86:87]
    s_nop 1
    s_branch AT_P1
AT_N1:
    s_waitcnt lgkmcnt(0)
    ds_read_b128 a[96:99], v106 offset:0
    ds_read_b128 a[100:103], v106 offset:1024
    ds_read_b128 a[104:107], v106 offset:2048
    ds_read_b128 a[108:111], v106 offset:3072
    ds_read_b128 a[112:115], v106 offset:4096
    ds_read_b128 a[116:119], v106 offset:5120
    ds_read_b128 a[120:123], v106 offset:6144
    ds_read_b128 a[124:127], v106 offset:7168
    s_waitcnt lgkmcnt(7)
    v_mfma_f32_16x16x32_bf16 a[0:3], a[96:99], v[80:83], a[0:3]
    v_add_f32 v102, v100, v96
    v_exp_f32 v97, v41
    v_mfma_f32_16x16x32_bf16 a[4:7], a[96:99], v[84:87], a[4:7]
    v_add_f32 v102, v102, v97
    v_cvt_pk_bf16_f32 v88, v96, v97
    v_exp_f32 v98, v42
    s_waitcnt lgkmcnt(6)
    v_mfma_f32_16x16x32_bf16 a[8:11], a[100:103], v[80:83], a[8:11]
    v_add_f32 v102, v102, v98
    v_exp_f32 v99, v43
    v_mfma_f32_16x16x32_bf16 a[12:15], a[100:103], v[84:87], a[12:15]
    v_add_f32 v102, v102, v99
    v_cvt_pk_bf16_f32 v89, v98, v99
    v_exp_f32 v96, v44
    s_waitcnt lgkmcnt(5)
    v_mfma_f32_16x16x32_bf16 a[16:19], a[104:107], v[80:83], a[16:19]
    v_add_f32 v102, v102, v96
    v_exp_f32 v97, v45
    v_mfma_f32_16x16x32_bf16 a[20:23], a[104:107], v[84:87], a[20:23]
    v_add_f32 v102, v102, v97
    v_cvt_pk_bf16_f32 v90, v96, v97
    v_exp_f32 v98, v46
    s_waitcnt lgkmcnt(4)
    v_mfma_f32_16x16x32_bf16 a[24:27], a[108:111], v[80:83], a[24:27]
    v_add_f32 v102, v102, v98
    v_exp_f32 v99, v47
    v_mfma_f32_16x16x32_bf16 a[28:31], a[108:111], v[84:87], a[28:31]
    v_add_f32 v102, v102, v99
    v_cvt_pk_bf16_f32 v91, v98, v99
    v_exp_f32 v96, v56
    s_waitcnt lgkmcnt(3)
    v_mfma_f32_16x16x32_bf16 a[32:35], a[112:115], v[80:83], a[32:35]
    v_add_f32 v103, v101, v96
    v_exp_f32 v97, v57
    v_mfma_f32_16x16x32_bf16 a[36:39], a[112:115], v[84:87], a[36:39]
    v_add_f32 v103, v103, v97
    v_cvt_pk_bf16_f32 v92, v96, v97
    v_exp_f32 v98, v58
    s_cmp_lt_u32 s3, 4
    s_cbranch_scc1 BT_18
    s_add_u32 s53, s24, 0
    buffer_load_dwordx4 a[64:67], v112, s[8:11], s53 offen offset:0 sc1
    buffer_load_dwordx4 a[68:71], v112, s[8:11], s53 offen offset:1024 sc1
    buffer_load_dwordx4 a[72:75], v112, s[8:11], s53 offen offset:2048 sc1
    buffer_load_dwordx4 a[76:79], v112, s[8:11], s53 offen offset:3072 sc1
BT_18:
    s_waitcnt lgkmcnt(2)
    v_mfma_f32_16x16x32_bf16 a[40:43], a[116:119], v[80:83], a[40:43]
    v_add_f32 v103, v103, v98
    v_exp_f32 v99, v59
    v_mfma_f32_16x16x32_bf16 a[44:47], a[116:119], v[84:87], a[44:47]
    v_add_f32 v103, v103, v99
    v_cvt_pk_bf16_f32 v93, v98, v99
    v_exp_f32 v96, v60
    s_waitcnt lgkmcnt(1)
    v_mfma_f32_16x16x32_bf16 a[48:51], a[120:123], v[80:83], a[48:51]
    v_add_f32 v103, v103, v96
    v_exp_f32 v97, v61
    v_mfma_f32_16x16x32_bf16 a[52:55], a[120:123], v[84:87], a[52:55]
    v_add_f32 v103, v103, v97
    v_cvt_pk_bf16_f32 v94, v96, v97
    v_exp_f32 v98, v62
    s_waitcnt lgkmcnt(0)
    v_mfma_f32_16x16x32_bf16 a[56:59], a[124:127], v[80:83], a[56:59]
    v_add_f32 v103, v103, v98
    v_exp_f32 v99, v63
    v_mfma_f32_16x16x32_bf16 a[60:63], a[124:127], v[84:87], a[60:63]
    v_add_f32 v103, v103, v99
    v_cvt_pk_bf16_f32 v95, v98, v99
    v_max_f32 v109, v102, v103
    v_cmp_lt_f32 vcc, s76, v109
    s_cmp_lt_u32 s3, 4
    s_cbranch_scc1 BT_19
    s_add_u32 s53, s24, 8192
    buffer_load_dwordx4 a[80:83], v112, s[8:11], s53 offen offset:0 sc1
    buffer_load_dwordx4 a[84:87], v112, s[8:11], s53 offen offset:1024 sc1
    buffer_load_dwordx4 a[88:91], v112, s[8:11], s53 offen offset:2048 sc1
    buffer_load_dwordx4 a[92:95], v112, s[8:11], s53 offen offset:3072 sc1
BT_19:
    s_cbranch_vccnz AT_FIX1
    s_branch AT_B1
AT_T1:
    s_waitcnt lgkmcnt(0)
    ds_read_b128 a[96:99], v106 offset:0
    ds_read_b128 a[100:103], v106 offset:1024
    ds_read_b128 a[104:107], v106 offset:2048
    ds_read_b128 a[108:111], v106 offset:3072
    ds_read_b128 a[112:115], v106 offset:4096
    ds_read_b128 a[116:119], v106 offset:5120
    ds_read_b128 a[120:123], v106 offset:6144
    ds_read_b128 a[124:127], v106 offset:7168
    v_mov_b32 v109, v100
    v_mov_b32 v110, v101
    s_waitcnt lgkmcnt(7)
    v_mfma_f32_16x16x32_bf16 a[0:3], a[96:99], v[80:83], a[0:3]
    v_mfma_f32_16x16x32_bf16 a[4:7], a[96:99], v[84:87], a[4:7]
    s_waitcnt lgkmcnt(6)
    v_mfma_f32_16x16x32_bf16 a[8:11], a[100:103], v[80:83], a[8:11]
    v_mfma_f32_16x16x32_bf16 a[12:15], a[100:103], v[84:87], a[12:15]
    s_waitcnt lgkmcnt(5)
    v_mfma_f32_16x16x32_bf16 a[16:19], a[104:107], v[80:83], a[16:19]
    v_mfma_f32_16x16x32_bf16 a[20:23], a[104:107], v[84:87], a[20:23]
    s_waitcnt lgkmcnt(4)
    v_mfma_f32_16x16x32_bf16 a[24:27], a[108:111], v[80:83], a[24:27]
    v_mfma_f32_16x16x32_bf16 a[28:31], a[108:111], v[84:87], a[28:31]
    s_waitcnt lgkmcnt(3)
    v_mfma_f32_16x16x32_bf16 a[32:35], a[112:115], v[80:83], a[32:35]
    v_mfma_f32_16x16x32_bf16 a[36:39], a[112:115], v[84:87], a[36:39]
    s_waitcnt lgkmcnt(2)
    v_mfma_f32_16x16x32_bf16 a[40:43], a[116:119], v[80:83], a[40:43]
    v_mfma_f32_16x16x32_bf16 a[44:47], a[116:119], v[84:87], a[44:47]
    s_waitcnt lgkmcnt(1)
    v_mfma_f32_16x16x32_bf16 a[48:51], a[120:123], v[80:83], a[48:51]
    v_mfma_f32_16x16x32_bf16 a[52:55], a[120:123], v[84:87], a[52:55]
    s_waitcnt lgkmcnt(0)
    v_mfma_f32_16x16x32_bf16 a[56:59], a[124:127], v[80:83], a[56:59]
    v_mfma_f32_16x16x32_bf16 a[60:63], a[124:127], v[84:87], a[60:63]
    s_branch AT_EPI
AT_FIX0:
    s_nop 7
    v_log_f32 v110, v102
    v_max3_f32 v109, v8, v9, v10
    v_max3_f32 v109, v109, v11, v12
    v_max3_f32 v109, v109, v13, v14
    v_max_f32 v109, v109, v15
    v_add_f32 v110, 0xc1400000, v110
    v_max_f32 v109, v109, v110
    v_mov_b32 v110, v109
    s_nop 1
    v_permlane16_swap_b32 v110, v109
    s_nop 1
    v_max_f32 v109, v109, v110
    v_mov_b32 v110, v109
    s_nop 1
    v_permlane32_swap_b32 v110, v109
    s_nop 1
    v_max_f32 v109, v109, v110
    v_ceil_f32 v109, v109
    v_max_f32 v109, 0, v109
    v_exp_f32 v110, -v109
    v_sub_f32 v8, v8, v109
    v_sub_f32 v40, v40, v109
    v_sub_f32 v64, v64, v109
    v_sub_f32 v9, v9, v109
    v_sub_f32 v41, v41, v109
    v_sub_f32 v65, v65, v109
    v_sub_f32 v10, v10, v109
    v_sub_f32 v42, v42, v109
    v_sub_f32 v66, v66, v109
    v_sub_f32 v11, v11, v109
    v_sub_f32 v43, v43, v109
    v_sub_f32 v67, v67, v109
    v_sub_f32 v12, v12, v109
    v_sub_f32 v44, v44, v109
    v_sub_f32 v68, v68, v109
    v_sub_f32 v13, v13, v109
    v_sub_f32 v45, v45, v109
    v_sub_f32 v69, v69, v109
    v_sub_f32 v14, v14, v109
    v_sub_f32 v46, v46, v109
    v_sub_f32 v70, v70, v109
    v_sub_f32 v15, v15, v109
    v_sub_f32 v47, v47, v109
    v_sub_f32 v71, v71, v109
    v_accvgpr_read_b32 v96, a0
    v_mul_f32 v96, v96, v110
    v_accvgpr_write_b32 a0, v96
    v_accvgpr_read_b32 v97, a1
    v_mul_f32 v97, v97, v110
    v_accvgpr_write_b32 a1, v97
    v_accvgpr_read_b32 v98, a2
    v_mul_f32 v98, v98, v110
    v_accvgpr_write_b32 a2, v98
    v_accvgpr_read_b32 v99, a3
    v_mul_f32 v99, v99, v110
    v_accvgpr_write_b32 a3, v99
    v_accvgpr_read_b32 v96, a8
    v_mul_f32 v96, v96, v110
    v_accvgpr_write_b32 a8, v96
    v_accvgpr_read_b32 v97, a9
    v_mul_f32 v97, v97, v110
    v_accvgpr_write_b32 a9, v97
    v_accvgpr_read_b32 v98, a10
    v_mul_f32 v98, v98, v110
    v_accvgpr_write_b32 a10, v98
    v_accvgpr_read_b32 v99, a11
    v_mul_f32 v99, v99, v110
    v_accvgpr_write_b32 a11, v99
    v_accvgpr_read_b32 v96, a16
    v_mul_f32 v96, v96, v110
    v_accvgpr_write_b32 a16, v96
    v_accvgpr_read_b32 v97, a17
    v_mul_f32 v97, v97, v110
    v_accvgpr_write_b32 a17, v97
    v_accvgpr_read_b32 v98, a18
    v_mul_f32 v98, v98, v110
    v_accvgpr_write_b32 a18, v98
    v_accvgpr_read_b32 v99, a19
    v_mul_f32 v99, v99, v110
    v_accvgpr_write_b32 a19, v99
    v_accvgpr_read_b32 v96, a24
    v_mul_f32 v96, v96, v110
    v_accvgpr_write_b32 a24, v96
    v_accvgpr_read_b32 v97, a25
    v_mul_f32 v97, v97, v110
    v_accvgpr_write_b32 a25, v97
    v_accvgpr_read_b32 v98, a26
    v_mul_f32 v98, v98, v110
    v_accvgpr_write_b32 a26, v98
    v_accvgpr_read_b32 v99, a27
    v_mul_f32 v99, v99, v110
    v_accvgpr_write_b32 a27, v99
    v_accvgpr_read_b32 v96, a32
    v_mul_f32 v96, v96, v110
    v_accvgpr_write_b32 a32, v96
    v_accvgpr_read_b32 v97, a33
    v_mul_f32 v97, v97, v110
    v_accvgpr_write_b32 a33, v97
    v_accvgpr_read_b32 v98, a34
    v_mul_f32 v98, v98, v110
    v_accvgpr_write_b32 a34, v98
    v_accvgpr_read_b32 v99, a35
    v_mul_f32 v99, v99, v110
    v_accvgpr_write_b32 a35, v99
    v_accvgpr_read_b32 v96, a40
    v_mul_f32 v96, v96, v110
    v_accvgpr_write_b32 a40, v96
    v_accvgpr_read_b32 v97, a41
    v_mul_f32 v97, v97, v110
    v_accvgpr_write_b32 a41, v97
    v_accvgpr_read_b32 v98, a42
    v_mul_f32 v98, v98, v110
    v_accvgpr_write_b32 a42, v98
    v_accvgpr_read_b32 v99, a43
    v_mul_f32 v99, v99, v110
    v_accvgpr_write_b32 a43, v99
    v_accvgpr_read_b32 v96, a48
    v_mul_f32 v96, v96, v110
    v_accvgpr_write_b32 a48, v96
    v_accvgpr_read_b32 v97, a49
    v_mul_f32 v97, v97, v110
    v_accvgpr_write_b32 a49, v97
    v_accvgpr_read_b32 v98, a50
    v_mul_f32 v98, v98, v110
    v_accvgpr_write_b32 a50, v98
    v_accvgpr_read_b32 v99, a51
    v_mul_f32 v99, v99, v110
    v_accvgpr_write_b32 a51, v99
    v_accvgpr_read_b32 v96, a56
    v_mul_f32 v96, v96, v110
    v_accvgpr_write_b32 a56, v96
    v_accvgpr_read_b32 v97, a57
    v_mul_f32 v97, v97, v110
    v_accvgpr_write_b32 a57, v97
    v_accvgpr_read_b32 v98, a58
    v_mul_f32 v98, v98, v110
    v_accvgpr_write_b32 a58, v98
    v_accvgpr_read_b32 v99, a59
    v_mul_f32 v99, v99, v110
    v_accvgpr_write_b32 a59, v99
    v_mul_f32 v100, v102, v110
    v_exp_f32 v96, v8
    v_exp_f32 v97, v9
    s_nop 0
    v_add_f32 v100, v100, v96
    v_add_f32 v100, v100, v97
    v_cvt_pk_bf16_f32 v80, v96, v97
    v_exp_f32 v96, v10
    v_exp_f32 v97, v11
    s_nop 0
    v_add_f32 v100, v100, v96
    v_add_f32 v100, v100, v97
    v_cvt_pk_bf16_f32 v81, v96, v97
    v_exp_f32 v96, v12
    v_exp_f32 v97, v13
    s_nop 0
    v_add_f32 v100, v100, v96
    v_add_f32 v100, v100, v97
    v_cvt_pk_bf16_f32 v82, v96, v97
    v_exp_f32 v96, v14
    v_exp_f32 v97, v15
    s_nop 0
    v_add_f32 v100, v100, v96
    v_add_f32 v100, v100, v97
    v_cvt_pk_bf16_f32 v83, v96, v97
    v_log_f32 v110, v103
    v_max3_f32 v109, v24, v25, v26
    v_max3_f32 v109, v109, v27, v28
    v_max3_f32 v109, v109, v29, v30
    v_max_f32 v109, v109, v31
    v_add_f32 v110, 0xc1400000, v110
    v_max_f32 v109, v109, v110
    v_mov_b32 v110, v109
    s_nop 1
    v_permlane16_swap_b32 v110, v109
    s_nop 1
    v_max_f32 v109, v109, v110
    v_mov_b32 v110, v109
    s_nop 1
    v_permlane32_swap_b32 v110, v109
    s_nop 1
    v_max_f32 v109, v109, v110
    v_ceil_f32 v109, v109
    v_max_f32 v109, 0, v109
    v_exp_f32 v110, -v109
    v_sub_f32 v24, v24, v109
    v_sub_f32 v56, v56, v109
    v_sub_f32 v72, v72, v109
    v_sub_f32 v25, v25, v109
    v_sub_f32 v57, v57, v109
    v_sub_f32 v73, v73, v109
    v_sub_f32 v26, v26, v109
    v_sub_f32 v58, v58, v109
    v_sub_f32 v74, v74, v109
    v_sub_f32 v27, v27, v109
    v_sub_f32 v59, v59, v109
    v_sub_f32 v75, v75, v109
    v_sub_f32 v28, v28, v109
    v_sub_f32 v60, v60, v109
    v_sub_f32 v76, v76, v109
    v_sub_f32 v29, v29, v109
    v_sub_f32 v61, v61, v109
    v_sub_f32 v77, v77, v109
    v_sub_f32 v30, v30, v109
    v_sub_f32 v62, v62, v109
    v_sub_f32 v78, v78, v109
    v_sub_f32 v31, v31, v109
    v_sub_f32 v63, v63, v109
    v_sub_f32 v79, v79, v109
    v_accvgpr_read_b32 v96, a4
    v_mul_f32 v96, v96, v110
    v_accvgpr_write_b32 a4, v96
    v_accvgpr_read_b32 v97, a5
    v_mul_f32 v97, v97, v110
    v_accvgpr_write_b32 a5, v97
    v_accvgpr_read_b32 v98, a6
    v_mul_f32 v98, v98, v110
    v_accvgpr_write_b32 a6, v98
    v_accvgpr_read_b32 v99, a7
    v_mul_f32 v99, v99, v110
    v_accvgpr_write_b32 a7, v99
    v_accvgpr_read_b32 v96, a12
    v_mul_f32 v96, v96, v110
    v_accvgpr_write_b32 a12, v96
    v_accvgpr_read_b32 v97, a13
    v_mul_f32 v97, v97, v110
    v_accvgpr_write_b32 a13, v97
    v_accvgpr_read_b32 v98, a14
    v_mul_f32 v98, v98, v110
    v_accvgpr_write_b32 a14, v98
    v_accvgpr_read_b32 v99, a15
    v_mul_f32 v99, v99, v110
    v_accvgpr_write_b32 a15, v99
    v_accvgpr_read_b32 v96, a20
    v_mul_f32 v96, v96, v110
    v_accvgpr_write_b32 a20, v96
    v_accvgpr_read_b32 v97, a21
    v_mul_f32 v97, v97, v110
    v_accvgpr_write_b32 a21, v97
    v_accvgpr_read_b32 v98, a22
    v_mul_f32 v98, v98, v110
    v_accvgpr_write_b32 a22, v98
    v_accvgpr_read_b32 v99, a23
    v_mul_f32 v99, v99, v110
    v_accvgpr_write_b32 a23, v99
    v_accvgpr_read_b32 v96, a28
    v_mul_f32 v96, v96, v110
    v_accvgpr_write_b32 a28, v96
    v_accvgpr_read_b32 v97, a29
    v_mul_f32 v97, v97, v110
    v_accvgpr_write_b32 a29, v97
    v_accvgpr_read_b32 v98, a30
    v_mul_f32 v98, v98, v110
    v_accvgpr_write_b32 a30, v98
    v_accvgpr_read_b32 v99, a31
    v_mul_f32 v99, v99, v110
    v_accvgpr_write_b32 a31, v99
    v_accvgpr_read_b32 v96, a36
    v_mul_f32 v96, v96, v110
    v_accvgpr_write_b32 a36, v96
    v_accvgpr_read_b32 v97, a37
    v_mul_f32 v97, v97, v110
    v_accvgpr_write_b32 a37, v97
    v_accvgpr_read_b32 v98, a38
    v_mul_f32 v98, v98, v110
    v_accvgpr_write_b32 a38, v98
    v_accvgpr_read_b32 v99, a39
    v_mul_f32 v99, v99, v110
    v_accvgpr_write_b32 a39, v99
    v_accvgpr_read_b32 v96, a44
    v_mul_f32 v96, v96, v110
    v_accvgpr_write_b32 a44, v96
    v_accvgpr_read_b32 v97, a45
    v_mul_f32 v97, v97, v110
    v_accvgpr_write_b32 a45, v97
    v_accvgpr_read_b32 v98, a46
    v_mul_f32 v98, v98, v110
    v_accvgpr_write_b32 a46, v98
    v_accvgpr_read_b32 v99, a47
    v_mul_f32 v99, v99, v110
    v_accvgpr_write_b32 a47, v99
    v_accvgpr_read_b32 v96, a52
    v_mul_f32 v96, v96, v110
    v_accvgpr_write_b32 a52, v96
    v_accvgpr_read_b32 v97, a53
    v_mul_f32 v97, v97, v110
    v_accvgpr_write_b32 a53, v97
    v_accvgpr_read_b32 v98, a54
    v_mul_f32 v98, v98, v110
    v_accvgpr_write_b32 a54, v98
    v_accvgpr_read_b32 v99, a55
    v_mul_f32 v99, v99, v110
    v_accvgpr_write_b32 a55, v99
    v_accvgpr_read_b32 v96, a60
    v_mul_f32 v96, v96, v110
    v_accvgpr_write_b32 a60, v96
    v_accvgpr_read_b32 v97, a61
    v_mul_f32 v97, v97, v110
    v_accvgpr_write_b32 a61, v97
    v_accvgpr_read_b32 v98, a62
    v_mul_f32 v98, v98, v110
    v_accvgpr_write_b32 a62, v98
    v_accvgpr_read_b32 v99, a63
    v_mul_f32 v99, v99, v110
    v_accvgpr_write_b32 a63, v99
    v_mul_f32 v101, v103, v110
    v_exp_f32 v96, v24
    v_exp_f32 v97, v25
    s_nop 0
    v_add_f32 v101, v101, v96
    v_add_f32 v101, v101, v97
    v_cvt_pk_bf16_f32 v84, v96, v97
    v_exp_f32 v96, v26
    v_exp_f32 v97, v27
    s_nop 0
    v_add_f32 v101, v101, v96
    v_add_f32 v101, v101, v97
    v_cvt_pk_bf16_f32 v85, v96, v97
    v_exp_f32 v96, v28
    v_exp_f32 v97, v29
    s_nop 0
    v_add_f32 v101, v101, v96
    v_add_f32 v101, v101, v97
    v_cvt_pk_bf16_f32 v86, v96, v97
    v_exp_f32 v96, v30
    v_exp_f32 v97, v31
    s_nop 0
    v_add_f32 v101, v101, v96
    v_add_f32 v101, v101, v97
    v_cvt_pk_bf16_f32 v87, v96, v97
    v_exp_f32 v96, v40
    s_cmp_eq_u32 s79, 0
    s_cbranch_scc1 AT_B0
    s_cmp_eq_u32 s79, 2
    s_cbranch_scc1 FXB_20
    s_cmp_lg_u32 s75, 0
    s_branch AT_FA_B0
FXB_20:
    s_cmp_lg_u32 s75, 0
    s_branch AT_FB_B0
AT_H0:
    s_sub_u32 s6, s77, s61
    s_cmp_eq_u32 s6, 1
    s_cbranch_scc1 AT_N0
    s_cmp_eq_u32 s6, 2
    s_cbranch_scc1 AT_T0
    v_mov_b32 v68, v108
    v_cndmask_b32 v64, v64, v108, s[80:81]
    v_cndmask_b32 v76, v76, v108, s[80:81]
    v_mov_b32 v69, v108
    v_cndmask_b32 v65, v65, v108, s[82:83]
    v_cndmask_b32 v77, v77, v108, s[82:83]
    v_mov_b32 v70, v108
    v_cndmask_b32 v66, v66, v108, s[84:85]
    v_cndmask_b32 v78, v78, v108, s[84:85]
    v_mov_b32 v71, v108
    v_cndmask_b32 v67, v67, v108, s[86:87]
    v_cndmask_b32 v79, v79, v108, s[86:87]
    s_nop 1
    s_branch AT_P0
AT_N0:
    s_waitcnt lgkmcnt(0)
    ds_read_b128 a[96:99], v106 offset:8192
    ds_read_b128 a[100:103], v106 offset:9216
    ds_read_b128 a[104:107], v106 offset:10240
    ds_read_b128 a[108:111], v106 offset:11264
    ds_read_b128 a[112:115], v106 offset:12288
    ds_read_b128 a[116:119], v106 offset:13312
    ds_read_b128 a[120:123], v106 offset:14336
    ds_read_b128 a[124:127], v106 offset:15360
    s_waitcnt lgkmcnt(7)
    v_mfma_f32_16x16x32_bf16 a[0:3], a[96:99], v[88:91], a[0:3]
    v_add_f32 v100, v102, v96
    v_exp_f32 v97, v9
    v_mfma_f32_16x16x32_bf16 a[4:7], a[96:99], v[92:95], a[4:7]
    v_add_f32 v100, v100, v97
    v_cvt_pk_bf16_f32 v80, v96, v97
    v_exp_f32 v98, v10
    s_waitcnt lgkmcnt(6)
    v_mfma_f32_16x16x32_bf16 a[8:11], a[100:103], v[88:91], a[8:11]
    v_add_f32 v100, v100, v98
    v_exp_f32 v99, v11
    v_mfma_f32_16x16x32_bf16 a[12:15], a[100:103], v[92:95], a[12:15]
    v_add_f32 v100, v100, v99
    v_cvt_pk_bf16_f32 v81, v98, v99
    v_exp_f32 v96, v12
    s_waitcnt lgkmcnt(5)
    v_mfma_f32_16x16x32_bf16 a[16:19], a[104:107], v[88:91], a[16:19]
    v_add_f32 v100, v100, v96
    v_exp_f32 v97, v13
    v_mfma_f32_16x16x32_bf16 a[20:23], a[104:107], v[92:95], a[20:23]
    v_add_f32 v100, v100, v97
    v_cvt_pk_bf16_f32 v82, v96, v97
    v_exp_f32 v98, v14
    s_waitcnt lgkmcnt(4)
    v_mfma_f32_16x16x32_bf16 a[24:27], a[108:111], v[88:91], a[24:27]
    v_add_f32 v100, v100, v98
    v_exp_f32 v99, v15
    v_mfma_f32_16x16x32_bf16 a[28:31], a[108:111], v[92:95], a[28:31]
    v_add_f32 v100, v100, v99
    v_cvt_pk_bf16_f32 v83, v98, v99
    v_exp_f32 v96, v24
    s_waitcnt lgkmcnt(3)
    v_mfma_f32_16x16x32_bf16 a[32:35], a[112:115], v[88:91], a[32:35]
    v_add_f32 v101, v103, v96
    v_exp_f32 v97, v25
    v_mfma_f32_16x16x32_bf16 a[36:39], a[112:115], v[92:95], a[36:39]
    v_add_f32 v101, v101, v97
    v_cvt_pk_bf16_f32 v84, v96, v97
    v_exp_f32 v98, v26
    s_cmp_lt_u32 s3, 4
    s_cbranch_scc1 BT_21
    s_add_u32 s53, s24, 0
    buffer_load_dwordx4 a[64:67], v112, s[8:11], s53 offen offset:0 sc1
    buffer_load_dwordx4 a[68:71], v112, s[8:11], s53 offen offset:1024 sc1
    buffer_load_dwordx4 a[72:75], v112, s[8:11], s53 offen offset:2048 sc1
    buffer_load_dwordx4 a[76:79], v112, s[8:11], s53 offen offset:3072 sc1
BT_21:
    s_waitcnt lgkmcnt(2)
    v_mfma_f32_16x16x32_bf16 a[40:43], a[116:119], v[88:91], a[40:43]
    v_add_f32 v101, v101, v98
    v_exp_f32 v99, v27
    v_mfma_f32_16x16x32_bf16 a[44:47], a[116:119], v[92:95], a[44:47]
    v_add_f32 v101, v101, v99
    v_cvt_pk_bf16_f32 v85, v98, v99
    v_exp_f32 v96, v28
    s_waitcnt lgkmcnt(1)
    v_mfma_f32_16x16x32_bf16 a[48:51], a[120:123], v[88:91], a[48:51]
    v_add_f32 v101, v101, v96
    v_exp_f32 v97, v29
    v_mfma_f32_16x16x32_bf16 a[52:55], a[120:123], v[92:95], a[52:55]
    v_add_f32 v101, v101, v97
    v_cvt_pk_bf16_f32 v86, v96, v97
    v_exp_f32 v98, v30
    s_waitcnt lgkmcnt(0)
    v_mfma_f32_16x16x32_bf16 a[56:59], a[124:127], v[88:91], a[56:59]
    v_add_f32 v101, v101, v98
    v_exp_f32 v99, v31
    v_mfma_f32_16x16x32_bf16 a[60:63], a[124:127], v[92:95], a[60:63]
    v_add_f32 v101, v101, v99
    v_cvt_pk_bf16_f32 v87, v98, v99
    v_max_f32 v109, v100, v101
    v_cmp_lt_f32 vcc, s76, v109
    s_cmp_lt_u32 s3, 4
    s_cbranch_scc1 BT_22
    s_add_u32 s53, s24, 8192
    buffer_load_dwordx4 a[80:83], v112, s[8:11], s53 offen offset:0 sc1
    buffer_load_dwordx4 a[84:87], v112, s[8:11], s53 offen offset:1024 sc1
    buffer_load_dwordx4 a[88:91], v112, s[8:11], s53 offen offset:2048 sc1
    buffer_load_dwordx4 a[92:95], v112, s[8:11], s53 offen offset:3072 sc1
BT_22:
    s_cbranch_vccnz AT_FIX0
    s_branch AT_B0
AT_T0:
    s_waitcnt lgkmcnt(0)
    ds_read_b128 a[96:99], v106 offset:8192
    ds_read_b128 a[100:103], v106 offset:9216
    ds_read_b128 a[104:107], v106 offset:10240
    ds_read_b128 a[108:111], v106 offset:11264
    ds_read_b128 a[112:115], v106 offset:12288
    ds_read_b128 a[116:119], v106 offset:13312
    ds_read_b128 a[120:123], v106 offset:14336
    ds_read_b128 a[124:127], v106 offset:15360
    v_mov_b32 v109, v102
    v_mov_b32 v110, v103
    s_waitcnt lgkmcnt(7)
    v_mfma_f32_16x16x32_bf16 a[0:3], a[96:99], v[88:91], a[0:3]
    v_mfma_f32_16x16x32_bf16 a[4:7], a[96:99], v[92:95], a[4:7]
    s_waitcnt lgkmcnt(6)
    v_mfma_f32_16x16x32_bf16 a[8:11], a[100:103], v[88:91], a[8:11]
    v_mfma_f32_16x16x32_bf16 a[12:15], a[100:103], v[92:95], a[12:15]
    s_waitcnt lgkmcnt(5)
    v_mfma_f32_16x16x32_bf16 a[16:19], a[104:107], v[88:91], a[16:19]
    v_mfma_f32_16x16x32_bf16 a[20:23], a[104:107], v[92:95], a[20:23]
    s_waitcnt lgkmcnt(4)
    v_mfma_f32_16x16x32_bf16 a[24:27], a[108:111], v[88:91], a[24:27]
    v_mfma_f32_16x16x32_bf16 a[28:31], a[108:111], v[92:95], a[28:31]
    s_waitcnt lgkmcnt(3)
    v_mfma_f32_16x16x32_bf16 a[32:35], a[112:115], v[88:91], a[32:35]
    v_mfma_f32_16x16x32_bf16 a[36:39], a[112:115], v[92:95], a[36:39]
    s_waitcnt lgkmcnt(2)
    v_mfma_f32_16x16x32_bf16 a[40:43], a[116:119], v[88:91], a[40:43]
    v_mfma_f32_16x16x32_bf16 a[44:47], a[116:119], v[92:95], a[44:47]
    s_waitcnt lgkmcnt(1)
    v_mfma_f32_16x16x32_bf16 a[48:51], a[120:123], v[88:91], a[48:51]
    v_mfma_f32_16x16x32_bf16 a[52:55], a[120:123], v[92:95], a[52:55]
    s_waitcnt lgkmcnt(0)
    v_mfma_f32_16x16x32_bf16 a[56:59], a[124:127], v[88:91], a[56:59]
    v_mfma_f32_16x16x32_bf16 a[60:63], a[124:127], v[92:95], a[60:63]
    s_branch AT_EPI
AT_EPI:
    s_cmp_lt_u32 s3, 4
    s_cbranch_scc1 AT_EPI2
    s_cmp_gt_u32 s3, 5
    s_cbranch_scc1 AT_EPI1
    s_barrier
AT_EPI1:
    s_add_u32 s53, s24, 16384
    buffer_load_dwordx4 a[96:99], v112, s[8:11], s53 offen offset:0 sc1
    buffer_load_dwordx4 a[100:103], v112, s[8:11], s53 offen offset:1024 sc1
    buffer_load_dwordx4 a[104:107], v112, s[8:11], s53 offen offset:2048 sc1
    buffer_load_dwordx4 a[108:111], v112, s[8:11], s53 offen offset:3072 sc1
AT_EPI2:
    v_mov_b32 v96, v109
    s_nop 1
    v_permlane16_swap_b32 v96, v109
    s_nop 1
    v_add_f32 v109, v109, v96
    v_mov_b32 v96, v109
    s_nop 1
    v_permlane32_swap_b32 v96, v109
    s_nop 1
    v_add_f32 v109, v109, v96
    v_mov_b32 v96, v110
    s_nop 1
    v_permlane16_swap_b32 v96, v110
    s_nop 1
    v_add_f32 v110, v110, v96
    v_mov_b32 v96, v110
    s_nop 1
    v_permlane32_swap_b32 v96, v110
    s_nop 1
    v_add_f32 v110, v110, v96
    v_rcp_f32 v96, v109
    v_rcp_f32 v97, v109
    v_rcp_f32 v98, v110
    v_rcp_f32 v99, v110
    v_mov_b32 v127, 1
    s_lshr_b32 s77, s77, 1
    s_lshr_b32 s62, s62, 1
    v_accvgpr_read_b32 v0, a0
    v_accvgpr_read_b32 v1, a1
    v_accvgpr_read_b32 v2, a2
    v_accvgpr_read_b32 v3, a3
    v_accvgpr_read_b32 v4, a8
    v_accvgpr_read_b32 v5, a9
    v_accvgpr_read_b32 v6, a10
    v_accvgpr_read_b32 v7, a11
    v_pk_mul_f32 v[0:1], v[0:1], v[96:97]
    v_pk_mul_f32 v[2:3], v[2:3], v[96:97]
    v_pk_mul_f32 v[4:5], v[4:5], v[96:97]
    v_pk_mul_f32 v[6:7], v[6:7], v[96:97]
    v_cvt_pk_bf16_f32 v0, v0, v1
    v_cvt_pk_bf16_f32 v1, v2, v3
    v_cvt_pk_bf16_f32 v2, v4, v5
    v_cvt_pk_bf16_f32 v3, v6, v7
    buffer_store_dwordx4 v[0:3], v112, s[8:11], s69 offen offset:0 sc1
    v_accvgpr_read_b32 v8, a4
    v_accvgpr_read_b32 v9, a5
    v_accvgpr_read_b32 v10, a6
    v_accvgpr_read_b32 v11, a7
    v_accvgpr_read_b32 v12, a12
    v_accvgpr_read_b32 v13, a13
    v_accvgpr_read_b32 v14, a14
    v_accvgpr_read_b32 v15, a15
    v_pk_mul_f32 v[8:9], v[8:9], v[98:99]
    v_pk_mul_f32 v[10:11], v[10:11], v[98:99]
    v_pk_mul_f32 v[12:13], v[12:13], v[98:99]
    v_pk_mul_f32 v[14:15], v[14:15], v[98:99]
    v_cvt_pk_bf16_f32 v8, v8, v9
    v_cvt_pk_bf16_f32 v9, v10, v11
    v_cvt_pk_bf16_f32 v10, v12, v13
    v_cvt_pk_bf16_f32 v11, v14, v15
    buffer_store_dwordx4 v[8:11], v112, s[8:11], s69 offen offset:1024 sc1
    v_accvgpr_read_b32 v16, a16
    v_accvgpr_read_b32 v17, a17
    v_accvgpr_read_b32 v18, a18
    v_accvgpr_read_b32 v19, a19
    v_accvgpr_read_b32 v20, a24
    v_accvgpr_read_b32 v21, a25
    v_accvgpr_read_b32 v22, a26
    v_accvgpr_read_b32 v23, a27
    v_pk_mul_f32 v[16:17], v[16:17], v[96:97]
    v_pk_mul_f32 v[18:19], v[18:19], v[96:97]
    v_pk_mul_f32 v[20:21], v[20:21], v[96:97]
    v_pk_mul_f32 v[22:23], v[22:23], v[96:97]
    v_cvt_pk_bf16_f32 v16, v16, v17
    v_cvt_pk_bf16_f32 v17, v18, v19
    v_cvt_pk_bf16_f32 v18, v20, v21
    v_cvt_pk_bf16_f32 v19, v22, v23
    buffer_store_dwordx4 v[16:19], v112, s[8:11], s69 offen offset:2048 sc1
    v_accvgpr_read_b32 v24, a20
    v_accvgpr_read_b32 v25, a21
    v_accvgpr_read_b32 v26, a22
    v_accvgpr_read_b32 v27, a23
    v_accvgpr_read_b32 v28, a28
    v_accvgpr_read_b32 v29, a29
    v_accvgpr_read_b32 v30, a30
    v_accvgpr_read_b32 v31, a31
    v_pk_mul_f32 v[24:25], v[24:25], v[98:99]
    v_pk_mul_f32 v[26:27], v[26:27], v[98:99]
    v_pk_mul_f32 v[28:29], v[28:29], v[98:99]
    v_pk_mul_f32 v[30:31], v[30:31], v[98:99]
    v_cvt_pk_bf16_f32 v24, v24, v25
    v_cvt_pk_bf16_f32 v25, v26, v27
    v_cvt_pk_bf16_f32 v26, v28, v29
    v_cvt_pk_bf16_f32 v27, v30, v31
    buffer_store_dwordx4 v[24:27], v112, s[8:11], s69 offen offset:3072 sc1
    s_add_u32 s69, s69, 4096
    s_cmp_ge_u32 s3, 4
    s_cbranch_scc1 AT_EPI3
    s_waitcnt vmcnt(12)
    s_barrier
    s_cmp_gt_u32 s71, s73
    s_cbranch_scc1 AT_EPI3
    s_min_u32 s6, s71, s73
    s_and_b32 s7, s72, 0xffff
    s_add_u32 m0, s7, s74
    s_add_u32 s52, s6, 4096
    buffer_load_dwordx4 v112, s[8:11], s6 offen offset:0 sc1 lds
    buffer_load_dwordx4 v112, s[8:11], s6 offen offset:1024 sc1 lds
    buffer_load_dwordx4 v112, s[8:11], s6 offen offset:2048 sc1 lds
    buffer_load_dwordx4 v112, s[8:11], s6 offen offset:3072 sc1 lds
    s_add_u32 m0, m0, 4096
    s_add_u32 s71, s71, 16384
    buffer_load_dwordx4 v112, s[8:11], s52 offen offset:0 sc1 lds
    buffer_load_dwordx4 v112, s[8:11], s52 offen offset:1024 sc1 lds
    buffer_load_dwordx4 v112, s[8:11], s52 offen offset:2048 sc1 lds
    buffer_load_dwordx4 v112, s[8:11], s52 offen offset:3072 sc1 lds
    s_add_u32 s72, s72, 16384
AT_EPI3:
    v_accvgpr_read_b32 v32, a32
    v_accvgpr_read_b32 v33, a33
    v_accvgpr_read_b32 v34, a34
    v_accvgpr_read_b32 v35, a35
    v_accvgpr_read_b32 v36, a40
    v_accvgpr_read_b32 v37, a41
    v_accvgpr_read_b32 v38, a42
    v_accvgpr_read_b32 v39, a43
    v_pk_mul_f32 v[32:33], v[32:33], v[96:97]
    v_pk_mul_f32 v[34:35], v[34:35], v[96:97]
    v_pk_mul_f32 v[36:37], v[36:37], v[96:97]
    v_pk_mul_f32 v[38:39], v[38:39], v[96:97]
    v_cvt_pk_bf16_f32 v32, v32, v33
    v_cvt_pk_bf16_f32 v33, v34, v35
    v_cvt_pk_bf16_f32 v34, v36, v37
    v_cvt_pk_bf16_f32 v35, v38, v39
    buffer_store_dwordx4 v[32:35], v112, s[8:11], s69 offen offset:0 sc1
    v_accvgpr_read_b32 v40, a36
    v_accvgpr_read_b32 v41, a37
    v_accvgpr_read_b32 v42, a38
    v_accvgpr_read_b32 v43, a39
    v_accvgpr_read_b32 v44, a44
    v_accvgpr_read_b32 v45, a45
    v_accvgpr_read_b32 v46, a46
    v_accvgpr_read_b32 v47, a47
    v_pk_mul_f32 v[40:41], v[40:41], v[98:99]
    v_pk_mul_f32 v[42:43], v[42:43], v[98:99]
    v_pk_mul_f32 v[44:45], v[44:45], v[98:99]
    v_pk_mul_f32 v[46:47], v[46:47], v[98:99]
    v_cvt_pk_bf16_f32 v40, v40, v41
    v_cvt_pk_bf16_f32 v41, v42, v43
    v_cvt_pk_bf16_f32 v42, v44, v45
    v_cvt_pk_bf16_f32 v43, v46, v47
    buffer_store_dwordx4 v[40:43], v112, s[8:11], s69 offen offset:1024 sc1
    v_accvgpr_read_b32 v48, a48
    v_accvgpr_read_b32 v49, a49
    v_accvgpr_read_b32 v50, a50
    v_accvgpr_read_b32 v51, a51
    v_accvgpr_read_b32 v52, a56
    v_accvgpr_read_b32 v53, a57
    v_accvgpr_read_b32 v54, a58
    v_accvgpr_read_b32 v55, a59
    v_pk_mul_f32 v[48:49], v[48:49], v[96:97]
    v_pk_mul_f32 v[50:51], v[50:51], v[96:97]
    v_pk_mul_f32 v[52:53], v[52:53], v[96:97]
    v_pk_mul_f32 v[54:55], v[54:55], v[96:97]
    v_cvt_pk_bf16_f32 v48, v48, v49
    v_cvt_pk_bf16_f32 v49, v50, v51
    v_cvt_pk_bf16_f32 v50, v52, v53
    v_cvt_pk_bf16_f32 v51, v54, v55
    buffer_store_dwordx4 v[48:51], v112, s[8:11], s69 offen offset:2048 sc1
    v_accvgpr_read_b32 v56, a52
    v_accvgpr_read_b32 v57, a53
    v_accvgpr_read_b32 v58, a54
    v_accvgpr_read_b32 v59, a55
    v_accvgpr_read_b32 v60, a60
    v_accvgpr_read_b32 v61, a61
    v_accvgpr_read_b32 v62, a62
    v_accvgpr_read_b32 v63, a63
    v_pk_mul_f32 v[56:57], v[56:57], v[98:99]
    v_pk_mul_f32 v[58:59], v[58:59], v[98:99]
    v_pk_mul_f32 v[60:61], v[60:61], v[98:99]
    v_pk_mul_f32 v[62:63], v[62:63], v[98:99]
    v_cvt_pk_bf16_f32 v56, v56, v57
    v_cvt_pk_bf16_f32 v57, v58, v59
    v_cvt_pk_bf16_f32 v58, v60, v61
    v_cvt_pk_bf16_f32 v59, v62, v63
    buffer_store_dwordx4 v[56:59], v112, s[8:11], s69 offen offset:3072 sc1
    s_cmp_ge_u32 s3, 4
    s_cbranch_scc1 P4_JOINF
    s_add_u32 s77, s77, 1
    s_cmp_gt_u32 s71, s73
    s_cbranch_scc1 AT_LDA1
    s_waitcnt vmcnt(12)
    s_sub_u32 s6, s4, 8
    s_cmp_lt_u32 s6, 16
    s_cbranch_scc1 AT_TS
    s_branch AT_LD
AT_LDA1:
    s_waitcnt vmcnt(4)
AT_LD:
    s_cmp_lg_u32 s79, 0
    s_cbranch_scc1 AT_LD2
    s_add_u32 s6, s77, 9
    s_cmp_lt_u32 s6, s62
    s_cbranch_scc1 AT_LD2
    s_cmp_eq_u32 s6, s62
    s_cbranch_scc1 AT_PS
    s_add_u32 s6, s77, 4
    s_cmp_lt_u32 s6, s62
    s_cbranch_scc1 AT_LD2
    s_add_u32 s53, s24, 0
    buffer_load_dwordx4 a[64:67], v112, s[8:11], s53 offen offset:0 sc1
    buffer_load_dwordx4 a[68:71], v112, s[8:11], s53 offen offset:1024 sc1
    buffer_load_dwordx4 a[72:75], v112, s[8:11], s53 offen offset:2048 sc1
    buffer_load_dwordx4 a[76:79], v112, s[8:11], s53 offen offset:3072 sc1
    s_add_u32 s53, s24, 8192
    buffer_load_dwordx4 a[80:83], v112, s[8:11], s53 offen offset:0 sc1
    buffer_load_dwordx4 a[84:87], v112, s[8:11], s53 offen offset:1024 sc1
    buffer_load_dwordx4 a[88:91], v112, s[8:11], s53 offen offset:2048 sc1
    buffer_load_dwordx4 a[92:95], v112, s[8:11], s53 offen offset:3072 sc1
    s_add_u32 s53, s24, 16384
    buffer_load_dwordx4 a[96:99], v112, s[8:11], s53 offen offset:0 sc1
    buffer_load_dwordx4 a[100:103], v112, s[8:11], s53 offen offset:1024 sc1
    buffer_load_dwordx4 a[104:107], v112, s[8:11], s53 offen offset:2048 sc1
    buffer_load_dwordx4 a[108:111], v112, s[8:11], s53 offen offset:3072 sc1
    s_lshl_b32 s6, s63, 14
    s_add_u32 s6, s6, s18
    s_add_u32 s6, s6, 0
    s_lshl_b32 s7, s63, 11
    s_add_u32 m0, s7, 131072
    s_nop 0
    buffer_load_dwordx4 v117, s[40:43], s6 offen offset:0 lds
    s_add_u32 m0, s7, 139136
    s_nop 0
    buffer_load_dwordx4 v117, s[40:43], s6 offen offset:128 lds
    s_add_u32 s6, s6, 8192
    s_add_u32 m0, s7, 132096
    s_nop 0
    buffer_load_dwordx4 v117, s[40:43], s6 offen offset:0 lds
    s_add_u32 m0, s7, 140160
    s_nop 0
    buffer_load_dwordx4 v117, s[40:43], s6 offen offset:128 lds
    s_lshl_b32 s6, s63, 14
    s_add_u32 s6, s6, s18
    s_add_u32 s6, s6, 65536
    s_lshl_b32 s7, s63, 11
    s_add_u32 m0, s7, 147456
    s_nop 0
    buffer_load_dwordx4 v117, s[40:43], s6 offen offset:0 lds
    s_add_u32 m0, s7, 155520
    s_nop 0
    buffer_load_dwordx4 v117, s[40:43], s6 offen offset:128 lds
    s_add_u32 s6, s6, 8192
    s_add_u32 m0, s7, 148480
    s_nop 0
    buffer_load_dwordx4 v117, s[40:43], s6 offen offset:0 lds
    s_add_u32 m0, s7, 156544
    s_nop 0
    buffer_load_dwordx4 v117, s[40:43], s6 offen offset:128 lds
    s_mov_b32 s79, 1
AT_LD2:
    s_cmp_gt_u32 s77, s62
    s_cbranch_scc1 AT_LDX
    s_barrier
    s_add_u32 s77, s77, 1
    s_cmp_le_u32 s71, s73
    s_cbranch_scc1 AT_LD4
    s_cmp_eq_u32 s79, 1
    s_cbranch_scc1 AT_LD5
    s_waitcnt vmcnt(0)
    s_branch AT_LDS
AT_LD5:
    s_mov_b32 s79, 2
    s_waitcnt vmcnt(20)
    s_branch AT_LDS
AT_LD4:
    s_min_u32 s6, s71, s73
    s_and_b32 s7, s72, 0xffff
    s_add_u32 m0, s7, s74
    s_add_u32 s52, s6, 4096
    buffer_load_dwordx4 v112, s[8:11], s6 offen offset:0 sc1 lds
    buffer_load_dwordx4 v112, s[8:11], s6 offen offset:1024 sc1 lds
    buffer_load_dwordx4 v112, s[8:11], s6 offen offset:2048 sc1 lds
    buffer_load_dwordx4 v112, s[8:11], s6 offen offset:3072 sc1 lds
    s_add_u32 m0, m0, 4096
    s_add_u32 s71, s71, 16384
    buffer_load_dwordx4 v112, s[8:11], s52 offen offset:0 sc1 lds
    buffer_load_dwordx4 v112, s[8:11], s52 offen offset:1024 sc1 lds
    buffer_load_dwordx4 v112, s[8:11], s52 offen offset:2048 sc1 lds
    buffer_load_dwordx4 v112, s[8:11], s52 offen offset:3072 sc1 lds
    s_add_u32 s72, s72, 16384
    s_cmp_eq_u32 s79, 1
    s_cbranch_scc1 AT_LD3
    s_waitcnt vmcnt(8)
    s_branch AT_LDS
AT_LD3:
    s_mov_b32 s79, 2
    s_waitcnt vmcnt(28)
AT_LDS:
    s_cmp_eq_u32 s78, 0x20000000
    s_cbranch_scc1 AT_LD
    v_mov_b32 v127, 1
    buffer_atomic_add v127, v123, s[8:11], s78 offen sc1
    s_mov_b32 s78, 0x20000000
    s_branch AT_LD
AT_PS:
    s_barrier
    s_min_u32 s6, s71, s73
    s_and_b32 s7, s72, 0xffff
    s_add_u32 m0, s7, s74
    s_add_u32 s52, s6, 4096
    buffer_load_dwordx4 v112, s[8:11], s6 offen offset:0 sc1 lds
    buffer_load_dwordx4 v112, s[8:11], s6 offen offset:1024 sc1 lds
    buffer_load_dwordx4 v112, s[8:11], s6 offen offset:2048 sc1 lds
    buffer_load_dwordx4 v112, s[8:11], s6 offen offset:3072 sc1 lds
    s_add_u32 m0, m0, 4096
    s_add_u32 s71, s71, 16384
    buffer_load_dwordx4 v112, s[8:11], s52 offen offset:0 sc1 lds
    buffer_load_dwordx4 v112, s[8:11], s52 offen offset:1024 sc1 lds
    buffer_load_dwordx4 v112, s[8:11], s52 offen offset:2048 sc1 lds
    buffer_load_dwordx4 v112, s[8:11], s52 offen offset:3072 sc1 lds
    s_add_u32 s72, s72, 16384
    s_add_u32 s53, s24, 0
    buffer_load_dwordx4 a[64:67], v112, s[8:11], s53 offen offset:0 sc1
    buffer_load_dwordx4 a[68:71], v112, s[8:11], s53 offen offset:1024 sc1
    buffer_load_dwordx4 a[72:75], v112, s[8:11], s53 offen offset:2048 sc1
    buffer_load_dwordx4 a[76:79], v112, s[8:11], s53 offen offset:3072 sc1
    s_waitcnt vmcnt(12)
    s_barrier
    s_min_u32 s6, s71, s73
    s_and_b32 s7, s72, 0xffff
    s_add_u32 m0, s7, s74
    s_add_u32 s52, s6, 4096
    buffer_load_dwordx4 v112, s[8:11], s6 offen offset:0 sc1 lds
    buffer_load_dwordx4 v112, s[8:11], s6 offen offset:1024 sc1 lds
    buffer_load_dwordx4 v112, s[8:11], s6 offen offset:2048 sc1 lds
    buffer_load_dwordx4 v112, s[8:11], s6 offen offset:3072 sc1 lds
    s_add_u32 m0, m0, 4096
    s_add_u32 s71, s71, 16384
    buffer_load_dwordx4 v112, s[8:11], s52 offen offset:0 sc1 lds
    buffer_load_dwordx4 v112, s[8:11], s52 offen offset:1024 sc1 lds
    buffer_load_dwordx4 v112, s[8:11], s52 offen offset:2048 sc1 lds
    buffer_load_dwordx4 v112, s[8:11], s52 offen offset:3072 sc1 lds
    s_add_u32 s72, s72, 16384
    s_add_u32 s53, s24, 8192
    buffer_load_dwordx4 a[80:83], v112, s[8:11], s53 offen offset:0 sc1
    buffer_load_dwordx4 a[84:87], v112, s[8:11], s53 offen offset:1024 sc1
    buffer_load_dwordx4 a[88:91], v112, s[8:11], s53 offen offset:2048 sc1
    buffer_load_dwordx4 a[92:95], v112, s[8:11], s53 offen offset:3072 sc1
    s_waitcnt vmcnt(16)
    s_barrier
    s_min_u32 s6, s71, s73
    s_and_b32 s7, s72, 0xffff
    s_add_u32 m0, s7, s74
    s_add_u32 s52, s6, 4096
    buffer_load_dwordx4 v112, s[8:11], s6 offen offset:0 sc1 lds
    buffer_load_dwordx4 v112, s[8:11], s6 offen offset:1024 sc1 lds
    buffer_load_dwordx4 v112, s[8:11], s6 offen offset:2048 sc1 lds
    buffer_load_dwordx4 v112, s[8:11], s6 offen offset:3072 sc1 lds
    s_add_u32 m0, m0, 4096
    s_add_u32 s71, s71, 16384
    buffer_load_dwordx4 v112, s[8:11], s52 offen offset:0 sc1 lds
    buffer_load_dwordx4 v112, s[8:11], s52 offen offset:1024 sc1 lds
    buffer_load_dwordx4 v112, s[8:11], s52 offen offset:2048 sc1 lds
    buffer_load_dwordx4 v112, s[8:11], s52 offen offset:3072 sc1 lds
    s_add_u32 s72, s72, 16384
    s_add_u32 s53, s24, 16384
    buffer_load_dwordx4 a[96:99], v112, s[8:11], s53 offen offset:0 sc1
    buffer_load_dwordx4 a[100:103], v112, s[8:11], s53 offen offset:1024 sc1
    buffer_load_dwordx4 a[104:107], v112, s[8:11], s53 offen offset:2048 sc1
    buffer_load_dwordx4 a[108:111], v112, s[8:11], s53 offen offset:3072 sc1
    s_waitcnt vmcnt(16)
    s_barrier
    s_min_u32 s6, s71, s73
    s_and_b32 s7, s72, 0xffff
    s_add_u32 m0, s7, s74
    s_add_u32 s52, s6, 4096
    buffer_load_dwordx4 v112, s[8:11], s6 offen offset:0 sc1 lds
    buffer_load_dwordx4 v112, s[8:11], s6 offen offset:1024 sc1 lds
    buffer_load_dwordx4 v112, s[8:11], s6 offen offset:2048 sc1 lds
    buffer_load_dwordx4 v112, s[8:11], s6 offen offset:3072 sc1 lds
    s_add_u32 m0, m0, 4096
    s_add_u32 s71, s71, 16384
    buffer_load_dwordx4 v112, s[8:11], s52 offen offset:0 sc1 lds
    buffer_load_dwordx4 v112, s[8:11], s52 offen offset:1024 sc1 lds
    buffer_load_dwordx4 v112, s[8:11], s52 offen offset:2048 sc1 lds
    buffer_load_dwordx4 v112, s[8:11], s52 offen offset:3072 sc1 lds
    s_add_u32 s72, s72, 16384
    s_lshl_b32 s6, s63, 14
    s_add_u32 s6, s6, s18
    s_add_u32 s6, s6, 0
    s_lshl_b32 s7, s63, 11
    s_add_u32 m0, s7, 131072
    s_nop 0
    buffer_load_dwordx4 v117, s[40:43], s6 offen offset:0 lds
    s_add_u32 m0, s7, 139136
    s_nop 0
    buffer_load_dwordx4 v117, s[40:43], s6 offen offset:128 lds
    s_add_u32 s6, s6, 8192
    s_add_u32 m0, s7, 132096
    s_nop 0
    buffer_load_dwordx4 v117, s[40:43], s6 offen offset:0 lds
    s_add_u32 m0, s7, 140160
    s_nop 0
    buffer_load_dwordx4 v117, s[40:43], s6 offen offset:128 lds
    s_waitcnt vmcnt(16)
    s_barrier
    s_min_u32 s6, s71, s73
    s_and_b32 s7, s72, 0xffff
    s_add_u32 m0, s7, s74
    s_add_u32 s52, s6, 4096
    buffer_load_dwordx4 v112, s[8:11], s6 offen offset:0 sc1 lds
    buffer_load_dwordx4 v112, s[8:11], s6 offen offset:1024 sc1 lds
    buffer_load_dwordx4 v112, s[8:11], s6 offen offset:2048 sc1 lds
    buffer_load_dwordx4 v112, s[8:11], s6 offen offset:3072 sc1 lds
    s_add_u32 m0, m0, 4096
    s_add_u32 s71, s71, 16384
    buffer_load_dwordx4 v112, s[8:11], s52 offen offset:0 sc1 lds
    buffer_load_dwordx4 v112, s[8:11], s52 offen offset:1024 sc1 lds
    buffer_load_dwordx4 v112, s[8:11], s52 offen offset:2048 sc1 lds
    buffer_load_dwordx4 v112, s[8:11], s52 offen offset:3072 sc1 lds
    s_add_u32 s72, s72, 16384
    s_lshl_b32 s6, s63, 14
    s_add_u32 s6, s6, s18
    s_add_u32 s6, s6, 65536
    s_lshl_b32 s7, s63, 11
    s_add_u32 m0, s7, 147456
    s_nop 0
    buffer_load_dwordx4 v117, s[40:43], s6 offen offset:0 lds
    s_add_u32 m0, s7, 155520
    s_nop 0
    buffer_load_dwordx4 v117, s[40:43], s6 offen offset:128 lds
    s_add_u32 s6, s6, 8192
    s_add_u32 m0, s7, 148480
    s_nop 0
    buffer_load_dwordx4 v117, s[40:43], s6 offen offset:0 lds
    s_add_u32 m0, s7, 156544
    s_nop 0
    buffer_load_dwordx4 v117, s[40:43], s6 offen offset:128 lds
    s_waitcnt vmcnt(16)
    s_add_u32 s77, s77, 5
    s_mov_b32 s79, 2
    s_branch AT_LDS
AT_TS:
    s_barrier
    s_min_u32 s6, s71, s73
    s_and_b32 s7, s72, 0xffff
    s_add_u32 m0, s7, s74
    s_add_u32 s52, s6, 4096
    buffer_load_dwordx4 v112, s[8:11], s6 offen offset:0 sc1 lds
    buffer_load_dwordx4 v112, s[8:11], s6 offen offset:1024 sc1 lds
    buffer_load_dwordx4 v112, s[8:11], s6 offen offset:2048 sc1 lds
    buffer_load_dwordx4 v112, s[8:11], s6 offen offset:3072 sc1 lds
    s_add_u32 m0, m0, 4096
    s_add_u32 s71, s71, 16384
    buffer_load_dwordx4 v112, s[8:11], s52 offen offset:0 sc1 lds
    buffer_load_dwordx4 v112, s[8:11], s52 offen offset:1024 sc1 lds
    buffer_load_dwordx4 v112, s[8:11], s52 offen offset:2048 sc1 lds
    buffer_load_dwordx4 v112, s[8:11], s52 offen offset:3072 sc1 lds
    s_add_u32 s72, s72, 16384
    v_lshrrev_b32 v125, 7, v112
    v_and_b32 v127, 0x380, v126
    v_lshl_add_u32 v127, v125, 10, v127
    s_lshl_b32 s6, s4, 2
    s_add_u32 s6, s6, s63
    s_sub_u32 s6, s6, 32
    s_mov_b32 s52, 0
    s_lshl_b32 s6, s6, 13
    s_lshl_b32 s7, s26, 16
    s_add_u32 s6, s6, s7
    s_add_u32 s6, s6, s52
    buffer_load_dword v124, v127, s[40:43], s6 offen
    s_waitcnt vmcnt(9)
    s_barrier
    s_min_u32 s6, s71, s73
    s_and_b32 s7, s72, 0xffff
    s_add_u32 m0, s7, s74
    s_add_u32 s52, s6, 4096
    buffer_load_dwordx4 v112, s[8:11], s6 offen offset:0 sc1 lds
    buffer_load_dwordx4 v112, s[8:11], s6 offen offset:1024 sc1 lds
    buffer_load_dwordx4 v112, s[8:11], s6 offen offset:2048 sc1 lds
    buffer_load_dwordx4 v112, s[8:11], s6 offen offset:3072 sc1 lds
    s_add_u32 m0, m0, 4096
    s_add_u32 s71, s71, 16384
    buffer_load_dwordx4 v112, s[8:11], s52 offen offset:0 sc1 lds
    buffer_load_dwordx4 v112, s[8:11], s52 offen offset:1024 sc1 lds
    buffer_load_dwordx4 v112, s[8:11], s52 offen offset:2048 sc1 lds
    buffer_load_dwordx4 v112, s[8:11], s52 offen offset:3072 sc1 lds
    s_add_u32 s72, s72, 16384
    v_lshrrev_b32 v125, 7, v112
    v_and_b32 v127, 0x380, v126
    v_lshl_add_u32 v127, v125, 10, v127
    s_lshl_b32 s6, s4, 2
    s_add_u32 s6, s6, s63
    s_sub_u32 s6, s6, 32
    s_cmp_ge_u32 s6, 128
    s_cselect_b32 s52, 0x20000000, 0
    s_lshl_b32 s6, s6, 13
    s_lshl_b32 s7, s12, 20
    s_add_u32 s6, s6, s7
    s_add_u32 s6, s6, s52
    buffer_load_dword v124, v127, s[36:39], s6 offen
    s_waitcnt vmcnt(10)
    s_barrier
    s_min_u32 s6, s71, s73
    s_and_b32 s7, s72, 0xffff
    s_add_u32 m0, s7, s74
    s_add_u32 s52, s6, 4096
    buffer_load_dwordx4 v112, s[8:11], s6 offen offset:0 sc1 lds
    buffer_load_dwordx4 v112, s[8:11], s6 offen offset:1024 sc1 lds
    buffer_load_dwordx4 v112, s[8:11], s6 offen offset:2048 sc1 lds
    buffer_load_dwordx4 v112, s[8:11], s6 offen offset:3072 sc1 lds
    s_add_u32 m0, m0, 4096
    s_add_u32 s71, s71, 16384
    buffer_load_dwordx4 v112, s[8:11], s52 offen offset:0 sc1 lds
    buffer_load_dwordx4 v112, s[8:11], s52 offen offset:1024 sc1 lds
    buffer_load_dwordx4 v112, s[8:11], s52 offen offset:2048 sc1 lds
    buffer_load_dwordx4 v112, s[8:11], s52 offen offset:3072 sc1 lds
    s_add_u32 s72, s72, 16384
    v_lshrrev_b32 v125, 7, v112
    v_and_b32 v127, 0x380, v126
    v_lshl_add_u32 v127, v125, 10, v127
    s_lshl_b32 s6, s4, 2
    s_add_u32 s6, s6, s63
    s_sub_u32 s6, s6, 32
    s_add_u32 s6, s6, 64
    s_cmp_ge_u32 s6, 128
    s_cselect_b32 s52, 0x20000000, 0
    s_lshl_b32 s6, s6, 13
    s_lshl_b32 s7, s12, 20
    s_add_u32 s6, s6, s7
    s_add_u32 s6, s6, s52
    buffer_load_dword v124, v127, s[36:39], s6 offen
    s_waitcnt vmcnt(10)
    s_add_u32 s77, s77, 3
    s_branch AT_LDS
AT_LDX:
    s_lshl_b32 s6, s63, 14
    s_add_u32 s6, s6, s18
    s_add_u32 s6, s6, 131072
    s_lshl_b32 s7, s63, 11
    s_add_u32 m0, s7, 0
    s_nop 0
    buffer_load_dwordx4 v117, s[40:43], s6 offen offset:0 lds
    s_add_u32 m0, s7, 8064
    s_nop 0
    buffer_load_dwordx4 v117, s[40:43], s6 offen offset:128 lds
    s_add_u32 s6, s6, 8192
    s_add_u32 m0, s7, 1024
    s_nop 0
    buffer_load_dwordx4 v117, s[40:43], s6 offen offset:0 lds
    s_add_u32 m0, s7, 9088
    s_nop 0
    buffer_load_dwordx4 v117, s[40:43], s6 offen offset:128 lds
    s_lshl_b32 s6, s63, 14
    s_add_u32 s6, s6, s18
    s_add_u32 s6, s6, 196608
    s_lshl_b32 s7, s63, 11
    s_add_u32 m0, s7, 16384
    s_nop 0
    buffer_load_dwordx4 v117, s[40:43], s6 offen offset:0 lds
    s_add_u32 m0, s7, 24448
    s_nop 0
    buffer_load_dwordx4 v117, s[40:43], s6 offen offset:128 lds
    s_add_u32 s6, s6, 8192
    s_add_u32 m0, s7, 17408
    s_nop 0
    buffer_load_dwordx4 v117, s[40:43], s6 offen offset:0 lds
    s_add_u32 m0, s7, 25472
    s_nop 0
    buffer_load_dwordx4 v117, s[40:43], s6 offen offset:128 lds
    s_lshl_b32 s6, s63, 14
    s_add_u32 s6, s6, s18
    s_add_u32 s6, s6, 262144
    s_lshl_b32 s7, s63, 11
    s_add_u32 m0, s7, 32768
    s_nop 0
    buffer_load_dwordx4 v117, s[40:43], s6 offen offset:0 lds
    s_add_u32 m0, s7, 40832
    s_nop 0
    buffer_load_dwordx4 v117, s[40:43], s6 offen offset:128 lds
    s_add_u32 s6, s6, 8192
    s_add_u32 m0, s7, 33792
    s_nop 0
    buffer_load_dwordx4 v117, s[40:43], s6 offen offset:0 lds
    s_add_u32 m0, s7, 41856
    s_nop 0
    buffer_load_dwordx4 v117, s[40:43], s6 offen offset:128 lds
    s_lshl_b32 s6, s63, 14
    s_add_u32 s6, s6, s18
    s_add_u32 s6, s6, 327680
    s_lshl_b32 s7, s63, 11
    s_add_u32 m0, s7, 49152
    s_nop 0
    buffer_load_dwordx4 v117, s[40:43], s6 offen offset:0 lds
    s_add_u32 m0, s7, 57216
    s_nop 0
    buffer_load_dwordx4 v117, s[40:43], s6 offen offset:128 lds
    s_add_u32 s6, s6, 8192
    s_add_u32 m0, s7, 50176
    s_nop 0
    buffer_load_dwordx4 v117, s[40:43], s6 offen offset:0 lds
    s_add_u32 m0, s7, 58240
    s_nop 0
    buffer_load_dwordx4 v117, s[40:43], s6 offen offset:128 lds
P4_JOINF:
    v_mov_b32 v127, 1
    s_waitcnt vmcnt(0)
    buffer_atomic_add v127, v123, s[8:11], s78 offen sc1
    s_barrier
    s_bitcmp1_b32 s12, 0
    s_cbranch_scc1 P4_SHORT
    v_add_u32 v113, 0x20000, v113
    ds_read_b64_tr_b16 v[64:65], v113 offset:0
    ds_read_b64_tr_b16 v[66:67], v113 offset:2048
    v_add_u32 v114, 0x20000, v114
    ds_read_b64_tr_b16 v[68:69], v114 offset:0
    ds_read_b64_tr_b16 v[70:71], v114 offset:2048
    v_add_u32 v115, 0x20000, v115
    ds_read_b64_tr_b16 v[72:73], v115 offset:0
    ds_read_b64_tr_b16 v[74:75], v115 offset:2048
    v_add_u32 v116, 0x20000, v116
    ds_read_b64_tr_b16 v[76:77], v116 offset:0
    ds_read_b64_tr_b16 v[78:79], v116 offset:2048
    ds_read_b64_tr_b16 v[80:81], v113 offset:4096
    ds_read_b64_tr_b16 v[82:83], v113 offset:6144
    ds_read_b64_tr_b16 v[84:85], v114 offset:4096
    ds_read_b64_tr_b16 v[86:87], v114 offset:6144
    s_waitcnt lgkmcnt(8)
    v_mfma_f32_16x16x32_bf16 v[0:3], v[64:67], a[64:67], 0
    ds_read_b64_tr_b16 v[88:89], v115 offset:4096
    s_add_u32 m0, s57, 65536
    v_mfma_f32_16x16x32_bf16 v[4:7], v[64:67], a[68:71], 0
    ds_read_b64_tr_b16 v[90:91], v115 offset:6144
    s_add_u32 s52, s18, 393216
    s_add_u32 s53, s24, 24576
    v_mfma_f32_16x16x32_bf16 v[8:11], v[68:71], a[64:67], 0
    ds_read_b64_tr_b16 v[92:93], v116 offset:4096
    buffer_load_dwordx4 v118, s[40:43], s52 offen lds
    buffer_load_dwordx4 a[112:115], v112, s[8:11], s53 offen offset:0 sc1
    v_mfma_f32_16x16x32_bf16 v[12:15], v[68:71], a[68:71], 0
    ds_read_b64_tr_b16 v[94:95], v116 offset:6144
    s_add_u32 m0, s57, 73600
    buffer_load_dwordx4 a[116:119], v112, s[8:11], s53 offen offset:1024 sc1
    s_waitcnt lgkmcnt(8)
    v_mfma_f32_16x16x32_bf16 v[16:19], v[72:75], a[64:67], 0
    ds_read_b64_tr_b16 v[64:65], v113 offset:8192
    s_nop 0
    buffer_load_dwordx4 a[120:123], v112, s[8:11], s53 offen offset:2048 sc1
    v_mfma_f32_16x16x32_bf16 v[20:23], v[72:75], a[68:71], 0
    ds_read_b64_tr_b16 v[66:67], v113 offset:10240
    buffer_load_dwordx4 v118, s[40:43], s52 offen offset:128 lds
    buffer_load_dwordx4 a[124:127], v112, s[8:11], s53 offen offset:3072 sc1
    v_mfma_f32_16x16x32_bf16 v[24:27], v[76:79], a[64:67], 0
    ds_read_b64_tr_b16 v[68:69], v114 offset:8192
    s_add_u32 m0, s57, 81920
    v_mfma_f32_16x16x32_bf16 v[28:31], v[76:79], a[68:71], 0
    ds_read_b64_tr_b16 v[70:71], v114 offset:10240
    s_add_u32 s52, s18, 458752
    s_waitcnt lgkmcnt(8)
    v_mfma_f32_16x16x32_bf16 v[0:3], v[80:83], a[72:75], v[0:3]
    ds_read_b64_tr_b16 v[72:73], v115 offset:8192
    buffer_load_dwordx4 v118, s[40:43], s52 offen lds
    v_mfma_f32_16x16x32_bf16 v[4:7], v[80:83], a[76:79], v[4:7]
    ds_read_b64_tr_b16 v[74:75], v115 offset:10240
    s_add_u32 m0, s57, 89984
    v_mfma_f32_16x16x32_bf16 v[8:11], v[84:87], a[72:75], v[8:11]
    ds_read_b64_tr_b16 v[76:77], v116 offset:8192
    s_nop 0
    v_mfma_f32_16x16x32_bf16 v[12:15], v[84:87], a[76:79], v[12:15]
    ds_read_b64_tr_b16 v[78:79], v116 offset:10240
    buffer_load_dwordx4 v118, s[40:43], s52 offen offset:128 lds
    s_waitcnt lgkmcnt(8)
    v_mfma_f32_16x16x32_bf16 v[16:19], v[88:91], a[72:75], v[16:19]
    ds_read_b64_tr_b16 v[80:81], v113 offset:12288
    s_add_u32 m0, s57, 98304
    v_mfma_f32_16x16x32_bf16 v[20:23], v[88:91], a[76:79], v[20:23]
    ds_read_b64_tr_b16 v[82:83], v113 offset:14336
    s_add_u32 s52, s19, 0
    v_mfma_f32_16x16x32_bf16 v[24:27], v[92:95], a[72:75], v[24:27]
    ds_read_b64_tr_b16 v[84:85], v114 offset:12288
    buffer_load_dwordx4 v118, s[36:39], s52 offen lds
    v_mfma_f32_16x16x32_bf16 v[28:31], v[92:95], a[76:79], v[28:31]
    ds_read_b64_tr_b16 v[86:87], v114 offset:14336
    s_add_u32 m0, s57, 106368
    s_barrier
    s_waitcnt lgkmcnt(8)
    v_mfma_f32_16x16x32_bf16 v[32:35], v[64:67], a[64:67], 0
    ds_read_b64_tr_b16 v[88:89], v115 offset:12288
    s_nop 0
    v_mfma_f32_16x16x32_bf16 v[36:39], v[64:67], a[68:71], 0
    ds_read_b64_tr_b16 v[90:91], v115 offset:14336
    buffer_load_dwordx4 v118, s[36:39], s52 offen offset:128 lds
    v_mfma_f32_16x16x32_bf16 v[40:43], v[68:71], a[64:67], 0
    ds_read_b64_tr_b16 v[92:93], v116 offset:12288
    s_add_u32 m0, s57, 114688
    v_mfma_f32_16x16x32_bf16 v[44:47], v[68:71], a[68:71], 0
    ds_read_b64_tr_b16 v[94:95], v116 offset:14336
    s_add_u32 s52, s19, 65536
    s_waitcnt lgkmcnt(8)
    v_mfma_f32_16x16x32_bf16 v[48:51], v[72:75], a[64:67], 0
    v_add_u32 v113, 0xfffe0000, v113
    ds_read_b64_tr_b16 v[64:65], v113 offset:0
    buffer_load_dwordx4 v118, s[36:39], s52 offen lds
    v_mfma_f32_16x16x32_bf16 v[52:55], v[72:75], a[68:71], 0
    ds_read_b64_tr_b16 v[66:67], v113 offset:2048
    s_add_u32 m0, s57, 122752
    v_mfma_f32_16x16x32_bf16 v[56:59], v[76:79], a[64:67], 0
    v_add_u32 v114, 0xfffe0000, v114
    ds_read_b64_tr_b16 v[68:69], v114 offset:0
    s_nop 0
    v_mfma_f32_16x16x32_bf16 v[60:63], v[76:79], a[68:71], 0
    ds_read_b64_tr_b16 v[70:71], v114 offset:2048
    buffer_load_dwordx4 v118, s[36:39], s52 offen offset:128 lds
    s_waitcnt lgkmcnt(8)
    v_mfma_f32_16x16x32_bf16 v[32:35], v[80:83], a[72:75], v[32:35]
    v_add_u32 v115, 0xfffe0000, v115
    ds_read_b64_tr_b16 v[72:73], v115 offset:0
    buffer_load_dword v125, off, s[8:11], s27 sc1
    v_mfma_f32_16x16x32_bf16 v[36:39], v[80:83], a[76:79], v[36:39]
    ds_read_b64_tr_b16 v[74:75], v115 offset:2048
    v_mfma_f32_16x16x32_bf16 v[40:43], v[84:87], a[72:75], v[40:43]
    v_add_u32 v116, 0xfffe0000, v116
    ds_read_b64_tr_b16 v[76:77], v116 offset:0
    v_mfma_f32_16x16x32_bf16 v[44:47], v[84:87], a[76:79], v[44:47]
    ds_read_b64_tr_b16 v[78:79], v116 offset:2048
    s_waitcnt lgkmcnt(8)
    v_mfma_f32_16x16x32_bf16 v[48:51], v[88:91], a[72:75], v[48:51]
    ds_read_b64_tr_b16 v[80:81], v113 offset:4096
    v_mfma_f32_16x16x32_bf16 v[52:55], v[88:91], a[76:79], v[52:55]
    ds_read_b64_tr_b16 v[82:83], v113 offset:6144
    v_mfma_f32_16x16x32_bf16 v[56:59], v[92:95], a[72:75], v[56:59]
    ds_read_b64_tr_b16 v[84:85], v114 offset:4096
    v_mfma_f32_16x16x32_bf16 v[60:63], v[92:95], a[76:79], v[60:63]
    ds_read_b64_tr_b16 v[86:87], v114 offset:6144
    s_waitcnt lgkmcnt(8)
    v_mfma_f32_16x16x32_bf16 v[0:3], v[64:67], a[80:83], v[0:3]
    ds_read_b64_tr_b16 v[88:89], v115 offset:4096
    v_mfma_f32_16x16x32_bf16 v[4:7], v[64:67], a[84:87], v[4:7]
    ds_read_b64_tr_b16 v[90:91], v115 offset:6144
    v_mfma_f32_16x16x32_bf16 v[8:11], v[68:71], a[80:83], v[8:11]
    ds_read_b64_tr_b16 v[92:93], v116 offset:4096
    v_mfma_f32_16x16x32_bf16 v[12:15], v[68:71], a[84:87], v[12:15]
    ds_read_b64_tr_b16 v[94:95], v116 offset:6144
    s_waitcnt lgkmcnt(8)
    v_mfma_f32_16x16x32_bf16 v[16:19], v[72:75], a[80:83], v[16:19]
    ds_read_b64_tr_b16 v[64:65], v113 offset:8192
    v_mfma_f32_16x16x32_bf16 v[20:23], v[72:75], a[84:87], v[20:23]
    ds_read_b64_tr_b16 v[66:67], v113 offset:10240
    v_mfma_f32_16x16x32_bf16 v[24:27], v[76:79], a[80:83], v[24:27]
    ds_read_b64_tr_b16 v[68:69], v114 offset:8192
    v_mfma_f32_16x16x32_bf16 v[28:31], v[76:79], a[84:87], v[28:31]
    ds_read_b64_tr_b16 v[70:71], v114 offset:10240
    s_waitcnt lgkmcnt(8)
    v_mfma_f32_16x16x32_bf16 v[0:3], v[80:83], a[88:91], v[0:3]
    ds_read_b64_tr_b16 v[72:73], v115 offset:8192
    s_waitcnt vmcnt(0)
    v_readfirstlane_b32 s6, v125
    s_mov_b32 s7, 0
    s_cmp_ge_u32 s6, 8
    s_cbranch_scc1 PK_23
PL_24:
    s_sleep 4
    buffer_load_dword v125, off, s[8:11], s27 sc1
    s_add_u32 s7, s7, 1
    s_waitcnt vmcnt(0)
    v_readfirstlane_b32 s6, v125
    s_cmp_ge_u32 s7, 0x40000
    s_cbranch_scc1 PK_23
    s_cmp_lt_u32 s6, 8
    s_cbranch_scc1 PL_24
PK_23:
    v_mfma_f32_16x16x32_bf16 v[4:7], v[80:83], a[92:95], v[4:7]
    ds_read_b64_tr_b16 v[74:75], v115 offset:10240
    s_add_u32 s53, s25, 0
    v_mfma_f32_16x16x32_bf16 v[8:11], v[84:87], a[88:91], v[8:11]
    ds_read_b64_tr_b16 v[76:77], v116 offset:8192
    buffer_load_dwordx4 a[0:3], v112, s[8:11], s53 offen offset:0 sc1
    v_mfma_f32_16x16x32_bf16 v[12:15], v[84:87], a[92:95], v[12:15]
    ds_read_b64_tr_b16 v[78:79], v116 offset:10240
    buffer_load_dwordx4 a[4:7], v112, s[8:11], s53 offen offset:1024 sc1
    s_waitcnt lgkmcnt(8)
    v_mfma_f32_16x16x32_bf16 v[16:19], v[88:91], a[88:91], v[16:19]
    ds_read_b64_tr_b16 v[80:81], v113 offset:12288
    buffer_load_dwordx4 a[8:11], v112, s[8:11], s53 offen offset:2048 sc1
    v_mfma_f32_16x16x32_bf16 v[20:23], v[88:91], a[92:95], v[20:23]
    ds_read_b64_tr_b16 v[82:83], v113 offset:14336
    buffer_load_dwordx4 a[12:15], v112, s[8:11], s53 offen offset:3072 sc1
    v_mfma_f32_16x16x32_bf16 v[24:27], v[92:95], a[88:91], v[24:27]
    ds_read_b64_tr_b16 v[84:85], v114 offset:12288
    s_add_u32 s53, s25, 8192
    v_mfma_f32_16x16x32_bf16 v[28:31], v[92:95], a[92:95], v[28:31]
    ds_read_b64_tr_b16 v[86:87], v114 offset:14336
    buffer_load_dwordx4 a[16:19], v112, s[8:11], s53 offen offset:0 sc1
    s_barrier
    s_waitcnt lgkmcnt(8)
    v_mfma_f32_16x16x32_bf16 v[32:35], v[64:67], a[80:83], v[32:35]
    ds_read_b64_tr_b16 v[88:89], v115 offset:12288
    s_add_u32 m0, s57, 131072
    buffer_load_dwordx4 a[20:23], v112, s[8:11], s53 offen offset:1024 sc1
    v_mfma_f32_16x16x32_bf16 v[36:39], v[64:67], a[84:87], v[36:39]
    ds_read_b64_tr_b16 v[90:91], v115 offset:14336
    s_add_u32 s52, s19, 131072
    buffer_load_dwordx4 a[24:27], v112, s[8:11], s53 offen offset:2048 sc1
    v_mfma_f32_16x16x32_bf16 v[40:43], v[68:71], a[80:83], v[40:43]
    ds_read_b64_tr_b16 v[92:93], v116 offset:12288
    buffer_load_dwordx4 v118, s[36:39], s52 offen lds
    buffer_load_dwordx4 a[28:31], v112, s[8:11], s53 offen offset:3072 sc1
    v_mfma_f32_16x16x32_bf16 v[44:47], v[68:71], a[84:87], v[44:47]
    ds_read_b64_tr_b16 v[94:95], v116 offset:14336
    s_add_u32 m0, s57, 139136
    s_waitcnt lgkmcnt(8)
    v_mfma_f32_16x16x32_bf16 v[48:51], v[72:75], a[80:83], v[48:51]
    v_add_u32 v113, 0x8000, v113
    ds_read_b64_tr_b16 v[64:65], v113 offset:0
    s_nop 0
    v_mfma_f32_16x16x32_bf16 v[52:55], v[72:75], a[84:87], v[52:55]
    ds_read_b64_tr_b16 v[66:67], v113 offset:2048
    buffer_load_dwordx4 v118, s[36:39], s52 offen offset:128 lds
    v_mfma_f32_16x16x32_bf16 v[56:59], v[76:79], a[80:83], v[56:59]
    v_add_u32 v114, 0x8000, v114
    ds_read_b64_tr_b16 v[68:69], v114 offset:0
    s_add_u32 m0, s57, 147456
    v_mfma_f32_16x16x32_bf16 v[60:63], v[76:79], a[84:87], v[60:63]
    ds_read_b64_tr_b16 v[70:71], v114 offset:2048
    s_add_u32 s52, s19, 196608
    s_waitcnt lgkmcnt(8)
    v_mfma_f32_16x16x32_bf16 v[32:35], v[80:83], a[88:91], v[32:35]
    v_add_u32 v115, 0x8000, v115
    ds_read_b64_tr_b16 v[72:73], v115 offset:0
    buffer_load_dwordx4 v118, s[36:39], s52 offen lds
    v_mfma_f32_16x16x32_bf16 v[36:39], v[80:83], a[92:95], v[36:39]
    ds_read_b64_tr_b16 v[74:75], v115 offset:2048
    s_add_u32 m0, s57, 155520
    v_mfma_f32_16x16x32_bf16 v[40:43], v[84:87], a[88:91], v[40:43]
    v_add_u32 v116, 0x8000, v116
    ds_read_b64_tr_b16 v[76:77], v116 offset:0
    s_nop 0
    v_mfma_f32_16x16x32_bf16 v[44:47], v[84:87], a[92:95], v[44:47]
    ds_read_b64_tr_b16 v[78:79], v116 offset:2048
    buffer_load_dwordx4 v118, s[36:39], s52 offen offset:128 lds
    s_waitcnt lgkmcnt(8)
    v_mfma_f32_16x16x32_bf16 v[48:51], v[88:91], a[88:91], v[48:51]
    ds_read_b64_tr_b16 v[80:81], v113 offset:4096
    v_mfma_f32_16x16x32_bf16 v[52:55], v[88:91], a[92:95], v[52:55]
    ds_read_b64_tr_b16 v[82:83], v113 offset:6144
    v_mfma_f32_16x16x32_bf16 v[56:59], v[92:95], a[88:91], v[56:59]
    ds_read_b64_tr_b16 v[84:85], v114 offset:4096
    v_mfma_f32_16x16x32_bf16 v[60:63], v[92:95], a[92:95], v[60:63]
    ds_read_b64_tr_b16 v[86:87], v114 offset:6144
    s_waitcnt lgkmcnt(8)
    v_mfma_f32_16x16x32_bf16 v[0:3], v[64:67], a[96:99], v[0:3]
    ds_read_b64_tr_b16 v[88:89], v115 offset:4096
    s_add_u32 s53, s25, 16384
    v_mfma_f32_16x16x32_bf16 v[4:7], v[64:67], a[100:103], v[4:7]
    ds_read_b64_tr_b16 v[90:91], v115 offset:6144
    buffer_load_dwordx4 a[32:35], v112, s[8:11], s53 offen offset:0 sc1
    v_mfma_f32_16x16x32_bf16 v[8:11], v[68:71], a[96:99], v[8:11]
    ds_read_b64_tr_b16 v[92:93], v116 offset:4096
    buffer_load_dwordx4 a[36:39], v112, s[8:11], s53 offen offset:1024 sc1
    v_mfma_f32_16x16x32_bf16 v[12:15], v[68:71], a[100:103], v[12:15]
    ds_read_b64_tr_b16 v[94:95], v116 offset:6144
    buffer_load_dwordx4 a[40:43], v112, s[8:11], s53 offen offset:2048 sc1
    s_waitcnt lgkmcnt(8)
    v_mfma_f32_16x16x32_bf16 v[16:19], v[72:75], a[96:99], v[16:19]
    ds_read_b64_tr_b16 v[64:65], v113 offset:8192
    buffer_load_dwordx4 a[44:47], v112, s[8:11], s53 offen offset:3072 sc1
    v_mfma_f32_16x16x32_bf16 v[20:23], v[72:75], a[100:103], v[20:23]
    ds_read_b64_tr_b16 v[66:67], v113 offset:10240
    v_mfma_f32_16x16x32_bf16 v[24:27], v[76:79], a[96:99], v[24:27]
    ds_read_b64_tr_b16 v[68:69], v114 offset:8192
    v_mfma_f32_16x16x32_bf16 v[28:31], v[76:79], a[100:103], v[28:31]
    ds_read_b64_tr_b16 v[70:71], v114 offset:10240
    s_waitcnt lgkmcnt(8)
    v_mfma_f32_16x16x32_bf16 v[0:3], v[80:83], a[104:107], v[0:3]
    ds_read_b64_tr_b16 v[72:73], v115 offset:8192
    v_mfma_f32_16x16x32_bf16 v[4:7], v[80:83], a[108:111], v[4:7]
    ds_read_b64_tr_b16 v[74:75], v115 offset:10240
    v_mfma_f32_16x16x32_bf16 v[8:11], v[84:87], a[104:107], v[8:11]
    ds_read_b64_tr_b16 v[76:77], v116 offset:8192
    v_mfma_f32_16x16x32_bf16 v[12:15], v[84:87], a[108:111], v[12:15]
    ds_read_b64_tr_b16 v[78:79], v116 offset:10240
    s_waitcnt lgkmcnt(8)
    v_mfma_f32_16x16x32_bf16 v[16:19], v[88:91], a[104:107], v[16:19]
    ds_read_b64_tr_b16 v[80:81], v113 offset:12288
    v_mfma_f32_16x16x32_bf16 v[20:23], v[88:91], a[108:111], v[20:23]
    ds_read_b64_tr_b16 v[82:83], v113 offset:14336
    v_mfma_f32_16x16x32_bf16 v[24:27], v[92:95], a[104:107], v[24:27]
    ds_read_b64_tr_b16 v[84:85], v114 offset:12288
    v_mfma_f32_16x16x32_bf16 v[28:31], v[92:95], a[108:111], v[28:31]
    ds_read_b64_tr_b16 v[86:87], v114 offset:14336
    s_barrier
    s_waitcnt lgkmcnt(8)
    v_mfma_f32_16x16x32_bf16 v[32:35], v[64:67], a[96:99], v[32:35]
    ds_read_b64_tr_b16 v[88:89], v115 offset:12288
    s_add_u32 m0, s57, 0
    v_mfma_f32_16x16x32_bf16 v[36:39], v[64:67], a[100:103], v[36:39]
    ds_read_b64_tr_b16 v[90:91], v115 offset:14336
    s_add_u32 s52, s19, 262144
    v_mfma_f32_16x16x32_bf16 v[40:43], v[68:71], a[96:99], v[40:43]
    ds_read_b64_tr_b16 v[92:93], v116 offset:12288
    buffer_load_dwordx4 v118, s[36:39], s52 offen lds
    v_mfma_f32_16x16x32_bf16 v[44:47], v[68:71], a[100:103], v[44:47]
    ds_read_b64_tr_b16 v[94:95], v116 offset:14336
    s_add_u32 m0, s57, 8064
    s_waitcnt lgkmcnt(8)
    v_mfma_f32_16x16x32_bf16 v[48:51], v[72:75], a[96:99], v[48:51]
    v_add_u32 v113, 0x8000, v113
    ds_read_b64_tr_b16 v[64:65], v113 offset:0
    s_nop 0
    v_mfma_f32_16x16x32_bf16 v[52:55], v[72:75], a[100:103], v[52:55]
    ds_read_b64_tr_b16 v[66:67], v113 offset:2048
    buffer_load_dwordx4 v118, s[36:39], s52 offen offset:128 lds
    v_mfma_f32_16x16x32_bf16 v[56:59], v[76:79], a[96:99], v[56:59]
    v_add_u32 v114, 0x8000, v114
    ds_read_b64_tr_b16 v[68:69], v114 offset:0
    s_add_u32 m0, s57, 16384
    v_mfma_f32_16x16x32_bf16 v[60:63], v[76:79], a[100:103], v[60:63]
    ds_read_b64_tr_b16 v[70:71], v114 offset:2048
    s_add_u32 s52, s19, 327680
    s_waitcnt lgkmcnt(8)
    v_mfma_f32_16x16x32_bf16 v[32:35], v[80:83], a[104:107], v[32:35]
    v_add_u32 v115, 0x8000, v115
    ds_read_b64_tr_b16 v[72:73], v115 offset:0
    buffer_load_dwordx4 v118, s[36:39], s52 offen lds
    v_mfma_f32_16x16x32_bf16 v[36:39], v[80:83], a[108:111], v[36:39]
    ds_read_b64_tr_b16 v[74:75], v115 offset:2048
    s_add_u32 m0, s57, 24448
    v_mfma_f32_16x16x32_bf16 v[40:43], v[84:87], a[104:107], v[40:43]
    v_add_u32 v116, 0x8000, v116
    ds_read_b64_tr_b16 v[76:77], v116 offset:0
    s_nop 0
    v_mfma_f32_16x16x32_bf16 v[44:47], v[84:87], a[108:111], v[44:47]
    ds_read_b64_tr_b16 v[78:79], v116 offset:2048
    buffer_load_dwordx4 v118, s[36:39], s52 offen offset:128 lds
    s_waitcnt lgkmcnt(8)
    v_mfma_f32_16x16x32_bf16 v[48:51], v[88:91], a[104:107], v[48:51]
    ds_read_b64_tr_b16 v[80:81], v113 offset:4096
    v_mfma_f32_16x16x32_bf16 v[52:55], v[88:91], a[108:111], v[52:55]
    ds_read_b64_tr_b16 v[82:83], v113 offset:6144
    v_mfma_f32_16x16x32_bf16 v[56:59], v[92:95], a[104:107], v[56:59]
    ds_read_b64_tr_b16 v[84:85], v114 offset:4096
    v_mfma_f32_16x16x32_bf16 v[60:63], v[92:95], a[108:111], v[60:63]
    ds_read_b64_tr_b16 v[86:87], v114 offset:6144
    s_waitcnt lgkmcnt(8)
    v_mfma_f32_16x16x32_bf16 v[0:3], v[64:67], a[112:115], v[0:3]
    ds_read_b64_tr_b16 v[88:89], v115 offset:4096
    s_add_u32 s53, s25, 24576
    v_mfma_f32_16x16x32_bf16 v[4:7], v[64:67], a[116:119], v[4:7]
    ds_read_b64_tr_b16 v[90:91], v115 offset:6144
    buffer_load_dwordx4 a[48:51], v112, s[8:11], s53 offen offset:0 sc1
    v_mfma_f32_16x16x32_bf16 v[8:11], v[68:71], a[112:115], v[8:11]
    ds_read_b64_tr_b16 v[92:93], v116 offset:4096
    buffer_load_dwordx4 a[52:55], v112, s[8:11], s53 offen offset:1024 sc1
    v_mfma_f32_16x16x32_bf16 v[12:15], v[68:71], a[116:119], v[12:15]
    ds_read_b64_tr_b16 v[94:95], v116 offset:6144
    buffer_load_dwordx4 a[56:59], v112, s[8:11], s53 offen offset:2048 sc1
    s_waitcnt lgkmcnt(8)
    v_mfma_f32_16x16x32_bf16 v[16:19], v[72:75], a[112:115], v[16:19]
    ds_read_b64_tr_b16 v[64:65], v113 offset:8192
    buffer_load_dwordx4 a[60:63], v112, s[8:11], s53 offen offset:3072 sc1
    v_mfma_f32_16x16x32_bf16 v[20:23], v[72:75], a[116:119], v[20:23]
    ds_read_b64_tr_b16 v[66:67], v113 offset:10240
    v_mfma_f32_16x16x32_bf16 v[24:27], v[76:79], a[112:115], v[24:27]
    ds_read_b64_tr_b16 v[68:69], v114 offset:8192
    v_mfma_f32_16x16x32_bf16 v[28:31], v[76:79], a[116:119], v[28:31]
    ds_read_b64_tr_b16 v[70:71], v114 offset:10240
    s_waitcnt lgkmcnt(8)
    v_mfma_f32_16x16x32_bf16 v[0:3], v[80:83], a[120:123], v[0:3]
    ds_read_b64_tr_b16 v[72:73], v115 offset:8192
    v_mfma_f32_16x16x32_bf16 v[4:7], v[80:83], a[124:127], v[4:7]
    ds_read_b64_tr_b16 v[74:75], v115 offset:10240
    v_mfma_f32_16x16x32_bf16 v[8:11], v[84:87], a[120:123], v[8:11]
    ds_read_b64_tr_b16 v[76:77], v116 offset:8192
    v_mfma_f32_16x16x32_bf16 v[12:15], v[84:87], a[124:127], v[12:15]
    ds_read_b64_tr_b16 v[78:79], v116 offset:10240
    s_waitcnt lgkmcnt(8)
    v_mfma_f32_16x16x32_bf16 v[16:19], v[88:91], a[120:123], v[16:19]
    ds_read_b64_tr_b16 v[80:81], v113 offset:12288
    v_mfma_f32_16x16x32_bf16 v[20:23], v[88:91], a[124:127], v[20:23]
    ds_read_b64_tr_b16 v[82:83], v113 offset:14336
    v_mfma_f32_16x16x32_bf16 v[24:27], v[92:95], a[120:123], v[24:27]
    ds_read_b64_tr_b16 v[84:85], v114 offset:12288
    v_mfma_f32_16x16x32_bf16 v[28:31], v[92:95], a[124:127], v[28:31]
    ds_read_b64_tr_b16 v[86:87], v114 offset:14336
    s_barrier
    s_waitcnt lgkmcnt(8)
    v_mfma_f32_16x16x32_bf16 v[32:35], v[64:67], a[112:115], v[32:35]
    ds_read_b64_tr_b16 v[88:89], v115 offset:12288
    s_add_u32 m0, s57, 32768
    v_mfma_f32_16x16x32_bf16 v[36:39], v[64:67], a[116:119], v[36:39]
    ds_read_b64_tr_b16 v[90:91], v115 offset:14336
    s_add_u32 s52, s19, 393216
    v_mfma_f32_16x16x32_bf16 v[40:43], v[68:71], a[112:115], v[40:43]
    ds_read_b64_tr_b16 v[92:93], v116 offset:12288
    buffer_load_dwordx4 v118, s[36:39], s52 offen lds
    v_mfma_f32_16x16x32_bf16 v[44:47], v[68:71], a[116:119], v[44:47]
    ds_read_b64_tr_b16 v[94:95], v116 offset:14336
    s_add_u32 m0, s57, 40832
    s_waitcnt lgkmcnt(8)
    v_mfma_f32_16x16x32_bf16 v[48:51], v[72:75], a[112:115], v[48:51]
    v_add_u32 v113, 0x8000, v113
    ds_read_b64_tr_b16 v[64:65], v113 offset:0
    s_nop 0
    v_mfma_f32_16x16x32_bf16 v[52:55], v[72:75], a[116:119], v[52:55]
    ds_read_b64_tr_b16 v[66:67], v113 offset:2048
    buffer_load_dwordx4 v118, s[36:39], s52 offen offset:128 lds
    v_mfma_f32_16x16x32_bf16 v[56:59], v[76:79], a[112:115], v[56:59]
    v_add_u32 v114, 0x8000, v114
    ds_read_b64_tr_b16 v[68:69], v114 offset:0
    s_add_u32 m0, s57, 49152
    v_mfma_f32_16x16x32_bf16 v[60:63], v[76:79], a[116:119], v[60:63]
    ds_read_b64_tr_b16 v[70:71], v114 offset:2048
    s_add_u32 s52, s19, 458752
    s_waitcnt lgkmcnt(8)
    v_mfma_f32_16x16x32_bf16 v[32:35], v[80:83], a[120:123], v[32:35]
    v_add_u32 v115, 0x8000, v115
    ds_read_b64_tr_b16 v[72:73], v115 offset:0
    buffer_load_dwordx4 v118, s[36:39], s52 offen lds
    v_mfma_f32_16x16x32_bf16 v[36:39], v[80:83], a[124:127], v[36:39]
    ds_read_b64_tr_b16 v[74:75], v115 offset:2048
    s_add_u32 m0, s57, 57216
    v_mfma_f32_16x16x32_bf16 v[40:43], v[84:87], a[120:123], v[40:43]
    v_add_u32 v116, 0x8000, v116
    ds_read_b64_tr_b16 v[76:77], v116 offset:0
    s_nop 0
    v_mfma_f32_16x16x32_bf16 v[44:47], v[84:87], a[124:127], v[44:47]
    ds_read_b64_tr_b16 v[78:79], v116 offset:2048
    buffer_load_dwordx4 v118, s[36:39], s52 offen offset:128 lds
    s_waitcnt lgkmcnt(8)
    v_mfma_f32_16x16x32_bf16 v[48:51], v[88:91], a[120:123], v[48:51]
    ds_read_b64_tr_b16 v[80:81], v113 offset:4096
    v_mfma_f32_16x16x32_bf16 v[52:55], v[88:91], a[124:127], v[52:55]
    ds_read_b64_tr_b16 v[82:83], v113 offset:6144
    v_mfma_f32_16x16x32_bf16 v[56:59], v[92:95], a[120:123], v[56:59]
    ds_read_b64_tr_b16 v[84:85], v114 offset:4096
    v_mfma_f32_16x16x32_bf16 v[60:63], v[92:95], a[124:127], v[60:63]
    ds_read_b64_tr_b16 v[86:87], v114 offset:6144
    s_waitcnt lgkmcnt(8)
    s_waitcnt vmcnt(27)
    v_mfma_f32_16x16x32_bf16 v[0:3], v[64:67], a[0:3], v[0:3]
    ds_read_b64_tr_b16 v[88:89], v115 offset:4096
    s_add_u32 s53, s25, 32768
    s_waitcnt vmcnt(26)
    v_mfma_f32_16x16x32_bf16 v[4:7], v[64:67], a[4:7], v[4:7]
    ds_read_b64_tr_b16 v[90:91], v115 offset:6144
    buffer_load_dwordx4 a[64:67], v112, s[8:11], s53 offen offset:0 sc1
    v_mfma_f32_16x16x32_bf16 v[8:11], v[68:71], a[0:3], v[8:11]
    ds_read_b64_tr_b16 v[92:93], v116 offset:4096
    buffer_load_dwordx4 a[68:71], v112, s[8:11], s53 offen offset:1024 sc1
    v_mfma_f32_16x16x32_bf16 v[12:15], v[68:71], a[4:7], v[12:15]
    ds_read_b64_tr_b16 v[94:95], v116 offset:6144
    buffer_load_dwordx4 a[72:75], v112, s[8:11], s53 offen offset:2048 sc1
    s_waitcnt lgkmcnt(8)
    v_mfma_f32_16x16x32_bf16 v[16:19], v[72:75], a[0:3], v[16:19]
    ds_read_b64_tr_b16 v[64:65], v113 offset:8192
    buffer_load_dwordx4 a[76:79], v112, s[8:11], s53 offen offset:3072 sc1
    v_mfma_f32_16x16x32_bf16 v[20:23], v[72:75], a[4:7], v[20:23]
    ds_read_b64_tr_b16 v[66:67], v113 offset:10240
    v_mfma_f32_16x16x32_bf16 v[24:27], v[76:79], a[0:3], v[24:27]
    ds_read_b64_tr_b16 v[68:69], v114 offset:8192
    v_mfma_f32_16x16x32_bf16 v[28:31], v[76:79], a[4:7], v[28:31]
    ds_read_b64_tr_b16 v[70:71], v114 offset:10240
    s_waitcnt lgkmcnt(8)
    s_waitcnt vmcnt(29)
    v_mfma_f32_16x16x32_bf16 v[0:3], v[80:83], a[8:11], v[0:3]
    ds_read_b64_tr_b16 v[72:73], v115 offset:8192
    s_waitcnt vmcnt(28)
    v_mfma_f32_16x16x32_bf16 v[4:7], v[80:83], a[12:15], v[4:7]
    ds_read_b64_tr_b16 v[74:75], v115 offset:10240
    v_mfma_f32_16x16x32_bf16 v[8:11], v[84:87], a[8:11], v[8:11]
    ds_read_b64_tr_b16 v[76:77], v116 offset:8192
    v_mfma_f32_16x16x32_bf16 v[12:15], v[84:87], a[12:15], v[12:15]
    ds_read_b64_tr_b16 v[78:79], v116 offset:10240
    s_waitcnt lgkmcnt(8)
    v_mfma_f32_16x16x32_bf16 v[16:19], v[88:91], a[8:11], v[16:19]
    ds_read_b64_tr_b16 v[80:81], v113 offset:12288
    v_mfma_f32_16x16x32_bf16 v[20:23], v[88:91], a[12:15], v[20:23]
    ds_read_b64_tr_b16 v[82:83], v113 offset:14336
    v_mfma_f32_16x16x32_bf16 v[24:27], v[92:95], a[8:11], v[24:27]
    ds_read_b64_tr_b16 v[84:85], v114 offset:12288
    v_mfma_f32_16x16x32_bf16 v[28:31], v[92:95], a[12:15], v[28:31]
    ds_read_b64_tr_b16 v[86:87], v114 offset:14336
    s_waitcnt vmcnt(20)
    s_barrier
    s_waitcnt lgkmcnt(8)
    v_mfma_f32_16x16x32_bf16 v[32:35], v[64:67], a[0:3], v[32:35]
    ds_read_b64_tr_b16 v[88:89], v115 offset:12288
    s_add_u32 m0, s57, 65536
    v_mfma_f32_16x16x32_bf16 v[36:39], v[64:67], a[4:7], v[36:39]
    ds_read_b64_tr_b16 v[90:91], v115 offset:14336
    s_add_u32 s52, s19, 524288
    v_mfma_f32_16x16x32_bf16 v[40:43], v[68:71], a[0:3], v[40:43]
    ds_read_b64_tr_b16 v[92:93], v116 offset:12288
    buffer_load_dwordx4 v118, s[36:39], s52 offen lds
    v_mfma_f32_16x16x32_bf16 v[44:47], v[68:71], a[4:7], v[44:47]
    ds_read_b64_tr_b16 v[94:95], v116 offset:14336
    s_add_u32 m0, s57, 73600
    s_waitcnt lgkmcnt(8)
    v_mfma_f32_16x16x32_bf16 v[48:51], v[72:75], a[0:3], v[48:51]
    v_add_u32 v113, 0x8000, v113
    ds_read_b64_tr_b16 v[64:65], v113 offset:0
    s_nop 0
    v_mfma_f32_16x16x32_bf16 v[52:55], v[72:75], a[4:7], v[52:55]
    ds_read_b64_tr_b16 v[66:67], v113 offset:2048
    buffer_load_dwordx4 v118, s[36:39], s52 offen offset:128 lds
    v_mfma_f32_16x16x32_bf16 v[56:59], v[76:79], a[0:3], v[56:59]
    v_add_u32 v114, 0x8000, v114
    ds_read_b64_tr_b16 v[68:69], v114 offset:0
    s_add_u32 m0, s57, 81920
    v_mfma_f32_16x16x32_bf16 v[60:63], v[76:79], a[4:7], v[60:63]
    ds_read_b64_tr_b16 v[70:71], v114 offset:2048
    s_add_u32 s52, s19, 589824
    s_waitcnt lgkmcnt(8)
    v_mfma_f32_16x16x32_bf16 v[32:35], v[80:83], a[8:11], v[32:35]
    v_add_u32 v115, 0x8000, v115
    ds_read_b64_tr_b16 v[72:73], v115 offset:0
    buffer_load_dwordx4 v118, s[36:39], s52 offen lds
    v_mfma_f32_16x16x32_bf16 v[36:39], v[80:83], a[12:15], v[36:39]
    ds_read_b64_tr_b16 v[74:75], v115 offset:2048
    s_add_u32 m0, s57, 89984
    v_mfma_f32_16x16x32_bf16 v[40:43], v[84:87], a[8:11], v[40:43]
    v_add_u32 v116, 0x8000, v116
    ds_read_b64_tr_b16 v[76:77], v116 offset:0
    s_nop 0
    v_mfma_f32_16x16x32_bf16 v[44:47], v[84:87], a[12:15], v[44:47]
    ds_read_b64_tr_b16 v[78:79], v116 offset:2048
    buffer_load_dwordx4 v118, s[36:39], s52 offen offset:128 lds
    s_waitcnt lgkmcnt(8)
    v_mfma_f32_16x16x32_bf16 v[48:51], v[88:91], a[8:11], v[48:51]
    ds_read_b64_tr_b16 v[80:81], v113 offset:4096
    v_mfma_f32_16x16x32_bf16 v[52:55], v[88:91], a[12:15], v[52:55]
    ds_read_b64_tr_b16 v[82:83], v113 offset:6144
    v_mfma_f32_16x16x32_bf16 v[56:59], v[92:95], a[8:11], v[56:59]
    ds_read_b64_tr_b16 v[84:85], v114 offset:4096
    v_mfma_f32_16x16x32_bf16 v[60:63], v[92:95], a[12:15], v[60:63]
    ds_read_b64_tr_b16 v[86:87], v114 offset:6144
    s_waitcnt lgkmcnt(8)
    v_mfma_f32_16x16x32_bf16 v[0:3], v[64:67], a[16:19], v[0:3]
    ds_read_b64_tr_b16 v[88:89], v115 offset:4096
    s_add_u32 s53, s25, 40960
    v_mfma_f32_16x16x32_bf16 v[4:7], v[64:67], a[20:23], v[4:7]
    ds_read_b64_tr_b16 v[90:91], v115 offset:6144
    buffer_load_dwordx4 a[80:83], v112, s[8:11], s53 offen offset:0 sc1
    v_mfma_f32_16x16x32_bf16 v[8:11], v[68:71], a[16:19], v[8:11]
    ds_read_b64_tr_b16 v[92:93], v116 offset:4096
    buffer_load_dwordx4 a[84:87], v112, s[8:11], s53 offen offset:1024 sc1
    v_mfma_f32_16x16x32_bf16 v[12:15], v[68:71], a[20:23], v[12:15]
    ds_read_b64_tr_b16 v[94:95], v116 offset:6144
    buffer_load_dwordx4 a[88:91], v112, s[8:11], s53 offen offset:2048 sc1
    s_waitcnt lgkmcnt(8)
    v_mfma_f32_16x16x32_bf16 v[16:19], v[72:75], a[16:19], v[16:19]
    ds_read_b64_tr_b16 v[64:65], v113 offset:8192
    buffer_load_dwordx4 a[92:95], v112, s[8:11], s53 offen offset:3072 sc1
    v_mfma_f32_16x16x32_bf16 v[20:23], v[72:75], a[20:23], v[20:23]
    ds_read_b64_tr_b16 v[66:67], v113 offset:10240
    v_mfma_f32_16x16x32_bf16 v[24:27], v[76:79], a[16:19], v[24:27]
    ds_read_b64_tr_b16 v[68:69], v114 offset:8192
    v_mfma_f32_16x16x32_bf16 v[28:31], v[76:79], a[20:23], v[28:31]
    ds_read_b64_tr_b16 v[70:71], v114 offset:10240
    s_waitcnt lgkmcnt(8)
    v_mfma_f32_16x16x32_bf16 v[0:3], v[80:83], a[24:27], v[0:3]
    ds_read_b64_tr_b16 v[72:73], v115 offset:8192
    v_mfma_f32_16x16x32_bf16 v[4:7], v[80:83], a[28:31], v[4:7]
    ds_read_b64_tr_b16 v[74:75], v115 offset:10240
    v_mfma_f32_16x16x32_bf16 v[8:11], v[84:87], a[24:27], v[8:11]
    ds_read_b64_tr_b16 v[76:77], v116 offset:8192
    v_mfma_f32_16x16x32_bf16 v[12:15], v[84:87], a[28:31], v[12:15]
    ds_read_b64_tr_b16 v[78:79], v116 offset:10240
    s_waitcnt lgkmcnt(8)
    v_mfma_f32_16x16x32_bf16 v[16:19], v[88:91], a[24:27], v[16:19]
    ds_read_b64_tr_b16 v[80:81], v113 offset:12288
    v_mfma_f32_16x16x32_bf16 v[20:23], v[88:91], a[28:31], v[20:23]
    ds_read_b64_tr_b16 v[82:83], v113 offset:14336
    v_mfma_f32_16x16x32_bf16 v[24:27], v[92:95], a[24:27], v[24:27]
    ds_read_b64_tr_b16 v[84:85], v114 offset:12288
    v_mfma_f32_16x16x32_bf16 v[28:31], v[92:95], a[28:31], v[28:31]
    ds_read_b64_tr_b16 v[86:87], v114 offset:14336
    s_waitcnt vmcnt(20)
    s_barrier
    s_waitcnt lgkmcnt(8)
    v_mfma_f32_16x16x32_bf16 v[32:35], v[64:67], a[16:19], v[32:35]
    ds_read_b64_tr_b16 v[88:89], v115 offset:12288
    s_add_u32 m0, s57, 98304
    v_mfma_f32_16x16x32_bf16 v[36:39], v[64:67], a[20:23], v[36:39]
    ds_read_b64_tr_b16 v[90:91], v115 offset:14336
    s_add_u32 s52, s19, 655360
    v_mfma_f32_16x16x32_bf16 v[40:43], v[68:71], a[16:19], v[40:43]
    ds_read_b64_tr_b16 v[92:93], v116 offset:12288
    buffer_load_dwordx4 v118, s[36:39], s52 offen lds
    v_mfma_f32_16x16x32_bf16 v[44:47], v[68:71], a[20:23], v[44:47]
    ds_read_b64_tr_b16 v[94:95], v116 offset:14336
    s_add_u32 m0, s57, 106368
    s_waitcnt lgkmcnt(8)
    v_mfma_f32_16x16x32_bf16 v[48:51], v[72:75], a[16:19], v[48:51]
    v_add_u32 v113, 0xfffe0000, v113
    ds_read_b64_tr_b16 v[64:65], v113 offset:0
    s_nop 0
    v_mfma_f32_16x16x32_bf16 v[52:55], v[72:75], a[20:23], v[52:55]
    ds_read_b64_tr_b16 v[66:67], v113 offset:2048
    buffer_load_dwordx4 v118, s[36:39], s52 offen offset:128 lds
    v_mfma_f32_16x16x32_bf16 v[56:59], v[76:79], a[16:19], v[56:59]
    v_add_u32 v114, 0xfffe0000, v114
    ds_read_b64_tr_b16 v[68:69], v114 offset:0
    s_add_u32 m0, s57, 114688
    v_mfma_f32_16x16x32_bf16 v[60:63], v[76:79], a[20:23], v[60:63]
    ds_read_b64_tr_b16 v[70:71], v114 offset:2048
    s_add_u32 s52, s19, 720896
    s_waitcnt lgkmcnt(8)
    v_mfma_f32_16x16x32_bf16 v[32:35], v[80:83], a[24:27], v[32:35]
    v_add_u32 v115, 0xfffe0000, v115
    ds_read_b64_tr_b16 v[72:73], v115 offset:0
    buffer_load_dwordx4 v118, s[36:39], s52 offen lds
    v_mfma_f32_16x16x32_bf16 v[36:39], v[80:83], a[28:31], v[36:39]
    ds_read_b64_tr_b16 v[74:75], v115 offset:2048
    s_add_u32 m0, s57, 122752
    v_mfma_f32_16x16x32_bf16 v[40:43], v[84:87], a[24:27], v[40:43]
    v_add_u32 v116, 0xfffe0000, v116
    ds_read_b64_tr_b16 v[76:77], v116 offset:0
    s_nop 0
    v_mfma_f32_16x16x32_bf16 v[44:47], v[84:87], a[28:31], v[44:47]
    ds_read_b64_tr_b16 v[78:79], v116 offset:2048
    buffer_load_dwordx4 v118, s[36:39], s52 offen offset:128 lds
    s_waitcnt lgkmcnt(8)
    v_mfma_f32_16x16x32_bf16 v[48:51], v[88:91], a[24:27], v[48:51]
    ds_read_b64_tr_b16 v[80:81], v113 offset:4096
    v_mfma_f32_16x16x32_bf16 v[52:55], v[88:91], a[28:31], v[52:55]
    ds_read_b64_tr_b16 v[82:83], v113 offset:6144
    v_mfma_f32_16x16x32_bf16 v[56:59], v[92:95], a[24:27], v[56:59]
    ds_read_b64_tr_b16 v[84:85], v114 offset:4096
    v_mfma_f32_16x16x32_bf16 v[60:63], v[92:95], a[28:31], v[60:63]
    ds_read_b64_tr_b16 v[86:87], v114 offset:6144
    s_waitcnt lgkmcnt(8)
    v_mfma_f32_16x16x32_bf16 v[0:3], v[64:67], a[32:35], v[0:3]
    ds_read_b64_tr_b16 v[88:89], v115 offset:4096
    s_add_u32 s53, s25, 49152
    v_mfma_f32_16x16x32_bf16 v[4:7], v[64:67], a[36:39], v[4:7]
    ds_read_b64_tr_b16 v[90:91], v115 offset:6144
    buffer_load_dwordx4 a[96:99], v112, s[8:11], s53 offen offset:0 sc1
    v_mfma_f32_16x16x32_bf16 v[8:11], v[68:71], a[32:35], v[8:11]
    ds_read_b64_tr_b16 v[92:93], v116 offset:4096
    buffer_load_dwordx4 a[100:103], v112, s[8:11], s53 offen offset:1024 sc1
    v_mfma_f32_16x16x32_bf16 v[12:15], v[68:71], a[36:39], v[12:15]
    ds_read_b64_tr_b16 v[94:95], v116 offset:6144
    buffer_load_dwordx4 a[104:107], v112, s[8:11], s53 offen offset:2048 sc1
    s_waitcnt lgkmcnt(8)
    v_mfma_f32_16x16x32_bf16 v[16:19], v[72:75], a[32:35], v[16:19]
    ds_read_b64_tr_b16 v[64:65], v113 offset:8192
    buffer_load_dwordx4 a[108:111], v112, s[8:11], s53 offen offset:3072 sc1
    v_mfma_f32_16x16x32_bf16 v[20:23], v[72:75], a[36:39], v[20:23]
    ds_read_b64_tr_b16 v[66:67], v113 offset:10240
    v_mfma_f32_16x16x32_bf16 v[24:27], v[76:79], a[32:35], v[24:27]
    ds_read_b64_tr_b16 v[68:69], v114 offset:8192
    v_mfma_f32_16x16x32_bf16 v[28:31], v[76:79], a[36:39], v[28:31]
    ds_read_b64_tr_b16 v[70:71], v114 offset:10240
    s_waitcnt lgkmcnt(8)
    v_mfma_f32_16x16x32_bf16 v[0:3], v[80:83], a[40:43], v[0:3]
    ds_read_b64_tr_b16 v[72:73], v115 offset:8192
    v_mfma_f32_16x16x32_bf16 v[4:7], v[80:83], a[44:47], v[4:7]
    ds_read_b64_tr_b16 v[74:75], v115 offset:10240
    v_mfma_f32_16x16x32_bf16 v[8:11], v[84:87], a[40:43], v[8:11]
    ds_read_b64_tr_b16 v[76:77], v116 offset:8192
    v_mfma_f32_16x16x32_bf16 v[12:15], v[84:87], a[44:47], v[12:15]
    ds_read_b64_tr_b16 v[78:79], v116 offset:10240
    s_waitcnt lgkmcnt(8)
    v_mfma_f32_16x16x32_bf16 v[16:19], v[88:91], a[40:43], v[16:19]
    ds_read_b64_tr_b16 v[80:81], v113 offset:12288
    v_mfma_f32_16x16x32_bf16 v[20:23], v[88:91], a[44:47], v[20:23]
    ds_read_b64_tr_b16 v[82:83], v113 offset:14336
    v_mfma_f32_16x16x32_bf16 v[24:27], v[92:95], a[40:43], v[24:27]
    ds_read_b64_tr_b16 v[84:85], v114 offset:12288
    v_mfma_f32_16x16x32_bf16 v[28:31], v[92:95], a[44:47], v[28:31]
    ds_read_b64_tr_b16 v[86:87], v114 offset:14336
    s_waitcnt vmcnt(20)
    s_barrier
    s_waitcnt lgkmcnt(8)
    v_mfma_f32_16x16x32_bf16 v[32:35], v[64:67], a[32:35], v[32:35]
    ds_read_b64_tr_b16 v[88:89], v115 offset:12288
    s_add_u32 m0, s57, 131072
    v_mfma_f32_16x16x32_bf16 v[36:39], v[64:67], a[36:39], v[36:39]
    ds_read_b64_tr_b16 v[90:91], v115 offset:14336
    s_add_u32 s52, s19, 786432
    v_mfma_f32_16x16x32_bf16 v[40:43], v[68:71], a[32:35], v[40:43]
    ds_read_b64_tr_b16 v[92:93], v116 offset:12288
    buffer_load_dwordx4 v118, s[36:39], s52 offen lds
    v_mfma_f32_16x16x32_bf16 v[44:47], v[68:71], a[36:39], v[44:47]
    ds_read_b64_tr_b16 v[94:95], v116 offset:14336
    s_add_u32 m0, s57, 139136
    s_waitcnt lgkmcnt(8)
    v_mfma_f32_16x16x32_bf16 v[48:51], v[72:75], a[32:35], v[48:51]
    v_add_u32 v113, 0x8000, v113
    ds_read_b64_tr_b16 v[64:65], v113 offset:0
    s_nop 0
    v_mfma_f32_16x16x32_bf16 v[52:55], v[72:75], a[36:39], v[52:55]
    ds_read_b64_tr_b16 v[66:67], v113 offset:2048
    buffer_load_dwordx4 v118, s[36:39], s52 offen offset:128 lds
    v_mfma_f32_16x16x32_bf16 v[56:59], v[76:79], a[32:35], v[56:59]
    v_add_u32 v114, 0x8000, v114
    ds_read_b64_tr_b16 v[68:69], v114 offset:0
    s_add_u32 m0, s57, 147456
    v_mfma_f32_16x16x32_bf16 v[60:63], v[76:79], a[36:39], v[60:63]
    ds_read_b64_tr_b16 v[70:71], v114 offset:2048
    s_add_u32 s52, s19, 851968
    s_waitcnt lgkmcnt(8)
    v_mfma_f32_16x16x32_bf16 v[32:35], v[80:83], a[40:43], v[32:35]
    v_add_u32 v115, 0x8000, v115
    ds_read_b64_tr_b16 v[72:73], v115 offset:0
    buffer_load_dwordx4 v118, s[36:39], s52 offen lds
    v_mfma_f32_16x16x32_bf16 v[36:39], v[80:83], a[44:47], v[36:39]
    ds_read_b64_tr_b16 v[74:75], v115 offset:2048
    s_add_u32 m0, s57, 155520
    v_mfma_f32_16x16x32_bf16 v[40:43], v[84:87], a[40:43], v[40:43]
    v_add_u32 v116, 0x8000, v116
    ds_read_b64_tr_b16 v[76:77], v116 offset:0
    s_nop 0
    v_mfma_f32_16x16x32_bf16 v[44:47], v[84:87], a[44:47], v[44:47]
    ds_read_b64_tr_b16 v[78:79], v116 offset:2048
    buffer_load_dwordx4 v118, s[36:39], s52 offen offset:128 lds
    s_waitcnt lgkmcnt(8)
    v_mfma_f32_16x16x32_bf16 v[48:51], v[88:91], a[40:43], v[48:51]
    ds_read_b64_tr_b16 v[80:81], v113 offset:4096
    v_mfma_f32_16x16x32_bf16 v[52:55], v[88:91], a[44:47], v[52:55]
    ds_read_b64_tr_b16 v[82:83], v113 offset:6144
    v_mfma_f32_16x16x32_bf16 v[56:59], v[92:95], a[40:43], v[56:59]
    ds_read_b64_tr_b16 v[84:85], v114 offset:4096
    v_mfma_f32_16x16x32_bf16 v[60:63], v[92:95], a[44:47], v[60:63]
    ds_read_b64_tr_b16 v[86:87], v114 offset:6144
    s_waitcnt lgkmcnt(8)
    v_mfma_f32_16x16x32_bf16 v[0:3], v[64:67], a[48:51], v[0:3]
    ds_read_b64_tr_b16 v[88:89], v115 offset:4096
    s_add_u32 s53, s25, 57344
    v_mfma_f32_16x16x32_bf16 v[4:7], v[64:67], a[52:55], v[4:7]
    ds_read_b64_tr_b16 v[90:91], v115 offset:6144
    buffer_load_dwordx4 a[112:115], v112, s[8:11], s53 offen offset:0 sc1
    v_mfma_f32_16x16x32_bf16 v[8:11], v[68:71], a[48:51], v[8:11]
    ds_read_b64_tr_b16 v[92:93], v116 offset:4096
    buffer_load_dwordx4 a[116:119], v112, s[8:11], s53 offen offset:1024 sc1
    v_mfma_f32_16x16x32_bf16 v[12:15], v[68:71], a[52:55], v[12:15]
    ds_read_b64_tr_b16 v[94:95], v116 offset:6144
    buffer_load_dwordx4 a[120:123], v112, s[8:11], s53 offen offset:2048 sc1
    s_waitcnt lgkmcnt(8)
    v_mfma_f32_16x16x32_bf16 v[16:19], v[72:75], a[48:51], v[16:19]
    ds_read_b64_tr_b16 v[64:65], v113 offset:8192
    buffer_load_dwordx4 a[124:127], v112, s[8:11], s53 offen offset:3072 sc1
    v_mfma_f32_16x16x32_bf16 v[20:23], v[72:75], a[52:55], v[20:23]
    ds_read_b64_tr_b16 v[66:67], v113 offset:10240
    v_mfma_f32_16x16x32_bf16 v[24:27], v[76:79], a[48:51], v[24:27]
    ds_read_b64_tr_b16 v[68:69], v114 offset:8192
    v_mfma_f32_16x16x32_bf16 v[28:31], v[76:79], a[52:55], v[28:31]
    ds_read_b64_tr_b16 v[70:71], v114 offset:10240
    s_waitcnt lgkmcnt(8)
    v_mfma_f32_16x16x32_bf16 v[0:3], v[80:83], a[56:59], v[0:3]
    ds_read_b64_tr_b16 v[72:73], v115 offset:8192
    v_mfma_f32_16x16x32_bf16 v[4:7], v[80:83], a[60:63], v[4:7]
    ds_read_b64_tr_b16 v[74:75], v115 offset:10240
    v_mfma_f32_16x16x32_bf16 v[8:11], v[84:87], a[56:59], v[8:11]
    ds_read_b64_tr_b16 v[76:77], v116 offset:8192
    v_mfma_f32_16x16x32_bf16 v[12:15], v[84:87], a[60:63], v[12:15]
    ds_read_b64_tr_b16 v[78:79], v116 offset:10240
    s_waitcnt lgkmcnt(8)
    v_mfma_f32_16x16x32_bf16 v[16:19], v[88:91], a[56:59], v[16:19]
    ds_read_b64_tr_b16 v[80:81], v113 offset:12288
    v_mfma_f32_16x16x32_bf16 v[20:23], v[88:91], a[60:63], v[20:23]
    ds_read_b64_tr_b16 v[82:83], v113 offset:14336
    v_mfma_f32_16x16x32_bf16 v[24:27], v[92:95], a[56:59], v[24:27]
    ds_read_b64_tr_b16 v[84:85], v114 offset:12288
    v_mfma_f32_16x16x32_bf16 v[28:31], v[92:95], a[60:63], v[28:31]
    ds_read_b64_tr_b16 v[86:87], v114 offset:14336
    s_waitcnt vmcnt(20)
    s_barrier
    s_waitcnt lgkmcnt(8)
    v_mfma_f32_16x16x32_bf16 v[32:35], v[64:67], a[48:51], v[32:35]
    ds_read_b64_tr_b16 v[88:89], v115 offset:12288
    s_add_u32 m0, s57, 0
    v_mfma_f32_16x16x32_bf16 v[36:39], v[64:67], a[52:55], v[36:39]
    ds_read_b64_tr_b16 v[90:91], v115 offset:14336
    s_add_u32 s52, s19, 917504
    v_mfma_f32_16x16x32_bf16 v[40:43], v[68:71], a[48:51], v[40:43]
    ds_read_b64_tr_b16 v[92:93], v116 offset:12288
    buffer_load_dwordx4 v118, s[36:39], s52 offen lds
    v_mfma_f32_16x16x32_bf16 v[44:47], v[68:71], a[52:55], v[44:47]
    ds_read_b64_tr_b16 v[94:95], v116 offset:14336
    s_add_u32 m0, s57, 8064
    s_waitcnt lgkmcnt(8)
    v_mfma_f32_16x16x32_bf16 v[48:51], v[72:75], a[48:51], v[48:51]
    v_add_u32 v113, 0x8000, v113
    ds_read_b64_tr_b16 v[64:65], v113 offset:0
    s_nop 0
    v_mfma_f32_16x16x32_bf16 v[52:55], v[72:75], a[52:55], v[52:55]
    ds_read_b64_tr_b16 v[66:67], v113 offset:2048
    buffer_load_dwordx4 v118, s[36:39], s52 offen offset:128 lds
    v_mfma_f32_16x16x32_bf16 v[56:59], v[76:79], a[48:51], v[56:59]
    v_add_u32 v114, 0x8000, v114
    ds_read_b64_tr_b16 v[68:69], v114 offset:0
    s_add_u32 m0, s57, 16384
    v_mfma_f32_16x16x32_bf16 v[60:63], v[76:79], a[52:55], v[60:63]
    ds_read_b64_tr_b16 v[70:71], v114 offset:2048
    s_add_u32 s52, s19, 983040
    s_waitcnt lgkmcnt(8)
    v_mfma_f32_16x16x32_bf16 v[32:35], v[80:83], a[56:59], v[32:35]
    v_add_u32 v115, 0x8000, v115
    ds_read_b64_tr_b16 v[72:73], v115 offset:0
    buffer_load_dwordx4 v118, s[36:39], s52 offen lds
    v_mfma_f32_16x16x32_bf16 v[36:39], v[80:83], a[60:63], v[36:39]
    ds_read_b64_tr_b16 v[74:75], v115 offset:2048
    s_add_u32 m0, s57, 24448
    v_mfma_f32_16x16x32_bf16 v[40:43], v[84:87], a[56:59], v[40:43]
    v_add_u32 v116, 0x8000, v116
    ds_read_b64_tr_b16 v[76:77], v116 offset:0
    s_nop 0
    v_mfma_f32_16x16x32_bf16 v[44:47], v[84:87], a[60:63], v[44:47]
    ds_read_b64_tr_b16 v[78:79], v116 offset:2048
    buffer_load_dwordx4 v118, s[36:39], s52 offen offset:128 lds
    s_waitcnt lgkmcnt(8)
    v_mfma_f32_16x16x32_bf16 v[48:51], v[88:91], a[56:59], v[48:51]
    ds_read_b64_tr_b16 v[80:81], v113 offset:4096
    v_mfma_f32_16x16x32_bf16 v[52:55], v[88:91], a[60:63], v[52:55]
    ds_read_b64_tr_b16 v[82:83], v113 offset:6144
    v_mfma_f32_16x16x32_bf16 v[56:59], v[92:95], a[56:59], v[56:59]
    ds_read_b64_tr_b16 v[84:85], v114 offset:4096
    v_mfma_f32_16x16x32_bf16 v[60:63], v[92:95], a[60:63], v[60:63]
    ds_read_b64_tr_b16 v[86:87], v114 offset:6144
    s_waitcnt lgkmcnt(8)
    v_mfma_f32_16x16x32_bf16 v[0:3], v[64:67], a[64:67], v[0:3]
    ds_read_b64_tr_b16 v[88:89], v115 offset:4096
    v_mfma_f32_16x16x32_bf16 v[4:7], v[64:67], a[68:71], v[4:7]
    ds_read_b64_tr_b16 v[90:91], v115 offset:6144
    v_mfma_f32_16x16x32_bf16 v[8:11], v[68:71], a[64:67], v[8:11]
    ds_read_b64_tr_b16 v[92:93], v116 offset:4096
    v_mfma_f32_16x16x32_bf16 v[12:15], v[68:71], a[68:71], v[12:15]
    ds_read_b64_tr_b16 v[94:95], v116 offset:6144
    s_waitcnt lgkmcnt(8)
    v_mfma_f32_16x16x32_bf16 v[16:19], v[72:75], a[64:67], v[16:19]
    ds_read_b64_tr_b16 v[64:65], v113 offset:8192
    v_mfma_f32_16x16x32_bf16 v[20:23], v[72:75], a[68:71], v[20:23]
    ds_read_b64_tr_b16 v[66:67], v113 offset:10240
    v_mfma_f32_16x16x32_bf16 v[24:27], v[76:79], a[64:67], v[24:27]
    ds_read_b64_tr_b16 v[68:69], v114 offset:8192
    v_mfma_f32_16x16x32_bf16 v[28:31], v[76:79], a[68:71], v[28:31]
    ds_read_b64_tr_b16 v[70:71], v114 offset:10240
    s_waitcnt lgkmcnt(8)
    v_mfma_f32_16x16x32_bf16 v[0:3], v[80:83], a[72:75], v[0:3]
    ds_read_b64_tr_b16 v[72:73], v115 offset:8192
    v_mfma_f32_16x16x32_bf16 v[4:7], v[80:83], a[76:79], v[4:7]
    ds_read_b64_tr_b16 v[74:75], v115 offset:10240
    v_mfma_f32_16x16x32_bf16 v[8:11], v[84:87], a[72:75], v[8:11]
    ds_read_b64_tr_b16 v[76:77], v116 offset:8192
    v_mfma_f32_16x16x32_bf16 v[12:15], v[84:87], a[76:79], v[12:15]
    ds_read_b64_tr_b16 v[78:79], v116 offset:10240
    s_waitcnt lgkmcnt(8)
    v_mfma_f32_16x16x32_bf16 v[16:19], v[88:91], a[72:75], v[16:19]
    ds_read_b64_tr_b16 v[80:81], v113 offset:12288
    v_mfma_f32_16x16x32_bf16 v[20:23], v[88:91], a[76:79], v[20:23]
    ds_read_b64_tr_b16 v[82:83], v113 offset:14336
    v_mfma_f32_16x16x32_bf16 v[24:27], v[92:95], a[72:75], v[24:27]
    ds_read_b64_tr_b16 v[84:85], v114 offset:12288
    v_mfma_f32_16x16x32_bf16 v[28:31], v[92:95], a[76:79], v[28:31]
    ds_read_b64_tr_b16 v[86:87], v114 offset:14336
    s_waitcnt vmcnt(16)
    s_barrier
    s_waitcnt lgkmcnt(8)
    v_mfma_f32_16x16x32_bf16 v[32:35], v[64:67], a[64:67], v[32:35]
    ds_read_b64_tr_b16 v[88:89], v115 offset:12288
    v_mfma_f32_16x16x32_bf16 v[36:39], v[64:67], a[68:71], v[36:39]
    ds_read_b64_tr_b16 v[90:91], v115 offset:14336
    v_mfma_f32_16x16x32_bf16 v[40:43], v[68:71], a[64:67], v[40:43]
    ds_read_b64_tr_b16 v[92:93], v116 offset:12288
    v_mfma_f32_16x16x32_bf16 v[44:47], v[68:71], a[68:71], v[44:47]
    ds_read_b64_tr_b16 v[94:95], v116 offset:14336
    s_waitcnt lgkmcnt(8)
    v_mfma_f32_16x16x32_bf16 v[48:51], v[72:75], a[64:67], v[48:51]
    v_add_u32 v113, 0x8000, v113
    ds_read_b64_tr_b16 v[64:65], v113 offset:0
    v_mfma_f32_16x16x32_bf16 v[52:55], v[72:75], a[68:71], v[52:55]
    ds_read_b64_tr_b16 v[66:67], v113 offset:2048
    v_mfma_f32_16x16x32_bf16 v[56:59], v[76:79], a[64:67], v[56:59]
    v_add_u32 v114, 0x8000, v114
    ds_read_b64_tr_b16 v[68:69], v114 offset:0
    v_mfma_f32_16x16x32_bf16 v[60:63], v[76:79], a[68:71], v[60:63]
    ds_read_b64_tr_b16 v[70:71], v114 offset:2048
    s_waitcnt lgkmcnt(8)
    v_mfma_f32_16x16x32_bf16 v[32:35], v[80:83], a[72:75], v[32:35]
    v_add_u32 v115, 0x8000, v115
    ds_read_b64_tr_b16 v[72:73], v115 offset:0
    v_mfma_f32_16x16x32_bf16 v[36:39], v[80:83], a[76:79], v[36:39]
    ds_read_b64_tr_b16 v[74:75], v115 offset:2048
    v_mfma_f32_16x16x32_bf16 v[40:43], v[84:87], a[72:75], v[40:43]
    v_add_u32 v116, 0x8000, v116
    ds_read_b64_tr_b16 v[76:77], v116 offset:0
    v_mfma_f32_16x16x32_bf16 v[44:47], v[84:87], a[76:79], v[44:47]
    ds_read_b64_tr_b16 v[78:79], v116 offset:2048
    s_waitcnt lgkmcnt(8)
    v_mfma_f32_16x16x32_bf16 v[48:51], v[88:91], a[72:75], v[48:51]
    ds_read_b64_tr_b16 v[80:81], v113 offset:4096
    v_mfma_f32_16x16x32_bf16 v[52:55], v[88:91], a[76:79], v[52:55]
    ds_read_b64_tr_b16 v[82:83], v113 offset:6144
    v_mfma_f32_16x16x32_bf16 v[56:59], v[92:95], a[72:75], v[56:59]
    ds_read_b64_tr_b16 v[84:85], v114 offset:4096
    v_mfma_f32_16x16x32_bf16 v[60:63], v[92:95], a[76:79], v[60:63]
    ds_read_b64_tr_b16 v[86:87], v114 offset:6144
    s_waitcnt lgkmcnt(8)
    v_mfma_f32_16x16x32_bf16 v[0:3], v[64:67], a[80:83], v[0:3]
    ds_read_b64_tr_b16 v[88:89], v115 offset:4096
    v_mfma_f32_16x16x32_bf16 v[4:7], v[64:67], a[84:87], v[4:7]
    ds_read_b64_tr_b16 v[90:91], v115 offset:6144
    v_mfma_f32_16x16x32_bf16 v[8:11], v[68:71], a[80:83], v[8:11]
    ds_read_b64_tr_b16 v[92:93], v116 offset:4096
    v_mfma_f32_16x16x32_bf16 v[12:15], v[68:71], a[84:87], v[12:15]
    ds_read_b64_tr_b16 v[94:95], v116 offset:6144
    s_waitcnt lgkmcnt(8)
    v_mfma_f32_16x16x32_bf16 v[16:19], v[72:75], a[80:83], v[16:19]
    ds_read_b64_tr_b16 v[64:65], v113 offset:8192
    v_mfma_f32_16x16x32_bf16 v[20:23], v[72:75], a[84:87], v[20:23]
    ds_read_b64_tr_b16 v[66:67], v113 offset:10240
    v_mfma_f32_16x16x32_bf16 v[24:27], v[76:79], a[80:83], v[24:27]
    ds_read_b64_tr_b16 v[68:69], v114 offset:8192
    v_mfma_f32_16x16x32_bf16 v[28:31], v[76:79], a[84:87], v[28:31]
    ds_read_b64_tr_b16 v[70:71], v114 offset:10240
    s_waitcnt lgkmcnt(8)
    v_mfma_f32_16x16x32_bf16 v[0:3], v[80:83], a[88:91], v[0:3]
    ds_read_b64_tr_b16 v[72:73], v115 offset:8192
    v_mfma_f32_16x16x32_bf16 v[4:7], v[80:83], a[92:95], v[4:7]
    ds_read_b64_tr_b16 v[74:75], v115 offset:10240
    v_mfma_f32_16x16x32_bf16 v[8:11], v[84:87], a[88:91], v[8:11]
    ds_read_b64_tr_b16 v[76:77], v116 offset:8192
    v_mfma_f32_16x16x32_bf16 v[12:15], v[84:87], a[92:95], v[12:15]
    ds_read_b64_tr_b16 v[78:79], v116 offset:10240
    s_waitcnt lgkmcnt(8)
    v_mfma_f32_16x16x32_bf16 v[16:19], v[88:91], a[88:91], v[16:19]
    ds_read_b64_tr_b16 v[80:81], v113 offset:12288
    v_mfma_f32_16x16x32_bf16 v[20:23], v[88:91], a[92:95], v[20:23]
    ds_read_b64_tr_b16 v[82:83], v113 offset:14336
    v_mfma_f32_16x16x32_bf16 v[24:27], v[92:95], a[88:91], v[24:27]
    ds_read_b64_tr_b16 v[84:85], v114 offset:12288
    v_mfma_f32_16x16x32_bf16 v[28:31], v[92:95], a[92:95], v[28:31]
    ds_read_b64_tr_b16 v[86:87], v114 offset:14336
    s_waitcnt vmcnt(8)
    s_barrier
    s_waitcnt lgkmcnt(8)
    v_mfma_f32_16x16x32_bf16 v[32:35], v[64:67], a[80:83], v[32:35]
    ds_read_b64_tr_b16 v[88:89], v115 offset:12288
    v_mfma_f32_16x16x32_bf16 v[36:39], v[64:67], a[84:87], v[36:39]
    ds_read_b64_tr_b16 v[90:91], v115 offset:14336
    v_mfma_f32_16x16x32_bf16 v[40:43], v[68:71], a[80:83], v[40:43]
    ds_read_b64_tr_b16 v[92:93], v116 offset:12288
    v_mfma_f32_16x16x32_bf16 v[44:47], v[68:71], a[84:87], v[44:47]
    ds_read_b64_tr_b16 v[94:95], v116 offset:14336
    s_waitcnt lgkmcnt(8)
    v_mfma_f32_16x16x32_bf16 v[48:51], v[72:75], a[80:83], v[48:51]
    v_add_u32 v113, 0x8000, v113
    ds_read_b64_tr_b16 v[64:65], v113 offset:0
    v_mfma_f32_16x16x32_bf16 v[52:55], v[72:75], a[84:87], v[52:55]
    ds_read_b64_tr_b16 v[66:67], v113 offset:2048
    v_mfma_f32_16x16x32_bf16 v[56:59], v[76:79], a[80:83], v[56:59]
    v_add_u32 v114, 0x8000, v114
    ds_read_b64_tr_b16 v[68:69], v114 offset:0
    v_mfma_f32_16x16x32_bf16 v[60:63], v[76:79], a[84:87], v[60:63]
    ds_read_b64_tr_b16 v[70:71], v114 offset:2048
    s_waitcnt lgkmcnt(8)
    v_mfma_f32_16x16x32_bf16 v[32:35], v[80:83], a[88:91], v[32:35]
    v_add_u32 v115, 0x8000, v115
    ds_read_b64_tr_b16 v[72:73], v115 offset:0
    v_mfma_f32_16x16x32_bf16 v[36:39], v[80:83], a[92:95], v[36:39]
    ds_read_b64_tr_b16 v[74:75], v115 offset:2048
    v_mfma_f32_16x16x32_bf16 v[40:43], v[84:87], a[88:91], v[40:43]
    v_add_u32 v116, 0x8000, v116
    ds_read_b64_tr_b16 v[76:77], v116 offset:0
    v_mfma_f32_16x16x32_bf16 v[44:47], v[84:87], a[92:95], v[44:47]
    ds_read_b64_tr_b16 v[78:79], v116 offset:2048
    s_waitcnt lgkmcnt(8)
    v_mfma_f32_16x16x32_bf16 v[48:51], v[88:91], a[88:91], v[48:51]
    ds_read_b64_tr_b16 v[80:81], v113 offset:4096
    v_mfma_f32_16x16x32_bf16 v[52:55], v[88:91], a[92:95], v[52:55]
    ds_read_b64_tr_b16 v[82:83], v113 offset:6144
    v_mfma_f32_16x16x32_bf16 v[56:59], v[92:95], a[88:91], v[56:59]
    ds_read_b64_tr_b16 v[84:85], v114 offset:4096
    v_mfma_f32_16x16x32_bf16 v[60:63], v[92:95], a[92:95], v[60:63]
    ds_read_b64_tr_b16 v[86:87], v114 offset:6144
    s_waitcnt lgkmcnt(8)
    v_mfma_f32_16x16x32_bf16 v[0:3], v[64:67], a[96:99], v[0:3]
    ds_read_b64_tr_b16 v[88:89], v115 offset:4096
    v_mfma_f32_16x16x32_bf16 v[4:7], v[64:67], a[100:103], v[4:7]
    ds_read_b64_tr_b16 v[90:91], v115 offset:6144
    v_mfma_f32_16x16x32_bf16 v[8:11], v[68:71], a[96:99], v[8:11]
    ds_read_b64_tr_b16 v[92:93], v116 offset:4096
    v_mfma_f32_16x16x32_bf16 v[12:15], v[68:71], a[100:103], v[12:15]
    ds_read_b64_tr_b16 v[94:95], v116 offset:6144
    s_waitcnt lgkmcnt(8)
    v_mfma_f32_16x16x32_bf16 v[16:19], v[72:75], a[96:99], v[16:19]
    ds_read_b64_tr_b16 v[64:65], v113 offset:8192
    v_mfma_f32_16x16x32_bf16 v[20:23], v[72:75], a[100:103], v[20:23]
    ds_read_b64_tr_b16 v[66:67], v113 offset:10240
    v_mfma_f32_16x16x32_bf16 v[24:27], v[76:79], a[96:99], v[24:27]
    ds_read_b64_tr_b16 v[68:69], v114 offset:8192
    v_mfma_f32_16x16x32_bf16 v[28:31], v[76:79], a[100:103], v[28:31]
    ds_read_b64_tr_b16 v[70:71], v114 offset:10240
    s_waitcnt lgkmcnt(8)
    v_mfma_f32_16x16x32_bf16 v[0:3], v[80:83], a[104:107], v[0:3]
    ds_read_b64_tr_b16 v[72:73], v115 offset:8192
    v_mfma_f32_16x16x32_bf16 v[4:7], v[80:83], a[108:111], v[4:7]
    ds_read_b64_tr_b16 v[74:75], v115 offset:10240
    v_mfma_f32_16x16x32_bf16 v[8:11], v[84:87], a[104:107], v[8:11]
    ds_read_b64_tr_b16 v[76:77], v116 offset:8192
    v_mfma_f32_16x16x32_bf16 v[12:15], v[84:87], a[108:111], v[12:15]
    ds_read_b64_tr_b16 v[78:79], v116 offset:10240
    s_waitcnt lgkmcnt(8)
    v_mfma_f32_16x16x32_bf16 v[16:19], v[88:91], a[104:107], v[16:19]
    ds_read_b64_tr_b16 v[80:81], v113 offset:12288
    v_mfma_f32_16x16x32_bf16 v[20:23], v[88:91], a[108:111], v[20:23]
    ds_read_b64_tr_b16 v[82:83], v113 offset:14336
    v_mfma_f32_16x16x32_bf16 v[24:27], v[92:95], a[104:107], v[24:27]
    ds_read_b64_tr_b16 v[84:85], v114 offset:12288
    v_mfma_f32_16x16x32_bf16 v[28:31], v[92:95], a[108:111], v[28:31]
    ds_read_b64_tr_b16 v[86:87], v114 offset:14336
    s_waitcnt vmcnt(0)
    s_barrier
    s_waitcnt lgkmcnt(8)
    v_mfma_f32_16x16x32_bf16 v[32:35], v[64:67], a[96:99], v[32:35]
    ds_read_b64_tr_b16 v[88:89], v115 offset:12288
    v_mfma_f32_16x16x32_bf16 v[36:39], v[64:67], a[100:103], v[36:39]
    ds_read_b64_tr_b16 v[90:91], v115 offset:14336
    v_mfma_f32_16x16x32_bf16 v[40:43], v[68:71], a[96:99], v[40:43]
    ds_read_b64_tr_b16 v[92:93], v116 offset:12288
    v_mfma_f32_16x16x32_bf16 v[44:47], v[68:71], a[100:103], v[44:47]
    ds_read_b64_tr_b16 v[94:95], v116 offset:14336
    s_waitcnt lgkmcnt(8)
    v_mfma_f32_16x16x32_bf16 v[48:51], v[72:75], a[96:99], v[48:51]
    v_add_u32 v113, 0xfffe0000, v113
    ds_read_b64_tr_b16 v[64:65], v113 offset:0
    v_mfma_f32_16x16x32_bf16 v[52:55], v[72:75], a[100:103], v[52:55]
    ds_read_b64_tr_b16 v[66:67], v113 offset:2048
    v_mfma_f32_16x16x32_bf16 v[56:59], v[76:79], a[96:99], v[56:59]
    v_add_u32 v114, 0xfffe0000, v114
    ds_read_b64_tr_b16 v[68:69], v114 offset:0
    v_mfma_f32_16x16x32_bf16 v[60:63], v[76:79], a[100:103], v[60:63]
    ds_read_b64_tr_b16 v[70:71], v114 offset:2048
    s_waitcnt lgkmcnt(8)
    v_mfma_f32_16x16x32_bf16 v[32:35], v[80:83], a[104:107], v[32:35]
    v_add_u32 v115, 0xfffe0000, v115
    ds_read_b64_tr_b16 v[72:73], v115 offset:0
    buffer_load_dwordx2 v[100:101], v119, s[20:23], s17 offen offset:0
    v_mfma_f32_16x16x32_bf16 v[36:39], v[80:83], a[108:111], v[36:39]
    ds_read_b64_tr_b16 v[74:75], v115 offset:2048
    v_mfma_f32_16x16x32_bf16 v[40:43], v[84:87], a[104:107], v[40:43]
    v_add_u32 v116, 0xfffe0000, v116
    ds_read_b64_tr_b16 v[76:77], v116 offset:0
    buffer_load_dwordx2 v[102:103], v120, s[20:23], s17 offen offset:0
    v_mfma_f32_16x16x32_bf16 v[44:47], v[84:87], a[108:111], v[44:47]
    ds_read_b64_tr_b16 v[78:79], v116 offset:2048
    s_waitcnt lgkmcnt(8)
    v_mfma_f32_16x16x32_bf16 v[48:51], v[88:91], a[104:107], v[48:51]
    ds_read_b64_tr_b16 v[80:81], v113 offset:4096
    buffer_load_dwordx2 v[104:105], v119, s[20:23], s17 offen offset:32
    v_mfma_f32_16x16x32_bf16 v[52:55], v[88:91], a[108:111], v[52:55]
    ds_read_b64_tr_b16 v[82:83], v113 offset:6144
    v_mfma_f32_16x16x32_bf16 v[56:59], v[92:95], a[104:107], v[56:59]
    ds_read_b64_tr_b16 v[84:85], v114 offset:4096
    buffer_load_dwordx2 v[106:107], v120, s[20:23], s17 offen offset:32
    v_mfma_f32_16x16x32_bf16 v[60:63], v[92:95], a[108:111], v[60:63]
    ds_read_b64_tr_b16 v[86:87], v114 offset:6144
    s_waitcnt lgkmcnt(8)
    v_mfma_f32_16x16x32_bf16 v[0:3], v[64:67], a[112:115], v[0:3]
    ds_read_b64_tr_b16 v[88:89], v115 offset:4096
    s_lshl_b32 s6, s63, 13
    s_cmp_eq_u32 s15, 0
    s_mov_b32 s7, 65536
    s_cselect_b32 s7, 32768, s7
    s_add_u32 s7, s7, s6
    v_add_u32 v96, s7, v112
    s_xor_b32 s7, s7, 98304
    v_add_u32 v97, s7, v112
    v_mfma_f32_16x16x32_bf16 v[4:7], v[64:67], a[116:119], v[4:7]
    ds_read_b64_tr_b16 v[90:91], v115 offset:6144
    v_mfma_f32_16x16x32_bf16 v[8:11], v[68:71], a[112:115], v[8:11]
    ds_read_b64_tr_b16 v[92:93], v116 offset:4096
    v_mfma_f32_16x16x32_bf16 v[12:15], v[68:71], a[116:119], v[12:15]
    ds_read_b64_tr_b16 v[94:95], v116 offset:6144
    s_waitcnt lgkmcnt(8)
    v_mfma_f32_16x16x32_bf16 v[16:19], v[72:75], a[112:115], v[16:19]
    ds_read_b64_tr_b16 v[64:65], v113 offset:8192
    v_mfma_f32_16x16x32_bf16 v[20:23], v[72:75], a[116:119], v[20:23]
    ds_read_b64_tr_b16 v[66:67], v113 offset:10240
    v_mfma_f32_16x16x32_bf16 v[24:27], v[76:79], a[112:115], v[24:27]
    ds_read_b64_tr_b16 v[68:69], v114 offset:8192
    v_mfma_f32_16x16x32_bf16 v[28:31], v[76:79], a[116:119], v[28:31]
    ds_read_b64_tr_b16 v[70:71], v114 offset:10240
    s_waitcnt lgkmcnt(8)
    v_mfma_f32_16x16x32_bf16 v[0:3], v[80:83], a[120:123], v[0:3]
    ds_read_b64_tr_b16 v[72:73], v115 offset:8192
    v_mfma_f32_16x16x32_bf16 v[4:7], v[80:83], a[124:127], v[4:7]
    ds_read_b64_tr_b16 v[74:75], v115 offset:10240
    v_mfma_f32_16x16x32_bf16 v[8:11], v[84:87], a[120:123], v[8:11]
    ds_read_b64_tr_b16 v[76:77], v116 offset:8192
    v_mfma_f32_16x16x32_bf16 v[12:15], v[84:87], a[124:127], v[12:15]
    ds_read_b64_tr_b16 v[78:79], v116 offset:10240
    s_waitcnt lgkmcnt(8)
    v_mfma_f32_16x16x32_bf16 v[16:19], v[88:91], a[120:123], v[16:19]
    ds_read_b64_tr_b16 v[80:81], v113 offset:12288
    v_mfma_f32_16x16x32_bf16 v[20:23], v[88:91], a[124:127], v[20:23]
    ds_read_b64_tr_b16 v[82:83], v113 offset:14336
    v_mfma_f32_16x16x32_bf16 v[24:27], v[92:95], a[120:123], v[24:27]
    ds_read_b64_tr_b16 v[84:85], v114 offset:12288
    v_mfma_f32_16x16x32_bf16 v[28:31], v[92:95], a[124:127], v[28:31]
    ds_read_b64_tr_b16 v[86:87], v114 offset:14336
    s_waitcnt lgkmcnt(8)
    v_mfma_f32_16x16x32_bf16 v[32:35], v[64:67], a[112:115], v[32:35]
    ds_read_b64_tr_b16 v[88:89], v115 offset:12288
    v_mfma_f32_16x16x32_bf16 v[36:39], v[64:67], a[116:119], v[36:39]
    ds_read_b64_tr_b16 v[90:91], v115 offset:14336
    v_mfma_f32_16x16x32_bf16 v[40:43], v[68:71], a[112:115], v[40:43]
    ds_read_b64_tr_b16 v[92:93], v116 offset:12288
    v_mfma_f32_16x16x32_bf16 v[44:47], v[68:71], a[116:119], v[44:47]
    ds_read_b64_tr_b16 v[94:95], v116 offset:14336
    s_waitcnt lgkmcnt(8)
    v_mfma_f32_16x16x32_bf16 v[48:51], v[72:75], a[112:115], v[48:51]
    v_mfma_f32_16x16x32_bf16 v[52:55], v[72:75], a[116:119], v[52:55]
    v_mfma_f32_16x16x32_bf16 v[56:59], v[76:79], a[112:115], v[56:59]
    v_mfma_f32_16x16x32_bf16 v[60:63], v[76:79], a[116:119], v[60:63]
    s_waitcnt lgkmcnt(4)
    v_mfma_f32_16x16x32_bf16 v[32:35], v[80:83], a[120:123], v[32:35]
    v_mfma_f32_16x16x32_bf16 v[36:39], v[80:83], a[124:127], v[36:39]
    v_mfma_f32_16x16x32_bf16 v[40:43], v[84:87], a[120:123], v[40:43]
    v_mfma_f32_16x16x32_bf16 v[44:47], v[84:87], a[124:127], v[44:47]
    s_waitcnt lgkmcnt(0)
    v_mfma_f32_16x16x32_bf16 v[48:51], v[88:91], a[120:123], v[48:51]
    v_mfma_f32_16x16x32_bf16 v[52:55], v[88:91], a[124:127], v[52:55]
    v_mfma_f32_16x16x32_bf16 v[56:59], v[92:95], a[120:123], v[56:59]
    v_mfma_f32_16x16x32_bf16 v[60:63], v[92:95], a[124:127], v[60:63]
    s_branch OUT_RED
P4_SHORT:
    v_add_u32 v113, 0x20000, v113
    ds_read_b64_tr_b16 v[64:65], v113 offset:0
    ds_read_b64_tr_b16 v[66:67], v113 offset:2048
    v_add_u32 v114, 0x20000, v114
    ds_read_b64_tr_b16 v[68:69], v114 offset:0
    ds_read_b64_tr_b16 v[70:71], v114 offset:2048
    v_add_u32 v115, 0x20000, v115
    ds_read_b64_tr_b16 v[72:73], v115 offset:0
    ds_read_b64_tr_b16 v[74:75], v115 offset:2048
    v_add_u32 v116, 0x20000, v116
    ds_read_b64_tr_b16 v[76:77], v116 offset:0
    ds_read_b64_tr_b16 v[78:79], v116 offset:2048
    ds_read_b64_tr_b16 v[80:81], v113 offset:4096
    ds_read_b64_tr_b16 v[82:83], v113 offset:6144
    ds_read_b64_tr_b16 v[84:85], v114 offset:4096
    ds_read_b64_tr_b16 v[86:87], v114 offset:6144
    s_waitcnt lgkmcnt(8)
    v_mfma_f32_16x16x32_bf16 v[0:3], v[64:67], a[64:67], 0
    ds_read_b64_tr_b16 v[88:89], v115 offset:4096
    s_add_u32 m0, s57, 65536
    v_mfma_f32_16x16x32_bf16 v[4:7], v[64:67], a[68:71], 0
    ds_read_b64_tr_b16 v[90:91], v115 offset:6144
    s_add_u32 s52, s19, 0
    v_mfma_f32_16x16x32_bf16 v[8:11], v[68:71], a[64:67], 0
    ds_read_b64_tr_b16 v[92:93], v116 offset:4096
    buffer_load_dwordx4 v118, s[36:39], s52 offen lds
    v_mfma_f32_16x16x32_bf16 v[12:15], v[68:71], a[68:71], 0
    ds_read_b64_tr_b16 v[94:95], v116 offset:6144
    s_add_u32 m0, s57, 73600
    s_waitcnt lgkmcnt(8)
    v_mfma_f32_16x16x32_bf16 v[16:19], v[72:75], a[64:67], 0
    ds_read_b64_tr_b16 v[64:65], v113 offset:8192
    s_nop 0
    v_mfma_f32_16x16x32_bf16 v[20:23], v[72:75], a[68:71], 0
    ds_read_b64_tr_b16 v[66:67], v113 offset:10240
    buffer_load_dwordx4 v118, s[36:39], s52 offen offset:128 lds
    v_mfma_f32_16x16x32_bf16 v[24:27], v[76:79], a[64:67], 0
    ds_read_b64_tr_b16 v[68:69], v114 offset:8192
    s_add_u32 m0, s57, 81920
    v_mfma_f32_16x16x32_bf16 v[28:31], v[76:79], a[68:71], 0
    ds_read_b64_tr_b16 v[70:71], v114 offset:10240
    s_add_u32 s52, s19, 65536
    s_waitcnt lgkmcnt(8)
    v_mfma_f32_16x16x32_bf16 v[0:3], v[80:83], a[72:75], v[0:3]
    ds_read_b64_tr_b16 v[72:73], v115 offset:8192
    buffer_load_dwordx4 v118, s[36:39], s52 offen lds
    buffer_load_dword v125, off, s[8:11], s27 sc1
    v_mfma_f32_16x16x32_bf16 v[4:7], v[80:83], a[76:79], v[4:7]
    ds_read_b64_tr_b16 v[74:75], v115 offset:10240
    s_add_u32 m0, s57, 89984
    v_mfma_f32_16x16x32_bf16 v[8:11], v[84:87], a[72:75], v[8:11]
    ds_read_b64_tr_b16 v[76:77], v116 offset:8192
    s_nop 0
    v_mfma_f32_16x16x32_bf16 v[12:15], v[84:87], a[76:79], v[12:15]
    ds_read_b64_tr_b16 v[78:79], v116 offset:10240
    buffer_load_dwordx4 v118, s[36:39], s52 offen offset:128 lds
    s_waitcnt lgkmcnt(8)
    v_mfma_f32_16x16x32_bf16 v[16:19], v[88:91], a[72:75], v[16:19]
    ds_read_b64_tr_b16 v[80:81], v113 offset:12288
    s_add_u32 m0, s57, 98304
    v_mfma_f32_16x16x32_bf16 v[20:23], v[88:91], a[76:79], v[20:23]
    ds_read_b64_tr_b16 v[82:83], v113 offset:14336
    s_add_u32 s52, s19, 131072
    v_mfma_f32_16x16x32_bf16 v[24:27], v[92:95], a[72:75], v[24:27]
    ds_read_b64_tr_b16 v[84:85], v114 offset:12288
    buffer_load_dwordx4 v118, s[36:39], s52 offen lds
    v_mfma_f32_16x16x32_bf16 v[28:31], v[92:95], a[76:79], v[28:31]
    ds_read_b64_tr_b16 v[86:87], v114 offset:14336
    s_add_u32 m0, s57, 106368
    s_barrier
    s_waitcnt lgkmcnt(8)
    v_mfma_f32_16x16x32_bf16 v[32:35], v[64:67], a[64:67], 0
    ds_read_b64_tr_b16 v[88:89], v115 offset:12288
    s_nop 0
    v_mfma_f32_16x16x32_bf16 v[36:39], v[64:67], a[68:71], 0
    ds_read_b64_tr_b16 v[90:91], v115 offset:14336
    buffer_load_dwordx4 v118, s[36:39], s52 offen offset:128 lds
    v_mfma_f32_16x16x32_bf16 v[40:43], v[68:71], a[64:67], 0
    ds_read_b64_tr_b16 v[92:93], v116 offset:12288
    s_add_u32 m0, s57, 114688
    v_mfma_f32_16x16x32_bf16 v[44:47], v[68:71], a[68:71], 0
    ds_read_b64_tr_b16 v[94:95], v116 offset:14336
    s_add_u32 s52, s19, 196608
    s_waitcnt lgkmcnt(8)
    v_mfma_f32_16x16x32_bf16 v[48:51], v[72:75], a[64:67], 0
    v_add_u32 v113, 0xfffe0000, v113
    ds_read_b64_tr_b16 v[64:65], v113 offset:0
    buffer_load_dwordx4 v118, s[36:39], s52 offen lds
    v_mfma_f32_16x16x32_bf16 v[52:55], v[72:75], a[68:71], 0
    ds_read_b64_tr_b16 v[66:67], v113 offset:2048
    s_add_u32 m0, s57, 122752
    v_mfma_f32_16x16x32_bf16 v[56:59], v[76:79], a[64:67], 0
    v_add_u32 v114, 0xfffe0000, v114
    ds_read_b64_tr_b16 v[68:69], v114 offset:0
    s_nop 0
    v_mfma_f32_16x16x32_bf16 v[60:63], v[76:79], a[68:71], 0
    ds_read_b64_tr_b16 v[70:71], v114 offset:2048
    buffer_load_dwordx4 v118, s[36:39], s52 offen offset:128 lds
    s_waitcnt lgkmcnt(8)
    v_mfma_f32_16x16x32_bf16 v[32:35], v[80:83], a[72:75], v[32:35]
    v_add_u32 v115, 0xfffe0000, v115
    ds_read_b64_tr_b16 v[72:73], v115 offset:0
    s_waitcnt vmcnt(5)
    v_readfirstlane_b32 s6, v125
    s_mov_b32 s7, 0
    s_cmp_ge_u32 s6, 8
    s_cbranch_scc1 PK_25
PL_26:
    s_sleep 4
    buffer_load_dword v125, off, s[8:11], s27 sc1
    s_add_u32 s7, s7, 1
    s_waitcnt vmcnt(0)
    v_readfirstlane_b32 s6, v125
    s_cmp_ge_u32 s7, 0x40000
    s_cbranch_scc1 PK_25
    s_cmp_lt_u32 s6, 8
    s_cbranch_scc1 PL_26
PK_25:
    v_mfma_f32_16x16x32_bf16 v[36:39], v[80:83], a[76:79], v[36:39]
    ds_read_b64_tr_b16 v[74:75], v115 offset:2048
    s_add_u32 s53, s25, 0
    v_mfma_f32_16x16x32_bf16 v[40:43], v[84:87], a[72:75], v[40:43]
    v_add_u32 v116, 0xfffe0000, v116
    ds_read_b64_tr_b16 v[76:77], v116 offset:0
    buffer_load_dwordx4 a[112:115], v112, s[8:11], s53 offen offset:0 sc1
    v_mfma_f32_16x16x32_bf16 v[44:47], v[84:87], a[76:79], v[44:47]
    ds_read_b64_tr_b16 v[78:79], v116 offset:2048
    buffer_load_dwordx4 a[116:119], v112, s[8:11], s53 offen offset:1024 sc1
    s_waitcnt lgkmcnt(8)
    v_mfma_f32_16x16x32_bf16 v[48:51], v[88:91], a[72:75], v[48:51]
    ds_read_b64_tr_b16 v[80:81], v113 offset:4096
    buffer_load_dwordx4 a[120:123], v112, s[8:11], s53 offen offset:2048 sc1
    v_mfma_f32_16x16x32_bf16 v[52:55], v[88:91], a[76:79], v[52:55]
    ds_read_b64_tr_b16 v[82:83], v113 offset:6144
    buffer_load_dwordx4 a[124:127], v112, s[8:11], s53 offen offset:3072 sc1
    v_mfma_f32_16x16x32_bf16 v[56:59], v[92:95], a[72:75], v[56:59]
    ds_read_b64_tr_b16 v[84:85], v114 offset:4096
    s_add_u32 s53, s25, 8192
    v_mfma_f32_16x16x32_bf16 v[60:63], v[92:95], a[76:79], v[60:63]
    ds_read_b64_tr_b16 v[86:87], v114 offset:6144
    buffer_load_dwordx4 a[0:3], v112, s[8:11], s53 offen offset:0 sc1
    s_waitcnt lgkmcnt(8)
    v_mfma_f32_16x16x32_bf16 v[0:3], v[64:67], a[80:83], v[0:3]
    ds_read_b64_tr_b16 v[88:89], v115 offset:4096
    buffer_load_dwordx4 a[4:7], v112, s[8:11], s53 offen offset:1024 sc1
    v_mfma_f32_16x16x32_bf16 v[4:7], v[64:67], a[84:87], v[4:7]
    ds_read_b64_tr_b16 v[90:91], v115 offset:6144
    buffer_load_dwordx4 a[8:11], v112, s[8:11], s53 offen offset:2048 sc1
    v_mfma_f32_16x16x32_bf16 v[8:11], v[68:71], a[80:83], v[8:11]
    ds_read_b64_tr_b16 v[92:93], v116 offset:4096
    buffer_load_dwordx4 a[12:15], v112, s[8:11], s53 offen offset:3072 sc1
    v_mfma_f32_16x16x32_bf16 v[12:15], v[68:71], a[84:87], v[12:15]
    ds_read_b64_tr_b16 v[94:95], v116 offset:6144
    s_add_u32 s53, s25, 16384
    s_waitcnt lgkmcnt(8)
    v_mfma_f32_16x16x32_bf16 v[16:19], v[72:75], a[80:83], v[16:19]
    ds_read_b64_tr_b16 v[64:65], v113 offset:8192
    buffer_load_dwordx4 a[16:19], v112, s[8:11], s53 offen offset:0 sc1
    v_mfma_f32_16x16x32_bf16 v[20:23], v[72:75], a[84:87], v[20:23]
    ds_read_b64_tr_b16 v[66:67], v113 offset:10240
    buffer_load_dwordx4 a[20:23], v112, s[8:11], s53 offen offset:1024 sc1
    v_mfma_f32_16x16x32_bf16 v[24:27], v[76:79], a[80:83], v[24:27]
    ds_read_b64_tr_b16 v[68:69], v114 offset:8192
    buffer_load_dwordx4 a[24:27], v112, s[8:11], s53 offen offset:2048 sc1
    v_mfma_f32_16x16x32_bf16 v[28:31], v[76:79], a[84:87], v[28:31]
    ds_read_b64_tr_b16 v[70:71], v114 offset:10240
    buffer_load_dwordx4 a[28:31], v112, s[8:11], s53 offen offset:3072 sc1
    s_waitcnt lgkmcnt(8)
    v_mfma_f32_16x16x32_bf16 v[0:3], v[80:83], a[88:91], v[0:3]
    ds_read_b64_tr_b16 v[72:73], v115 offset:8192
    v_mfma_f32_16x16x32_bf16 v[4:7], v[80:83], a[92:95], v[4:7]
    ds_read_b64_tr_b16 v[74:75], v115 offset:10240
    v_mfma_f32_16x16x32_bf16 v[8:11], v[84:87], a[88:91], v[8:11]
    ds_read_b64_tr_b16 v[76:77], v116 offset:8192
    v_mfma_f32_16x16x32_bf16 v[12:15], v[84:87], a[92:95], v[12:15]
    ds_read_b64_tr_b16 v[78:79], v116 offset:10240
    s_waitcnt lgkmcnt(8)
    v_mfma_f32_16x16x32_bf16 v[16:19], v[88:91], a[88:91], v[16:19]
    ds_read_b64_tr_b16 v[80:81], v113 offset:12288
    v_mfma_f32_16x16x32_bf16 v[20:23], v[88:91], a[92:95], v[20:23]
    ds_read_b64_tr_b16 v[82:83], v113 offset:14336
    v_mfma_f32_16x16x32_bf16 v[24:27], v[92:95], a[88:91], v[24:27]
    ds_read_b64_tr_b16 v[84:85], v114 offset:12288
    v_mfma_f32_16x16x32_bf16 v[28:31], v[92:95], a[92:95], v[28:31]
    ds_read_b64_tr_b16 v[86:87], v114 offset:14336
    s_barrier
    s_waitcnt lgkmcnt(8)
    v_mfma_f32_16x16x32_bf16 v[32:35], v[64:67], a[80:83], v[32:35]
    ds_read_b64_tr_b16 v[88:89], v115 offset:12288
    s_add_u32 m0, s57, 131072
    v_mfma_f32_16x16x32_bf16 v[36:39], v[64:67], a[84:87], v[36:39]
    ds_read_b64_tr_b16 v[90:91], v115 offset:14336
    s_add_u32 s52, s19, 262144
    v_mfma_f32_16x16x32_bf16 v[40:43], v[68:71], a[80:83], v[40:43]
    ds_read_b64_tr_b16 v[92:93], v116 offset:12288
    buffer_load_dwordx4 v118, s[36:39], s52 offen lds
    v_mfma_f32_16x16x32_bf16 v[44:47], v[68:71], a[84:87], v[44:47]
    ds_read_b64_tr_b16 v[94:95], v116 offset:14336
    s_add_u32 m0, s57, 139136
    s_waitcnt lgkmcnt(8)
    v_mfma_f32_16x16x32_bf16 v[48:51], v[72:75], a[80:83], v[48:51]
    v_add_u32 v113, 0x8000, v113
    ds_read_b64_tr_b16 v[64:65], v113 offset:0
    s_nop 0
    v_mfma_f32_16x16x32_bf16 v[52:55], v[72:75], a[84:87], v[52:55]
    ds_read_b64_tr_b16 v[66:67], v113 offset:2048
    buffer_load_dwordx4 v118, s[36:39], s52 offen offset:128 lds
    v_mfma_f32_16x16x32_bf16 v[56:59], v[76:79], a[80:83], v[56:59]
    v_add_u32 v114, 0x8000, v114
    ds_read_b64_tr_b16 v[68:69], v114 offset:0
    s_add_u32 m0, s57, 147456
    v_mfma_f32_16x16x32_bf16 v[60:63], v[76:79], a[84:87], v[60:63]
    ds_read_b64_tr_b16 v[70:71], v114 offset:2048
    s_add_u32 s52, s19, 327680
    s_waitcnt lgkmcnt(8)
    v_mfma_f32_16x16x32_bf16 v[32:35], v[80:83], a[88:91], v[32:35]
    v_add_u32 v115, 0x8000, v115
    ds_read_b64_tr_b16 v[72:73], v115 offset:0
    buffer_load_dwordx4 v118, s[36:39], s52 offen lds
    v_mfma_f32_16x16x32_bf16 v[36:39], v[80:83], a[92:95], v[36:39]
    ds_read_b64_tr_b16 v[74:75], v115 offset:2048
    s_add_u32 m0, s57, 155520
    v_mfma_f32_16x16x32_bf16 v[40:43], v[84:87], a[88:91], v[40:43]
    v_add_u32 v116, 0x8000, v116
    ds_read_b64_tr_b16 v[76:77], v116 offset:0
    s_nop 0
    v_mfma_f32_16x16x32_bf16 v[44:47], v[84:87], a[92:95], v[44:47]
    ds_read_b64_tr_b16 v[78:79], v116 offset:2048
    buffer_load_dwordx4 v118, s[36:39], s52 offen offset:128 lds
    s_waitcnt lgkmcnt(8)
    v_mfma_f32_16x16x32_bf16 v[48:51], v[88:91], a[88:91], v[48:51]
    ds_read_b64_tr_b16 v[80:81], v113 offset:4096
    v_mfma_f32_16x16x32_bf16 v[52:55], v[88:91], a[92:95], v[52:55]
    ds_read_b64_tr_b16 v[82:83], v113 offset:6144
    v_mfma_f32_16x16x32_bf16 v[56:59], v[92:95], a[88:91], v[56:59]
    ds_read_b64_tr_b16 v[84:85], v114 offset:4096
    v_mfma_f32_16x16x32_bf16 v[60:63], v[92:95], a[92:95], v[60:63]
    ds_read_b64_tr_b16 v[86:87], v114 offset:6144
    s_waitcnt lgkmcnt(8)
    v_mfma_f32_16x16x32_bf16 v[0:3], v[64:67], a[96:99], v[0:3]
    ds_read_b64_tr_b16 v[88:89], v115 offset:4096
    s_add_u32 s53, s25, 24576
    v_mfma_f32_16x16x32_bf16 v[4:7], v[64:67], a[100:103], v[4:7]
    ds_read_b64_tr_b16 v[90:91], v115 offset:6144
    buffer_load_dwordx4 a[32:35], v112, s[8:11], s53 offen offset:0 sc1
    v_mfma_f32_16x16x32_bf16 v[8:11], v[68:71], a[96:99], v[8:11]
    ds_read_b64_tr_b16 v[92:93], v116 offset:4096
    buffer_load_dwordx4 a[36:39], v112, s[8:11], s53 offen offset:1024 sc1
    v_mfma_f32_16x16x32_bf16 v[12:15], v[68:71], a[100:103], v[12:15]
    ds_read_b64_tr_b16 v[94:95], v116 offset:6144
    buffer_load_dwordx4 a[40:43], v112, s[8:11], s53 offen offset:2048 sc1
    s_waitcnt lgkmcnt(8)
    v_mfma_f32_16x16x32_bf16 v[16:19], v[72:75], a[96:99], v[16:19]
    ds_read_b64_tr_b16 v[64:65], v113 offset:8192
    buffer_load_dwordx4 a[44:47], v112, s[8:11], s53 offen offset:3072 sc1
    v_mfma_f32_16x16x32_bf16 v[20:23], v[72:75], a[100:103], v[20:23]
    ds_read_b64_tr_b16 v[66:67], v113 offset:10240
    v_mfma_f32_16x16x32_bf16 v[24:27], v[76:79], a[96:99], v[24:27]
    ds_read_b64_tr_b16 v[68:69], v114 offset:8192
    v_mfma_f32_16x16x32_bf16 v[28:31], v[76:79], a[100:103], v[28:31]
    ds_read_b64_tr_b16 v[70:71], v114 offset:10240
    s_waitcnt lgkmcnt(8)
    v_mfma_f32_16x16x32_bf16 v[0:3], v[80:83], a[104:107], v[0:3]
    ds_read_b64_tr_b16 v[72:73], v115 offset:8192
    v_mfma_f32_16x16x32_bf16 v[4:7], v[80:83], a[108:111], v[4:7]
    ds_read_b64_tr_b16 v[74:75], v115 offset:10240
    v_mfma_f32_16x16x32_bf16 v[8:11], v[84:87], a[104:107], v[8:11]
    ds_read_b64_tr_b16 v[76:77], v116 offset:8192
    v_mfma_f32_16x16x32_bf16 v[12:15], v[84:87], a[108:111], v[12:15]
    ds_read_b64_tr_b16 v[78:79], v116 offset:10240
    s_waitcnt lgkmcnt(8)
    v_mfma_f32_16x16x32_bf16 v[16:19], v[88:91], a[104:107], v[16:19]
    ds_read_b64_tr_b16 v[80:81], v113 offset:12288
    v_mfma_f32_16x16x32_bf16 v[20:23], v[88:91], a[108:111], v[20:23]
    ds_read_b64_tr_b16 v[82:83], v113 offset:14336
    v_mfma_f32_16x16x32_bf16 v[24:27], v[92:95], a[104:107], v[24:27]
    ds_read_b64_tr_b16 v[84:85], v114 offset:12288
    v_mfma_f32_16x16x32_bf16 v[28:31], v[92:95], a[108:111], v[28:31]
    ds_read_b64_tr_b16 v[86:87], v114 offset:14336
    s_waitcnt vmcnt(24)
    s_barrier
    s_waitcnt lgkmcnt(8)
    v_mfma_f32_16x16x32_bf16 v[32:35], v[64:67], a[96:99], v[32:35]
    ds_read_b64_tr_b16 v[88:89], v115 offset:12288
    s_add_u32 m0, s57, 0
    v_mfma_f32_16x16x32_bf16 v[36:39], v[64:67], a[100:103], v[36:39]
    ds_read_b64_tr_b16 v[90:91], v115 offset:14336
    s_add_u32 s52, s19, 393216
    v_mfma_f32_16x16x32_bf16 v[40:43], v[68:71], a[96:99], v[40:43]
    ds_read_b64_tr_b16 v[92:93], v116 offset:12288
    buffer_load_dwordx4 v118, s[36:39], s52 offen lds
    v_mfma_f32_16x16x32_bf16 v[44:47], v[68:71], a[100:103], v[44:47]
    ds_read_b64_tr_b16 v[94:95], v116 offset:14336
    s_add_u32 m0, s57, 8064
    s_waitcnt lgkmcnt(8)
    v_mfma_f32_16x16x32_bf16 v[48:51], v[72:75], a[96:99], v[48:51]
    v_add_u32 v113, 0x8000, v113
    ds_read_b64_tr_b16 v[64:65], v113 offset:0
    s_nop 0
    v_mfma_f32_16x16x32_bf16 v[52:55], v[72:75], a[100:103], v[52:55]
    ds_read_b64_tr_b16 v[66:67], v113 offset:2048
    buffer_load_dwordx4 v118, s[36:39], s52 offen offset:128 lds
    v_mfma_f32_16x16x32_bf16 v[56:59], v[76:79], a[96:99], v[56:59]
    v_add_u32 v114, 0x8000, v114
    ds_read_b64_tr_b16 v[68:69], v114 offset:0
    s_add_u32 m0, s57, 16384
    v_mfma_f32_16x16x32_bf16 v[60:63], v[76:79], a[100:103], v[60:63]
    ds_read_b64_tr_b16 v[70:71], v114 offset:2048
    s_add_u32 s52, s19, 458752
    s_waitcnt lgkmcnt(8)
    v_mfma_f32_16x16x32_bf16 v[32:35], v[80:83], a[104:107], v[32:35]
    v_add_u32 v115, 0x8000, v115
    ds_read_b64_tr_b16 v[72:73], v115 offset:0
    buffer_load_dwordx4 v118, s[36:39], s52 offen lds
    v_mfma_f32_16x16x32_bf16 v[36:39], v[80:83], a[108:111], v[36:39]
    ds_read_b64_tr_b16 v[74:75], v115 offset:2048
    s_add_u32 m0, s57, 24448
    v_mfma_f32_16x16x32_bf16 v[40:43], v[84:87], a[104:107], v[40:43]
    v_add_u32 v116, 0x8000, v116
    ds_read_b64_tr_b16 v[76:77], v116 offset:0
    s_nop 0
    v_mfma_f32_16x16x32_bf16 v[44:47], v[84:87], a[108:111], v[44:47]
    ds_read_b64_tr_b16 v[78:79], v116 offset:2048
    buffer_load_dwordx4 v118, s[36:39], s52 offen offset:128 lds
    s_waitcnt lgkmcnt(8)
    v_mfma_f32_16x16x32_bf16 v[48:51], v[88:91], a[104:107], v[48:51]
    ds_read_b64_tr_b16 v[80:81], v113 offset:4096
    v_mfma_f32_16x16x32_bf16 v[52:55], v[88:91], a[108:111], v[52:55]
    ds_read_b64_tr_b16 v[82:83], v113 offset:6144
    v_mfma_f32_16x16x32_bf16 v[56:59], v[92:95], a[104:107], v[56:59]
    ds_read_b64_tr_b16 v[84:85], v114 offset:4096
    v_mfma_f32_16x16x32_bf16 v[60:63], v[92:95], a[108:111], v[60:63]
    ds_read_b64_tr_b16 v[86:87], v114 offset:6144
    s_waitcnt lgkmcnt(8)
    s_waitcnt vmcnt(23)
    v_mfma_f32_16x16x32_bf16 v[0:3], v[64:67], a[112:115], v[0:3]
    ds_read_b64_tr_b16 v[88:89], v115 offset:4096
    s_add_u32 s53, s25, 32768
    s_waitcnt vmcnt(22)
    v_mfma_f32_16x16x32_bf16 v[4:7], v[64:67], a[116:119], v[4:7]
    ds_read_b64_tr_b16 v[90:91], v115 offset:6144
    buffer_load_dwordx4 a[48:51], v112, s[8:11], s53 offen offset:0 sc1
    v_mfma_f32_16x16x32_bf16 v[8:11], v[68:71], a[112:115], v[8:11]
    ds_read_b64_tr_b16 v[92:93], v116 offset:4096
    buffer_load_dwordx4 a[52:55], v112, s[8:11], s53 offen offset:1024 sc1
    v_mfma_f32_16x16x32_bf16 v[12:15], v[68:71], a[116:119], v[12:15]
    ds_read_b64_tr_b16 v[94:95], v116 offset:6144
    buffer_load_dwordx4 a[56:59], v112, s[8:11], s53 offen offset:2048 sc1
    s_waitcnt lgkmcnt(8)
    v_mfma_f32_16x16x32_bf16 v[16:19], v[72:75], a[112:115], v[16:19]
    ds_read_b64_tr_b16 v[64:65], v113 offset:8192
    buffer_load_dwordx4 a[60:63], v112, s[8:11], s53 offen offset:3072 sc1
    v_mfma_f32_16x16x32_bf16 v[20:23], v[72:75], a[116:119], v[20:23]
    ds_read_b64_tr_b16 v[66:67], v113 offset:10240
    v_mfma_f32_16x16x32_bf16 v[24:27], v[76:79], a[112:115], v[24:27]
    ds_read_b64_tr_b16 v[68:69], v114 offset:8192
    v_mfma_f32_16x16x32_bf16 v[28:31], v[76:79], a[116:119], v[28:31]
    ds_read_b64_tr_b16 v[70:71], v114 offset:10240
    s_waitcnt lgkmcnt(8)
    s_waitcnt vmcnt(25)
    v_mfma_f32_16x16x32_bf16 v[0:3], v[80:83], a[120:123], v[0:3]
    ds_read_b64_tr_b16 v[72:73], v115 offset:8192
    s_waitcnt vmcnt(24)
    v_mfma_f32_16x16x32_bf16 v[4:7], v[80:83], a[124:127], v[4:7]
    ds_read_b64_tr_b16 v[74:75], v115 offset:10240
    v_mfma_f32_16x16x32_bf16 v[8:11], v[84:87], a[120:123], v[8:11]
    ds_read_b64_tr_b16 v[76:77], v116 offset:8192
    v_mfma_f32_16x16x32_bf16 v[12:15], v[84:87], a[124:127], v[12:15]
    ds_read_b64_tr_b16 v[78:79], v116 offset:10240
    s_waitcnt lgkmcnt(8)
    v_mfma_f32_16x16x32_bf16 v[16:19], v[88:91], a[120:123], v[16:19]
    ds_read_b64_tr_b16 v[80:81], v113 offset:12288
    v_mfma_f32_16x16x32_bf16 v[20:23], v[88:91], a[124:127], v[20:23]
    ds_read_b64_tr_b16 v[82:83], v113 offset:14336
    v_mfma_f32_16x16x32_bf16 v[24:27], v[92:95], a[120:123], v[24:27]
    ds_read_b64_tr_b16 v[84:85], v114 offset:12288
    v_mfma_f32_16x16x32_bf16 v[28:31], v[92:95], a[124:127], v[28:31]
    ds_read_b64_tr_b16 v[86:87], v114 offset:14336
    s_barrier
    s_waitcnt lgkmcnt(8)
    v_mfma_f32_16x16x32_bf16 v[32:35], v[64:67], a[112:115], v[32:35]
    ds_read_b64_tr_b16 v[88:89], v115 offset:12288
    s_add_u32 m0, s57, 32768
    v_mfma_f32_16x16x32_bf16 v[36:39], v[64:67], a[116:119], v[36:39]
    ds_read_b64_tr_b16 v[90:91], v115 offset:14336
    s_add_u32 s52, s19, 524288
    v_mfma_f32_16x16x32_bf16 v[40:43], v[68:71], a[112:115], v[40:43]
    ds_read_b64_tr_b16 v[92:93], v116 offset:12288
    buffer_load_dwordx4 v118, s[36:39], s52 offen lds
    v_mfma_f32_16x16x32_bf16 v[44:47], v[68:71], a[116:119], v[44:47]
    ds_read_b64_tr_b16 v[94:95], v116 offset:14336
    s_add_u32 m0, s57, 40832
    s_waitcnt lgkmcnt(8)
    v_mfma_f32_16x16x32_bf16 v[48:51], v[72:75], a[112:115], v[48:51]
    v_add_u32 v113, 0x8000, v113
    ds_read_b64_tr_b16 v[64:65], v113 offset:0
    s_nop 0
    v_mfma_f32_16x16x32_bf16 v[52:55], v[72:75], a[116:119], v[52:55]
    ds_read_b64_tr_b16 v[66:67], v113 offset:2048
    buffer_load_dwordx4 v118, s[36:39], s52 offen offset:128 lds
    v_mfma_f32_16x16x32_bf16 v[56:59], v[76:79], a[112:115], v[56:59]
    v_add_u32 v114, 0x8000, v114
    ds_read_b64_tr_b16 v[68:69], v114 offset:0
    s_add_u32 m0, s57, 49152
    v_mfma_f32_16x16x32_bf16 v[60:63], v[76:79], a[116:119], v[60:63]
    ds_read_b64_tr_b16 v[70:71], v114 offset:2048
    s_add_u32 s52, s19, 589824
    s_waitcnt lgkmcnt(8)
    v_mfma_f32_16x16x32_bf16 v[32:35], v[80:83], a[120:123], v[32:35]
    v_add_u32 v115, 0x8000, v115
    ds_read_b64_tr_b16 v[72:73], v115 offset:0
    buffer_load_dwordx4 v118, s[36:39], s52 offen lds
    v_mfma_f32_16x16x32_bf16 v[36:39], v[80:83], a[124:127], v[36:39]
    ds_read_b64_tr_b16 v[74:75], v115 offset:2048
    s_add_u32 m0, s57, 57216
    v_mfma_f32_16x16x32_bf16 v[40:43], v[84:87], a[120:123], v[40:43]
    v_add_u32 v116, 0x8000, v116
    ds_read_b64_tr_b16 v[76:77], v116 offset:0
    s_nop 0
    v_mfma_f32_16x16x32_bf16 v[44:47], v[84:87], a[124:127], v[44:47]
    ds_read_b64_tr_b16 v[78:79], v116 offset:2048
    buffer_load_dwordx4 v118, s[36:39], s52 offen offset:128 lds
    s_waitcnt lgkmcnt(8)
    v_mfma_f32_16x16x32_bf16 v[48:51], v[88:91], a[120:123], v[48:51]
    ds_read_b64_tr_b16 v[80:81], v113 offset:4096
    v_mfma_f32_16x16x32_bf16 v[52:55], v[88:91], a[124:127], v[52:55]
    ds_read_b64_tr_b16 v[82:83], v113 offset:6144
    v_mfma_f32_16x16x32_bf16 v[56:59], v[92:95], a[120:123], v[56:59]
    ds_read_b64_tr_b16 v[84:85], v114 offset:4096
    v_mfma_f32_16x16x32_bf16 v[60:63], v[92:95], a[124:127], v[60:63]
    ds_read_b64_tr_b16 v[86:87], v114 offset:6144
    s_waitcnt lgkmcnt(8)
    s_waitcnt vmcnt(27)
    v_mfma_f32_16x16x32_bf16 v[0:3], v[64:67], a[0:3], v[0:3]
    ds_read_b64_tr_b16 v[88:89], v115 offset:4096
    s_add_u32 s53, s25, 40960
    s_waitcnt vmcnt(26)
    v_mfma_f32_16x16x32_bf16 v[4:7], v[64:67], a[4:7], v[4:7]
    ds_read_b64_tr_b16 v[90:91], v115 offset:6144
    buffer_load_dwordx4 a[64:67], v112, s[8:11], s53 offen offset:0 sc1
    v_mfma_f32_16x16x32_bf16 v[8:11], v[68:71], a[0:3], v[8:11]
    ds_read_b64_tr_b16 v[92:93], v116 offset:4096
    buffer_load_dwordx4 a[68:71], v112, s[8:11], s53 offen offset:1024 sc1
    v_mfma_f32_16x16x32_bf16 v[12:15], v[68:71], a[4:7], v[12:15]
    ds_read_b64_tr_b16 v[94:95], v116 offset:6144
    buffer_load_dwordx4 a[72:75], v112, s[8:11], s53 offen offset:2048 sc1
    s_waitcnt lgkmcnt(8)
    v_mfma_f32_16x16x32_bf16 v[16:19], v[72:75], a[0:3], v[16:19]
    ds_read_b64_tr_b16 v[64:65], v113 offset:8192
    buffer_load_dwordx4 a[76:79], v112, s[8:11], s53 offen offset:3072 sc1
    v_mfma_f32_16x16x32_bf16 v[20:23], v[72:75], a[4:7], v[20:23]
    ds_read_b64_tr_b16 v[66:67], v113 offset:10240
    v_mfma_f32_16x16x32_bf16 v[24:27], v[76:79], a[0:3], v[24:27]
    ds_read_b64_tr_b16 v[68:69], v114 offset:8192
    v_mfma_f32_16x16x32_bf16 v[28:31], v[76:79], a[4:7], v[28:31]
    ds_read_b64_tr_b16 v[70:71], v114 offset:10240
    s_waitcnt lgkmcnt(8)
    s_waitcnt vmcnt(29)
    v_mfma_f32_16x16x32_bf16 v[0:3], v[80:83], a[8:11], v[0:3]
    ds_read_b64_tr_b16 v[72:73], v115 offset:8192
    s_waitcnt vmcnt(28)
    v_mfma_f32_16x16x32_bf16 v[4:7], v[80:83], a[12:15], v[4:7]
    ds_read_b64_tr_b16 v[74:75], v115 offset:10240
    v_mfma_f32_16x16x32_bf16 v[8:11], v[84:87], a[8:11], v[8:11]
    ds_read_b64_tr_b16 v[76:77], v116 offset:8192
    v_mfma_f32_16x16x32_bf16 v[12:15], v[84:87], a[12:15], v[12:15]
    ds_read_b64_tr_b16 v[78:79], v116 offset:10240
    s_waitcnt lgkmcnt(8)
    v_mfma_f32_16x16x32_bf16 v[16:19], v[88:91], a[8:11], v[16:19]
    ds_read_b64_tr_b16 v[80:81], v113 offset:12288
    v_mfma_f32_16x16x32_bf16 v[20:23], v[88:91], a[12:15], v[20:23]
    ds_read_b64_tr_b16 v[82:83], v113 offset:14336
    v_mfma_f32_16x16x32_bf16 v[24:27], v[92:95], a[8:11], v[24:27]
    ds_read_b64_tr_b16 v[84:85], v114 offset:12288
    v_mfma_f32_16x16x32_bf16 v[28:31], v[92:95], a[12:15], v[28:31]
    ds_read_b64_tr_b16 v[86:87], v114 offset:14336
    s_waitcnt vmcnt(20)
    s_barrier
    s_waitcnt lgkmcnt(8)
    v_mfma_f32_16x16x32_bf16 v[32:35], v[64:67], a[0:3], v[32:35]
    ds_read_b64_tr_b16 v[88:89], v115 offset:12288
    s_add_u32 m0, s57, 65536
    v_mfma_f32_16x16x32_bf16 v[36:39], v[64:67], a[4:7], v[36:39]
    ds_read_b64_tr_b16 v[90:91], v115 offset:14336
    s_add_u32 s52, s19, 655360
    v_mfma_f32_16x16x32_bf16 v[40:43], v[68:71], a[0:3], v[40:43]
    ds_read_b64_tr_b16 v[92:93], v116 offset:12288
    buffer_load_dwordx4 v118, s[36:39], s52 offen lds
    v_mfma_f32_16x16x32_bf16 v[44:47], v[68:71], a[4:7], v[44:47]
    ds_read_b64_tr_b16 v[94:95], v116 offset:14336
    s_add_u32 m0, s57, 73600
    s_waitcnt lgkmcnt(8)
    v_mfma_f32_16x16x32_bf16 v[48:51], v[72:75], a[0:3], v[48:51]
    v_add_u32 v113, 0x8000, v113
    ds_read_b64_tr_b16 v[64:65], v113 offset:0
    s_nop 0
    v_mfma_f32_16x16x32_bf16 v[52:55], v[72:75], a[4:7], v[52:55]
    ds_read_b64_tr_b16 v[66:67], v113 offset:2048
    buffer_load_dwordx4 v118, s[36:39], s52 offen offset:128 lds
    v_mfma_f32_16x16x32_bf16 v[56:59], v[76:79], a[0:3], v[56:59]
    v_add_u32 v114, 0x8000, v114
    ds_read_b64_tr_b16 v[68:69], v114 offset:0
    s_add_u32 m0, s57, 81920
    v_mfma_f32_16x16x32_bf16 v[60:63], v[76:79], a[4:7], v[60:63]
    ds_read_b64_tr_b16 v[70:71], v114 offset:2048
    s_add_u32 s52, s19, 720896
    s_waitcnt lgkmcnt(8)
    v_mfma_f32_16x16x32_bf16 v[32:35], v[80:83], a[8:11], v[32:35]
    v_add_u32 v115, 0x8000, v115
    ds_read_b64_tr_b16 v[72:73], v115 offset:0
    buffer_load_dwordx4 v118, s[36:39], s52 offen lds
    v_mfma_f32_16x16x32_bf16 v[36:39], v[80:83], a[12:15], v[36:39]
    ds_read_b64_tr_b16 v[74:75], v115 offset:2048
    s_add_u32 m0, s57, 89984
    v_mfma_f32_16x16x32_bf16 v[40:43], v[84:87], a[8:11], v[40:43]
    v_add_u32 v116, 0x8000, v116
    ds_read_b64_tr_b16 v[76:77], v116 offset:0
    s_nop 0
    v_mfma_f32_16x16x32_bf16 v[44:47], v[84:87], a[12:15], v[44:47]
    ds_read_b64_tr_b16 v[78:79], v116 offset:2048
    buffer_load_dwordx4 v118, s[36:39], s52 offen offset:128 lds
    s_waitcnt lgkmcnt(8)
    v_mfma_f32_16x16x32_bf16 v[48:51], v[88:91], a[8:11], v[48:51]
    ds_read_b64_tr_b16 v[80:81], v113 offset:4096
    v_mfma_f32_16x16x32_bf16 v[52:55], v[88:91], a[12:15], v[52:55]
    ds_read_b64_tr_b16 v[82:83], v113 offset:6144
    v_mfma_f32_16x16x32_bf16 v[56:59], v[92:95], a[8:11], v[56:59]
    ds_read_b64_tr_b16 v[84:85], v114 offset:4096
    v_mfma_f32_16x16x32_bf16 v[60:63], v[92:95], a[12:15], v[60:63]
    ds_read_b64_tr_b16 v[86:87], v114 offset:6144
    s_waitcnt lgkmcnt(8)
    v_mfma_f32_16x16x32_bf16 v[0:3], v[64:67], a[16:19], v[0:3]
    ds_read_b64_tr_b16 v[88:89], v115 offset:4096
    s_add_u32 s53, s25, 49152
    v_mfma_f32_16x16x32_bf16 v[4:7], v[64:67], a[20:23], v[4:7]
    ds_read_b64_tr_b16 v[90:91], v115 offset:6144
    buffer_load_dwordx4 a[80:83], v112, s[8:11], s53 offen offset:0 sc1
    v_mfma_f32_16x16x32_bf16 v[8:11], v[68:71], a[16:19], v[8:11]
    ds_read_b64_tr_b16 v[92:93], v116 offset:4096
    buffer_load_dwordx4 a[84:87], v112, s[8:11], s53 offen offset:1024 sc1
    v_mfma_f32_16x16x32_bf16 v[12:15], v[68:71], a[20:23], v[12:15]
    ds_read_b64_tr_b16 v[94:95], v116 offset:6144
    buffer_load_dwordx4 a[88:91], v112, s[8:11], s53 offen offset:2048 sc1
    s_waitcnt lgkmcnt(8)
    v_mfma_f32_16x16x32_bf16 v[16:19], v[72:75], a[16:19], v[16:19]
    ds_read_b64_tr_b16 v[64:65], v113 offset:8192
    buffer_load_dwordx4 a[92:95], v112, s[8:11], s53 offen offset:3072 sc1
    v_mfma_f32_16x16x32_bf16 v[20:23], v[72:75], a[20:23], v[20:23]
    ds_read_b64_tr_b16 v[66:67], v113 offset:10240
    v_mfma_f32_16x16x32_bf16 v[24:27], v[76:79], a[16:19], v[24:27]
    ds_read_b64_tr_b16 v[68:69], v114 offset:8192
    v_mfma_f32_16x16x32_bf16 v[28:31], v[76:79], a[20:23], v[28:31]
    ds_read_b64_tr_b16 v[70:71], v114 offset:10240
    s_waitcnt lgkmcnt(8)
    v_mfma_f32_16x16x32_bf16 v[0:3], v[80:83], a[24:27], v[0:3]
    ds_read_b64_tr_b16 v[72:73], v115 offset:8192
    v_mfma_f32_16x16x32_bf16 v[4:7], v[80:83], a[28:31], v[4:7]
    ds_read_b64_tr_b16 v[74:75], v115 offset:10240
    v_mfma_f32_16x16x32_bf16 v[8:11], v[84:87], a[24:27], v[8:11]
    ds_read_b64_tr_b16 v[76:77], v116 offset:8192
    v_mfma_f32_16x16x32_bf16 v[12:15], v[84:87], a[28:31], v[12:15]
    ds_read_b64_tr_b16 v[78:79], v116 offset:10240
    s_waitcnt lgkmcnt(8)
    v_mfma_f32_16x16x32_bf16 v[16:19], v[88:91], a[24:27], v[16:19]
    ds_read_b64_tr_b16 v[80:81], v113 offset:12288
    v_mfma_f32_16x16x32_bf16 v[20:23], v[88:91], a[28:31], v[20:23]
    ds_read_b64_tr_b16 v[82:83], v113 offset:14336
    v_mfma_f32_16x16x32_bf16 v[24:27], v[92:95], a[24:27], v[24:27]
    ds_read_b64_tr_b16 v[84:85], v114 offset:12288
    v_mfma_f32_16x16x32_bf16 v[28:31], v[92:95], a[28:31], v[28:31]
    ds_read_b64_tr_b16 v[86:87], v114 offset:14336
    s_waitcnt vmcnt(20)
    s_barrier
    s_waitcnt lgkmcnt(8)
    v_mfma_f32_16x16x32_bf16 v[32:35], v[64:67], a[16:19], v[32:35]
    ds_read_b64_tr_b16 v[88:89], v115 offset:12288
    s_add_u32 m0, s57, 98304
    v_mfma_f32_16x16x32_bf16 v[36:39], v[64:67], a[20:23], v[36:39]
    ds_read_b64_tr_b16 v[90:91], v115 offset:14336
    s_add_u32 s52, s19, 786432
    v_mfma_f32_16x16x32_bf16 v[40:43], v[68:71], a[16:19], v[40:43]
    ds_read_b64_tr_b16 v[92:93], v116 offset:12288
    buffer_load_dwordx4 v118, s[36:39], s52 offen lds
    v_mfma_f32_16x16x32_bf16 v[44:47], v[68:71], a[20:23], v[44:47]
    ds_read_b64_tr_b16 v[94:95], v116 offset:14336
    s_add_u32 m0, s57, 106368
    s_waitcnt lgkmcnt(8)
    v_mfma_f32_16x16x32_bf16 v[48:51], v[72:75], a[16:19], v[48:51]
    v_add_u32 v113, 0xfffe0000, v113
    ds_read_b64_tr_b16 v[64:65], v113 offset:0
    s_nop 0
    v_mfma_f32_16x16x32_bf16 v[52:55], v[72:75], a[20:23], v[52:55]
    ds_read_b64_tr_b16 v[66:67], v113 offset:2048
    buffer_load_dwordx4 v118, s[36:39], s52 offen offset:128 lds
    v_mfma_f32_16x16x32_bf16 v[56:59], v[76:79], a[16:19], v[56:59]
    v_add_u32 v114, 0xfffe0000, v114
    ds_read_b64_tr_b16 v[68:69], v114 offset:0
    s_add_u32 m0, s57, 114688
    v_mfma_f32_16x16x32_bf16 v[60:63], v[76:79], a[20:23], v[60:63]
    ds_read_b64_tr_b16 v[70:71], v114 offset:2048
    s_add_u32 s52, s19, 851968
    s_waitcnt lgkmcnt(8)
    v_mfma_f32_16x16x32_bf16 v[32:35], v[80:83], a[24:27], v[32:35]
    v_add_u32 v115, 0xfffe0000, v115
    ds_read_b64_tr_b16 v[72:73], v115 offset:0
    buffer_load_dwordx4 v118, s[36:39], s52 offen lds
    v_mfma_f32_16x16x32_bf16 v[36:39], v[80:83], a[28:31], v[36:39]
    ds_read_b64_tr_b16 v[74:75], v115 offset:2048
    s_add_u32 m0, s57, 122752
    v_mfma_f32_16x16x32_bf16 v[40:43], v[84:87], a[24:27], v[40:43]
    v_add_u32 v116, 0xfffe0000, v116
    ds_read_b64_tr_b16 v[76:77], v116 offset:0
    s_nop 0
    v_mfma_f32_16x16x32_bf16 v[44:47], v[84:87], a[28:31], v[44:47]
    ds_read_b64_tr_b16 v[78:79], v116 offset:2048
    buffer_load_dwordx4 v118, s[36:39], s52 offen offset:128 lds
    s_waitcnt lgkmcnt(8)
    v_mfma_f32_16x16x32_bf16 v[48:51], v[88:91], a[24:27], v[48:51]
    ds_read_b64_tr_b16 v[80:81], v113 offset:4096
    v_mfma_f32_16x16x32_bf16 v[52:55], v[88:91], a[28:31], v[52:55]
    ds_read_b64_tr_b16 v[82:83], v113 offset:6144
    v_mfma_f32_16x16x32_bf16 v[56:59], v[92:95], a[24:27], v[56:59]
    ds_read_b64_tr_b16 v[84:85], v114 offset:4096
    v_mfma_f32_16x16x32_bf16 v[60:63], v[92:95], a[28:31], v[60:63]
    ds_read_b64_tr_b16 v[86:87], v114 offset:6144
    s_waitcnt lgkmcnt(8)
    v_mfma_f32_16x16x32_bf16 v[0:3], v[64:67], a[32:35], v[0:3]
    ds_read_b64_tr_b16 v[88:89], v115 offset:4096
    s_add_u32 s53, s25, 57344
    v_mfma_f32_16x16x32_bf16 v[4:7], v[64:67], a[36:39], v[4:7]
    ds_read_b64_tr_b16 v[90:91], v115 offset:6144
    buffer_load_dwordx4 a[96:99], v112, s[8:11], s53 offen offset:0 sc1
    v_mfma_f32_16x16x32_bf16 v[8:11], v[68:71], a[32:35], v[8:11]
    ds_read_b64_tr_b16 v[92:93], v116 offset:4096
    buffer_load_dwordx4 a[100:103], v112, s[8:11], s53 offen offset:1024 sc1
    v_mfma_f32_16x16x32_bf16 v[12:15], v[68:71], a[36:39], v[12:15]
    ds_read_b64_tr_b16 v[94:95], v116 offset:6144
    buffer_load_dwordx4 a[104:107], v112, s[8:11], s53 offen offset:2048 sc1
    s_waitcnt lgkmcnt(8)
    v_mfma_f32_16x16x32_bf16 v[16:19], v[72:75], a[32:35], v[16:19]
    ds_read_b64_tr_b16 v[64:65], v113 offset:8192
    buffer_load_dwordx4 a[108:111], v112, s[8:11], s53 offen offset:3072 sc1
    v_mfma_f32_16x16x32_bf16 v[20:23], v[72:75], a[36:39], v[20:23]
    ds_read_b64_tr_b16 v[66:67], v113 offset:10240
    v_mfma_f32_16x16x32_bf16 v[24:27], v[76:79], a[32:35], v[24:27]
    ds_read_b64_tr_b16 v[68:69], v114 offset:8192
    v_mfma_f32_16x16x32_bf16 v[28:31], v[76:79], a[36:39], v[28:31]
    ds_read_b64_tr_b16 v[70:71], v114 offset:10240
    s_waitcnt lgkmcnt(8)
    v_mfma_f32_16x16x32_bf16 v[0:3], v[80:83], a[40:43], v[0:3]
    ds_read_b64_tr_b16 v[72:73], v115 offset:8192
    v_mfma_f32_16x16x32_bf16 v[4:7], v[80:83], a[44:47], v[4:7]
    ds_read_b64_tr_b16 v[74:75], v115 offset:10240
    v_mfma_f32_16x16x32_bf16 v[8:11], v[84:87], a[40:43], v[8:11]
    ds_read_b64_tr_b16 v[76:77], v116 offset:8192
    v_mfma_f32_16x16x32_bf16 v[12:15], v[84:87], a[44:47], v[12:15]
    ds_read_b64_tr_b16 v[78:79], v116 offset:10240
    s_waitcnt lgkmcnt(8)
    v_mfma_f32_16x16x32_bf16 v[16:19], v[88:91], a[40:43], v[16:19]
    ds_read_b64_tr_b16 v[80:81], v113 offset:12288
    v_mfma_f32_16x16x32_bf16 v[20:23], v[88:91], a[44:47], v[20:23]
    ds_read_b64_tr_b16 v[82:83], v113 offset:14336
    v_mfma_f32_16x16x32_bf16 v[24:27], v[92:95], a[40:43], v[24:27]
    ds_read_b64_tr_b16 v[84:85], v114 offset:12288
    v_mfma_f32_16x16x32_bf16 v[28:31], v[92:95], a[44:47], v[28:31]
    ds_read_b64_tr_b16 v[86:87], v114 offset:14336
    s_waitcnt vmcnt(20)
    s_barrier
    s_waitcnt lgkmcnt(8)
    v_mfma_f32_16x16x32_bf16 v[32:35], v[64:67], a[32:35], v[32:35]
    ds_read_b64_tr_b16 v[88:89], v115 offset:12288
    s_add_u32 m0, s57, 131072
    v_mfma_f32_16x16x32_bf16 v[36:39], v[64:67], a[36:39], v[36:39]
    ds_read_b64_tr_b16 v[90:91], v115 offset:14336
    s_add_u32 s52, s19, 917504
    v_mfma_f32_16x16x32_bf16 v[40:43], v[68:71], a[32:35], v[40:43]
    ds_read_b64_tr_b16 v[92:93], v116 offset:12288
    buffer_load_dwordx4 v118, s[36:39], s52 offen lds
    v_mfma_f32_16x16x32_bf16 v[44:47], v[68:71], a[36:39], v[44:47]
    ds_read_b64_tr_b16 v[94:95], v116 offset:14336
    s_add_u32 m0, s57, 139136
    s_waitcnt lgkmcnt(8)
    v_mfma_f32_16x16x32_bf16 v[48:51], v[72:75], a[32:35], v[48:51]
    v_add_u32 v113, 0x8000, v113
    ds_read_b64_tr_b16 v[64:65], v113 offset:0
    s_nop 0
    v_mfma_f32_16x16x32_bf16 v[52:55], v[72:75], a[36:39], v[52:55]
    ds_read_b64_tr_b16 v[66:67], v113 offset:2048
    buffer_load_dwordx4 v118, s[36:39], s52 offen offset:128 lds
    v_mfma_f32_16x16x32_bf16 v[56:59], v[76:79], a[32:35], v[56:59]
    v_add_u32 v114, 0x8000, v114
    ds_read_b64_tr_b16 v[68:69], v114 offset:0
    s_add_u32 m0, s57, 147456
    v_mfma_f32_16x16x32_bf16 v[60:63], v[76:79], a[36:39], v[60:63]
    ds_read_b64_tr_b16 v[70:71], v114 offset:2048
    s_add_u32 s52, s19, 983040
    s_waitcnt lgkmcnt(8)
    v_mfma_f32_16x16x32_bf16 v[32:35], v[80:83], a[40:43], v[32:35]
    v_add_u32 v115, 0x8000, v115
    ds_read_b64_tr_b16 v[72:73], v115 offset:0
    buffer_load_dwordx4 v118, s[36:39], s52 offen lds
    v_mfma_f32_16x16x32_bf16 v[36:39], v[80:83], a[44:47], v[36:39]
    ds_read_b64_tr_b16 v[74:75], v115 offset:2048
    s_add_u32 m0, s57, 155520
    v_mfma_f32_16x16x32_bf16 v[40:43], v[84:87], a[40:43], v[40:43]
    v_add_u32 v116, 0x8000, v116
    ds_read_b64_tr_b16 v[76:77], v116 offset:0
    s_nop 0
    v_mfma_f32_16x16x32_bf16 v[44:47], v[84:87], a[44:47], v[44:47]
    ds_read_b64_tr_b16 v[78:79], v116 offset:2048
    buffer_load_dwordx4 v118, s[36:39], s52 offen offset:128 lds
    s_waitcnt lgkmcnt(8)
    v_mfma_f32_16x16x32_bf16 v[48:51], v[88:91], a[40:43], v[48:51]
    ds_read_b64_tr_b16 v[80:81], v113 offset:4096
    v_mfma_f32_16x16x32_bf16 v[52:55], v[88:91], a[44:47], v[52:55]
    ds_read_b64_tr_b16 v[82:83], v113 offset:6144
    v_mfma_f32_16x16x32_bf16 v[56:59], v[92:95], a[40:43], v[56:59]
    ds_read_b64_tr_b16 v[84:85], v114 offset:4096
    v_mfma_f32_16x16x32_bf16 v[60:63], v[92:95], a[44:47], v[60:63]
    ds_read_b64_tr_b16 v[86:87], v114 offset:6144
    s_waitcnt lgkmcnt(8)
    v_mfma_f32_16x16x32_bf16 v[0:3], v[64:67], a[48:51], v[0:3]
    ds_read_b64_tr_b16 v[88:89], v115 offset:4096
    v_mfma_f32_16x16x32_bf16 v[4:7], v[64:67], a[52:55], v[4:7]
    ds_read_b64_tr_b16 v[90:91], v115 offset:6144
    v_mfma_f32_16x16x32_bf16 v[8:11], v[68:71], a[48:51], v[8:11]
    ds_read_b64_tr_b16 v[92:93], v116 offset:4096
    v_mfma_f32_16x16x32_bf16 v[12:15], v[68:71], a[52:55], v[12:15]
    ds_read_b64_tr_b16 v[94:95], v116 offset:6144
    s_waitcnt lgkmcnt(8)
    v_mfma_f32_16x16x32_bf16 v[16:19], v[72:75], a[48:51], v[16:19]
    ds_read_b64_tr_b16 v[64:65], v113 offset:8192
    v_mfma_f32_16x16x32_bf16 v[20:23], v[72:75], a[52:55], v[20:23]
    ds_read_b64_tr_b16 v[66:67], v113 offset:10240
    v_mfma_f32_16x16x32_bf16 v[24:27], v[76:79], a[48:51], v[24:27]
    ds_read_b64_tr_b16 v[68:69], v114 offset:8192
    v_mfma_f32_16x16x32_bf16 v[28:31], v[76:79], a[52:55], v[28:31]
    ds_read_b64_tr_b16 v[70:71], v114 offset:10240
    s_waitcnt lgkmcnt(8)
    v_mfma_f32_16x16x32_bf16 v[0:3], v[80:83], a[56:59], v[0:3]
    ds_read_b64_tr_b16 v[72:73], v115 offset:8192
    v_mfma_f32_16x16x32_bf16 v[4:7], v[80:83], a[60:63], v[4:7]
    ds_read_b64_tr_b16 v[74:75], v115 offset:10240
    v_mfma_f32_16x16x32_bf16 v[8:11], v[84:87], a[56:59], v[8:11]
    ds_read_b64_tr_b16 v[76:77], v116 offset:8192
    v_mfma_f32_16x16x32_bf16 v[12:15], v[84:87], a[60:63], v[12:15]
    ds_read_b64_tr_b16 v[78:79], v116 offset:10240
    s_waitcnt lgkmcnt(8)
    v_mfma_f32_16x16x32_bf16 v[16:19], v[88:91], a[56:59], v[16:19]
    ds_read_b64_tr_b16 v[80:81], v113 offset:12288
    v_mfma_f32_16x16x32_bf16 v[20:23], v[88:91], a[60:63], v[20:23]
    ds_read_b64_tr_b16 v[82:83], v113 offset:14336
    v_mfma_f32_16x16x32_bf16 v[24:27], v[92:95], a[56:59], v[24:27]
    ds_read_b64_tr_b16 v[84:85], v114 offset:12288
    v_mfma_f32_16x16x32_bf16 v[28:31], v[92:95], a[60:63], v[28:31]
    ds_read_b64_tr_b16 v[86:87], v114 offset:14336
    s_waitcnt vmcnt(16)
    s_barrier
    s_waitcnt lgkmcnt(8)
    v_mfma_f32_16x16x32_bf16 v[32:35], v[64:67], a[48:51], v[32:35]
    ds_read_b64_tr_b16 v[88:89], v115 offset:12288
    v_mfma_f32_16x16x32_bf16 v[36:39], v[64:67], a[52:55], v[36:39]
    ds_read_b64_tr_b16 v[90:91], v115 offset:14336
    v_mfma_f32_16x16x32_bf16 v[40:43], v[68:71], a[48:51], v[40:43]
    ds_read_b64_tr_b16 v[92:93], v116 offset:12288
    v_mfma_f32_16x16x32_bf16 v[44:47], v[68:71], a[52:55], v[44:47]
    ds_read_b64_tr_b16 v[94:95], v116 offset:14336
    s_waitcnt lgkmcnt(8)
    v_mfma_f32_16x16x32_bf16 v[48:51], v[72:75], a[48:51], v[48:51]
    v_add_u32 v113, 0x8000, v113
    ds_read_b64_tr_b16 v[64:65], v113 offset:0
    v_mfma_f32_16x16x32_bf16 v[52:55], v[72:75], a[52:55], v[52:55]
    ds_read_b64_tr_b16 v[66:67], v113 offset:2048
    v_mfma_f32_16x16x32_bf16 v[56:59], v[76:79], a[48:51], v[56:59]
    v_add_u32 v114, 0x8000, v114
    ds_read_b64_tr_b16 v[68:69], v114 offset:0
    v_mfma_f32_16x16x32_bf16 v[60:63], v[76:79], a[52:55], v[60:63]
    ds_read_b64_tr_b16 v[70:71], v114 offset:2048
    s_waitcnt lgkmcnt(8)
    v_mfma_f32_16x16x32_bf16 v[32:35], v[80:83], a[56:59], v[32:35]
    v_add_u32 v115, 0x8000, v115
    ds_read_b64_tr_b16 v[72:73], v115 offset:0
    v_mfma_f32_16x16x32_bf16 v[36:39], v[80:83], a[60:63], v[36:39]
    ds_read_b64_tr_b16 v[74:75], v115 offset:2048
    v_mfma_f32_16x16x32_bf16 v[40:43], v[84:87], a[56:59], v[40:43]
    v_add_u32 v116, 0x8000, v116
    ds_read_b64_tr_b16 v[76:77], v116 offset:0
    v_mfma_f32_16x16x32_bf16 v[44:47], v[84:87], a[60:63], v[44:47]
    ds_read_b64_tr_b16 v[78:79], v116 offset:2048
    s_waitcnt lgkmcnt(8)
    v_mfma_f32_16x16x32_bf16 v[48:51], v[88:91], a[56:59], v[48:51]
    ds_read_b64_tr_b16 v[80:81], v113 offset:4096
    v_mfma_f32_16x16x32_bf16 v[52:55], v[88:91], a[60:63], v[52:55]
    ds_read_b64_tr_b16 v[82:83], v113 offset:6144
    v_mfma_f32_16x16x32_bf16 v[56:59], v[92:95], a[56:59], v[56:59]
    ds_read_b64_tr_b16 v[84:85], v114 offset:4096
    v_mfma_f32_16x16x32_bf16 v[60:63], v[92:95], a[60:63], v[60:63]
    ds_read_b64_tr_b16 v[86:87], v114 offset:6144
    s_waitcnt lgkmcnt(8)
    v_mfma_f32_16x16x32_bf16 v[0:3], v[64:67], a[64:67], v[0:3]
    ds_read_b64_tr_b16 v[88:89], v115 offset:4096
    v_mfma_f32_16x16x32_bf16 v[4:7], v[64:67], a[68:71], v[4:7]
    ds_read_b64_tr_b16 v[90:91], v115 offset:6144
    v_mfma_f32_16x16x32_bf16 v[8:11], v[68:71], a[64:67], v[8:11]
    ds_read_b64_tr_b16 v[92:93], v116 offset:4096
    v_mfma_f32_16x16x32_bf16 v[12:15], v[68:71], a[68:71], v[12:15]
    ds_read_b64_tr_b16 v[94:95], v116 offset:6144
    s_waitcnt lgkmcnt(8)
    v_mfma_f32_16x16x32_bf16 v[16:19], v[72:75], a[64:67], v[16:19]
    ds_read_b64_tr_b16 v[64:65], v113 offset:8192
    v_mfma_f32_16x16x32_bf16 v[20:23], v[72:75], a[68:71], v[20:23]
    ds_read_b64_tr_b16 v[66:67], v113 offset:10240
    v_mfma_f32_16x16x32_bf16 v[24:27], v[76:79], a[64:67], v[24:27]
    ds_read_b64_tr_b16 v[68:69], v114 offset:8192
    v_mfma_f32_16x16x32_bf16 v[28:31], v[76:79], a[68:71], v[28:31]
    ds_read_b64_tr_b16 v[70:71], v114 offset:10240
    s_waitcnt lgkmcnt(8)
    v_mfma_f32_16x16x32_bf16 v[0:3], v[80:83], a[72:75], v[0:3]
    ds_read_b64_tr_b16 v[72:73], v115 offset:8192
    v_mfma_f32_16x16x32_bf16 v[4:7], v[80:83], a[76:79], v[4:7]
    ds_read_b64_tr_b16 v[74:75], v115 offset:10240
    v_mfma_f32_16x16x32_bf16 v[8:11], v[84:87], a[72:75], v[8:11]
    ds_read_b64_tr_b16 v[76:77], v116 offset:8192
    v_mfma_f32_16x16x32_bf16 v[12:15], v[84:87], a[76:79], v[12:15]
    ds_read_b64_tr_b16 v[78:79], v116 offset:10240
    s_waitcnt lgkmcnt(8)
    v_mfma_f32_16x16x32_bf16 v[16:19], v[88:91], a[72:75], v[16:19]
    ds_read_b64_tr_b16 v[80:81], v113 offset:12288
    v_mfma_f32_16x16x32_bf16 v[20:23], v[88:91], a[76:79], v[20:23]
    ds_read_b64_tr_b16 v[82:83], v113 offset:14336
    v_mfma_f32_16x16x32_bf16 v[24:27], v[92:95], a[72:75], v[24:27]
    ds_read_b64_tr_b16 v[84:85], v114 offset:12288
    v_mfma_f32_16x16x32_bf16 v[28:31], v[92:95], a[76:79], v[28:31]
    ds_read_b64_tr_b16 v[86:87], v114 offset:14336
    s_waitcnt vmcnt(8)
    s_barrier
    s_waitcnt lgkmcnt(8)
    v_mfma_f32_16x16x32_bf16 v[32:35], v[64:67], a[64:67], v[32:35]
    ds_read_b64_tr_b16 v[88:89], v115 offset:12288
    v_mfma_f32_16x16x32_bf16 v[36:39], v[64:67], a[68:71], v[36:39]
    ds_read_b64_tr_b16 v[90:91], v115 offset:14336
    v_mfma_f32_16x16x32_bf16 v[40:43], v[68:71], a[64:67], v[40:43]
    ds_read_b64_tr_b16 v[92:93], v116 offset:12288
    v_mfma_f32_16x16x32_bf16 v[44:47], v[68:71], a[68:71], v[44:47]
    ds_read_b64_tr_b16 v[94:95], v116 offset:14336
    s_waitcnt lgkmcnt(8)
    v_mfma_f32_16x16x32_bf16 v[48:51], v[72:75], a[64:67], v[48:51]
    v_add_u32 v113, 0x8000, v113
    ds_read_b64_tr_b16 v[64:65], v113 offset:0
    v_mfma_f32_16x16x32_bf16 v[52:55], v[72:75], a[68:71], v[52:55]
    ds_read_b64_tr_b16 v[66:67], v113 offset:2048
    v_mfma_f32_16x16x32_bf16 v[56:59], v[76:79], a[64:67], v[56:59]
    v_add_u32 v114, 0x8000, v114
    ds_read_b64_tr_b16 v[68:69], v114 offset:0
    v_mfma_f32_16x16x32_bf16 v[60:63], v[76:79], a[68:71], v[60:63]
    ds_read_b64_tr_b16 v[70:71], v114 offset:2048
    s_waitcnt lgkmcnt(8)
    v_mfma_f32_16x16x32_bf16 v[32:35], v[80:83], a[72:75], v[32:35]
    v_add_u32 v115, 0x8000, v115
    ds_read_b64_tr_b16 v[72:73], v115 offset:0
    v_mfma_f32_16x16x32_bf16 v[36:39], v[80:83], a[76:79], v[36:39]
    ds_read_b64_tr_b16 v[74:75], v115 offset:2048
    v_mfma_f32_16x16x32_bf16 v[40:43], v[84:87], a[72:75], v[40:43]
    v_add_u32 v116, 0x8000, v116
    ds_read_b64_tr_b16 v[76:77], v116 offset:0
    v_mfma_f32_16x16x32_bf16 v[44:47], v[84:87], a[76:79], v[44:47]
    ds_read_b64_tr_b16 v[78:79], v116 offset:2048
    s_waitcnt lgkmcnt(8)
    v_mfma_f32_16x16x32_bf16 v[48:51], v[88:91], a[72:75], v[48:51]
    ds_read_b64_tr_b16 v[80:81], v113 offset:4096
    v_mfma_f32_16x16x32_bf16 v[52:55], v[88:91], a[76:79], v[52:55]
    ds_read_b64_tr_b16 v[82:83], v113 offset:6144
    v_mfma_f32_16x16x32_bf16 v[56:59], v[92:95], a[72:75], v[56:59]
    ds_read_b64_tr_b16 v[84:85], v114 offset:4096
    v_mfma_f32_16x16x32_bf16 v[60:63], v[92:95], a[76:79], v[60:63]
    ds_read_b64_tr_b16 v[86:87], v114 offset:6144
    s_waitcnt lgkmcnt(8)
    v_mfma_f32_16x16x32_bf16 v[0:3], v[64:67], a[80:83], v[0:3]
    ds_read_b64_tr_b16 v[88:89], v115 offset:4096
    v_mfma_f32_16x16x32_bf16 v[4:7], v[64:67], a[84:87], v[4:7]
    ds_read_b64_tr_b16 v[90:91], v115 offset:6144
    v_mfma_f32_16x16x32_bf16 v[8:11], v[68:71], a[80:83], v[8:11]
    ds_read_b64_tr_b16 v[92:93], v116 offset:4096
    v_mfma_f32_16x16x32_bf16 v[12:15], v[68:71], a[84:87], v[12:15]
    ds_read_b64_tr_b16 v[94:95], v116 offset:6144
    s_waitcnt lgkmcnt(8)
    v_mfma_f32_16x16x32_bf16 v[16:19], v[72:75], a[80:83], v[16:19]
    ds_read_b64_tr_b16 v[64:65], v113 offset:8192
    v_mfma_f32_16x16x32_bf16 v[20:23], v[72:75], a[84:87], v[20:23]
    ds_read_b64_tr_b16 v[66:67], v113 offset:10240
    v_mfma_f32_16x16x32_bf16 v[24:27], v[76:79], a[80:83], v[24:27]
    ds_read_b64_tr_b16 v[68:69], v114 offset:8192
    v_mfma_f32_16x16x32_bf16 v[28:31], v[76:79], a[84:87], v[28:31]
    ds_read_b64_tr_b16 v[70:71], v114 offset:10240
    s_waitcnt lgkmcnt(8)
    v_mfma_f32_16x16x32_bf16 v[0:3], v[80:83], a[88:91], v[0:3]
    ds_read_b64_tr_b16 v[72:73], v115 offset:8192
    v_mfma_f32_16x16x32_bf16 v[4:7], v[80:83], a[92:95], v[4:7]
    ds_read_b64_tr_b16 v[74:75], v115 offset:10240
    v_mfma_f32_16x16x32_bf16 v[8:11], v[84:87], a[88:91], v[8:11]
    ds_read_b64_tr_b16 v[76:77], v116 offset:8192
    v_mfma_f32_16x16x32_bf16 v[12:15], v[84:87], a[92:95], v[12:15]
    ds_read_b64_tr_b16 v[78:79], v116 offset:10240
    s_waitcnt lgkmcnt(8)
    v_mfma_f32_16x16x32_bf16 v[16:19], v[88:91], a[88:91], v[16:19]
    ds_read_b64_tr_b16 v[80:81], v113 offset:12288
    v_mfma_f32_16x16x32_bf16 v[20:23], v[88:91], a[92:95], v[20:23]
    ds_read_b64_tr_b16 v[82:83], v113 offset:14336
    v_mfma_f32_16x16x32_bf16 v[24:27], v[92:95], a[88:91], v[24:27]
    ds_read_b64_tr_b16 v[84:85], v114 offset:12288
    v_mfma_f32_16x16x32_bf16 v[28:31], v[92:95], a[92:95], v[28:31]
    ds_read_b64_tr_b16 v[86:87], v114 offset:14336
    s_waitcnt vmcnt(0)
    s_barrier
    s_waitcnt lgkmcnt(8)
    v_mfma_f32_16x16x32_bf16 v[32:35], v[64:67], a[80:83], v[32:35]
    ds_read_b64_tr_b16 v[88:89], v115 offset:12288
    v_mfma_f32_16x16x32_bf16 v[36:39], v[64:67], a[84:87], v[36:39]
    ds_read_b64_tr_b16 v[90:91], v115 offset:14336
    v_mfma_f32_16x16x32_bf16 v[40:43], v[68:71], a[80:83], v[40:43]
    ds_read_b64_tr_b16 v[92:93], v116 offset:12288
    v_mfma_f32_16x16x32_bf16 v[44:47], v[68:71], a[84:87], v[44:47]
    ds_read_b64_tr_b16 v[94:95], v116 offset:14336
    s_waitcnt lgkmcnt(8)
    v_mfma_f32_16x16x32_bf16 v[48:51], v[72:75], a[80:83], v[48:51]
    v_add_u32 v113, 0x8000, v113
    ds_read_b64_tr_b16 v[64:65], v113 offset:0
    v_mfma_f32_16x16x32_bf16 v[52:55], v[72:75], a[84:87], v[52:55]
    ds_read_b64_tr_b16 v[66:67], v113 offset:2048
    v_mfma_f32_16x16x32_bf16 v[56:59], v[76:79], a[80:83], v[56:59]
    v_add_u32 v114, 0x8000, v114
    ds_read_b64_tr_b16 v[68:69], v114 offset:0
    v_mfma_f32_16x16x32_bf16 v[60:63], v[76:79], a[84:87], v[60:63]
    ds_read_b64_tr_b16 v[70:71], v114 offset:2048
    s_waitcnt lgkmcnt(8)
    v_mfma_f32_16x16x32_bf16 v[32:35], v[80:83], a[88:91], v[32:35]
    v_add_u32 v115, 0x8000, v115
    ds_read_b64_tr_b16 v[72:73], v115 offset:0
    buffer_load_dwordx2 v[100:101], v119, s[20:23], s17 offen offset:0
    v_mfma_f32_16x16x32_bf16 v[36:39], v[80:83], a[92:95], v[36:39]
    ds_read_b64_tr_b16 v[74:75], v115 offset:2048
    v_mfma_f32_16x16x32_bf16 v[40:43], v[84:87], a[88:91], v[40:43]
    v_add_u32 v116, 0x8000, v116
    ds_read_b64_tr_b16 v[76:77], v116 offset:0
    buffer_load_dwordx2 v[102:103], v120, s[20:23], s17 offen offset:0
    v_mfma_f32_16x16x32_bf16 v[44:47], v[84:87], a[92:95], v[44:47]
    ds_read_b64_tr_b16 v[78:79], v116 offset:2048
    s_waitcnt lgkmcnt(8)
    v_mfma_f32_16x16x32_bf16 v[48:51], v[88:91], a[88:91], v[48:51]
    ds_read_b64_tr_b16 v[80:81], v113 offset:4096
    buffer_load_dwordx2 v[104:105], v119, s[20:23], s17 offen offset:32
    v_mfma_f32_16x16x32_bf16 v[52:55], v[88:91], a[92:95], v[52:55]
    ds_read_b64_tr_b16 v[82:83], v113 offset:6144
    v_mfma_f32_16x16x32_bf16 v[56:59], v[92:95], a[88:91], v[56:59]
    ds_read_b64_tr_b16 v[84:85], v114 offset:4096
    buffer_load_dwordx2 v[106:107], v120, s[20:23], s17 offen offset:32
    v_mfma_f32_16x16x32_bf16 v[60:63], v[92:95], a[92:95], v[60:63]
    ds_read_b64_tr_b16 v[86:87], v114 offset:6144
    s_waitcnt lgkmcnt(8)
    v_mfma_f32_16x16x32_bf16 v[0:3], v[64:67], a[96:99], v[0:3]
    ds_read_b64_tr_b16 v[88:89], v115 offset:4096
    s_lshl_b32 s6, s63, 13
    s_cmp_eq_u32 s15, 0
    s_mov_b32 s7, 32768
    s_cselect_b32 s7, 0, s7
    s_add_u32 s7, s7, s6
    v_add_u32 v96, s7, v112
    s_xor_b32 s7, s7, 32768
    v_add_u32 v97, s7, v112
    v_mfma_f32_16x16x32_bf16 v[4:7], v[64:67], a[100:103], v[4:7]
    ds_read_b64_tr_b16 v[90:91], v115 offset:6144
    v_mfma_f32_16x16x32_bf16 v[8:11], v[68:71], a[96:99], v[8:11]
    ds_read_b64_tr_b16 v[92:93], v116 offset:4096
    v_mfma_f32_16x16x32_bf16 v[12:15], v[68:71], a[100:103], v[12:15]
    ds_read_b64_tr_b16 v[94:95], v116 offset:6144
    s_waitcnt lgkmcnt(8)
    v_mfma_f32_16x16x32_bf16 v[16:19], v[72:75], a[96:99], v[16:19]
    ds_read_b64_tr_b16 v[64:65], v113 offset:8192
    v_mfma_f32_16x16x32_bf16 v[20:23], v[72:75], a[100:103], v[20:23]
    ds_read_b64_tr_b16 v[66:67], v113 offset:10240
    v_mfma_f32_16x16x32_bf16 v[24:27], v[76:79], a[96:99], v[24:27]
    ds_read_b64_tr_b16 v[68:69], v114 offset:8192
    v_mfma_f32_16x16x32_bf16 v[28:31], v[76:79], a[100:103], v[28:31]
    ds_read_b64_tr_b16 v[70:71], v114 offset:10240
    s_waitcnt lgkmcnt(8)
    v_mfma_f32_16x16x32_bf16 v[0:3], v[80:83], a[104:107], v[0:3]
    ds_read_b64_tr_b16 v[72:73], v115 offset:8192
    v_mfma_f32_16x16x32_bf16 v[4:7], v[80:83], a[108:111], v[4:7]
    ds_read_b64_tr_b16 v[74:75], v115 offset:10240
    v_mfma_f32_16x16x32_bf16 v[8:11], v[84:87], a[104:107], v[8:11]
    ds_read_b64_tr_b16 v[76:77], v116 offset:8192
    v_mfma_f32_16x16x32_bf16 v[12:15], v[84:87], a[108:111], v[12:15]
    ds_read_b64_tr_b16 v[78:79], v116 offset:10240
    s_waitcnt lgkmcnt(8)
    v_mfma_f32_16x16x32_bf16 v[16:19], v[88:91], a[104:107], v[16:19]
    ds_read_b64_tr_b16 v[80:81], v113 offset:12288
    v_mfma_f32_16x16x32_bf16 v[20:23], v[88:91], a[108:111], v[20:23]
    ds_read_b64_tr_b16 v[82:83], v113 offset:14336
    v_mfma_f32_16x16x32_bf16 v[24:27], v[92:95], a[104:107], v[24:27]
    ds_read_b64_tr_b16 v[84:85], v114 offset:12288
    v_mfma_f32_16x16x32_bf16 v[28:31], v[92:95], a[108:111], v[28:31]
    ds_read_b64_tr_b16 v[86:87], v114 offset:14336
    s_waitcnt lgkmcnt(8)
    v_mfma_f32_16x16x32_bf16 v[32:35], v[64:67], a[96:99], v[32:35]
    ds_read_b64_tr_b16 v[88:89], v115 offset:12288
    v_mfma_f32_16x16x32_bf16 v[36:39], v[64:67], a[100:103], v[36:39]
    ds_read_b64_tr_b16 v[90:91], v115 offset:14336
    v_mfma_f32_16x16x32_bf16 v[40:43], v[68:71], a[96:99], v[40:43]
    ds_read_b64_tr_b16 v[92:93], v116 offset:12288
    v_mfma_f32_16x16x32_bf16 v[44:47], v[68:71], a[100:103], v[44:47]
    ds_read_b64_tr_b16 v[94:95], v116 offset:14336
    s_waitcnt lgkmcnt(8)
    v_mfma_f32_16x16x32_bf16 v[48:51], v[72:75], a[96:99], v[48:51]
    v_mfma_f32_16x16x32_bf16 v[52:55], v[72:75], a[100:103], v[52:55]
    v_mfma_f32_16x16x32_bf16 v[56:59], v[76:79], a[96:99], v[56:59]
    v_mfma_f32_16x16x32_bf16 v[60:63], v[76:79], a[100:103], v[60:63]
    s_waitcnt lgkmcnt(4)
    v_mfma_f32_16x16x32_bf16 v[32:35], v[80:83], a[104:107], v[32:35]
    v_mfma_f32_16x16x32_bf16 v[36:39], v[80:83], a[108:111], v[36:39]
    v_mfma_f32_16x16x32_bf16 v[40:43], v[84:87], a[104:107], v[40:43]
    v_mfma_f32_16x16x32_bf16 v[44:47], v[84:87], a[108:111], v[44:47]
    s_waitcnt lgkmcnt(0)
    v_mfma_f32_16x16x32_bf16 v[48:51], v[88:91], a[104:107], v[48:51]
    v_mfma_f32_16x16x32_bf16 v[52:55], v[88:91], a[108:111], v[52:55]
    v_mfma_f32_16x16x32_bf16 v[56:59], v[92:95], a[104:107], v[56:59]
    v_mfma_f32_16x16x32_bf16 v[60:63], v[92:95], a[108:111], v[60:63]
OUT_RED:
    s_waitcnt lgkmcnt(0)
    s_nop 5
    s_cmp_eq_u32 s15, 1
    s_cbranch_scc1 OUT_G1
    ds_write_b128 v96, v[32:35] offset:0
    ds_write_b128 v96, v[36:39] offset:1024
    ds_write_b128 v96, v[40:43] offset:2048
    ds_write_b128 v96, v[44:47] offset:3072
    ds_write_b128 v96, v[48:51] offset:4096
    ds_write_b128 v96, v[52:55] offset:5120
    ds_write_b128 v96, v[56:59] offset:6144
    ds_write_b128 v96, v[60:63] offset:7168
    s_waitcnt lgkmcnt(0)
    s_barrier
    ds_read_b128 v[32:35], v97 offset:0
    ds_read_b128 v[36:39], v97 offset:1024
    ds_read_b128 v[40:43], v97 offset:2048
    ds_read_b128 v[44:47], v97 offset:3072
    ds_read_b128 v[48:51], v97 offset:4096
    ds_read_b128 v[52:55], v97 offset:5120
    ds_read_b128 v[56:59], v97 offset:6144
    ds_read_b128 v[60:63], v97 offset:7168
    s_waitcnt lgkmcnt(7)
    v_add_f32 v0, v0, v32
    v_add_f32 v1, v1, v33
    v_add_f32 v2, v2, v34
    v_add_f32 v3, v3, v35
    s_waitcnt lgkmcnt(6)
    v_add_f32 v4, v4, v36
    v_add_f32 v5, v5, v37
    v_add_f32 v6, v6, v38
    v_add_f32 v7, v7, v39
    s_waitcnt lgkmcnt(5)
    v_add_f32 v8, v8, v40
    v_add_f32 v9, v9, v41
    v_add_f32 v10, v10, v42
    v_add_f32 v11, v11, v43
    s_waitcnt lgkmcnt(4)
    v_add_f32 v12, v12, v44
    v_add_f32 v13, v13, v45
    v_add_f32 v14, v14, v46
    v_add_f32 v15, v15, v47
    s_waitcnt lgkmcnt(3)
    v_add_f32 v16, v16, v48
    v_add_f32 v17, v17, v49
    v_add_f32 v18, v18, v50
    v_add_f32 v19, v19, v51
    s_waitcnt lgkmcnt(2)
    v_add_f32 v20, v20, v52
    v_add_f32 v21, v21, v53
    v_add_f32 v22, v22, v54
    v_add_f32 v23, v23, v55
    s_waitcnt lgkmcnt(1)
    v_add_f32 v24, v24, v56
    v_add_f32 v25, v25, v57
    v_add_f32 v26, v26, v58
    v_add_f32 v27, v27, v59
    s_waitcnt lgkmcnt(0)
    v_add_f32 v28, v28, v60
    v_add_f32 v29, v29, v61
    v_add_f32 v30, v30, v62
    v_add_f32 v31, v31, v63
    s_branch OUT_X
OUT_G1:
    ds_write_b128 v96, v[0:3] offset:0
    ds_write_b128 v96, v[4:7] offset:1024
    ds_write_b128 v96, v[8:11] offset:2048
    ds_write_b128 v96, v[12:15] offset:3072
    ds_write_b128 v96, v[16:19] offset:4096
    ds_write_b128 v96, v[20:23] offset:5120
    ds_write_b128 v96, v[24:27] offset:6144
    ds_write_b128 v96, v[28:31] offset:7168
    s_waitcnt lgkmcnt(0)
    s_barrier
    ds_read_b128 v[0:3], v97 offset:0
    ds_read_b128 v[4:7], v97 offset:1024
    ds_read_b128 v[8:11], v97 offset:2048
    ds_read_b128 v[12:15], v97 offset:3072
    ds_read_b128 v[16:19], v97 offset:4096
    ds_read_b128 v[20:23], v97 offset:5120
    ds_read_b128 v[24:27], v97 offset:6144
    ds_read_b128 v[28:31], v97 offset:7168
    s_waitcnt lgkmcnt(7)
    v_add_f32 v0, v32, v0
    v_add_f32 v1, v33, v1
    v_add_f32 v2, v34, v2
    v_add_f32 v3, v35, v3
    s_waitcnt lgkmcnt(6)
    v_add_f32 v4, v36, v4
    v_add_f32 v5, v37, v5
    v_add_f32 v6, v38, v6
    v_add_f32 v7, v39, v7
    s_waitcnt lgkmcnt(5)
    v_add_f32 v8, v40, v8
    v_add_f32 v9, v41, v9
    v_add_f32 v10, v42, v10
    v_add_f32 v11, v43, v11
    s_waitcnt lgkmcnt(4)
    v_add_f32 v12, v44, v12
    v_add_f32 v13, v45, v13
    v_add_f32 v14, v46, v14
    v_add_f32 v15, v47, v15
    s_waitcnt lgkmcnt(3)
    v_add_f32 v16, v48, v16
    v_add_f32 v17, v49, v17
    v_add_f32 v18, v50, v18
    v_add_f32 v19, v51, v19
    s_waitcnt lgkmcnt(2)
    v_add_f32 v20, v52, v20
    v_add_f32 v21, v53, v21
    v_add_f32 v22, v54, v22
    v_add_f32 v23, v55, v23
    s_waitcnt lgkmcnt(1)
    v_add_f32 v24, v56, v24
    v_add_f32 v25, v57, v25
    v_add_f32 v26, v58, v26
    v_add_f32 v27, v59, v27
    s_waitcnt lgkmcnt(0)
    v_add_f32 v28, v60, v28
    v_add_f32 v29, v61, v29
    v_add_f32 v30, v62, v30
    v_add_f32 v31, v63, v31
OUT_X:
    s_lshl_b32 s6, s12, 13
    s_add_u32 s6, s6, s28
    s_lshl_b32 s7, s15, 16
    s_add_u32 s6, s6, s7
    s_lshl_b32 s7, s15, 9
    s_add_u32 s24, s7, s29
    s_lshl_b32 s7, s15, 1
    s_add_u32 s52, s6, 0
    s_add_u32 s25, s24, 0
    s_add_u32 s53, s7, 0
    s_cmp_eq_u32 s53, s12
    s_cselect_b32 s52, 0x20000000, s52
    s_cselect_b32 s25, 0x20000000, s25
    v_cvt_pk_bf16_f32 v32, v0, v1
    v_cvt_pk_bf16_f32 v33, v2, v3
    v_cvt_pk_bf16_f32 v34, v4, v5
    v_cvt_pk_bf16_f32 v35, v6, v7
    v_cvt_pk_bf16_f32 v36, v8, v9
    v_cvt_pk_bf16_f32 v37, v10, v11
    v_cvt_pk_bf16_f32 v38, v12, v13
    v_cvt_pk_bf16_f32 v39, v14, v15
    buffer_store_dwordx4 v[32:35], v112, s[8:11], s52 offen offset:0 sc1
    buffer_store_dwordx4 v[36:39], v112, s[8:11], s52 offen offset:1024 sc1
    s_add_u32 s52, s6, 32768
    s_add_u32 s26, s24, 256
    s_add_u32 s53, s7, 1
    s_cmp_eq_u32 s53, s12
    s_cselect_b32 s52, 0x20000000, s52
    s_cselect_b32 s26, 0x20000000, s26
    v_cvt_pk_bf16_f32 v40, v16, v17
    v_cvt_pk_bf16_f32 v41, v18, v19
    v_cvt_pk_bf16_f32 v42, v20, v21
    v_cvt_pk_bf16_f32 v43, v22, v23
    v_cvt_pk_bf16_f32 v44, v24, v25
    v_cvt_pk_bf16_f32 v45, v26, v27
    v_cvt_pk_bf16_f32 v46, v28, v29
    v_cvt_pk_bf16_f32 v47, v30, v31
    buffer_store_dwordx4 v[40:43], v112, s[8:11], s52 offen offset:0 sc1
    buffer_store_dwordx4 v[44:47], v112, s[8:11], s52 offen offset:1024 sc1
    v_mov_b32 v127, 1
    s_lshl_b32 s6, s12, 8
    s_add_u32 s29, s29, s6
    s_waitcnt vmcnt(0)
    buffer_atomic_add v127, v123, s[8:11], s25 offen sc1
    buffer_atomic_add v127, v123, s[8:11], s26 offen sc1
    s_lshr_b32 s6, s12, 1
    s_cmp_lg_u32 s6, s15
    s_cbranch_scc1 K_END
    buffer_load_dword v125, off, s[8:11], s29 sc1
    s_and_b32 s6, s12, 1
    s_cmp_eq_u32 s6, 0
    s_cbranch_scc1 OUT_OWN
    v_mov_b32 v0, v16
    v_mov_b32 v1, v17
    v_mov_b32 v2, v18
    v_mov_b32 v3, v19
    v_mov_b32 v4, v20
    v_mov_b32 v5, v21
    v_mov_b32 v6, v22
    v_mov_b32 v7, v23
    v_mov_b32 v8, v24
    v_mov_b32 v9, v25
    v_mov_b32 v10, v26
    v_mov_b32 v11, v27
    v_mov_b32 v12, v28
    v_mov_b32 v13, v29
    v_mov_b32 v14, v30
    v_mov_b32 v15, v31
OUT_OWN:
    v_lshlrev_b32 v64, 16, v100
    v_and_b32 v65, 0xffff0000, v100
    v_lshlrev_b32 v66, 16, v101
    v_and_b32 v67, 0xffff0000, v101
    v_lshlrev_b32 v68, 16, v102
    v_and_b32 v69, 0xffff0000, v102
    v_lshlrev_b32 v70, 16, v103
    v_and_b32 v71, 0xffff0000, v103
    v_lshlrev_b32 v72, 16, v104
    v_and_b32 v73, 0xffff0000, v104
    v_lshlrev_b32 v74, 16, v105
    v_and_b32 v75, 0xffff0000, v105
    v_lshlrev_b32 v76, 16, v106
    v_and_b32 v77, 0xffff0000, v106
    v_lshlrev_b32 v78, 16, v107
    v_and_b32 v79, 0xffff0000, v107
    v_add_f32 v0, v0, v64
    v_add_f32 v1, v1, v65
    v_add_f32 v2, v2, v66
    v_add_f32 v3, v3, v67
    v_add_f32 v4, v4, v68
    v_add_f32 v5, v5, v69
    v_add_f32 v6, v6, v70
    v_add_f32 v7, v7, v71
    v_add_f32 v8, v8, v72
    v_add_f32 v9, v9, v73
    v_add_f32 v10, v10, v74
    v_add_f32 v11, v11, v75
    v_add_f32 v12, v12, v76
    v_add_f32 v13, v13, v77
    v_add_f32 v14, v14, v78
    v_add_f32 v15, v15, v79
    s_waitcnt vmcnt(0)
    v_readfirstlane_b32 s6, v125
    s_mov_b32 s7, 0
    s_cmp_ge_u32 s6, 3
    s_cbranch_scc1 PK_27
PL_28:
    s_sleep 1
    buffer_load_dword v125, off, s[8:11], s29 sc1
    s_add_u32 s7, s7, 1
    s_waitcnt vmcnt(0)
    v_readfirstlane_b32 s6, v125
    s_cmp_ge_u32 s7, 0x40000
    s_cbranch_scc1 PK_27
    s_cmp_lt_u32 s6, 3
    s_cbranch_scc1 PL_28
PK_27:
    s_lshl_b32 s53, s12, 15
    s_add_u32 s53, s53, s28
    s_add_u32 s6, s12, 1
    s_and_b32 s6, s6, 3
    s_lshl_b32 s6, s6, 13
    s_add_u32 s6, s6, s53
    buffer_load_dwordx4 v[24:27], v112, s[8:11], s6 offen offset:0 sc1
    buffer_load_dwordx4 v[28:31], v112, s[8:11], s6 offen offset:1024 sc1
    s_add_u32 s6, s12, 2
    s_and_b32 s6, s6, 3
    s_lshl_b32 s6, s6, 13
    s_add_u32 s6, s6, s53
    buffer_load_dwordx4 v[32:35], v112, s[8:11], s6 offen offset:0 sc1
    buffer_load_dwordx4 v[36:39], v112, s[8:11], s6 offen offset:1024 sc1
    s_add_u32 s6, s12, 3
    s_and_b32 s6, s6, 3
    s_lshl_b32 s6, s6, 13
    s_add_u32 s6, s6, s53
    buffer_load_dwordx4 v[40:43], v112, s[8:11], s6 offen offset:0 sc1
    buffer_load_dwordx4 v[44:47], v112, s[8:11], s6 offen offset:1024 sc1
    s_waitcnt vmcnt(5)
    v_lshlrev_b32 v64, 16, v24
    v_and_b32 v65, 0xffff0000, v24
    v_add_f32 v0, v0, v64
    v_add_f32 v1, v1, v65
    v_lshlrev_b32 v64, 16, v25
    v_and_b32 v65, 0xffff0000, v25
    v_add_f32 v2, v2, v64
    v_add_f32 v3, v3, v65
    v_lshlrev_b32 v64, 16, v26
    v_and_b32 v65, 0xffff0000, v26
    v_add_f32 v4, v4, v64
    v_add_f32 v5, v5, v65
    v_lshlrev_b32 v64, 16, v27
    v_and_b32 v65, 0xffff0000, v27
    v_add_f32 v6, v6, v64
    v_add_f32 v7, v7, v65
    s_waitcnt vmcnt(4)
    v_lshlrev_b32 v64, 16, v28
    v_and_b32 v65, 0xffff0000, v28
    v_add_f32 v8, v8, v64
    v_add_f32 v9, v9, v65
    v_lshlrev_b32 v64, 16, v29
    v_and_b32 v65, 0xffff0000, v29
    v_add_f32 v10, v10, v64
    v_add_f32 v11, v11, v65
    v_lshlrev_b32 v64, 16, v30
    v_and_b32 v65, 0xffff0000, v30
    v_add_f32 v12, v12, v64
    v_add_f32 v13, v13, v65
    v_lshlrev_b32 v64, 16, v31
    v_and_b32 v65, 0xffff0000, v31
    v_add_f32 v14, v14, v64
    v_add_f32 v15, v15, v65
    s_waitcnt vmcnt(3)
    v_lshlrev_b32 v64, 16, v32
    v_and_b32 v65, 0xffff0000, v32
    v_add_f32 v0, v0, v64
    v_add_f32 v1, v1, v65
    v_lshlrev_b32 v64, 16, v33
    v_and_b32 v65, 0xffff0000, v33
    v_add_f32 v2, v2, v64
    v_add_f32 v3, v3, v65
    v_lshlrev_b32 v64, 16, v34
    v_and_b32 v65, 0xffff0000, v34
    v_add_f32 v4, v4, v64
    v_add_f32 v5, v5, v65
    v_lshlrev_b32 v64, 16, v35
    v_and_b32 v65, 0xffff0000, v35
    v_add_f32 v6, v6, v64
    v_add_f32 v7, v7, v65
    s_waitcnt vmcnt(2)
    v_lshlrev_b32 v64, 16, v36
    v_and_b32 v65, 0xffff0000, v36
    v_add_f32 v8, v8, v64
    v_add_f32 v9, v9, v65
    v_lshlrev_b32 v64, 16, v37
    v_and_b32 v65, 0xffff0000, v37
    v_add_f32 v10, v10, v64
    v_add_f32 v11, v11, v65
    v_lshlrev_b32 v64, 16, v38
    v_and_b32 v65, 0xffff0000, v38
    v_add_f32 v12, v12, v64
    v_add_f32 v13, v13, v65
    v_lshlrev_b32 v64, 16, v39
    v_and_b32 v65, 0xffff0000, v39
    v_add_f32 v14, v14, v64
    v_add_f32 v15, v15, v65
    s_waitcnt vmcnt(1)
    v_lshlrev_b32 v64, 16, v40
    v_and_b32 v65, 0xffff0000, v40
    v_add_f32 v0, v0, v64
    v_add_f32 v1, v1, v65
    v_lshlrev_b32 v64, 16, v41
    v_and_b32 v65, 0xffff0000, v41
    v_add_f32 v2, v2, v64
    v_add_f32 v3, v3, v65
    v_lshlrev_b32 v64, 16, v42
    v_and_b32 v65, 0xffff0000, v42
    v_add_f32 v4, v4, v64
    v_add_f32 v5, v5, v65
    v_lshlrev_b32 v64, 16, v43
    v_and_b32 v65, 0xffff0000, v43
    v_add_f32 v6, v6, v64
    v_add_f32 v7, v7, v65
    s_waitcnt vmcnt(0)
    v_lshlrev_b32 v64, 16, v44
    v_and_b32 v65, 0xffff0000, v44
    v_add_f32 v8, v8, v64
    v_add_f32 v9, v9, v65
    v_lshlrev_b32 v64, 16, v45
    v_and_b32 v65, 0xffff0000, v45
    v_add_f32 v10, v10, v64
    v_add_f32 v11, v11, v65
    v_lshlrev_b32 v64, 16, v46
    v_and_b32 v65, 0xffff0000, v46
    v_add_f32 v12, v12, v64
    v_add_f32 v13, v13, v65
    v_lshlrev_b32 v64, 16, v47
    v_and_b32 v65, 0xffff0000, v47
    v_add_f32 v14, v14, v64
    v_add_f32 v15, v15, v65
    v_cvt_pk_bf16_f32 v64, v0, v1
    v_cvt_pk_bf16_f32 v65, v2, v3
    buffer_store_dwordx2 v[64:65], v119, s[44:47], s17 offen offset:0
    v_cvt_pk_bf16_f32 v66, v4, v5
    v_cvt_pk_bf16_f32 v67, v6, v7
    buffer_store_dwordx2 v[66:67], v120, s[44:47], s17 offen offset:0
    v_cvt_pk_bf16_f32 v68, v8, v9
    v_cvt_pk_bf16_f32 v69, v10, v11
    buffer_store_dwordx2 v[68:69], v119, s[44:47], s17 offen offset:32
    v_cvt_pk_bf16_f32 v70, v12, v13
    v_cvt_pk_bf16_f32 v71, v14, v15
    buffer_store_dwordx2 v[70:71], v120, s[44:47], s17 offen offset:32
K_END:
    s_endpgm
.section .rodata,"a"
.p2align 6
.amdhsa_kernel parallel_sum__compressed_kv_cla__swiglu_ffn__prompt_kernel
  .amdhsa_next_free_vgpr 256
  .amdhsa_next_free_sgpr 102
  .amdhsa_accum_offset 128
  .amdhsa_group_segment_fixed_size 0
  .amdhsa_kernarg_size 104
  .amdhsa_user_sgpr_count 2
  .amdhsa_user_sgpr_kernarg_segment_ptr 1
  .amdhsa_system_sgpr_workgroup_id_x 1
.end_amdhsa_kernel
```
